```python
import torch

def _softmax(x, axis=-1):
    return torch.softmax(x, dim=axis)
def _gelu(x):
    return torch.nn.functional.gelu(x, approximate="tanh")
def _silu(x):
    return torch.nn.functional.silu(x)
def _sigmoid(x):
    return torch.sigmoid(x)
def _layernorm(x, axis=-1, eps=1e-5):
    m = x.mean(dim=axis, keepdim=True)
    v = x.var(dim=axis, keepdim=True, unbiased=False)
    return (x - m) / torch.sqrt(v + eps)
def _scatter_add(tgt, idx, src, axis=0):
    return tgt.clone().index_add_(axis, idx, src)
def _segment_sum(src, seg, n):
    out = torch.zeros((n,) + src.shape[1:], dtype=src.dtype)
    return out.index_add_(0, seg, src)
def _pad(x, pw):
    flat = tuple(v for pair in reversed(pw) for v in pair)
    return torch.nn.functional.pad(x, flat)

kernel_name = 'standalone__gqa_block_cached__near_ridge'

def setup_inputs():

    _w = (lambda a: (lambda t: t.to(torch.bfloat16) if t.is_floating_point() else t)(torch.as_tensor(a)))
    B, Sq, D = 8, 144, 640
    Hq, Hkv, Sk, Dh = 32, 32, 512, 192
    assert Hq % Hkv == 0, (Hq, Hkv)
    return {
        "x": _w((lambda *s: torch.randn(*s, dtype=torch.bfloat16) * 0.8)(B, Sq, D)),
        "k_cache": _w((lambda *s: torch.randn(*s, dtype=torch.bfloat16) * 0.8)(B, Hkv, Sk, Dh)),
        "v_cache": _w((lambda *s: torch.randn(*s, dtype=torch.bfloat16) * 0.05)(B, Hkv, Sk, Dh)),
        "wq": _w((lambda *s: torch.randn(*s, dtype=torch.bfloat16) * 0.8)(D, Hq * Dh) * (D ** -0.5)),
        "wo": _w((lambda *s: torch.randn(*s, dtype=torch.bfloat16) * 0.05)(Hq * Dh, D) * ((Hq * Dh) ** -0.5)),
    }

def reference(x, k_cache, v_cache, wq, wo):
    B, Sq, D = x.shape
    Hq, Dh = 32, 192
    Hkv = k_cache.shape[1]
    rep = Hq // Hkv
    q = (lambda x, *d: x.permute(*d))((x @ wq).reshape(B, Sq, Hq, Dh), 0, 2, 1, 3)
    k = (lambda x, n, axis: torch.repeat_interleave(x, n, dim=axis))(k_cache, rep, axis=1)
    v = (lambda x, n, axis: torch.repeat_interleave(x, n, dim=axis))(v_cache, rep, axis=1)
    scores = torch.einsum("bhqd,bhkd->bhqk", q, k) * (Dh ** -0.5)
    p = _softmax(scores, axis=-1)
    o = torch.einsum("bhqk,bhkd->bhqd", p, v)
    return (lambda x, *d: x.permute(*d))(o, 0, 2, 1, 3).reshape(B, Sq, Hq * Dh) @ wo
```

```asm
; @launch grid=(256,1,1) block=(512,1,1) lds=161792
.amdgcn_target "amdgcn-amd-amdhsa--gfx950"
.text
.globl standalone__gqa_block_cached__near_ridge_kernel
.p2align 8
.type standalone__gqa_block_cached__near_ridge_kernel,@function
standalone__gqa_block_cached__near_ridge_kernel:
    s_cmp_ge_u32 s2, 256
    s_cbranch_scc1 L_k1_exit
    s_load_dwordx8 s[4:11], s[0:1], 0
    s_load_dwordx2 s[12:13], s[0:1], 56
    s_load_dwordx2 s[14:15], s[0:1], 32
    s_load_dwordx2 s[54:55], s[0:1], 40
    v_and_b32 v1, 63, v0
    v_lshrrev_b32 v15, 6, v0
    s_and_b32 s53, s2, 7
    s_lshr_b32 s48, s2, 3
    v_readfirstlane_b32 s36, v15
    s_and_b32 s47, s48, 3
    s_lshr_b32 s52, s48, 2
    s_lshl_b32 s46, s53, 2
    s_add_u32 s46, s46, s47
    s_and_b32 s39, s52, 1
    s_lshl_b32 s41, s48, 1
    s_mul_i32 s41, s41, 12288
    s_mul_i32 s42, s53, 1536
    s_add_u32 s41, s41, s42
    s_lshl_b32 s42, s36, 9
    s_add_u32 s41, s41, s42
    v_lshrrev_b32 v247, 5, v1
    v_mul_u32_u24 v247, 12288, v247
    v_and_b32 v248, 31, v1
    v_lshlrev_b32 v248, 4, v248
    v_add3_u32 v249, v247, v248, s41
    v_lshrrev_b32 v244, 3, v1
    v_and_b32 v245, 7, v1
    v_lshrrev_b32 v246, 4, v1
    s_mul_i32 s41, s48, 36
    s_lshl_b32 s43, s36, 3
    s_add_u32 s41, s41, s43
    s_sub_u32 s41, s41, 24
    v_add_u32 v247, s41, v244
    s_cmp_lt_u32 s36, 3
    s_cselect_b64 vcc, -1, 0
    s_movk_i32 s45, 128
    s_cselect_b32 s45, 786432, s45
    v_add_u32 v248, 0, v247
    v_min_u32 v248, 1151, v248
    v_mul_u32_u24 v248, 1280, v248
    v_lshl_add_u32 v248, v245, 4, v248
    v_add_u32 v241, 0, v249
    v_cndmask_b32 v241, v248, v241, vcc
    v_add_u32 v248, 4294967152, v247
    v_min_u32 v248, 1151, v248
    v_mul_u32_u24 v248, 1280, v248
    v_lshl_add_u32 v248, v245, 4, v248
    v_add_u32 v254, 4294868992, v249
    v_cndmask_b32 v254, v248, v254, vcc
    s_and_b32 s49, s36, 3
    s_mul_i32 s37, s36, 3072
    s_lshl_b32 s38, s36, 10
    s_and_b32 s41, s36, 1
    s_lshl_b32 s42, s41, 2
    v_add_u32 v247, s42, v246
    v_xor_b32 v247, v247, v245
    v_add_u32 v248, s43, v244
    v_mul_u32_u24 v2, 1280, v248
    v_lshl_add_u32 v2, v247, 4, v2
    v_and_b32 v247, 1, v246
    v_lshl_add_u32 v247, v247, 1, s42
    v_xor_b32 v247, v247, v245
    v_mul_u32_u24 v3, 12288, v248
    v_lshl_add_u32 v3, v247, 4, v3
    s_lshl_b32 s43, s36, 6
    v_add_u32 v248, s43, v244
    v_mul_u32_u24 v248, 384, v248
    v_xor_b32 v247, v246, v245
    v_lshl_add_u32 v4, v247, 4, v248
    v_xor_b32 v5, 64, v4
    v_add_u32 v5, 3072, v5
    v_lshlrev_b32 v247, 1, v246
    v_xor_b32 v247, v247, v245
    v_lshl_add_u32 v252, v247, 4, v248
    s_and_b32 s42, s36, 6
    s_lshr_b32 s57, 0x27, s42
    s_and_b32 s57, s57, 3
    s_lshl_b32 s57, s57, 1
    s_add_u32 s57, s57, s41
    s_mul_i32 s57, s57, 12288
    s_add_u32 s57, s57, 55296
    v_bfe_u32 v247, v1, 3, 1
    v_lshlrev_b32 v247, 10, v247
    v_lshl_add_u32 v247, v245, 7, v247
    v_bfe_u32 v248, v1, 1, 3
    v_xor_b32 v248, v248, v246
    v_lshlrev_b32 v15, 4, v248
    v_add_u32 v7, v247, v15
    v_bfe_u32 v248, v1, 1, 3
    v_lshrrev_b32 v249, 5, v1
    v_xor_b32 v248, v248, v249
    v_lshl_add_u32 v247, v248, 4, v247
    v_and_b32 v248, 1, v246
    v_lshl_add_u32 v247, v248, 3, v247
    v_add_u32 v250, s57, v247
    v_xor_b32 v251, 64, v250
    s_lshr_b32 s42, s36, 2
    s_lshl_b32 s42, s42, 6
    s_lshl_b32 s41, s49, 3
    s_add_u32 s41, s41, s42
    v_add_u32 v247, s41, v244
    v_mul_u32_u24 v6, 384, v247
    v_lshlrev_b32 v247, 1, v246
    v_xor_b32 v247, v247, v245
    v_lshl_add_u32 v6, v247, 4, v6
    s_mul_i32 s19, s52, 184320
    s_mul_i32 s23, s46, 384
    s_lshl_b32 s42, s52, 5
    s_add_u32 s42, s42, s46
    s_mul_i32 s43, s42, 196608
    s_mul_i32 s35, s42, 55296
    s_lshl_b32 s41, s52, 8
    s_add_u32 s41, s41, 29360128
    s_mov_b32 s18, 184320
    s_sub_u32 s22, 7864320, s23
    s_cmp_lt_u32 s36, 3
    s_waitcnt lgkmcnt(0)
    s_cselect_b64 s[50:51], s[10:11], s[4:5]
    s_getpc_b64 s[58:59]
L_pce:
    s_add_u32 s58, s58, k1_body_start-L_pce
    s_addc_u32 s59, s59, 0
    s_and_b32 s42, s48, 15
    s_lshl_b32 s42, s42, 13
    v_lshlrev_b32 v255, 4, v0
    v_add_u32 v255, s42, v255
    v_min_u32 v255, k1_body_end-k1_body_start-16, v255
    global_load_dwordx4 v[112:115], v255, s[58:59]
    s_load_dword s88, s[12:13], s41
    s_add_u32 s20, s10, s23
    s_addc_u32 s21, s11, 0
    s_mov_b32 s23, 0x20000
    s_add_u32 s16, s4, s19
    s_addc_u32 s17, s5, 0
    s_mov_b32 s19, 0x20000
    s_add_u32 s24, s6, s43
    s_addc_u32 s25, s7, 0
    s_mov_b32 s26, 196608
    s_mov_b32 s27, 0x20000
    s_add_u32 s28, s8, s43
    s_addc_u32 s29, s9, 0
    s_mov_b32 s30, 196608
    s_mov_b32 s31, 0x20000
    s_cmp_eq_u32 s39, 1
    s_cbranch_scc0 L_nok1
    s_cmp_lt_u32 s36, 3
    s_cbranch_scc0 L_pfx
    global_load_dwordx4 v[112:115], v254, s[50:51]
    v_add_u32 v254, s45, v254
    global_load_dwordx4 v[112:115], v241, s[50:51]
    v_add_u32 v241, s45, v241
    global_load_dwordx4 v[112:115], v254, s[50:51]
    v_add_u32 v254, s45, v254
    global_load_dwordx4 v[112:115], v241, s[50:51]
    v_add_u32 v241, s45, v241
    global_load_dwordx4 v[112:115], v254, s[50:51]
    v_add_u32 v254, s45, v254
    global_load_dwordx4 v[112:115], v241, s[50:51]
    v_add_u32 v241, s45, v241
    global_load_dwordx4 v[112:115], v254, s[50:51]
    v_add_u32 v254, s45, v254
    global_load_dwordx4 v[112:115], v241, s[50:51]
    v_add_u32 v241, s45, v241
    global_load_dwordx4 v[112:115], v254, s[50:51]
    v_add_u32 v254, s45, v254
    global_load_dwordx4 v[112:115], v241, s[50:51]
    v_add_u32 v241, s45, v241
    global_load_dwordx4 v[112:115], v254, s[50:51]
    v_add_u32 v254, s45, v254
    global_load_dwordx4 v[112:115], v241, s[50:51]
    v_add_u32 v241, s45, v241
    global_load_dwordx4 v[112:115], v254, s[50:51]
    v_add_u32 v254, s45, v254
    global_load_dwordx4 v[112:115], v241, s[50:51]
    v_add_u32 v241, s45, v241
    global_load_dwordx4 v[112:115], v254, s[50:51]
    v_add_u32 v254, s45, v254
    global_load_dwordx4 v[112:115], v241, s[50:51]
    v_add_u32 v241, s45, v241
    global_load_dwordx4 v[112:115], v254, s[50:51]
    v_add_u32 v254, s45, v254
    global_load_dwordx4 v[112:115], v241, s[50:51]
    v_add_u32 v241, s45, v241
    global_load_dwordx4 v[112:115], v254, s[50:51]
    v_add_u32 v254, s45, v254
    global_load_dwordx4 v[112:115], v241, s[50:51]
    v_add_u32 v241, s45, v241
    s_branch L_nok1
L_pfx:
    global_load_dwordx4 v[112:115], v254, s[50:51]
    v_add_u32 v254, s45, v254
    global_load_dwordx4 v[112:115], v254, s[50:51]
    v_add_u32 v254, s45, v254
    global_load_dwordx4 v[112:115], v254, s[50:51]
    v_add_u32 v254, s45, v254
    global_load_dwordx4 v[112:115], v254, s[50:51]
    v_add_u32 v254, s45, v254
    global_load_dwordx4 v[112:115], v254, s[50:51]
    v_add_u32 v254, s45, v254
    global_load_dwordx4 v[112:115], v254, s[50:51]
    v_add_u32 v254, s45, v254
    global_load_dwordx4 v[112:115], v254, s[50:51]
    v_add_u32 v254, s45, v254
    global_load_dwordx4 v[112:115], v254, s[50:51]
    v_add_u32 v254, s45, v254
    global_load_dwordx4 v[112:115], v254, s[50:51]
    v_add_u32 v254, s45, v254
    global_load_dwordx4 v[112:115], v254, s[50:51]
    v_add_u32 v254, s45, v254
    global_load_dwordx4 v[112:115], v241, s[50:51]
    v_add_u32 v241, s45, v241
    global_load_dwordx4 v[112:115], v241, s[50:51]
    v_add_u32 v241, s45, v241
    global_load_dwordx4 v[112:115], v241, s[50:51]
    v_add_u32 v241, s45, v241
    global_load_dwordx4 v[112:115], v241, s[50:51]
    v_add_u32 v241, s45, v241
    global_load_dwordx4 v[112:115], v241, s[50:51]
    v_add_u32 v241, s45, v241
    global_load_dwordx4 v[112:115], v241, s[50:51]
    v_add_u32 v241, s45, v241
    global_load_dwordx4 v[112:115], v241, s[50:51]
    v_add_u32 v241, s45, v241
    global_load_dwordx4 v[112:115], v241, s[50:51]
    v_add_u32 v241, s45, v241
    global_load_dwordx4 v[112:115], v241, s[50:51]
    v_add_u32 v241, s45, v241
    global_load_dwordx4 v[112:115], v241, s[50:51]
    v_add_u32 v241, s45, v241
L_nok1:
    s_lshr_b32 s41, s36, 2
    s_lshl_b32 s41, s41, 1
    s_or_b32 s41, s41, s39
    s_cmp_eq_u32 s41, 0
    s_cbranch_scc1 L_qp00
    s_cmp_eq_u32 s41, 2
    s_cbranch_scc1 L_qp10
    s_cmp_eq_u32 s41, 3
    s_cbranch_scc1 L_qp11
k1_body_start:
    s_add_u32 m0, s57, 0
    s_mov_b32 s40, 0
    buffer_load_dwordx4 v4, s[24:27], s40 offen offset:0 nt lds
    s_add_u32 m0, s57, 1024
    s_mov_b32 s40, 0
    buffer_load_dwordx4 v5, s[24:27], s40 offen offset:0 nt lds
    s_add_u32 m0, s57, 6144
    s_mov_b32 s40, 6144
    buffer_load_dwordx4 v4, s[24:27], s40 offen offset:0 nt lds
    s_add_u32 m0, s57, 7168
    s_mov_b32 s40, 6144
    buffer_load_dwordx4 v5, s[24:27], s40 offen offset:0 nt lds
    s_add_u32 m0, s57, 1920
    s_mov_b32 s40, 0
    buffer_load_dwordx4 v4, s[24:27], s40 offen offset:128 nt lds
    s_add_u32 m0, s57, 2944
    s_mov_b32 s40, 0
    buffer_load_dwordx4 v5, s[24:27], s40 offen offset:128 nt lds
    s_add_u32 m0, s57, 8064
    s_mov_b32 s40, 6144
    buffer_load_dwordx4 v4, s[24:27], s40 offen offset:128 nt lds
    s_add_u32 m0, s57, 9088
    s_mov_b32 s40, 6144
    buffer_load_dwordx4 v5, s[24:27], s40 offen offset:128 nt lds
    s_add_u32 m0, s57, 3840
    s_mov_b32 s40, 0
    buffer_load_dwordx4 v4, s[24:27], s40 offen offset:256 nt lds
    s_add_u32 m0, s57, 4864
    s_mov_b32 s40, 0
    buffer_load_dwordx4 v5, s[24:27], s40 offen offset:256 nt lds
    s_add_u32 m0, s57, 9984
    s_mov_b32 s40, 6144
    buffer_load_dwordx4 v4, s[24:27], s40 offen offset:256 nt lds
    s_add_u32 m0, s57, 11008
    s_mov_b32 s40, 6144
    buffer_load_dwordx4 v5, s[24:27], s40 offen offset:256 nt lds
    s_add_u32 s32, s12, s35
    s_addc_u32 s33, s13, 0
    s_mov_b32 s34, 55296
    s_mov_b32 s35, 0x20000
    s_mov_b32 s44, 1037384597
    v_lshlrev_b32 v247, 2, v0
    v_add_u32 v247, 153600, v247
    v_mov_b32 v248, 0xff800000
    ds_write_b32 v247, v248
    v_and_b32 v243, 15, v1
    v_lshlrev_b32 v243, 2, v243
    v_add_u32 v243, 153600, v243
    v_add_u32 v7, 0, v7
    v_xor_b32 v8, 64, v7
    s_lshl_b32 s41, s49, 2
    s_lshr_b32 s41, 42560, s41
    s_and_b32 s41, s41, 15
    s_lshr_b32 s42, s41, 2
    s_lshl_b32 s42, s42, 10
    s_add_u32 s42, s42, 55296
    s_and_b32 s41, s41, 3
    v_lshrrev_b32 v244, 4, v1
    v_bfe_u32 v245, v1, 2, 2
    v_and_b32 v246, 1, v244
    v_lshlrev_b32 v246, 1, v246
    v_lshrrev_b32 v247, 1, v245
    v_add_u32 v247, v247, v246
    v_xor_b32 v247, s41, v247
    v_lshlrev_b32 v247, 5, v247
    v_lshlrev_b32 v9, 7, v245
    v_add_u32 v9, v9, v247
    v_mul_u32_u24 v247, 3072, v244
    v_add_u32 v9, v9, v247
    v_and_b32 v247, 3, v1
    v_lshlrev_b32 v247, 3, v247
    v_add_u32 v9, v9, v247
    v_add_u32 v9, s42, v9
    s_lshl_b32 s41, s49, 2
    s_lshr_b32 s41, 46929, s41
    s_and_b32 s41, s41, 15
    s_lshr_b32 s42, s41, 2
    s_lshl_b32 s42, s42, 10
    s_add_u32 s42, s42, 55296
    s_and_b32 s41, s41, 3
    v_lshrrev_b32 v244, 4, v1
    v_bfe_u32 v245, v1, 2, 2
    v_and_b32 v246, 1, v244
    v_lshlrev_b32 v246, 1, v246
    v_lshrrev_b32 v247, 1, v245
    v_add_u32 v247, v247, v246
    v_xor_b32 v247, s41, v247
    v_lshlrev_b32 v247, 5, v247
    v_lshlrev_b32 v10, 7, v245
    v_add_u32 v10, v10, v247
    v_mul_u32_u24 v247, 3072, v244
    v_add_u32 v10, v10, v247
    v_and_b32 v247, 3, v1
    v_lshlrev_b32 v247, 3, v247
    v_add_u32 v10, v10, v247
    v_add_u32 v10, s42, v10
    s_lshl_b32 s41, s49, 2
    s_lshr_b32 s41, 38962, s41
    s_and_b32 s41, s41, 15
    s_lshr_b32 s42, s41, 2
    s_lshl_b32 s42, s42, 10
    s_add_u32 s42, s42, 55296
    s_and_b32 s41, s41, 3
    v_lshrrev_b32 v244, 4, v1
    v_bfe_u32 v245, v1, 2, 2
    v_and_b32 v246, 1, v244
    v_lshlrev_b32 v246, 1, v246
    v_lshrrev_b32 v247, 1, v245
    v_add_u32 v247, v247, v246
    v_xor_b32 v247, s41, v247
    v_lshlrev_b32 v247, 5, v247
    v_lshlrev_b32 v11, 7, v245
    v_add_u32 v11, v11, v247
    v_mul_u32_u24 v247, 3072, v244
    v_add_u32 v11, v11, v247
    v_and_b32 v247, 3, v1
    v_lshlrev_b32 v247, 3, v247
    v_add_u32 v11, v11, v247
    v_add_u32 v11, s42, v11
    s_lshl_b32 s41, s49, 2
    s_lshr_b32 s41, 42560, s41
    s_and_b32 s41, s41, 15
    s_lshr_b32 s42, s41, 1
    s_mul_i32 s42, s42, 9216
    s_and_b32 s41, s41, 1
    s_lshl_b32 s41, s41, 3
    s_add_u32 s41, s41, s42
    s_add_u32 s41, s41, 0
    v_lshl_add_u32 v12, v1, 4, s41
    s_lshl_b32 s41, s49, 2
    s_lshr_b32 s41, 38962, s41
    s_and_b32 s41, s41, 15
    s_lshr_b32 s42, s41, 1
    s_mul_i32 s42, s42, 9216
    s_and_b32 s41, s41, 1
    s_lshl_b32 s41, s41, 3
    s_add_u32 s41, s41, s42
    s_add_u32 s41, s41, 0
    v_lshl_add_u32 v14, v1, 4, s41
    v_lshlrev_b32 v240, 4, v1
    s_lshl_b32 s41, s36, 2
    s_lshr_b32 s42, 0x10543210, s41
    s_and_b32 s42, s42, 15
    s_mul_i32 s42, s42, 9216
    v_add_u32 v242, s42, v240
    v_add_u32 v240, 0, v240
    s_waitcnt lgkmcnt(0)
    v_xor_b32 v246, 32, v250
    v_xor_b32 v247, 32, v251
    s_waitcnt vmcnt(10)
    ds_read_b64 v[16:17], v250 offset:0
    ds_read_b64 v[18:19], v246 offset:0
    ds_read_b64 v[20:21], v251 offset:0
    ds_read_b64 v[22:23], v247 offset:0
    s_waitcnt vmcnt(8)
    ds_read_b64 v[40:41], v250 offset:6144
    ds_read_b64 v[42:43], v246 offset:6144
    ds_read_b64 v[44:45], v251 offset:6144
    ds_read_b64 v[46:47], v247 offset:6144
    s_waitcnt vmcnt(6)
    ds_read_b64 v[24:25], v250 offset:2048
    ds_read_b64 v[26:27], v246 offset:2048
    ds_read_b64 v[28:29], v251 offset:2048
    ds_read_b64 v[30:31], v247 offset:2048
    s_waitcnt vmcnt(4)
    ds_read_b64 v[48:49], v250 offset:8192
    ds_read_b64 v[50:51], v246 offset:8192
    ds_read_b64 v[52:53], v251 offset:8192
    ds_read_b64 v[54:55], v247 offset:8192
    s_waitcnt vmcnt(2)
    ds_read_b64 v[32:33], v250 offset:4096
    ds_read_b64 v[34:35], v246 offset:4096
    ds_read_b64 v[36:37], v251 offset:4096
    ds_read_b64 v[38:39], v247 offset:4096
    s_waitcnt vmcnt(0)
    ds_read_b64 v[56:57], v250 offset:10240
    ds_read_b64 v[58:59], v246 offset:10240
    ds_read_b64 v[60:61], v251 offset:10240
    ds_read_b64 v[62:63], v247 offset:10240
    s_waitcnt lgkmcnt(0)
    s_barrier
    s_add_u32 m0, s37, 55296
    s_mov_b32 s3, 0
    buffer_load_dwordx4 v3, s[20:23], s3 offen offset:0 lds
    s_add_u32 m0, s37, 56192
    s_nop 0
    buffer_load_dwordx4 v3, s[20:23], s3 offen offset:128 lds
    s_add_u32 m0, s37, 57088
    s_nop 0
    buffer_load_dwordx4 v3, s[20:23], s3 offen offset:256 lds
    s_add_u32 m0, s38, 0
    s_mov_b32 s40, 0
    buffer_load_dwordx4 v2, s[16:19], s40 offen lds
    s_add_u32 m0, s38, 8192
    s_mov_b32 s40, 81920
    buffer_load_dwordx4 v2, s[16:19], s40 offen lds
    s_barrier
    s_add_u32 m0, s37, 79872
    s_mov_b32 s3, 786432
    buffer_load_dwordx4 v3, s[20:23], s3 offen offset:0 lds
    s_add_u32 m0, s37, 80768
    s_nop 0
    buffer_load_dwordx4 v3, s[20:23], s3 offen offset:128 lds
    s_add_u32 m0, s37, 81664
    s_nop 0
    buffer_load_dwordx4 v3, s[20:23], s3 offen offset:256 lds
    s_add_u32 m0, s38, 18432
    s_mov_b32 s40, 128
    buffer_load_dwordx4 v2, s[16:19], s40 offen lds
    s_add_u32 m0, s38, 26624
    s_mov_b32 s40, 82048
    buffer_load_dwordx4 v2, s[16:19], s40 offen lds
    s_waitcnt vmcnt(5)
    s_barrier
    s_add_u32 s88, s88, 1
    ds_read_b64_tr_b16 v[176:177], v9 offset:0
    ds_read_b64_tr_b16 v[178:179], v9 offset:512
    ds_read_b128 v[200:203], v7 offset:0
    ds_read_b64_tr_b16 v[180:181], v10 offset:0
    ds_read_b64_tr_b16 v[182:183], v10 offset:512
    ds_read_b64_tr_b16 v[184:185], v11 offset:0
    ds_read_b64_tr_b16 v[186:187], v11 offset:512
    ds_read_b128 v[204:207], v7 offset:2048
    ds_read_b128 v[208:211], v7 offset:4096
    ds_read_b128 v[212:215], v7 offset:6144
    ds_read_b128 v[216:219], v7 offset:8192
    s_waitcnt lgkmcnt(8)
    v_mfma_f32_16x16x32_bf16 v[116:119], v[176:179], v[200:203], 0
    ds_read_b64_tr_b16 v[188:189], v9 offset:12288
    ds_read_b64_tr_b16 v[190:191], v9 offset:12800
    s_add_u32 m0, s37, 104448
    s_mov_b32 s3, 1572864
    buffer_load_dwordx4 v3, s[20:23], s3 offen offset:0 lds
    s_waitcnt lgkmcnt(8)
    v_mfma_f32_16x16x32_bf16 v[120:123], v[180:183], v[200:203], 0
    ds_read_b128 v[220:223], v8 offset:0
    s_waitcnt lgkmcnt(7)
    v_mfma_f32_16x16x32_bf16 v[124:127], v[184:187], v[200:203], 0
    ds_read_b64_tr_b16 v[192:193], v10 offset:12288
    s_waitcnt lgkmcnt(7)
    v_mfma_f32_16x16x32_bf16 v[128:131], v[176:179], v[204:207], 0
    ds_read_b64_tr_b16 v[194:195], v10 offset:12800
    s_add_u32 m0, s37, 105344
    s_nop 0
    buffer_load_dwordx4 v3, s[20:23], s3 offen offset:128 lds
    v_mfma_f32_16x16x32_bf16 v[132:135], v[180:183], v[204:207], 0
    ds_read_b64_tr_b16 v[196:197], v11 offset:12288
    ds_read_b64_tr_b16 v[198:199], v11 offset:12800
    v_mfma_f32_16x16x32_bf16 v[136:139], v[184:187], v[204:207], 0
    ds_read_b128 v[224:227], v8 offset:2048
    s_waitcnt lgkmcnt(10)
    v_mfma_f32_16x16x32_bf16 v[140:143], v[176:179], v[208:211], 0
    ds_read_b128 v[228:231], v8 offset:4096
    s_add_u32 m0, s37, 106240
    s_nop 0
    buffer_load_dwordx4 v3, s[20:23], s3 offen offset:256 lds
    v_mfma_f32_16x16x32_bf16 v[144:147], v[180:183], v[208:211], 0
    ds_read_b128 v[232:235], v8 offset:6144
    v_mfma_f32_16x16x32_bf16 v[148:151], v[184:187], v[208:211], 0
    ds_read_b128 v[236:239], v8 offset:8192
    s_add_u32 m0, s38, 36864
    s_mov_b32 s40, 256
    buffer_load_dwordx4 v2, s[16:19], s40 offen lds
    s_waitcnt lgkmcnt(12)
    v_mfma_f32_16x16x32_bf16 v[152:155], v[176:179], v[212:215], 0
    v_mfma_f32_16x16x32_bf16 v[156:159], v[180:183], v[212:215], 0
    v_mfma_f32_16x16x32_bf16 v[160:163], v[184:187], v[212:215], 0
    s_add_u32 m0, s38, 45056
    s_mov_b32 s40, 82176
    buffer_load_dwordx4 v2, s[16:19], s40 offen lds
    s_waitcnt lgkmcnt(11)
    v_mfma_f32_16x16x32_bf16 v[164:167], v[176:179], v[216:219], 0
    v_mfma_f32_16x16x32_bf16 v[168:171], v[180:183], v[216:219], 0
    v_mfma_f32_16x16x32_bf16 v[172:175], v[184:187], v[216:219], 0
    s_waitcnt vmcnt(5) lgkmcnt(0)
    s_barrier
    v_mfma_f32_16x16x32_bf16 v[116:119], v[188:191], v[220:223], v[116:119]
    ds_read_b64_tr_b16 v[176:177], v9 offset:24576
    ds_read_b64_tr_b16 v[178:179], v9 offset:25088
    v_mfma_f32_16x16x32_bf16 v[120:123], v[192:195], v[220:223], v[120:123]
    s_add_u32 m0, s37, 55296
    s_mov_b32 s3, 2359296
    buffer_load_dwordx4 v3, s[20:23], s3 offen offset:0 lds
    ds_read_b128 v[200:203], v7 offset:18432
    v_mfma_f32_16x16x32_bf16 v[124:127], v[196:199], v[220:223], v[124:127]
    ds_read_b64_tr_b16 v[180:181], v10 offset:24576
    v_mfma_f32_16x16x32_bf16 v[128:131], v[188:191], v[224:227], v[128:131]
    ds_read_b64_tr_b16 v[182:183], v10 offset:25088
    v_mfma_f32_16x16x32_bf16 v[132:135], v[192:195], v[224:227], v[132:135]
    ds_read_b64_tr_b16 v[184:185], v11 offset:24576
    ds_read_b64_tr_b16 v[186:187], v11 offset:25088
    v_mfma_f32_16x16x32_bf16 v[136:139], v[196:199], v[224:227], v[136:139]
    s_add_u32 m0, s37, 56192
    s_nop 0
    buffer_load_dwordx4 v3, s[20:23], s3 offen offset:128 lds
    ds_read_b128 v[204:207], v7 offset:20480
    v_mfma_f32_16x16x32_bf16 v[140:143], v[188:191], v[228:231], v[140:143]
    ds_read_b128 v[208:211], v7 offset:22528
    v_mfma_f32_16x16x32_bf16 v[144:147], v[192:195], v[228:231], v[144:147]
    ds_read_b128 v[212:215], v7 offset:24576
    v_mfma_f32_16x16x32_bf16 v[148:151], v[196:199], v[228:231], v[148:151]
    ds_read_b128 v[216:219], v7 offset:26624
    v_mfma_f32_16x16x32_bf16 v[152:155], v[188:191], v[232:235], v[152:155]
    v_mfma_f32_16x16x32_bf16 v[156:159], v[192:195], v[232:235], v[156:159]
    s_add_u32 m0, s37, 57088
    s_nop 0
    buffer_load_dwordx4 v3, s[20:23], s3 offen offset:256 lds
    v_mfma_f32_16x16x32_bf16 v[160:163], v[196:199], v[232:235], v[160:163]
    v_mfma_f32_16x16x32_bf16 v[164:167], v[188:191], v[236:239], v[164:167]
    v_mfma_f32_16x16x32_bf16 v[168:171], v[192:195], v[236:239], v[168:171]
    v_mfma_f32_16x16x32_bf16 v[172:175], v[196:199], v[236:239], v[172:175]
    s_waitcnt lgkmcnt(0)
    v_mfma_f32_16x16x32_bf16 v[116:119], v[176:179], v[200:203], v[116:119]
    ds_read_b64_tr_b16 v[188:189], v9 offset:36864
    ds_read_b64_tr_b16 v[190:191], v9 offset:37376
    s_add_u32 m0, s38, 0
    s_mov_b32 s40, 384
    buffer_load_dwordx4 v2, s[16:19], s40 offen lds
    v_mfma_f32_16x16x32_bf16 v[120:123], v[180:183], v[200:203], v[120:123]
    ds_read_b128 v[220:223], v8 offset:18432
    v_mfma_f32_16x16x32_bf16 v[124:127], v[184:187], v[200:203], v[124:127]
    ds_read_b64_tr_b16 v[192:193], v10 offset:36864
    v_mfma_f32_16x16x32_bf16 v[128:131], v[176:179], v[204:207], v[128:131]
    ds_read_b64_tr_b16 v[194:195], v10 offset:37376
    v_mfma_f32_16x16x32_bf16 v[132:135], v[180:183], v[204:207], v[132:135]
    ds_read_b64_tr_b16 v[196:197], v11 offset:36864
    ds_read_b64_tr_b16 v[198:199], v11 offset:37376
    v_mfma_f32_16x16x32_bf16 v[136:139], v[184:187], v[204:207], v[136:139]
    ds_read_b128 v[224:227], v8 offset:20480
    v_mfma_f32_16x16x32_bf16 v[140:143], v[176:179], v[208:211], v[140:143]
    ds_read_b128 v[228:231], v8 offset:22528
    v_mfma_f32_16x16x32_bf16 v[144:147], v[180:183], v[208:211], v[144:147]
    ds_read_b128 v[232:235], v8 offset:24576
    s_add_u32 m0, s38, 8192
    s_mov_b32 s40, 82304
    buffer_load_dwordx4 v2, s[16:19], s40 offen lds
    v_mfma_f32_16x16x32_bf16 v[148:151], v[184:187], v[208:211], v[148:151]
    ds_read_b128 v[236:239], v8 offset:26624
    v_mfma_f32_16x16x32_bf16 v[152:155], v[176:179], v[212:215], v[152:155]
    v_mfma_f32_16x16x32_bf16 v[156:159], v[180:183], v[212:215], v[156:159]
    v_mfma_f32_16x16x32_bf16 v[160:163], v[184:187], v[212:215], v[160:163]
    v_mfma_f32_16x16x32_bf16 v[164:167], v[176:179], v[216:219], v[164:167]
    v_mfma_f32_16x16x32_bf16 v[168:171], v[180:183], v[216:219], v[168:171]
    v_mfma_f32_16x16x32_bf16 v[172:175], v[184:187], v[216:219], v[172:175]
    s_waitcnt vmcnt(5) lgkmcnt(0)
    s_barrier
    v_mfma_f32_16x16x32_bf16 v[116:119], v[188:191], v[220:223], v[116:119]
    ds_read_b64_tr_b16 v[176:177], v9 offset:49152
    ds_read_b64_tr_b16 v[178:179], v9 offset:49664
    v_mfma_f32_16x16x32_bf16 v[120:123], v[192:195], v[220:223], v[120:123]
    s_add_u32 m0, s37, 79872
    s_mov_b32 s3, 3145728
    buffer_load_dwordx4 v3, s[20:23], s3 offen offset:0 lds
    ds_read_b128 v[200:203], v7 offset:36864
    v_mfma_f32_16x16x32_bf16 v[124:127], v[196:199], v[220:223], v[124:127]
    ds_read_b64_tr_b16 v[180:181], v10 offset:49152
    v_mfma_f32_16x16x32_bf16 v[128:131], v[188:191], v[224:227], v[128:131]
    ds_read_b64_tr_b16 v[182:183], v10 offset:49664
    v_mfma_f32_16x16x32_bf16 v[132:135], v[192:195], v[224:227], v[132:135]
    ds_read_b64_tr_b16 v[184:185], v11 offset:49152
    ds_read_b64_tr_b16 v[186:187], v11 offset:49664
    v_mfma_f32_16x16x32_bf16 v[136:139], v[196:199], v[224:227], v[136:139]
    s_add_u32 m0, s37, 80768
    s_nop 0
    buffer_load_dwordx4 v3, s[20:23], s3 offen offset:128 lds
    ds_read_b128 v[204:207], v7 offset:38912
    v_mfma_f32_16x16x32_bf16 v[140:143], v[188:191], v[228:231], v[140:143]
    ds_read_b128 v[208:211], v7 offset:40960
    v_mfma_f32_16x16x32_bf16 v[144:147], v[192:195], v[228:231], v[144:147]
    ds_read_b128 v[212:215], v7 offset:43008
    v_mfma_f32_16x16x32_bf16 v[148:151], v[196:199], v[228:231], v[148:151]
    ds_read_b128 v[216:219], v7 offset:45056
    v_mfma_f32_16x16x32_bf16 v[152:155], v[188:191], v[232:235], v[152:155]
    v_mfma_f32_16x16x32_bf16 v[156:159], v[192:195], v[232:235], v[156:159]
    s_add_u32 m0, s37, 81664
    s_nop 0
    buffer_load_dwordx4 v3, s[20:23], s3 offen offset:256 lds
    v_mfma_f32_16x16x32_bf16 v[160:163], v[196:199], v[232:235], v[160:163]
    v_mfma_f32_16x16x32_bf16 v[164:167], v[188:191], v[236:239], v[164:167]
    v_mfma_f32_16x16x32_bf16 v[168:171], v[192:195], v[236:239], v[168:171]
    v_mfma_f32_16x16x32_bf16 v[172:175], v[196:199], v[236:239], v[172:175]
    s_waitcnt lgkmcnt(0)
    v_mfma_f32_16x16x32_bf16 v[116:119], v[176:179], v[200:203], v[116:119]
    ds_read_b64_tr_b16 v[188:189], v9 offset:61440
    ds_read_b64_tr_b16 v[190:191], v9 offset:61952
    s_add_u32 m0, s38, 18432
    s_mov_b32 s40, 512
    buffer_load_dwordx4 v2, s[16:19], s40 offen lds
    v_mfma_f32_16x16x32_bf16 v[120:123], v[180:183], v[200:203], v[120:123]
    ds_read_b128 v[220:223], v8 offset:36864
    v_mfma_f32_16x16x32_bf16 v[124:127], v[184:187], v[200:203], v[124:127]
    ds_read_b64_tr_b16 v[192:193], v10 offset:61440
    v_mfma_f32_16x16x32_bf16 v[128:131], v[176:179], v[204:207], v[128:131]
    ds_read_b64_tr_b16 v[194:195], v10 offset:61952
    v_mfma_f32_16x16x32_bf16 v[132:135], v[180:183], v[204:207], v[132:135]
    ds_read_b64_tr_b16 v[196:197], v11 offset:61440
    ds_read_b64_tr_b16 v[198:199], v11 offset:61952
    v_mfma_f32_16x16x32_bf16 v[136:139], v[184:187], v[204:207], v[136:139]
    ds_read_b128 v[224:227], v8 offset:38912
    v_mfma_f32_16x16x32_bf16 v[140:143], v[176:179], v[208:211], v[140:143]
    ds_read_b128 v[228:231], v8 offset:40960
    v_mfma_f32_16x16x32_bf16 v[144:147], v[180:183], v[208:211], v[144:147]
    ds_read_b128 v[232:235], v8 offset:43008
    s_add_u32 m0, s38, 26624
    s_mov_b32 s40, 82432
    buffer_load_dwordx4 v2, s[16:19], s40 offen lds
    v_mfma_f32_16x16x32_bf16 v[148:151], v[184:187], v[208:211], v[148:151]
    ds_read_b128 v[236:239], v8 offset:45056
    v_mfma_f32_16x16x32_bf16 v[152:155], v[176:179], v[212:215], v[152:155]
    v_mfma_f32_16x16x32_bf16 v[156:159], v[180:183], v[212:215], v[156:159]
    v_mfma_f32_16x16x32_bf16 v[160:163], v[184:187], v[212:215], v[160:163]
    v_mfma_f32_16x16x32_bf16 v[164:167], v[176:179], v[216:219], v[164:167]
    v_mfma_f32_16x16x32_bf16 v[168:171], v[180:183], v[216:219], v[168:171]
    v_mfma_f32_16x16x32_bf16 v[172:175], v[184:187], v[216:219], v[172:175]
    s_waitcnt vmcnt(5) lgkmcnt(0)
    s_barrier
    v_mfma_f32_16x16x32_bf16 v[116:119], v[188:191], v[220:223], v[116:119]
    ds_read_b64_tr_b16 v[176:177], v9 offset:0
    ds_read_b64_tr_b16 v[178:179], v9 offset:512
    v_mfma_f32_16x16x32_bf16 v[120:123], v[192:195], v[220:223], v[120:123]
    s_add_u32 m0, s37, 104448
    s_mov_b32 s3, 3932160
    buffer_load_dwordx4 v3, s[20:23], s3 offen offset:0 lds
    ds_read_b128 v[200:203], v7 offset:0
    v_mfma_f32_16x16x32_bf16 v[124:127], v[196:199], v[220:223], v[124:127]
    ds_read_b64_tr_b16 v[180:181], v10 offset:0
    v_mfma_f32_16x16x32_bf16 v[128:131], v[188:191], v[224:227], v[128:131]
    ds_read_b64_tr_b16 v[182:183], v10 offset:512
    v_mfma_f32_16x16x32_bf16 v[132:135], v[192:195], v[224:227], v[132:135]
    ds_read_b64_tr_b16 v[184:185], v11 offset:0
    ds_read_b64_tr_b16 v[186:187], v11 offset:512
    v_mfma_f32_16x16x32_bf16 v[136:139], v[196:199], v[224:227], v[136:139]
    s_add_u32 m0, s37, 105344
    s_nop 0
    buffer_load_dwordx4 v3, s[20:23], s3 offen offset:128 lds
    ds_read_b128 v[204:207], v7 offset:2048
    v_mfma_f32_16x16x32_bf16 v[140:143], v[188:191], v[228:231], v[140:143]
    ds_read_b128 v[208:211], v7 offset:4096
    v_mfma_f32_16x16x32_bf16 v[144:147], v[192:195], v[228:231], v[144:147]
    ds_read_b128 v[212:215], v7 offset:6144
    v_mfma_f32_16x16x32_bf16 v[148:151], v[196:199], v[228:231], v[148:151]
    ds_read_b128 v[216:219], v7 offset:8192
    v_mfma_f32_16x16x32_bf16 v[152:155], v[188:191], v[232:235], v[152:155]
    v_mfma_f32_16x16x32_bf16 v[156:159], v[192:195], v[232:235], v[156:159]
    s_add_u32 m0, s37, 106240
    s_nop 0
    buffer_load_dwordx4 v3, s[20:23], s3 offen offset:256 lds
    v_mfma_f32_16x16x32_bf16 v[160:163], v[196:199], v[232:235], v[160:163]
    v_mfma_f32_16x16x32_bf16 v[164:167], v[188:191], v[236:239], v[164:167]
    v_mfma_f32_16x16x32_bf16 v[168:171], v[192:195], v[236:239], v[168:171]
    v_mfma_f32_16x16x32_bf16 v[172:175], v[196:199], v[236:239], v[172:175]
    s_waitcnt lgkmcnt(0)
    v_mfma_f32_16x16x32_bf16 v[116:119], v[176:179], v[200:203], v[116:119]
    ds_read_b64_tr_b16 v[188:189], v9 offset:12288
    ds_read_b64_tr_b16 v[190:191], v9 offset:12800
    s_add_u32 m0, s38, 36864
    s_mov_b32 s40, 640
    buffer_load_dwordx4 v2, s[16:19], s40 offen lds
    v_mfma_f32_16x16x32_bf16 v[120:123], v[180:183], v[200:203], v[120:123]
    ds_read_b128 v[220:223], v8 offset:0
    v_mfma_f32_16x16x32_bf16 v[124:127], v[184:187], v[200:203], v[124:127]
    ds_read_b64_tr_b16 v[192:193], v10 offset:12288
    v_mfma_f32_16x16x32_bf16 v[128:131], v[176:179], v[204:207], v[128:131]
    ds_read_b64_tr_b16 v[194:195], v10 offset:12800
    v_mfma_f32_16x16x32_bf16 v[132:135], v[180:183], v[204:207], v[132:135]
    ds_read_b64_tr_b16 v[196:197], v11 offset:12288
    ds_read_b64_tr_b16 v[198:199], v11 offset:12800
    v_mfma_f32_16x16x32_bf16 v[136:139], v[184:187], v[204:207], v[136:139]
    ds_read_b128 v[224:227], v8 offset:2048
    v_mfma_f32_16x16x32_bf16 v[140:143], v[176:179], v[208:211], v[140:143]
    ds_read_b128 v[228:231], v8 offset:4096
    v_mfma_f32_16x16x32_bf16 v[144:147], v[180:183], v[208:211], v[144:147]
    ds_read_b128 v[232:235], v8 offset:6144
    s_add_u32 m0, s38, 45056
    s_mov_b32 s40, 82560
    buffer_load_dwordx4 v2, s[16:19], s40 offen lds
    v_mfma_f32_16x16x32_bf16 v[148:151], v[184:187], v[208:211], v[148:151]
    ds_read_b128 v[236:239], v8 offset:8192
    v_mfma_f32_16x16x32_bf16 v[152:155], v[176:179], v[212:215], v[152:155]
    v_mfma_f32_16x16x32_bf16 v[156:159], v[180:183], v[212:215], v[156:159]
    v_mfma_f32_16x16x32_bf16 v[160:163], v[184:187], v[212:215], v[160:163]
    v_mfma_f32_16x16x32_bf16 v[164:167], v[176:179], v[216:219], v[164:167]
    v_mfma_f32_16x16x32_bf16 v[168:171], v[180:183], v[216:219], v[168:171]
    v_mfma_f32_16x16x32_bf16 v[172:175], v[184:187], v[216:219], v[172:175]
    s_waitcnt vmcnt(5) lgkmcnt(0)
    s_barrier
    v_mfma_f32_16x16x32_bf16 v[116:119], v[188:191], v[220:223], v[116:119]
    ds_read_b64_tr_b16 v[176:177], v9 offset:24576
    ds_read_b64_tr_b16 v[178:179], v9 offset:25088
    v_mfma_f32_16x16x32_bf16 v[120:123], v[192:195], v[220:223], v[120:123]
    s_add_u32 m0, s37, 55296
    s_mov_b32 s3, 4718592
    buffer_load_dwordx4 v3, s[20:23], s3 offen offset:0 lds
    ds_read_b128 v[200:203], v7 offset:18432
    v_mfma_f32_16x16x32_bf16 v[124:127], v[196:199], v[220:223], v[124:127]
    ds_read_b64_tr_b16 v[180:181], v10 offset:24576
    v_mfma_f32_16x16x32_bf16 v[128:131], v[188:191], v[224:227], v[128:131]
    ds_read_b64_tr_b16 v[182:183], v10 offset:25088
    v_mfma_f32_16x16x32_bf16 v[132:135], v[192:195], v[224:227], v[132:135]
    ds_read_b64_tr_b16 v[184:185], v11 offset:24576
    ds_read_b64_tr_b16 v[186:187], v11 offset:25088
    v_mfma_f32_16x16x32_bf16 v[136:139], v[196:199], v[224:227], v[136:139]
    s_add_u32 m0, s37, 56192
    s_nop 0
    buffer_load_dwordx4 v3, s[20:23], s3 offen offset:128 lds
    ds_read_b128 v[204:207], v7 offset:20480
    v_mfma_f32_16x16x32_bf16 v[140:143], v[188:191], v[228:231], v[140:143]
    ds_read_b128 v[208:211], v7 offset:22528
    v_mfma_f32_16x16x32_bf16 v[144:147], v[192:195], v[228:231], v[144:147]
    ds_read_b128 v[212:215], v7 offset:24576
    v_mfma_f32_16x16x32_bf16 v[148:151], v[196:199], v[228:231], v[148:151]
    ds_read_b128 v[216:219], v7 offset:26624
    v_mfma_f32_16x16x32_bf16 v[152:155], v[188:191], v[232:235], v[152:155]
    v_mfma_f32_16x16x32_bf16 v[156:159], v[192:195], v[232:235], v[156:159]
    s_add_u32 m0, s37, 57088
    s_nop 0
    buffer_load_dwordx4 v3, s[20:23], s3 offen offset:256 lds
    v_mfma_f32_16x16x32_bf16 v[160:163], v[196:199], v[232:235], v[160:163]
    v_mfma_f32_16x16x32_bf16 v[164:167], v[188:191], v[236:239], v[164:167]
    v_mfma_f32_16x16x32_bf16 v[168:171], v[192:195], v[236:239], v[168:171]
    v_mfma_f32_16x16x32_bf16 v[172:175], v[196:199], v[236:239], v[172:175]
    s_waitcnt lgkmcnt(0)
    v_mfma_f32_16x16x32_bf16 v[116:119], v[176:179], v[200:203], v[116:119]
    ds_read_b64_tr_b16 v[188:189], v9 offset:36864
    ds_read_b64_tr_b16 v[190:191], v9 offset:37376
    s_add_u32 m0, s38, 0
    s_mov_b32 s40, 768
    buffer_load_dwordx4 v2, s[16:19], s40 offen lds
    v_mfma_f32_16x16x32_bf16 v[120:123], v[180:183], v[200:203], v[120:123]
    ds_read_b128 v[220:223], v8 offset:18432
    v_mfma_f32_16x16x32_bf16 v[124:127], v[184:187], v[200:203], v[124:127]
    ds_read_b64_tr_b16 v[192:193], v10 offset:36864
    v_mfma_f32_16x16x32_bf16 v[128:131], v[176:179], v[204:207], v[128:131]
    ds_read_b64_tr_b16 v[194:195], v10 offset:37376
    v_mfma_f32_16x16x32_bf16 v[132:135], v[180:183], v[204:207], v[132:135]
    ds_read_b64_tr_b16 v[196:197], v11 offset:36864
    ds_read_b64_tr_b16 v[198:199], v11 offset:37376
    v_mfma_f32_16x16x32_bf16 v[136:139], v[184:187], v[204:207], v[136:139]
    ds_read_b128 v[224:227], v8 offset:20480
    v_mfma_f32_16x16x32_bf16 v[140:143], v[176:179], v[208:211], v[140:143]
    ds_read_b128 v[228:231], v8 offset:22528
    v_mfma_f32_16x16x32_bf16 v[144:147], v[180:183], v[208:211], v[144:147]
    ds_read_b128 v[232:235], v8 offset:24576
    s_add_u32 m0, s38, 8192
    s_mov_b32 s40, 82688
    buffer_load_dwordx4 v2, s[16:19], s40 offen lds
    v_mfma_f32_16x16x32_bf16 v[148:151], v[184:187], v[208:211], v[148:151]
    ds_read_b128 v[236:239], v8 offset:26624
    v_mfma_f32_16x16x32_bf16 v[152:155], v[176:179], v[212:215], v[152:155]
    v_mfma_f32_16x16x32_bf16 v[156:159], v[180:183], v[212:215], v[156:159]
    v_mfma_f32_16x16x32_bf16 v[160:163], v[184:187], v[212:215], v[160:163]
    v_mfma_f32_16x16x32_bf16 v[164:167], v[176:179], v[216:219], v[164:167]
    v_mfma_f32_16x16x32_bf16 v[168:171], v[180:183], v[216:219], v[168:171]
    v_mfma_f32_16x16x32_bf16 v[172:175], v[184:187], v[216:219], v[172:175]
    s_waitcnt vmcnt(5) lgkmcnt(0)
    s_barrier
    v_mfma_f32_16x16x32_bf16 v[116:119], v[188:191], v[220:223], v[116:119]
    ds_read_b64_tr_b16 v[176:177], v9 offset:49152
    ds_read_b64_tr_b16 v[178:179], v9 offset:49664
    v_mfma_f32_16x16x32_bf16 v[120:123], v[192:195], v[220:223], v[120:123]
    s_add_u32 m0, s37, 79872
    s_mov_b32 s3, 5505024
    buffer_load_dwordx4 v3, s[20:23], s3 offen offset:0 lds
    ds_read_b128 v[200:203], v7 offset:36864
    v_mfma_f32_16x16x32_bf16 v[124:127], v[196:199], v[220:223], v[124:127]
    ds_read_b64_tr_b16 v[180:181], v10 offset:49152
    v_mfma_f32_16x16x32_bf16 v[128:131], v[188:191], v[224:227], v[128:131]
    ds_read_b64_tr_b16 v[182:183], v10 offset:49664
    v_mfma_f32_16x16x32_bf16 v[132:135], v[192:195], v[224:227], v[132:135]
    ds_read_b64_tr_b16 v[184:185], v11 offset:49152
    ds_read_b64_tr_b16 v[186:187], v11 offset:49664
    v_mfma_f32_16x16x32_bf16 v[136:139], v[196:199], v[224:227], v[136:139]
    s_add_u32 m0, s37, 80768
    s_nop 0
    buffer_load_dwordx4 v3, s[20:23], s3 offen offset:128 lds
    ds_read_b128 v[204:207], v7 offset:38912
    v_mfma_f32_16x16x32_bf16 v[140:143], v[188:191], v[228:231], v[140:143]
    ds_read_b128 v[208:211], v7 offset:40960
    v_mfma_f32_16x16x32_bf16 v[144:147], v[192:195], v[228:231], v[144:147]
    ds_read_b128 v[212:215], v7 offset:43008
    v_mfma_f32_16x16x32_bf16 v[148:151], v[196:199], v[228:231], v[148:151]
    ds_read_b128 v[216:219], v7 offset:45056
    v_mfma_f32_16x16x32_bf16 v[152:155], v[188:191], v[232:235], v[152:155]
    v_mfma_f32_16x16x32_bf16 v[156:159], v[192:195], v[232:235], v[156:159]
    s_add_u32 m0, s37, 81664
    s_nop 0
    buffer_load_dwordx4 v3, s[20:23], s3 offen offset:256 lds
    v_mfma_f32_16x16x32_bf16 v[160:163], v[196:199], v[232:235], v[160:163]
    v_mfma_f32_16x16x32_bf16 v[164:167], v[188:191], v[236:239], v[164:167]
    v_mfma_f32_16x16x32_bf16 v[168:171], v[192:195], v[236:239], v[168:171]
    v_mfma_f32_16x16x32_bf16 v[172:175], v[196:199], v[236:239], v[172:175]
    s_waitcnt lgkmcnt(0)
    v_mfma_f32_16x16x32_bf16 v[116:119], v[176:179], v[200:203], v[116:119]
    ds_read_b64_tr_b16 v[188:189], v9 offset:61440
    ds_read_b64_tr_b16 v[190:191], v9 offset:61952
    s_add_u32 m0, s38, 18432
    s_mov_b32 s40, 896
    buffer_load_dwordx4 v2, s[16:19], s40 offen lds
    v_mfma_f32_16x16x32_bf16 v[120:123], v[180:183], v[200:203], v[120:123]
    ds_read_b128 v[220:223], v8 offset:36864
    v_mfma_f32_16x16x32_bf16 v[124:127], v[184:187], v[200:203], v[124:127]
    ds_read_b64_tr_b16 v[192:193], v10 offset:61440
    v_mfma_f32_16x16x32_bf16 v[128:131], v[176:179], v[204:207], v[128:131]
    ds_read_b64_tr_b16 v[194:195], v10 offset:61952
    v_mfma_f32_16x16x32_bf16 v[132:135], v[180:183], v[204:207], v[132:135]
    ds_read_b64_tr_b16 v[196:197], v11 offset:61440
    ds_read_b64_tr_b16 v[198:199], v11 offset:61952
    v_mfma_f32_16x16x32_bf16 v[136:139], v[184:187], v[204:207], v[136:139]
    ds_read_b128 v[224:227], v8 offset:38912
    v_mfma_f32_16x16x32_bf16 v[140:143], v[176:179], v[208:211], v[140:143]
    ds_read_b128 v[228:231], v8 offset:40960
    v_mfma_f32_16x16x32_bf16 v[144:147], v[180:183], v[208:211], v[144:147]
    ds_read_b128 v[232:235], v8 offset:43008
    s_add_u32 m0, s38, 26624
    s_mov_b32 s40, 82816
    buffer_load_dwordx4 v2, s[16:19], s40 offen lds
    v_mfma_f32_16x16x32_bf16 v[148:151], v[184:187], v[208:211], v[148:151]
    ds_read_b128 v[236:239], v8 offset:45056
    v_mfma_f32_16x16x32_bf16 v[152:155], v[176:179], v[212:215], v[152:155]
    v_mfma_f32_16x16x32_bf16 v[156:159], v[180:183], v[212:215], v[156:159]
    v_mfma_f32_16x16x32_bf16 v[160:163], v[184:187], v[212:215], v[160:163]
    v_mfma_f32_16x16x32_bf16 v[164:167], v[176:179], v[216:219], v[164:167]
    v_mfma_f32_16x16x32_bf16 v[168:171], v[180:183], v[216:219], v[168:171]
    v_mfma_f32_16x16x32_bf16 v[172:175], v[184:187], v[216:219], v[172:175]
    s_waitcnt vmcnt(5) lgkmcnt(0)
    s_barrier
    v_mfma_f32_16x16x32_bf16 v[116:119], v[188:191], v[220:223], v[116:119]
    ds_read_b64_tr_b16 v[176:177], v9 offset:0
    ds_read_b64_tr_b16 v[178:179], v9 offset:512
    v_mfma_f32_16x16x32_bf16 v[120:123], v[192:195], v[220:223], v[120:123]
    s_add_u32 m0, s37, 104448
    s_mov_b32 s3, 6291456
    buffer_load_dwordx4 v3, s[20:23], s3 offen offset:0 lds
    ds_read_b128 v[200:203], v7 offset:0
    v_mfma_f32_16x16x32_bf16 v[124:127], v[196:199], v[220:223], v[124:127]
    ds_read_b64_tr_b16 v[180:181], v10 offset:0
    v_mfma_f32_16x16x32_bf16 v[128:131], v[188:191], v[224:227], v[128:131]
    ds_read_b64_tr_b16 v[182:183], v10 offset:512
    v_mfma_f32_16x16x32_bf16 v[132:135], v[192:195], v[224:227], v[132:135]
    ds_read_b64_tr_b16 v[184:185], v11 offset:0
    ds_read_b64_tr_b16 v[186:187], v11 offset:512
    v_mfma_f32_16x16x32_bf16 v[136:139], v[196:199], v[224:227], v[136:139]
    s_add_u32 m0, s37, 105344
    s_nop 0
    buffer_load_dwordx4 v3, s[20:23], s3 offen offset:128 lds
    ds_read_b128 v[204:207], v7 offset:2048
    v_mfma_f32_16x16x32_bf16 v[140:143], v[188:191], v[228:231], v[140:143]
    ds_read_b128 v[208:211], v7 offset:4096
    v_mfma_f32_16x16x32_bf16 v[144:147], v[192:195], v[228:231], v[144:147]
    ds_read_b128 v[212:215], v7 offset:6144
    v_mfma_f32_16x16x32_bf16 v[148:151], v[196:199], v[228:231], v[148:151]
    ds_read_b128 v[216:219], v7 offset:8192
    v_mfma_f32_16x16x32_bf16 v[152:155], v[188:191], v[232:235], v[152:155]
    v_mfma_f32_16x16x32_bf16 v[156:159], v[192:195], v[232:235], v[156:159]
    s_add_u32 m0, s37, 106240
    s_nop 0
    buffer_load_dwordx4 v3, s[20:23], s3 offen offset:256 lds
    v_mfma_f32_16x16x32_bf16 v[160:163], v[196:199], v[232:235], v[160:163]
    v_mfma_f32_16x16x32_bf16 v[164:167], v[188:191], v[236:239], v[164:167]
    v_mfma_f32_16x16x32_bf16 v[168:171], v[192:195], v[236:239], v[168:171]
    v_mfma_f32_16x16x32_bf16 v[172:175], v[196:199], v[236:239], v[172:175]
    s_waitcnt lgkmcnt(0)
    v_mfma_f32_16x16x32_bf16 v[116:119], v[176:179], v[200:203], v[116:119]
    ds_read_b64_tr_b16 v[188:189], v9 offset:12288
    ds_read_b64_tr_b16 v[190:191], v9 offset:12800
    s_add_u32 m0, s38, 36864
    s_mov_b32 s40, 1024
    buffer_load_dwordx4 v2, s[16:19], s40 offen lds
    v_mfma_f32_16x16x32_bf16 v[120:123], v[180:183], v[200:203], v[120:123]
    ds_read_b128 v[220:223], v8 offset:0
    v_mfma_f32_16x16x32_bf16 v[124:127], v[184:187], v[200:203], v[124:127]
    ds_read_b64_tr_b16 v[192:193], v10 offset:12288
    v_mfma_f32_16x16x32_bf16 v[128:131], v[176:179], v[204:207], v[128:131]
    ds_read_b64_tr_b16 v[194:195], v10 offset:12800
    v_mfma_f32_16x16x32_bf16 v[132:135], v[180:183], v[204:207], v[132:135]
    ds_read_b64_tr_b16 v[196:197], v11 offset:12288
    ds_read_b64_tr_b16 v[198:199], v11 offset:12800
    v_mfma_f32_16x16x32_bf16 v[136:139], v[184:187], v[204:207], v[136:139]
    ds_read_b128 v[224:227], v8 offset:2048
    v_mfma_f32_16x16x32_bf16 v[140:143], v[176:179], v[208:211], v[140:143]
    ds_read_b128 v[228:231], v8 offset:4096
    v_mfma_f32_16x16x32_bf16 v[144:147], v[180:183], v[208:211], v[144:147]
    ds_read_b128 v[232:235], v8 offset:6144
    s_add_u32 m0, s38, 45056
    s_mov_b32 s40, 82944
    buffer_load_dwordx4 v2, s[16:19], s40 offen lds
    v_mfma_f32_16x16x32_bf16 v[148:151], v[184:187], v[208:211], v[148:151]
    ds_read_b128 v[236:239], v8 offset:8192
    v_mfma_f32_16x16x32_bf16 v[152:155], v[176:179], v[212:215], v[152:155]
    v_mfma_f32_16x16x32_bf16 v[156:159], v[180:183], v[212:215], v[156:159]
    v_mfma_f32_16x16x32_bf16 v[160:163], v[184:187], v[212:215], v[160:163]
    v_mfma_f32_16x16x32_bf16 v[164:167], v[176:179], v[216:219], v[164:167]
    v_mfma_f32_16x16x32_bf16 v[168:171], v[180:183], v[216:219], v[168:171]
    v_mfma_f32_16x16x32_bf16 v[172:175], v[184:187], v[216:219], v[172:175]
    s_waitcnt vmcnt(5) lgkmcnt(0)
    s_barrier
    v_mfma_f32_16x16x32_bf16 v[116:119], v[188:191], v[220:223], v[116:119]
    ds_read_b64_tr_b16 v[176:177], v9 offset:24576
    ds_read_b64_tr_b16 v[178:179], v9 offset:25088
    v_mfma_f32_16x16x32_bf16 v[120:123], v[192:195], v[220:223], v[120:123]
    s_add_u32 m0, s37, 55296
    s_mov_b32 s3, 7077888
    buffer_load_dwordx4 v3, s[20:23], s3 offen offset:0 lds
    ds_read_b128 v[200:203], v7 offset:18432
    v_mfma_f32_16x16x32_bf16 v[124:127], v[196:199], v[220:223], v[124:127]
    ds_read_b64_tr_b16 v[180:181], v10 offset:24576
    v_mfma_f32_16x16x32_bf16 v[128:131], v[188:191], v[224:227], v[128:131]
    ds_read_b64_tr_b16 v[182:183], v10 offset:25088
    v_mfma_f32_16x16x32_bf16 v[132:135], v[192:195], v[224:227], v[132:135]
    ds_read_b64_tr_b16 v[184:185], v11 offset:24576
    ds_read_b64_tr_b16 v[186:187], v11 offset:25088
    v_mfma_f32_16x16x32_bf16 v[136:139], v[196:199], v[224:227], v[136:139]
    s_add_u32 m0, s37, 56192
    s_nop 0
    buffer_load_dwordx4 v3, s[20:23], s3 offen offset:128 lds
    ds_read_b128 v[204:207], v7 offset:20480
    v_mfma_f32_16x16x32_bf16 v[140:143], v[188:191], v[228:231], v[140:143]
    ds_read_b128 v[208:211], v7 offset:22528
    v_mfma_f32_16x16x32_bf16 v[144:147], v[192:195], v[228:231], v[144:147]
    ds_read_b128 v[212:215], v7 offset:24576
    v_mfma_f32_16x16x32_bf16 v[148:151], v[196:199], v[228:231], v[148:151]
    ds_read_b128 v[216:219], v7 offset:26624
    v_mfma_f32_16x16x32_bf16 v[152:155], v[188:191], v[232:235], v[152:155]
    v_mfma_f32_16x16x32_bf16 v[156:159], v[192:195], v[232:235], v[156:159]
    s_add_u32 m0, s37, 57088
    s_nop 0
    buffer_load_dwordx4 v3, s[20:23], s3 offen offset:256 lds
    v_mfma_f32_16x16x32_bf16 v[160:163], v[196:199], v[232:235], v[160:163]
    v_mfma_f32_16x16x32_bf16 v[164:167], v[188:191], v[236:239], v[164:167]
    v_mfma_f32_16x16x32_bf16 v[168:171], v[192:195], v[236:239], v[168:171]
    v_mfma_f32_16x16x32_bf16 v[172:175], v[196:199], v[236:239], v[172:175]
    s_waitcnt lgkmcnt(0)
    v_mfma_f32_16x16x32_bf16 v[116:119], v[176:179], v[200:203], v[116:119]
    ds_read_b64_tr_b16 v[188:189], v9 offset:36864
    ds_read_b64_tr_b16 v[190:191], v9 offset:37376
    s_add_u32 m0, s38, 0
    s_mov_b32 s40, 1152
    buffer_load_dwordx4 v2, s[16:19], s40 offen lds
    v_mfma_f32_16x16x32_bf16 v[120:123], v[180:183], v[200:203], v[120:123]
    ds_read_b128 v[220:223], v8 offset:18432
    v_mfma_f32_16x16x32_bf16 v[124:127], v[184:187], v[200:203], v[124:127]
    ds_read_b64_tr_b16 v[192:193], v10 offset:36864
    v_mfma_f32_16x16x32_bf16 v[128:131], v[176:179], v[204:207], v[128:131]
    ds_read_b64_tr_b16 v[194:195], v10 offset:37376
    v_mfma_f32_16x16x32_bf16 v[132:135], v[180:183], v[204:207], v[132:135]
    ds_read_b64_tr_b16 v[196:197], v11 offset:36864
    ds_read_b64_tr_b16 v[198:199], v11 offset:37376
    v_mfma_f32_16x16x32_bf16 v[136:139], v[184:187], v[204:207], v[136:139]
    ds_read_b128 v[224:227], v8 offset:20480
    v_mfma_f32_16x16x32_bf16 v[140:143], v[176:179], v[208:211], v[140:143]
    ds_read_b128 v[228:231], v8 offset:22528
    v_mfma_f32_16x16x32_bf16 v[144:147], v[180:183], v[208:211], v[144:147]
    ds_read_b128 v[232:235], v8 offset:24576
    s_add_u32 m0, s38, 8192
    s_mov_b32 s40, 83072
    buffer_load_dwordx4 v2, s[16:19], s40 offen lds
    v_mfma_f32_16x16x32_bf16 v[148:151], v[184:187], v[208:211], v[148:151]
    ds_read_b128 v[236:239], v8 offset:26624
    v_mfma_f32_16x16x32_bf16 v[152:155], v[176:179], v[212:215], v[152:155]
    v_mfma_f32_16x16x32_bf16 v[156:159], v[180:183], v[212:215], v[156:159]
    v_mfma_f32_16x16x32_bf16 v[160:163], v[184:187], v[212:215], v[160:163]
    v_mfma_f32_16x16x32_bf16 v[164:167], v[176:179], v[216:219], v[164:167]
    v_mfma_f32_16x16x32_bf16 v[168:171], v[180:183], v[216:219], v[168:171]
    v_mfma_f32_16x16x32_bf16 v[172:175], v[184:187], v[216:219], v[172:175]
    s_waitcnt vmcnt(5) lgkmcnt(0)
    s_barrier
    v_mfma_f32_16x16x32_bf16 v[116:119], v[188:191], v[220:223], v[116:119]
    ds_read_b64_tr_b16 v[176:177], v9 offset:49152
    ds_read_b64_tr_b16 v[178:179], v9 offset:49664
    s_lshl_b32 s41, s49, 2
    s_lshr_b32 s41, 42560, s41
    s_and_b32 s41, s41, 15
    s_lshr_b32 s42, s41, 2
    s_lshl_b32 s42, s42, 10
    s_add_u32 s42, s42, 55296
    s_add_u32 m0, s57, 0
    s_mov_b32 s40, 12288
    buffer_load_dwordx4 v4, s[24:27], s40 offen offset:0 nt lds
    v_mfma_f32_16x16x32_bf16 v[120:123], v[192:195], v[220:223], v[120:123]
    ds_read_b128 v[200:203], v7 offset:36864
    s_and_b32 s41, s41, 3
    v_lshrrev_b32 v244, 4, v1
    v_bfe_u32 v245, v1, 2, 2
    v_and_b32 v246, 1, v244
    v_lshlrev_b32 v246, 1, v246
    v_mfma_f32_16x16x32_bf16 v[124:127], v[196:199], v[220:223], v[124:127]
    ds_read_b64_tr_b16 v[180:181], v10 offset:49152
    v_lshrrev_b32 v247, 1, v245
    v_add_u32 v247, v247, v246
    v_xor_b32 v247, s41, v247
    v_lshlrev_b32 v247, 5, v247
    v_lshlrev_b32 v248, 7, v245
    v_mfma_f32_16x16x32_bf16 v[128:131], v[188:191], v[224:227], v[128:131]
    ds_read_b64_tr_b16 v[182:183], v10 offset:49664
    v_add_u32 v248, v248, v247
    v_lshlrev_b32 v246, 8, v246
    v_add_u32 v248, v248, v246
    v_lshrrev_b32 v247, 1, v244
    v_mul_u32_u24 v247, 3072, v247
    s_add_u32 m0, s57, 1024
    s_mov_b32 s40, 12288
    buffer_load_dwordx4 v5, s[24:27], s40 offen offset:0 nt lds
    v_mfma_f32_16x16x32_bf16 v[132:135], v[192:195], v[224:227], v[132:135]
    ds_read_b64_tr_b16 v[184:185], v11 offset:49152
    ds_read_b64_tr_b16 v[186:187], v11 offset:49664
    v_add_u32 v248, v248, v247
    v_and_b32 v247, 3, v1
    v_lshlrev_b32 v247, 3, v247
    v_add_u32 v248, v248, v247
    v_add_u32 v248, s42, v248
    v_mfma_f32_16x16x32_bf16 v[136:139], v[196:199], v[224:227], v[136:139]
    ds_read_b128 v[204:207], v7 offset:38912
    s_lshl_b32 s41, s49, 2
    s_lshr_b32 s41, 46929, s41
    s_and_b32 s41, s41, 15
    s_lshr_b32 s42, s41, 2
    s_lshl_b32 s42, s42, 10
    s_add_u32 s42, s42, 55296
    v_mfma_f32_16x16x32_bf16 v[140:143], v[188:191], v[228:231], v[140:143]
    ds_read_b128 v[208:211], v7 offset:40960
    s_and_b32 s41, s41, 3
    v_lshrrev_b32 v244, 4, v1
    v_bfe_u32 v245, v1, 2, 2
    v_and_b32 v246, 1, v244
    v_lshlrev_b32 v246, 1, v246
    s_add_u32 m0, s57, 6144
    s_mov_b32 s40, 18432
    buffer_load_dwordx4 v4, s[24:27], s40 offen offset:0 nt lds
    v_mfma_f32_16x16x32_bf16 v[144:147], v[192:195], v[228:231], v[144:147]
    ds_read_b128 v[212:215], v7 offset:43008
    v_lshrrev_b32 v247, 1, v245
    v_add_u32 v247, v247, v246
    v_xor_b32 v247, s41, v247
    v_lshlrev_b32 v247, 5, v247
    v_lshlrev_b32 v249, 7, v245
    v_mfma_f32_16x16x32_bf16 v[148:151], v[196:199], v[228:231], v[148:151]
    ds_read_b128 v[216:219], v7 offset:45056
    v_add_u32 v249, v249, v247
    v_lshlrev_b32 v246, 8, v246
    v_add_u32 v249, v249, v246
    v_lshrrev_b32 v247, 1, v244
    v_mul_u32_u24 v247, 3072, v247
    v_mfma_f32_16x16x32_bf16 v[152:155], v[188:191], v[232:235], v[152:155]
    v_add_u32 v249, v249, v247
    v_and_b32 v247, 3, v1
    v_lshlrev_b32 v247, 3, v247
    v_add_u32 v249, v249, v247
    v_add_u32 v249, s42, v249
    v_mfma_f32_16x16x32_bf16 v[156:159], v[192:195], v[232:235], v[156:159]
    s_lshl_b32 s41, s49, 2
    s_lshr_b32 s41, 38962, s41
    s_and_b32 s41, s41, 15
    s_lshr_b32 s42, s41, 2
    s_lshl_b32 s42, s42, 10
    s_add_u32 s42, s42, 55296
    s_add_u32 m0, s57, 7168
    s_mov_b32 s40, 18432
    buffer_load_dwordx4 v5, s[24:27], s40 offen offset:0 nt lds
    v_mfma_f32_16x16x32_bf16 v[160:163], v[196:199], v[232:235], v[160:163]
    s_and_b32 s41, s41, 3
    v_lshrrev_b32 v244, 4, v1
    v_bfe_u32 v245, v1, 2, 2
    v_and_b32 v246, 1, v244
    v_lshlrev_b32 v246, 1, v246
    v_mfma_f32_16x16x32_bf16 v[164:167], v[188:191], v[236:239], v[164:167]
    v_lshrrev_b32 v247, 1, v245
    v_add_u32 v247, v247, v246
    v_xor_b32 v247, s41, v247
    v_lshlrev_b32 v247, 5, v247
    v_lshlrev_b32 v253, 7, v245
    v_mfma_f32_16x16x32_bf16 v[168:171], v[192:195], v[236:239], v[168:171]
    v_add_u32 v253, v253, v247
    v_lshlrev_b32 v246, 8, v246
    v_add_u32 v253, v253, v246
    v_lshrrev_b32 v247, 1, v244
    v_mul_u32_u24 v247, 3072, v247
    v_mfma_f32_16x16x32_bf16 v[172:175], v[196:199], v[236:239], v[172:175]
    v_add_u32 v253, v253, v247
    v_and_b32 v247, 3, v1
    v_lshlrev_b32 v247, 3, v247
    v_add_u32 v253, v253, v247
    v_add_u32 v253, s42, v253
    s_waitcnt lgkmcnt(0)
    v_mfma_f32_16x16x32_bf16 v[116:119], v[176:179], v[200:203], v[116:119]
    ds_read_b64_tr_b16 v[188:189], v9 offset:61440
    ds_read_b64_tr_b16 v[190:191], v9 offset:61952
    v_mfma_f32_16x16x32_bf16 v[120:123], v[180:183], v[200:203], v[120:123]
    ds_read_b128 v[220:223], v8 offset:36864
    s_add_u32 m0, s57, 1920
    s_mov_b32 s40, 12288
    buffer_load_dwordx4 v4, s[24:27], s40 offen offset:128 nt lds
    v_mfma_f32_16x16x32_bf16 v[124:127], v[184:187], v[200:203], v[124:127]
    ds_read_b64_tr_b16 v[192:193], v10 offset:61440
    v_mfma_f32_16x16x32_bf16 v[128:131], v[176:179], v[204:207], v[128:131]
    ds_read_b64_tr_b16 v[194:195], v10 offset:61952
    v_mfma_f32_16x16x32_bf16 v[132:135], v[180:183], v[204:207], v[132:135]
    ds_read_b64_tr_b16 v[196:197], v11 offset:61440
    ds_read_b64_tr_b16 v[198:199], v11 offset:61952
    v_mfma_f32_16x16x32_bf16 v[136:139], v[184:187], v[204:207], v[136:139]
    ds_read_b128 v[224:227], v8 offset:38912
    v_mfma_f32_16x16x32_bf16 v[140:143], v[176:179], v[208:211], v[140:143]
    ds_read_b128 v[228:231], v8 offset:40960
    s_add_u32 m0, s57, 2944
    s_mov_b32 s40, 12288
    buffer_load_dwordx4 v5, s[24:27], s40 offen offset:128 nt lds
    v_mfma_f32_16x16x32_bf16 v[144:147], v[180:183], v[208:211], v[144:147]
    ds_read_b128 v[232:235], v8 offset:43008
    v_mfma_f32_16x16x32_bf16 v[148:151], v[184:187], v[208:211], v[148:151]
    ds_read_b128 v[236:239], v8 offset:45056
    v_mfma_f32_16x16x32_bf16 v[152:155], v[176:179], v[212:215], v[152:155]
    v_mfma_f32_16x16x32_bf16 v[156:159], v[180:183], v[212:215], v[156:159]
    s_add_u32 m0, s57, 8064
    s_mov_b32 s40, 18432
    buffer_load_dwordx4 v4, s[24:27], s40 offen offset:128 nt lds
    v_mfma_f32_16x16x32_bf16 v[160:163], v[184:187], v[212:215], v[160:163]
    v_mfma_f32_16x16x32_bf16 v[164:167], v[176:179], v[216:219], v[164:167]
    v_mfma_f32_16x16x32_bf16 v[168:171], v[180:183], v[216:219], v[168:171]
    v_mfma_f32_16x16x32_bf16 v[172:175], v[184:187], v[216:219], v[172:175]
    s_waitcnt vmcnt(7) lgkmcnt(0)
    s_barrier
    v_mfma_f32_16x16x32_bf16 v[116:119], v[188:191], v[220:223], v[116:119]
    ds_read_b64_tr_b16 v[176:177], v9 offset:0
    ds_read_b64_tr_b16 v[178:179], v9 offset:512
    s_add_u32 m0, s57, 9088
    s_mov_b32 s40, 18432
    buffer_load_dwordx4 v5, s[24:27], s40 offen offset:128 nt lds
    v_mfma_f32_16x16x32_bf16 v[120:123], v[192:195], v[220:223], v[120:123]
    ds_read_b128 v[200:203], v7 offset:0
    v_mfma_f32_16x16x32_bf16 v[124:127], v[196:199], v[220:223], v[124:127]
    ds_read_b64_tr_b16 v[180:181], v10 offset:0
    v_mfma_f32_16x16x32_bf16 v[128:131], v[188:191], v[224:227], v[128:131]
    ds_read_b64_tr_b16 v[182:183], v10 offset:512
    v_mfma_f32_16x16x32_bf16 v[132:135], v[192:195], v[224:227], v[132:135]
    ds_read_b64_tr_b16 v[184:185], v11 offset:0
    ds_read_b64_tr_b16 v[186:187], v11 offset:512
    s_add_u32 m0, s57, 3840
    s_mov_b32 s40, 12288
    buffer_load_dwordx4 v4, s[24:27], s40 offen offset:256 nt lds
    v_mfma_f32_16x16x32_bf16 v[136:139], v[196:199], v[224:227], v[136:139]
    ds_read_b128 v[204:207], v7 offset:2048
    v_mfma_f32_16x16x32_bf16 v[140:143], v[188:191], v[228:231], v[140:143]
    ds_read_b128 v[208:211], v7 offset:4096
    v_mfma_f32_16x16x32_bf16 v[144:147], v[192:195], v[228:231], v[144:147]
    ds_read_b128 v[212:215], v7 offset:6144
    v_mfma_f32_16x16x32_bf16 v[148:151], v[196:199], v[228:231], v[148:151]
    ds_read_b128 v[216:219], v7 offset:8192
    v_mfma_f32_16x16x32_bf16 v[152:155], v[188:191], v[232:235], v[152:155]
    s_add_u32 m0, s57, 4864
    s_mov_b32 s40, 12288
    buffer_load_dwordx4 v5, s[24:27], s40 offen offset:256 nt lds
    v_mfma_f32_16x16x32_bf16 v[156:159], v[192:195], v[232:235], v[156:159]
    v_mfma_f32_16x16x32_bf16 v[160:163], v[196:199], v[232:235], v[160:163]
    v_mfma_f32_16x16x32_bf16 v[164:167], v[188:191], v[236:239], v[164:167]
    v_mfma_f32_16x16x32_bf16 v[168:171], v[192:195], v[236:239], v[168:171]
    v_mfma_f32_16x16x32_bf16 v[172:175], v[196:199], v[236:239], v[172:175]
    s_waitcnt lgkmcnt(0)
    v_mfma_f32_16x16x32_bf16 v[116:119], v[176:179], v[200:203], v[116:119]
    ds_read_b64_tr_b16 v[188:189], v9 offset:12288
    ds_read_b64_tr_b16 v[190:191], v9 offset:12800
    v_mfma_f32_16x16x32_bf16 v[120:123], v[180:183], v[200:203], v[120:123]
    ds_read_b128 v[220:223], v8 offset:0
    s_add_u32 m0, s57, 9984
    s_mov_b32 s40, 18432
    buffer_load_dwordx4 v4, s[24:27], s40 offen offset:256 nt lds
    v_mfma_f32_16x16x32_bf16 v[124:127], v[184:187], v[200:203], v[124:127]
    ds_read_b64_tr_b16 v[192:193], v10 offset:12288
    v_mfma_f32_16x16x32_bf16 v[128:131], v[176:179], v[204:207], v[128:131]
    ds_read_b64_tr_b16 v[194:195], v10 offset:12800
    v_mfma_f32_16x16x32_bf16 v[132:135], v[180:183], v[204:207], v[132:135]
    ds_read_b64_tr_b16 v[196:197], v11 offset:12288
    ds_read_b64_tr_b16 v[198:199], v11 offset:12800
    v_mfma_f32_16x16x32_bf16 v[136:139], v[184:187], v[204:207], v[136:139]
    ds_read_b128 v[224:227], v8 offset:2048
    v_mfma_f32_16x16x32_bf16 v[140:143], v[176:179], v[208:211], v[140:143]
    ds_read_b128 v[228:231], v8 offset:4096
    v_mfma_f32_16x16x32_bf16 v[144:147], v[180:183], v[208:211], v[144:147]
    ds_read_b128 v[232:235], v8 offset:6144
    v_mfma_f32_16x16x32_bf16 v[148:151], v[184:187], v[208:211], v[148:151]
    ds_read_b128 v[236:239], v8 offset:8192
    s_add_u32 m0, s57, 11008
    s_mov_b32 s40, 18432
    buffer_load_dwordx4 v5, s[24:27], s40 offen offset:256 nt lds
    v_mfma_f32_16x16x32_bf16 v[152:155], v[176:179], v[212:215], v[152:155]
    v_mfma_f32_16x16x32_bf16 v[156:159], v[180:183], v[212:215], v[156:159]
    v_mfma_f32_16x16x32_bf16 v[160:163], v[184:187], v[212:215], v[160:163]
    v_mfma_f32_16x16x32_bf16 v[164:167], v[176:179], v[216:219], v[164:167]
    v_mfma_f32_16x16x32_bf16 v[168:171], v[180:183], v[216:219], v[168:171]
    v_mfma_f32_16x16x32_bf16 v[172:175], v[184:187], v[216:219], v[172:175]
    s_waitcnt lgkmcnt(0)
    s_barrier
    v_mfma_f32_16x16x32_bf16 v[116:119], v[188:191], v[220:223], v[116:119]
    v_mfma_f32_16x16x32_bf16 v[120:123], v[192:195], v[220:223], v[120:123]
    v_mfma_f32_16x16x32_bf16 v[124:127], v[196:199], v[220:223], v[124:127]
    v_mfma_f32_16x16x32_bf16 v[128:131], v[188:191], v[224:227], v[128:131]
    v_mfma_f32_16x16x32_bf16 v[132:135], v[192:195], v[224:227], v[132:135]
    s_nop 3
    v_cvt_pk_bf16_f32 v116, v116, v117
    v_cvt_pk_bf16_f32 v117, v118, v119
    v_cvt_pk_bf16_f32 v118, v120, v121
    v_cvt_pk_bf16_f32 v119, v122, v123
    ds_write_b128 v12, v[116:119] offset:0
    v_mfma_f32_16x16x32_bf16 v[136:139], v[196:199], v[224:227], v[136:139]
    v_cvt_pk_bf16_f32 v124, v124, v125
    v_cvt_pk_bf16_f32 v125, v126, v127
    ds_write_b64 v14, v[124:125] offset:0
    v_mfma_f32_16x16x32_bf16 v[140:143], v[188:191], v[228:231], v[140:143]
    v_mfma_f32_16x16x32_bf16 v[144:147], v[192:195], v[228:231], v[144:147]
    v_cvt_pk_bf16_f32 v128, v128, v129
    v_cvt_pk_bf16_f32 v129, v130, v131
    v_cvt_pk_bf16_f32 v130, v132, v133
    v_cvt_pk_bf16_f32 v131, v134, v135
    ds_write_b128 v12, v[128:131] offset:1024
    v_mfma_f32_16x16x32_bf16 v[148:151], v[196:199], v[228:231], v[148:151]
    v_cvt_pk_bf16_f32 v136, v136, v137
    v_cvt_pk_bf16_f32 v137, v138, v139
    ds_write_b64 v14, v[136:137] offset:1024
    v_mfma_f32_16x16x32_bf16 v[152:155], v[188:191], v[232:235], v[152:155]
    v_mfma_f32_16x16x32_bf16 v[156:159], v[192:195], v[232:235], v[156:159]
    v_cvt_pk_bf16_f32 v140, v140, v141
    v_cvt_pk_bf16_f32 v141, v142, v143
    v_cvt_pk_bf16_f32 v142, v144, v145
    v_cvt_pk_bf16_f32 v143, v146, v147
    ds_write_b128 v12, v[140:143] offset:2048
    v_mfma_f32_16x16x32_bf16 v[160:163], v[196:199], v[232:235], v[160:163]
    v_cvt_pk_bf16_f32 v148, v148, v149
    v_cvt_pk_bf16_f32 v149, v150, v151
    ds_write_b64 v14, v[148:149] offset:2048
    v_mfma_f32_16x16x32_bf16 v[164:167], v[188:191], v[236:239], v[164:167]
    v_mfma_f32_16x16x32_bf16 v[168:171], v[192:195], v[236:239], v[168:171]
    v_cvt_pk_bf16_f32 v152, v152, v153
    v_cvt_pk_bf16_f32 v153, v154, v155
    v_cvt_pk_bf16_f32 v154, v156, v157
    v_cvt_pk_bf16_f32 v155, v158, v159
    ds_write_b128 v12, v[152:155] offset:3072
    v_mfma_f32_16x16x32_bf16 v[172:175], v[196:199], v[236:239], v[172:175]
    v_cvt_pk_bf16_f32 v160, v160, v161
    v_cvt_pk_bf16_f32 v161, v162, v163
    ds_write_b64 v14, v[160:161] offset:3072
    v_cvt_pk_bf16_f32 v164, v164, v165
    v_cvt_pk_bf16_f32 v165, v166, v167
    v_cvt_pk_bf16_f32 v166, v168, v169
    v_cvt_pk_bf16_f32 v167, v170, v171
    ds_write_b128 v12, v[164:167] offset:4096
    v_cvt_pk_bf16_f32 v172, v172, v173
    v_cvt_pk_bf16_f32 v173, v174, v175
    ds_write_b64 v14, v[172:173] offset:4096
    v_lshlrev_b32 v7, 4, v1
    v_mov_b32 v9, v248
    v_mov_b32 v10, v249
    v_mov_b32 v11, v253
    s_waitcnt lgkmcnt(0)
    s_barrier
    v_add_u32 v12, 49152, v9
    v_add_u32 v13, 49152, v10
    v_add_u32 v14, 49152, v11
    s_lshl_b32 s41, s36, 2
    s_lshr_b32 s42, 0x32105432, s41
    s_and_b32 s42, s42, 15
    s_mul_i32 s42, s42, 9216
    v_lshlrev_b32 v241, 4, v1
    v_add_u32 v241, s42, v241
    ds_read_b128 v[224:227], v7 offset:0
    ds_read_b128 v[228:231], v7 offset:9216
    ds_read_b128 v[232:235], v7 offset:18432
    ds_read_b128 v[236:239], v7 offset:27648
    s_waitcnt lgkmcnt(3)
    v_mfma_f32_16x16x32_bf16 v[116:119], v[16:19], v[224:227], 0
    v_mfma_f32_16x16x32_bf16 v[120:123], v[40:43], v[224:227], 0
    ds_read_b128 v[224:227], v7 offset:36864
    s_waitcnt lgkmcnt(3)
    v_mfma_f32_16x16x32_bf16 v[116:119], v[20:23], v[228:231], v[116:119]
    v_mfma_f32_16x16x32_bf16 v[120:123], v[44:47], v[228:231], v[120:123]
    ds_read_b128 v[228:231], v7 offset:46080
    s_waitcnt lgkmcnt(3)
    v_mfma_f32_16x16x32_bf16 v[116:119], v[24:27], v[232:235], v[116:119]
    v_mfma_f32_16x16x32_bf16 v[120:123], v[48:51], v[232:235], v[120:123]
    ds_read_b128 v[232:235], v7 offset:1024
    s_waitcnt lgkmcnt(3)
    v_mfma_f32_16x16x32_bf16 v[116:119], v[28:31], v[236:239], v[116:119]
    v_mfma_f32_16x16x32_bf16 v[120:123], v[52:55], v[236:239], v[120:123]
    ds_read_b128 v[236:239], v7 offset:10240
    s_waitcnt lgkmcnt(3)
    v_mfma_f32_16x16x32_bf16 v[116:119], v[32:35], v[224:227], v[116:119]
    v_mfma_f32_16x16x32_bf16 v[120:123], v[56:59], v[224:227], v[120:123]
    ds_read_b128 v[224:227], v7 offset:19456
    s_waitcnt lgkmcnt(3)
    v_mfma_f32_16x16x32_bf16 v[116:119], v[36:39], v[228:231], v[116:119]
    v_mfma_f32_16x16x32_bf16 v[120:123], v[60:63], v[228:231], v[120:123]
    ds_read_b128 v[228:231], v7 offset:28672
    s_waitcnt lgkmcnt(3)
    v_mfma_f32_16x16x32_bf16 v[124:127], v[16:19], v[232:235], 0
    v_mfma_f32_16x16x32_bf16 v[128:131], v[40:43], v[232:235], 0
    ds_read_b128 v[232:235], v7 offset:37888
    s_waitcnt lgkmcnt(3)
    v_mfma_f32_16x16x32_bf16 v[124:127], v[20:23], v[236:239], v[124:127]
    v_mfma_f32_16x16x32_bf16 v[128:131], v[44:47], v[236:239], v[128:131]
    ds_read_b128 v[236:239], v7 offset:47104
    s_waitcnt lgkmcnt(3)
    v_mfma_f32_16x16x32_bf16 v[124:127], v[24:27], v[224:227], v[124:127]
    v_mfma_f32_16x16x32_bf16 v[128:131], v[48:51], v[224:227], v[128:131]
    ds_read_b128 v[224:227], v7 offset:2048
    s_waitcnt lgkmcnt(3)
    v_mfma_f32_16x16x32_bf16 v[124:127], v[28:31], v[228:231], v[124:127]
    v_mfma_f32_16x16x32_bf16 v[128:131], v[52:55], v[228:231], v[128:131]
    ds_read_b128 v[228:231], v7 offset:11264
    s_waitcnt lgkmcnt(3)
    v_mfma_f32_16x16x32_bf16 v[124:127], v[32:35], v[232:235], v[124:127]
    v_mfma_f32_16x16x32_bf16 v[128:131], v[56:59], v[232:235], v[128:131]
    ds_read_b128 v[232:235], v7 offset:20480
    s_waitcnt lgkmcnt(3)
    v_mfma_f32_16x16x32_bf16 v[124:127], v[36:39], v[236:239], v[124:127]
    v_mfma_f32_16x16x32_bf16 v[128:131], v[60:63], v[236:239], v[128:131]
    ds_read_b128 v[236:239], v7 offset:29696
    s_waitcnt lgkmcnt(3)
    v_mfma_f32_16x16x32_bf16 v[132:135], v[16:19], v[224:227], 0
    v_mfma_f32_16x16x32_bf16 v[136:139], v[40:43], v[224:227], 0
    ds_read_b128 v[224:227], v7 offset:38912
    s_waitcnt lgkmcnt(3)
    v_mfma_f32_16x16x32_bf16 v[132:135], v[20:23], v[228:231], v[132:135]
    v_mfma_f32_16x16x32_bf16 v[136:139], v[44:47], v[228:231], v[136:139]
    ds_read_b128 v[228:231], v7 offset:48128
    s_waitcnt lgkmcnt(3)
    v_mfma_f32_16x16x32_bf16 v[132:135], v[24:27], v[232:235], v[132:135]
    v_mfma_f32_16x16x32_bf16 v[136:139], v[48:51], v[232:235], v[136:139]
    ds_read_b128 v[232:235], v7 offset:3072
    s_waitcnt lgkmcnt(3)
    v_mfma_f32_16x16x32_bf16 v[132:135], v[28:31], v[236:239], v[132:135]
    v_mfma_f32_16x16x32_bf16 v[136:139], v[52:55], v[236:239], v[136:139]
    ds_read_b128 v[236:239], v7 offset:12288
    s_waitcnt lgkmcnt(3)
    v_mfma_f32_16x16x32_bf16 v[132:135], v[32:35], v[224:227], v[132:135]
    v_mfma_f32_16x16x32_bf16 v[136:139], v[56:59], v[224:227], v[136:139]
    ds_read_b128 v[224:227], v7 offset:21504
    s_waitcnt lgkmcnt(3)
    v_mfma_f32_16x16x32_bf16 v[132:135], v[36:39], v[228:231], v[132:135]
    v_mfma_f32_16x16x32_bf16 v[136:139], v[60:63], v[228:231], v[136:139]
    ds_read_b128 v[228:231], v7 offset:30720
    s_waitcnt lgkmcnt(3)
    v_mfma_f32_16x16x32_bf16 v[140:143], v[16:19], v[232:235], 0
    v_mfma_f32_16x16x32_bf16 v[144:147], v[40:43], v[232:235], 0
    ds_read_b128 v[232:235], v7 offset:39936
    s_waitcnt lgkmcnt(3)
    v_mfma_f32_16x16x32_bf16 v[140:143], v[20:23], v[236:239], v[140:143]
    v_mfma_f32_16x16x32_bf16 v[144:147], v[44:47], v[236:239], v[144:147]
    ds_read_b128 v[236:239], v7 offset:49152
    s_waitcnt lgkmcnt(3)
    v_mfma_f32_16x16x32_bf16 v[140:143], v[24:27], v[224:227], v[140:143]
    v_mfma_f32_16x16x32_bf16 v[144:147], v[48:51], v[224:227], v[144:147]
    ds_read_b128 v[224:227], v7 offset:4096
    s_waitcnt lgkmcnt(3)
    v_mfma_f32_16x16x32_bf16 v[140:143], v[28:31], v[228:231], v[140:143]
    v_mfma_f32_16x16x32_bf16 v[144:147], v[52:55], v[228:231], v[144:147]
    ds_read_b128 v[228:231], v7 offset:13312
    s_waitcnt lgkmcnt(3)
    v_mfma_f32_16x16x32_bf16 v[140:143], v[32:35], v[232:235], v[140:143]
    v_mfma_f32_16x16x32_bf16 v[144:147], v[56:59], v[232:235], v[144:147]
    ds_read_b128 v[232:235], v7 offset:22528
    s_waitcnt lgkmcnt(3)
    v_mfma_f32_16x16x32_bf16 v[140:143], v[36:39], v[236:239], v[140:143]
    v_mfma_f32_16x16x32_bf16 v[144:147], v[60:63], v[236:239], v[144:147]
    ds_read_b128 v[236:239], v7 offset:31744
    s_waitcnt lgkmcnt(3)
    v_mfma_f32_16x16x32_bf16 v[148:151], v[16:19], v[224:227], 0
    v_mfma_f32_16x16x32_bf16 v[152:155], v[40:43], v[224:227], 0
    ds_read_b128 v[224:227], v7 offset:40960
    s_waitcnt lgkmcnt(3)
    v_mfma_f32_16x16x32_bf16 v[148:151], v[20:23], v[228:231], v[148:151]
    v_mfma_f32_16x16x32_bf16 v[152:155], v[44:47], v[228:231], v[152:155]
    ds_read_b128 v[228:231], v7 offset:50176
    s_waitcnt lgkmcnt(3)
    v_mfma_f32_16x16x32_bf16 v[148:151], v[24:27], v[232:235], v[148:151]
    v_mfma_f32_16x16x32_bf16 v[152:155], v[48:51], v[232:235], v[152:155]
    ds_read_b128 v[232:235], v7 offset:5120
    s_waitcnt lgkmcnt(3)
    v_mfma_f32_16x16x32_bf16 v[148:151], v[28:31], v[236:239], v[148:151]
    v_mfma_f32_16x16x32_bf16 v[152:155], v[52:55], v[236:239], v[152:155]
    ds_read_b128 v[236:239], v7 offset:14336
    s_waitcnt lgkmcnt(3)
    v_mfma_f32_16x16x32_bf16 v[148:151], v[32:35], v[224:227], v[148:151]
    v_mfma_f32_16x16x32_bf16 v[152:155], v[56:59], v[224:227], v[152:155]
    ds_read_b128 v[224:227], v7 offset:23552
    s_waitcnt lgkmcnt(3)
    v_mfma_f32_16x16x32_bf16 v[148:151], v[36:39], v[228:231], v[148:151]
    v_mfma_f32_16x16x32_bf16 v[152:155], v[60:63], v[228:231], v[152:155]
    ds_read_b128 v[228:231], v7 offset:32768
    s_waitcnt lgkmcnt(3)
    v_mfma_f32_16x16x32_bf16 v[156:159], v[16:19], v[232:235], 0
    v_mfma_f32_16x16x32_bf16 v[160:163], v[40:43], v[232:235], 0
    ds_read_b128 v[232:235], v7 offset:41984
    s_waitcnt lgkmcnt(3)
    v_mfma_f32_16x16x32_bf16 v[156:159], v[20:23], v[236:239], v[156:159]
    v_mfma_f32_16x16x32_bf16 v[160:163], v[44:47], v[236:239], v[160:163]
    v_xor_b32 v246, 32, v250
    ds_read_b128 v[236:239], v7 offset:51200
    v_xor_b32 v247, 32, v251
    s_waitcnt lgkmcnt(3)
    v_mfma_f32_16x16x32_bf16 v[156:159], v[24:27], v[224:227], v[156:159]
    v_mfma_f32_16x16x32_bf16 v[160:163], v[48:51], v[224:227], v[160:163]
    s_waitcnt vmcnt(10)
    ds_read_b128 v[224:227], v7 offset:6144
    ds_read_b64 v[64:65], v250 offset:0
    s_waitcnt lgkmcnt(4)
    v_mfma_f32_16x16x32_bf16 v[156:159], v[28:31], v[228:231], v[156:159]
    v_mfma_f32_16x16x32_bf16 v[160:163], v[52:55], v[228:231], v[160:163]
    ds_read_b64 v[66:67], v246 offset:0
    ds_read_b128 v[228:231], v7 offset:15360
    ds_read_b64 v[68:69], v251 offset:0
    s_waitcnt lgkmcnt(6)
    v_mfma_f32_16x16x32_bf16 v[156:159], v[32:35], v[232:235], v[156:159]
    v_mfma_f32_16x16x32_bf16 v[160:163], v[56:59], v[232:235], v[160:163]
    ds_read_b64 v[70:71], v247 offset:0
    ds_read_b128 v[232:235], v7 offset:24576
    s_waitcnt vmcnt(8)
    s_waitcnt lgkmcnt(7)
    v_mfma_f32_16x16x32_bf16 v[156:159], v[36:39], v[236:239], v[156:159]
    v_mfma_f32_16x16x32_bf16 v[160:163], v[60:63], v[236:239], v[160:163]
    ds_read_b64 v[88:89], v250 offset:6144
    ds_read_b128 v[236:239], v7 offset:33792
    ds_read_b64 v[90:91], v246 offset:6144
    s_waitcnt lgkmcnt(9)
    v_mfma_f32_16x16x32_bf16 v[164:167], v[16:19], v[224:227], 0
    v_mfma_f32_16x16x32_bf16 v[168:171], v[40:43], v[224:227], 0
    ds_read_b64 v[92:93], v251 offset:6144
    ds_read_b128 v[224:227], v7 offset:43008
    ds_read_b64 v[94:95], v247 offset:6144
    s_waitcnt lgkmcnt(9)
    v_mfma_f32_16x16x32_bf16 v[164:167], v[20:23], v[228:231], v[164:167]
    v_mfma_f32_16x16x32_bf16 v[168:171], v[44:47], v[228:231], v[168:171]
    s_waitcnt vmcnt(6)
    ds_read_b128 v[228:231], v7 offset:52224
    ds_read_b64 v[72:73], v250 offset:2048
    s_waitcnt lgkmcnt(8)
    v_mfma_f32_16x16x32_bf16 v[164:167], v[24:27], v[232:235], v[164:167]
    v_mfma_f32_16x16x32_bf16 v[168:171], v[48:51], v[232:235], v[168:171]
    ds_read_b64 v[74:75], v246 offset:2048
    ds_read_b128 v[232:235], v7 offset:7168
    ds_read_b64 v[76:77], v251 offset:2048
    s_waitcnt lgkmcnt(9)
    v_mfma_f32_16x16x32_bf16 v[164:167], v[28:31], v[236:239], v[164:167]
    v_mfma_f32_16x16x32_bf16 v[168:171], v[52:55], v[236:239], v[168:171]
    ds_read_b64 v[78:79], v247 offset:2048
    ds_read_b128 v[236:239], v7 offset:16384
    s_waitcnt vmcnt(4)
    s_waitcnt lgkmcnt(8)
    v_mfma_f32_16x16x32_bf16 v[164:167], v[32:35], v[224:227], v[164:167]
    v_mfma_f32_16x16x32_bf16 v[168:171], v[56:59], v[224:227], v[168:171]
    ds_read_b64 v[96:97], v250 offset:8192
    ds_read_b128 v[224:227], v7 offset:25600
    ds_read_b64 v[98:99], v246 offset:8192
    s_waitcnt lgkmcnt(9)
    v_mfma_f32_16x16x32_bf16 v[164:167], v[36:39], v[228:231], v[164:167]
    v_mfma_f32_16x16x32_bf16 v[168:171], v[60:63], v[228:231], v[168:171]
    ds_read_b64 v[100:101], v251 offset:8192
    ds_read_b128 v[228:231], v7 offset:34816
    ds_read_b64 v[102:103], v247 offset:8192
    s_waitcnt lgkmcnt(9)
    v_mfma_f32_16x16x32_bf16 v[172:175], v[16:19], v[232:235], 0
    v_mfma_f32_16x16x32_bf16 v[176:179], v[40:43], v[232:235], 0
    s_waitcnt vmcnt(2)
    ds_read_b128 v[232:235], v7 offset:44032
    ds_read_b64 v[80:81], v250 offset:4096
    s_waitcnt lgkmcnt(8)
    v_mfma_f32_16x16x32_bf16 v[172:175], v[20:23], v[236:239], v[172:175]
    v_mfma_f32_16x16x32_bf16 v[176:179], v[44:47], v[236:239], v[176:179]
    ds_read_b64 v[82:83], v246 offset:4096
    ds_read_b128 v[236:239], v7 offset:53248
    ds_read_b64 v[84:85], v251 offset:4096
    s_waitcnt lgkmcnt(9)
    v_mfma_f32_16x16x32_bf16 v[172:175], v[24:27], v[224:227], v[172:175]
    v_mfma_f32_16x16x32_bf16 v[176:179], v[48:51], v[224:227], v[176:179]
    ds_read_b64 v[86:87], v247 offset:4096
    ds_read_b128 v[224:227], v7 offset:8192
    s_waitcnt vmcnt(0)
    s_waitcnt lgkmcnt(8)
    v_mfma_f32_16x16x32_bf16 v[172:175], v[28:31], v[228:231], v[172:175]
    v_mfma_f32_16x16x32_bf16 v[176:179], v[52:55], v[228:231], v[176:179]
    ds_read_b64 v[104:105], v250 offset:10240
    ds_read_b128 v[228:231], v7 offset:17408
    ds_read_b64 v[106:107], v246 offset:10240
    s_waitcnt lgkmcnt(9)
    v_mfma_f32_16x16x32_bf16 v[172:175], v[32:35], v[232:235], v[172:175]
    v_mfma_f32_16x16x32_bf16 v[176:179], v[56:59], v[232:235], v[176:179]
    ds_read_b64 v[108:109], v251 offset:10240
    ds_read_b128 v[232:235], v7 offset:26624
    ds_read_b64 v[110:111], v247 offset:10240
    s_waitcnt lgkmcnt(9)
    v_mfma_f32_16x16x32_bf16 v[172:175], v[36:39], v[236:239], v[172:175]
    v_mfma_f32_16x16x32_bf16 v[176:179], v[60:63], v[236:239], v[176:179]
    ds_read_b128 v[236:239], v7 offset:35840
    s_waitcnt lgkmcnt(7)
    v_mfma_f32_16x16x32_bf16 v[180:183], v[16:19], v[224:227], 0
    v_mfma_f32_16x16x32_bf16 v[184:187], v[40:43], v[224:227], 0
    ds_read_b128 v[224:227], v7 offset:45056
    s_waitcnt lgkmcnt(6)
    v_mfma_f32_16x16x32_bf16 v[180:183], v[20:23], v[228:231], v[180:183]
    v_mfma_f32_16x16x32_bf16 v[184:187], v[44:47], v[228:231], v[184:187]
    ds_read_b128 v[228:231], v7 offset:54272
    s_waitcnt lgkmcnt(4)
    v_mfma_f32_16x16x32_bf16 v[180:183], v[24:27], v[232:235], v[180:183]
    v_mfma_f32_16x16x32_bf16 v[184:187], v[48:51], v[232:235], v[184:187]
    s_waitcnt lgkmcnt(2)
    v_mfma_f32_16x16x32_bf16 v[180:183], v[28:31], v[236:239], v[180:183]
    v_mfma_f32_16x16x32_bf16 v[184:187], v[52:55], v[236:239], v[184:187]
    s_waitcnt lgkmcnt(1)
    v_mfma_f32_16x16x32_bf16 v[180:183], v[32:35], v[224:227], v[180:183]
    v_mfma_f32_16x16x32_bf16 v[184:187], v[56:59], v[224:227], v[184:187]
    s_waitcnt lgkmcnt(0)
    v_mfma_f32_16x16x32_bf16 v[180:183], v[36:39], v[228:231], v[180:183]
    v_mfma_f32_16x16x32_bf16 v[184:187], v[60:63], v[228:231], v[184:187]
    ds_read_b128 v[224:227], v7 offset:0
    ds_read_b128 v[228:231], v7 offset:9216
    ds_read_b128 v[232:235], v7 offset:18432
    ds_read_b128 v[236:239], v7 offset:27648
    s_add_u32 m0, s57, 0
    s_mov_b32 s40, 0
    buffer_load_dwordx4 v252, s[28:31], s40 offen offset:0 nt lds
    s_waitcnt lgkmcnt(3)
    v_mfma_f32_16x16x32_bf16 v[16:19], v[64:67], v[224:227], 0
    v_mfma_f32_16x16x32_bf16 v[20:23], v[88:91], v[224:227], 0
    ds_read_b128 v[224:227], v7 offset:36864
    v_max3_f32 v212, v116, v117, v118
    s_waitcnt lgkmcnt(3)
    v_mfma_f32_16x16x32_bf16 v[16:19], v[68:71], v[228:231], v[16:19]
    v_mfma_f32_16x16x32_bf16 v[20:23], v[92:95], v[228:231], v[20:23]
    v_max3_f32 v212, v212, v119, v120
    ds_read_b128 v[228:231], v7 offset:46080
    s_waitcnt lgkmcnt(3)
    v_mfma_f32_16x16x32_bf16 v[16:19], v[72:75], v[232:235], v[16:19]
    v_max3_f32 v212, v212, v121, v122
    s_add_u32 m0, s57, 896
    s_mov_b32 s40, 0
    buffer_load_dwordx4 v252, s[28:31], s40 offen offset:128 nt lds
    v_mfma_f32_16x16x32_bf16 v[20:23], v[96:99], v[232:235], v[20:23]
    ds_read_b128 v[232:235], v7 offset:1024
    v_max_f32 v212, v212, v123
    s_waitcnt lgkmcnt(3)
    v_mfma_f32_16x16x32_bf16 v[16:19], v[76:79], v[236:239], v[16:19]
    v_mfma_f32_16x16x32_bf16 v[20:23], v[100:103], v[236:239], v[20:23]
    v_max3_f32 v213, v124, v125, v126
    ds_read_b128 v[236:239], v7 offset:10240
    s_waitcnt lgkmcnt(3)
    v_mfma_f32_16x16x32_bf16 v[16:19], v[80:83], v[224:227], v[16:19]
    v_max3_f32 v213, v213, v127, v128
    v_mfma_f32_16x16x32_bf16 v[20:23], v[104:107], v[224:227], v[20:23]
    ds_read_b128 v[224:227], v7 offset:19456
    v_max3_f32 v213, v213, v129, v130
    s_add_u32 m0, s57, 1792
    s_mov_b32 s40, 0
    buffer_load_dwordx4 v252, s[28:31], s40 offen offset:256 nt lds
    s_waitcnt lgkmcnt(3)
    v_mfma_f32_16x16x32_bf16 v[16:19], v[84:87], v[228:231], v[16:19]
    v_mfma_f32_16x16x32_bf16 v[20:23], v[108:111], v[228:231], v[20:23]
    ds_read_b128 v[228:231], v7 offset:28672
    v_max_f32 v213, v213, v131
    s_waitcnt lgkmcnt(3)
    v_mfma_f32_16x16x32_bf16 v[24:27], v[64:67], v[232:235], 0
    v_mfma_f32_16x16x32_bf16 v[28:31], v[88:91], v[232:235], 0
    v_max3_f32 v214, v132, v133, v134
    ds_read_b128 v[232:235], v7 offset:37888
    s_waitcnt lgkmcnt(3)
    v_mfma_f32_16x16x32_bf16 v[24:27], v[68:71], v[236:239], v[24:27]
    v_max3_f32 v214, v214, v135, v136
    v_mfma_f32_16x16x32_bf16 v[28:31], v[92:95], v[236:239], v[28:31]
    s_add_u32 m0, s57, 3072
    s_mov_b32 s40, 3072
    buffer_load_dwordx4 v252, s[28:31], s40 offen offset:0 nt lds
    ds_read_b128 v[236:239], v7 offset:47104
    v_max3_f32 v214, v214, v137, v138
    s_waitcnt lgkmcnt(3)
    v_mfma_f32_16x16x32_bf16 v[24:27], v[72:75], v[224:227], v[24:27]
    v_mfma_f32_16x16x32_bf16 v[28:31], v[96:99], v[224:227], v[28:31]
    v_max_f32 v214, v214, v139
    ds_read_b128 v[224:227], v7 offset:2048
    s_waitcnt lgkmcnt(3)
    v_mfma_f32_16x16x32_bf16 v[24:27], v[76:79], v[228:231], v[24:27]
    v_max3_f32 v215, v140, v141, v142
    v_mfma_f32_16x16x32_bf16 v[28:31], v[100:103], v[228:231], v[28:31]
    ds_read_b128 v[228:231], v7 offset:11264
    v_max3_f32 v215, v215, v143, v144
    s_waitcnt lgkmcnt(3)
    v_mfma_f32_16x16x32_bf16 v[24:27], v[80:83], v[232:235], v[24:27]
    s_add_u32 m0, s57, 3968
    s_mov_b32 s40, 3072
    buffer_load_dwordx4 v252, s[28:31], s40 offen offset:128 nt lds
    v_mfma_f32_16x16x32_bf16 v[28:31], v[104:107], v[232:235], v[28:31]
    v_max3_f32 v215, v215, v145, v146
    ds_read_b128 v[232:235], v7 offset:20480
    s_waitcnt lgkmcnt(3)
    v_mfma_f32_16x16x32_bf16 v[24:27], v[84:87], v[236:239], v[24:27]
    v_max_f32 v215, v215, v147
    v_mfma_f32_16x16x32_bf16 v[28:31], v[108:111], v[236:239], v[28:31]
    ds_read_b128 v[236:239], v7 offset:29696
    s_waitcnt lgkmcnt(3)
    v_mfma_f32_16x16x32_bf16 v[32:35], v[64:67], v[224:227], 0
    v_max3_f32 v216, v148, v149, v150
    v_mfma_f32_16x16x32_bf16 v[36:39], v[88:91], v[224:227], 0
    ds_read_b128 v[224:227], v7 offset:38912
    v_max3_f32 v216, v216, v151, v152
    s_add_u32 m0, s57, 4864
    s_mov_b32 s40, 3072
    buffer_load_dwordx4 v252, s[28:31], s40 offen offset:256 nt lds
    s_waitcnt lgkmcnt(3)
    v_mfma_f32_16x16x32_bf16 v[32:35], v[68:71], v[228:231], v[32:35]
    v_mfma_f32_16x16x32_bf16 v[36:39], v[92:95], v[228:231], v[36:39]
    v_max3_f32 v216, v216, v153, v154
    ds_read_b128 v[228:231], v7 offset:48128
    s_waitcnt lgkmcnt(3)
    v_mfma_f32_16x16x32_bf16 v[32:35], v[72:75], v[232:235], v[32:35]
    v_max_f32 v216, v216, v155
    v_mfma_f32_16x16x32_bf16 v[36:39], v[96:99], v[232:235], v[36:39]
    ds_read_b128 v[232:235], v7 offset:3072
    v_max3_f32 v217, v156, v157, v158
    s_waitcnt lgkmcnt(3)
    v_mfma_f32_16x16x32_bf16 v[32:35], v[76:79], v[236:239], v[32:35]
    v_mfma_f32_16x16x32_bf16 v[36:39], v[100:103], v[236:239], v[36:39]
    v_max3_f32 v217, v217, v159, v160
    s_add_u32 m0, s57, 6144
    s_mov_b32 s40, 6144
    buffer_load_dwordx4 v252, s[28:31], s40 offen offset:0 nt lds
    ds_read_b128 v[236:239], v7 offset:12288
    s_waitcnt lgkmcnt(3)
    v_mfma_f32_16x16x32_bf16 v[32:35], v[80:83], v[224:227], v[32:35]
    v_max3_f32 v217, v217, v161, v162
    v_mfma_f32_16x16x32_bf16 v[36:39], v[104:107], v[224:227], v[36:39]
    ds_read_b128 v[224:227], v7 offset:21504
    v_max_f32 v217, v217, v163
    s_waitcnt lgkmcnt(3)
    v_mfma_f32_16x16x32_bf16 v[32:35], v[84:87], v[228:231], v[32:35]
    v_mfma_f32_16x16x32_bf16 v[36:39], v[108:111], v[228:231], v[36:39]
    ds_read_b128 v[228:231], v7 offset:30720
    v_max3_f32 v218, v164, v165, v166
    s_waitcnt lgkmcnt(3)
    v_mfma_f32_16x16x32_bf16 v[40:43], v[64:67], v[232:235], 0
    s_add_u32 m0, s57, 7040
    s_mov_b32 s40, 6144
    buffer_load_dwordx4 v252, s[28:31], s40 offen offset:128 nt lds
    v_mfma_f32_16x16x32_bf16 v[44:47], v[88:91], v[232:235], 0
    v_max3_f32 v218, v218, v167, v168
    ds_read_b128 v[232:235], v7 offset:39936
    s_waitcnt lgkmcnt(3)
    v_mfma_f32_16x16x32_bf16 v[40:43], v[68:71], v[236:239], v[40:43]
    v_max3_f32 v218, v218, v169, v170
    v_mfma_f32_16x16x32_bf16 v[44:47], v[92:95], v[236:239], v[44:47]
    ds_read_b128 v[236:239], v7 offset:49152
    v_max_f32 v218, v218, v171
    s_waitcnt lgkmcnt(3)
    v_mfma_f32_16x16x32_bf16 v[40:43], v[72:75], v[224:227], v[40:43]
    v_mfma_f32_16x16x32_bf16 v[44:47], v[96:99], v[224:227], v[44:47]
    v_max3_f32 v219, v172, v173, v174
    ds_read_b128 v[224:227], v7 offset:4096
    s_add_u32 m0, s57, 7936
    s_mov_b32 s40, 6144
    buffer_load_dwordx4 v252, s[28:31], s40 offen offset:256 nt lds
    s_waitcnt lgkmcnt(3)
    v_mfma_f32_16x16x32_bf16 v[40:43], v[76:79], v[228:231], v[40:43]
    v_max3_f32 v219, v219, v175, v176
    v_mfma_f32_16x16x32_bf16 v[44:47], v[100:103], v[228:231], v[44:47]
    ds_read_b128 v[228:231], v7 offset:13312
    v_max3_f32 v219, v219, v177, v178
    s_waitcnt lgkmcnt(3)
    v_mfma_f32_16x16x32_bf16 v[40:43], v[80:83], v[232:235], v[40:43]
    v_mfma_f32_16x16x32_bf16 v[44:47], v[104:107], v[232:235], v[44:47]
    v_max_f32 v219, v219, v179
    ds_read_b128 v[232:235], v7 offset:22528
    s_waitcnt lgkmcnt(3)
    v_mfma_f32_16x16x32_bf16 v[40:43], v[84:87], v[236:239], v[40:43]
    v_mfma_f32_16x16x32_bf16 v[44:47], v[108:111], v[236:239], v[44:47]
    v_max3_f32 v220, v180, v181, v182
    s_add_u32 m0, s57, 9216
    s_mov_b32 s40, 9216
    buffer_load_dwordx4 v252, s[28:31], s40 offen offset:0 nt lds
    ds_read_b128 v[236:239], v7 offset:31744
    s_waitcnt lgkmcnt(3)
    v_mfma_f32_16x16x32_bf16 v[48:51], v[64:67], v[224:227], 0
    v_max3_f32 v220, v220, v183, v184
    v_mfma_f32_16x16x32_bf16 v[52:55], v[88:91], v[224:227], 0
    ds_read_b128 v[224:227], v7 offset:40960
    v_max3_f32 v220, v220, v185, v186
    s_waitcnt lgkmcnt(3)
    v_mfma_f32_16x16x32_bf16 v[48:51], v[68:71], v[228:231], v[48:51]
    v_mfma_f32_16x16x32_bf16 v[52:55], v[92:95], v[228:231], v[52:55]
    v_max_f32 v220, v220, v187
    ds_read_b128 v[228:231], v7 offset:50176
    s_waitcnt lgkmcnt(3)
    v_mfma_f32_16x16x32_bf16 v[48:51], v[72:75], v[232:235], v[48:51]
    v_max3_f32 v212, v212, v16, v17
    s_add_u32 m0, s57, 10112
    s_mov_b32 s40, 9216
    buffer_load_dwordx4 v252, s[28:31], s40 offen offset:128 nt lds
    v_mfma_f32_16x16x32_bf16 v[52:55], v[96:99], v[232:235], v[52:55]
    ds_read_b128 v[232:235], v7 offset:5120
    v_max3_f32 v212, v212, v18, v19
    s_waitcnt lgkmcnt(3)
    v_mfma_f32_16x16x32_bf16 v[48:51], v[76:79], v[236:239], v[48:51]
    v_mfma_f32_16x16x32_bf16 v[52:55], v[100:103], v[236:239], v[52:55]
    v_max3_f32 v212, v212, v20, v21
    ds_read_b128 v[236:239], v7 offset:14336
    s_waitcnt lgkmcnt(3)
    v_mfma_f32_16x16x32_bf16 v[48:51], v[80:83], v[224:227], v[48:51]
    v_max3_f32 v212, v212, v22, v23
    v_mfma_f32_16x16x32_bf16 v[52:55], v[104:107], v[224:227], v[52:55]
    ds_read_b128 v[224:227], v7 offset:23552
    v_max3_f32 v213, v213, v24, v25
    s_add_u32 m0, s57, 11008
    s_mov_b32 s40, 9216
    buffer_load_dwordx4 v252, s[28:31], s40 offen offset:256 nt lds
    s_waitcnt lgkmcnt(3)
    v_mfma_f32_16x16x32_bf16 v[48:51], v[84:87], v[228:231], v[48:51]
    v_mfma_f32_16x16x32_bf16 v[52:55], v[108:111], v[228:231], v[52:55]
    v_max3_f32 v213, v213, v26, v27
    ds_read_b128 v[228:231], v7 offset:32768
    s_waitcnt lgkmcnt(3)
    v_mfma_f32_16x16x32_bf16 v[56:59], v[64:67], v[232:235], 0
    v_max3_f32 v213, v213, v28, v29
    v_mfma_f32_16x16x32_bf16 v[60:63], v[88:91], v[232:235], 0
    ds_read_b128 v[232:235], v7 offset:41984
    v_max3_f32 v213, v213, v30, v31
    s_waitcnt lgkmcnt(3)
    v_mfma_f32_16x16x32_bf16 v[56:59], v[68:71], v[236:239], v[56:59]
    v_mfma_f32_16x16x32_bf16 v[60:63], v[92:95], v[236:239], v[60:63]
    v_max3_f32 v214, v214, v32, v33
    ds_read_b128 v[236:239], v7 offset:51200
    s_waitcnt lgkmcnt(3)
    v_mfma_f32_16x16x32_bf16 v[56:59], v[72:75], v[224:227], v[56:59]
    v_max3_f32 v214, v214, v34, v35
    v_mfma_f32_16x16x32_bf16 v[60:63], v[96:99], v[224:227], v[60:63]
    ds_read_b128 v[224:227], v7 offset:6144
    v_max3_f32 v214, v214, v36, v37
    s_waitcnt lgkmcnt(3)
    v_mfma_f32_16x16x32_bf16 v[56:59], v[76:79], v[228:231], v[56:59]
    v_mfma_f32_16x16x32_bf16 v[60:63], v[100:103], v[228:231], v[60:63]
    v_max3_f32 v214, v214, v38, v39
    ds_read_b128 v[228:231], v7 offset:15360
    s_waitcnt lgkmcnt(3)
    v_mfma_f32_16x16x32_bf16 v[56:59], v[80:83], v[232:235], v[56:59]
    v_max3_f32 v215, v215, v40, v41
    v_mfma_f32_16x16x32_bf16 v[60:63], v[104:107], v[232:235], v[60:63]
    ds_read_b128 v[232:235], v7 offset:24576
    v_max3_f32 v215, v215, v42, v43
    s_waitcnt lgkmcnt(3)
    v_mfma_f32_16x16x32_bf16 v[56:59], v[84:87], v[236:239], v[56:59]
    v_mfma_f32_16x16x32_bf16 v[60:63], v[108:111], v[236:239], v[60:63]
    v_max3_f32 v215, v215, v44, v45
    ds_read_b128 v[236:239], v7 offset:33792
    s_waitcnt lgkmcnt(3)
    v_mfma_f32_16x16x32_bf16 v[188:191], v[64:67], v[224:227], 0
    v_max3_f32 v215, v215, v46, v47
    v_mfma_f32_16x16x32_bf16 v[192:195], v[88:91], v[224:227], 0
    ds_read_b128 v[224:227], v7 offset:43008
    v_max3_f32 v216, v216, v48, v49
    s_waitcnt lgkmcnt(3)
    v_mfma_f32_16x16x32_bf16 v[188:191], v[68:71], v[228:231], v[188:191]
    v_mfma_f32_16x16x32_bf16 v[192:195], v[92:95], v[228:231], v[192:195]
    v_max3_f32 v216, v216, v50, v51
    ds_read_b128 v[228:231], v7 offset:52224
    s_waitcnt lgkmcnt(3)
    v_mfma_f32_16x16x32_bf16 v[188:191], v[72:75], v[232:235], v[188:191]
    v_max3_f32 v216, v216, v52, v53
    v_mfma_f32_16x16x32_bf16 v[192:195], v[96:99], v[232:235], v[192:195]
    ds_read_b128 v[232:235], v7 offset:7168
    v_max3_f32 v216, v216, v54, v55
    s_waitcnt lgkmcnt(3)
    v_mfma_f32_16x16x32_bf16 v[188:191], v[76:79], v[236:239], v[188:191]
    v_mfma_f32_16x16x32_bf16 v[192:195], v[100:103], v[236:239], v[192:195]
    v_max3_f32 v217, v217, v56, v57
    ds_read_b128 v[236:239], v7 offset:16384
    s_waitcnt lgkmcnt(3)
    v_mfma_f32_16x16x32_bf16 v[188:191], v[80:83], v[224:227], v[188:191]
    v_max3_f32 v217, v217, v58, v59
    v_mfma_f32_16x16x32_bf16 v[192:195], v[104:107], v[224:227], v[192:195]
    ds_read_b128 v[224:227], v7 offset:25600
    v_max3_f32 v217, v217, v60, v61
    s_waitcnt lgkmcnt(3)
    v_mfma_f32_16x16x32_bf16 v[188:191], v[84:87], v[228:231], v[188:191]
    v_mfma_f32_16x16x32_bf16 v[192:195], v[108:111], v[228:231], v[192:195]
    v_max3_f32 v217, v217, v62, v63
    ds_read_b128 v[228:231], v7 offset:34816
    s_waitcnt lgkmcnt(3)
    v_mfma_f32_16x16x32_bf16 v[196:199], v[64:67], v[232:235], 0
    v_mfma_f32_16x16x32_bf16 v[200:203], v[88:91], v[232:235], 0
    ds_read_b128 v[232:235], v7 offset:44032
    s_waitcnt lgkmcnt(3)
    v_mfma_f32_16x16x32_bf16 v[196:199], v[68:71], v[236:239], v[196:199]
    v_mfma_f32_16x16x32_bf16 v[200:203], v[92:95], v[236:239], v[200:203]
    ds_read_b128 v[236:239], v7 offset:53248
    v_max3_f32 v218, v218, v188, v189
    s_waitcnt lgkmcnt(3)
    v_mfma_f32_16x16x32_bf16 v[196:199], v[72:75], v[224:227], v[196:199]
    v_mfma_f32_16x16x32_bf16 v[200:203], v[96:99], v[224:227], v[200:203]
    v_max3_f32 v218, v218, v190, v191
    ds_read_b128 v[224:227], v7 offset:8192
    s_waitcnt lgkmcnt(3)
    v_mfma_f32_16x16x32_bf16 v[196:199], v[76:79], v[228:231], v[196:199]
    v_max3_f32 v218, v218, v192, v193
    v_mfma_f32_16x16x32_bf16 v[200:203], v[100:103], v[228:231], v[200:203]
    v_max3_f32 v218, v218, v194, v195
    ds_read_b128 v[228:231], v7 offset:17408
    s_waitcnt lgkmcnt(3)
    v_mfma_f32_16x16x32_bf16 v[196:199], v[80:83], v[232:235], v[196:199]
    v_mfma_f32_16x16x32_bf16 v[200:203], v[104:107], v[232:235], v[200:203]
    ds_read_b128 v[232:235], v7 offset:26624
    s_waitcnt lgkmcnt(3)
    v_mfma_f32_16x16x32_bf16 v[196:199], v[84:87], v[236:239], v[196:199]
    v_mfma_f32_16x16x32_bf16 v[200:203], v[108:111], v[236:239], v[200:203]
    ds_read_b128 v[236:239], v7 offset:35840
    s_waitcnt lgkmcnt(3)
    v_mfma_f32_16x16x32_bf16 v[204:207], v[64:67], v[224:227], 0
    v_mfma_f32_16x16x32_bf16 v[208:211], v[88:91], v[224:227], 0
    ds_read_b128 v[224:227], v7 offset:45056
    s_waitcnt lgkmcnt(3)
    v_mfma_f32_16x16x32_bf16 v[204:207], v[68:71], v[228:231], v[204:207]
    v_mfma_f32_16x16x32_bf16 v[208:211], v[92:95], v[228:231], v[208:211]
    ds_read_b128 v[228:231], v7 offset:54272
    v_max3_f32 v219, v219, v196, v197
    s_waitcnt lgkmcnt(3)
    v_mfma_f32_16x16x32_bf16 v[204:207], v[72:75], v[232:235], v[204:207]
    v_max3_f32 v219, v219, v198, v199
    v_mfma_f32_16x16x32_bf16 v[208:211], v[96:99], v[232:235], v[208:211]
    s_waitcnt lgkmcnt(2)
    v_mfma_f32_16x16x32_bf16 v[204:207], v[76:79], v[236:239], v[204:207]
    v_max3_f32 v219, v219, v200, v201
    v_mfma_f32_16x16x32_bf16 v[208:211], v[100:103], v[236:239], v[208:211]
    s_waitcnt lgkmcnt(1)
    v_mfma_f32_16x16x32_bf16 v[204:207], v[80:83], v[224:227], v[204:207]
    v_max3_f32 v219, v219, v202, v203
    v_mfma_f32_16x16x32_bf16 v[208:211], v[104:107], v[224:227], v[208:211]
    s_waitcnt lgkmcnt(0)
    v_mfma_f32_16x16x32_bf16 v[204:207], v[84:87], v[228:231], v[204:207]
    v_mfma_f32_16x16x32_bf16 v[208:211], v[108:111], v[228:231], v[208:211]
    s_nop 6
    v_max3_f32 v220, v220, v204, v205
    v_max3_f32 v220, v220, v206, v207
    v_max3_f32 v220, v220, v208, v209
    v_max3_f32 v220, v220, v210, v211
    ds_max_f32 v243, v212 offset:0
    ds_max_f32 v243, v213 offset:64
    ds_max_f32 v243, v214 offset:128
    ds_max_f32 v243, v215 offset:192
    ds_max_f32 v243, v216 offset:256
    ds_max_f32 v243, v217 offset:320
    ds_max_f32 v243, v218 offset:384
    ds_max_f32 v243, v219 offset:448
    ds_max_f32 v243, v220 offset:512
    v_mov_b32 v112, v252
    s_and_b32 s42, s36, 2
    s_lshr_b32 s50, 2, s42
    s_and_b32 s50, s50, 3
    s_lshl_b32 s50, s50, 1
    s_and_b32 s42, s36, 1
    s_add_u32 s50, s50, s42
    s_mul_i32 s50, s50, 12288
    s_add_u32 s50, s50, 55296
    s_mul_i32 s41, s53, 983040
    s_mul_i32 s42, s47, 320
    s_add_u32 s41, s41, s42
    s_add_u32 s16, s14, s41
    s_addc_u32 s17, s15, 0
    s_mov_b32 s18, 7864320
    s_mov_b32 s19, 0x20000
    s_sub_u32 s18, s18, s41
    s_mov_b32 s89, 81920
    s_lshl_b32 s43, s36, 4
    s_mov_b32 s42, 52429
    v_add_u32 v252, 0, v1
    v_mul_lo_u32 v253, v252, s42
    v_lshrrev_b32 v253, 20, v253
    v_mul_u32_u24 v244, 20, v253
    v_sub_u32 v244, v252, v244
    v_bfe_u32 v245, v253, 2, 1
    v_lshlrev_b32 v245, 1, v245
    v_xor_b32 v244, v244, v245
    v_add_u32 v253, s43, v253
    v_mul_u32_u24 v253, 1280, v253
    v_lshl_add_u32 v2, v244, 4, v253
    v_add_u32 v252, 64, v1
    v_mul_lo_u32 v253, v252, s42
    v_lshrrev_b32 v253, 20, v253
    v_mul_u32_u24 v244, 20, v253
    v_sub_u32 v244, v252, v244
    v_bfe_u32 v245, v253, 2, 1
    v_lshlrev_b32 v245, 1, v245
    v_xor_b32 v244, v244, v245
    v_add_u32 v253, s43, v253
    v_mul_u32_u24 v253, 1280, v253
    v_lshl_add_u32 v3, v244, 4, v253
    v_add_u32 v252, 128, v1
    v_mul_lo_u32 v253, v252, s42
    v_lshrrev_b32 v253, 20, v253
    v_mul_u32_u24 v244, 20, v253
    v_sub_u32 v244, v252, v244
    v_bfe_u32 v245, v253, 2, 1
    v_lshlrev_b32 v245, 1, v245
    v_xor_b32 v244, v244, v245
    v_add_u32 v253, s43, v253
    v_mul_u32_u24 v253, 1280, v253
    v_lshl_add_u32 v4, v244, 4, v253
    v_add_u32 v252, 192, v1
    v_mul_lo_u32 v253, v252, s42
    v_lshrrev_b32 v253, 20, v253
    v_mul_u32_u24 v244, 20, v253
    v_sub_u32 v244, v252, v244
    v_bfe_u32 v245, v253, 2, 1
    v_lshlrev_b32 v245, 1, v245
    v_xor_b32 v244, v244, v245
    v_add_u32 v253, s43, v253
    v_mul_u32_u24 v253, 1280, v253
    v_lshl_add_u32 v5, v244, 4, v253
    v_add_u32 v252, 256, v1
    v_mul_lo_u32 v253, v252, s42
    v_lshrrev_b32 v253, 20, v253
    v_mul_u32_u24 v244, 20, v253
    v_sub_u32 v244, v252, v244
    v_bfe_u32 v245, v253, 2, 1
    v_lshlrev_b32 v245, 1, v245
    v_xor_b32 v244, v244, v245
    v_add_u32 v253, s43, v253
    v_mul_u32_u24 v253, 1280, v253
    v_lshl_add_u32 v7, v244, 4, v253
    s_and_b32 s100, s36, 1
    s_mul_i32 s100, s100, 3
    s_bfe_u32 s99, s36, 0x10001
    s_mul_i32 s99, s99, 5
    s_lshr_b32 s41, s36, 1
    s_mul_i32 s41, s41, 40960
    s_mov_b32 s81, s41
    s_add_u32 s82, s41, 122880
    s_lshl_b32 s41, s41, 1
    s_add_u32 s83, s41, 40960
    s_mul_i32 s98, s49, 5120
    s_add_u32 s98, s98, 79872
    s_add_u32 s41, s47, 0
    s_and_b32 s41, s41, 3
    s_mul_i32 s94, s41, 245760
    s_add_u32 s41, s47, 1
    s_and_b32 s41, s41, 3
    s_mul_i32 s95, s41, 245760
    s_add_u32 s41, s47, 2
    s_and_b32 s41, s41, 3
    s_mul_i32 s96, s41, 245760
    s_add_u32 s41, s47, 3
    s_and_b32 s41, s41, 3
    s_mul_i32 s97, s41, 245760
    v_lshrrev_b32 v252, 2, v1
    v_mul_u32_u24 v252, 320, v252
    v_and_b32 v253, 3, v1
    v_lshl_add_u32 v252, v253, 3, v252
    v_add_u32 v252, 79872, v252
    v_bfe_u32 v253, v1, 4, 1
    s_add_u32 s42, s100, 0
    v_xor_b32 v244, s42, v253
    v_lshl_add_u32 v248, v244, 5, v252
    s_add_u32 s42, s100, 1
    v_xor_b32 v244, s42, v253
    v_lshl_add_u32 v249, v244, 5, v252
    s_add_u32 s42, s100, 2
    v_xor_b32 v244, s42, v253
    v_lshl_add_u32 v250, v244, 5, v252
    s_lshl_b32 s41, s99, 10
    s_add_u32 s41, s41, 0
    v_lshl_add_u32 v251, v1, 4, s41
    s_lshl_b32 s41, s49, 2
    s_lshr_b32 s41, 42560, s41
    s_and_b32 s41, s41, 15
    s_lshl_b32 s42, s41, 1
    s_and_b32 s42, s42, 0x1c
    s_lshr_b32 s42, 0x352140, s42
    s_and_b32 s42, s42, 15
    s_mul_i32 s43, s42, 9216
    v_add_u32 v254, s43, v240
    s_and_b32 s41, s41, 1
    s_lshl_b32 s42, s42, 1
    s_add_u32 s41, s41, s42
    s_lshr_b32 s42, s41, 2
    s_mul_i32 s42, s42, 20480
    s_bfe_u32 s43, s41, 0x10001
    s_mul_i32 s43, s43, 9216
    s_add_u32 s42, s42, s43
    s_and_b32 s41, s41, 1
    s_lshl_b32 s41, s41, 3
    s_add_u32 s41, s41, s42
    s_add_u32 s41, s41, 0
    v_add_u32 v8, s41, v240
    s_lshl_b32 s41, s49, 2
    s_lshr_b32 s41, 38962, s41
    s_and_b32 s41, s41, 15
    s_lshl_b32 s42, s41, 1
    s_and_b32 s42, s42, 0x1c
    s_lshr_b32 s42, 0x352140, s42
    s_and_b32 s42, s42, 15
    s_and_b32 s41, s41, 1
    s_lshl_b32 s42, s42, 1
    s_add_u32 s41, s41, s42
    s_lshr_b32 s42, s41, 2
    s_mul_i32 s42, s42, 20480
    s_bfe_u32 s43, s41, 0x10001
    s_mul_i32 s43, s43, 9216
    s_add_u32 s42, s42, s43
    s_and_b32 s41, s41, 1
    s_lshl_b32 s41, s41, 3
    s_add_u32 s41, s41, s42
    s_add_u32 s41, s41, 0
    v_add_u32 v255, s41, v240
    s_lshl_b32 s41, s52, 3
    s_add_u32 s41, s41, s53
    s_lshl_b32 s41, s41, 7
    s_add_u32 s41, s41, 29364224
    s_add_u32 s90, s12, s41
    s_addc_u32 s91, s13, 0
    s_lshl_b32 s41, s48, 7
    s_add_u32 s41, s41, 29376512
    s_add_u32 s92, s12, s41
    s_addc_u32 s93, s13, 0
    s_mul_i32 s41, s48, 376832
    s_add_u32 s41, s41, 16777216
    s_add_u32 s24, s12, s41
    s_addc_u32 s25, s13, 0
    s_mov_b32 s26, 376832
    s_mov_b32 s27, 0x20000
    s_mul_i32 s42, s53, 47104
    s_add_u32 s41, s41, s42
    s_add_u32 s20, s12, s41
    s_addc_u32 s21, s13, 0
    s_mov_b32 s22, 47104
    s_mov_b32 s23, 0x20000
    s_mov_b32 s84, s54
    s_mov_b32 s85, s55
    s_mov_b32 s86, 1474560
    s_mov_b32 s87, 0x20000
    s_lshl_b32 s41, s49, 2
    s_add_u32 s41, s41, 154176
    v_mov_b32 v113, s41
    s_mov_b32 s101, 0x100000
    s_waitcnt lgkmcnt(0)
L_vf1:
    ds_read_b32 v114, v113
    s_sub_u32 s101, s101, 1
    s_cbranch_scc1 L_vfd1
    s_waitcnt lgkmcnt(0)
    v_cmp_ne_u32 vcc, 1, v114
    s_nop 4
    s_cbranch_vccz L_vfd1
    s_sleep 1
    s_branch L_vf1
L_vfd1:
    s_waitcnt lgkmcnt(0)
    s_add_u32 m0, s50, 0
    s_mov_b32 s40, 98304
    buffer_load_dwordx4 v112, s[28:31], s40 offen offset:0 nt lds
    s_add_u32 m0, s50, 896
    s_mov_b32 s40, 98304
    buffer_load_dwordx4 v112, s[28:31], s40 offen offset:128 nt lds
    s_add_u32 m0, s50, 1792
    s_mov_b32 s40, 98304
    buffer_load_dwordx4 v112, s[28:31], s40 offen offset:256 nt lds
    s_add_u32 m0, s50, 3072
    s_mov_b32 s40, 101376
    buffer_load_dwordx4 v112, s[28:31], s40 offen offset:0 nt lds
    s_add_u32 m0, s50, 3968
    s_mov_b32 s40, 101376
    buffer_load_dwordx4 v112, s[28:31], s40 offen offset:128 nt lds
    s_add_u32 m0, s50, 4864
    s_mov_b32 s40, 101376
    buffer_load_dwordx4 v112, s[28:31], s40 offen offset:256 nt lds
    s_add_u32 m0, s50, 6144
    s_mov_b32 s40, 104448
    buffer_load_dwordx4 v112, s[28:31], s40 offen offset:0 nt lds
    s_add_u32 m0, s50, 7040
    s_mov_b32 s40, 104448
    buffer_load_dwordx4 v112, s[28:31], s40 offen offset:128 nt lds
    s_add_u32 m0, s50, 7936
    s_mov_b32 s40, 104448
    buffer_load_dwordx4 v112, s[28:31], s40 offen offset:256 nt lds
    s_add_u32 m0, s50, 9216
    s_mov_b32 s40, 107520
    buffer_load_dwordx4 v112, s[28:31], s40 offen offset:0 nt lds
    s_add_u32 m0, s50, 10112
    s_mov_b32 s40, 107520
    buffer_load_dwordx4 v112, s[28:31], s40 offen offset:128 nt lds
    s_add_u32 m0, s50, 11008
    s_mov_b32 s40, 107520
    buffer_load_dwordx4 v112, s[28:31], s40 offen offset:256 nt lds
    s_barrier
    s_branch L_sm0
L_qp00:
    s_barrier
    s_add_u32 m0, s37, 55296
    s_mov_b32 s3, 0
    buffer_load_dwordx4 v3, s[20:23], s3 offen offset:0 lds
    s_add_u32 m0, s37, 56192
    s_nop 0
    buffer_load_dwordx4 v3, s[20:23], s3 offen offset:128 lds
    s_add_u32 m0, s37, 57088
    s_nop 0
    buffer_load_dwordx4 v3, s[20:23], s3 offen offset:256 lds
    s_add_u32 m0, s38, 0
    s_mov_b32 s40, 0
    buffer_load_dwordx4 v2, s[16:19], s40 offen lds
    s_add_u32 m0, s38, 8192
    s_mov_b32 s40, 81920
    buffer_load_dwordx4 v2, s[16:19], s40 offen lds
    s_barrier
    s_add_u32 m0, s37, 79872
    s_mov_b32 s3, 786432
    buffer_load_dwordx4 v3, s[20:23], s3 offen offset:0 lds
    s_add_u32 m0, s37, 80768
    s_nop 0
    buffer_load_dwordx4 v3, s[20:23], s3 offen offset:128 lds
    s_add_u32 m0, s37, 81664
    s_nop 0
    buffer_load_dwordx4 v3, s[20:23], s3 offen offset:256 lds
    s_add_u32 m0, s38, 18432
    s_mov_b32 s40, 128
    buffer_load_dwordx4 v2, s[16:19], s40 offen lds
    s_add_u32 m0, s38, 26624
    s_mov_b32 s40, 82048
    buffer_load_dwordx4 v2, s[16:19], s40 offen lds
    s_add_u32 s32, s12, s35
    s_addc_u32 s33, s13, 0
    s_mov_b32 s34, 55296
    s_mov_b32 s35, 0x20000
    s_mov_b32 s44, 1037384597
    v_lshlrev_b32 v247, 2, v0
    v_add_u32 v247, 153600, v247
    v_mov_b32 v248, 0xff800000
    ds_write_b32 v247, v248
    v_and_b32 v243, 15, v1
    v_lshlrev_b32 v243, 2, v243
    v_add_u32 v243, 153600, v243
    v_add_u32 v7, 0, v7
    v_xor_b32 v8, 64, v7
    s_lshl_b32 s41, s49, 2
    s_lshr_b32 s41, 42560, s41
    s_and_b32 s41, s41, 15
    s_lshr_b32 s42, s41, 2
    s_lshl_b32 s42, s42, 10
    s_add_u32 s42, s42, 55296
    s_and_b32 s41, s41, 3
    v_lshrrev_b32 v244, 4, v1
    v_bfe_u32 v245, v1, 2, 2
    v_and_b32 v246, 1, v244
    v_lshlrev_b32 v246, 1, v246
    v_lshrrev_b32 v247, 1, v245
    v_add_u32 v247, v247, v246
    v_xor_b32 v247, s41, v247
    v_lshlrev_b32 v247, 5, v247
    v_lshlrev_b32 v9, 7, v245
    v_add_u32 v9, v9, v247
    v_mul_u32_u24 v247, 3072, v244
    v_add_u32 v9, v9, v247
    v_and_b32 v247, 3, v1
    v_lshlrev_b32 v247, 3, v247
    v_add_u32 v9, v9, v247
    v_add_u32 v9, s42, v9
    s_lshl_b32 s41, s49, 2
    s_lshr_b32 s41, 46929, s41
    s_and_b32 s41, s41, 15
    s_lshr_b32 s42, s41, 2
    s_lshl_b32 s42, s42, 10
    s_add_u32 s42, s42, 55296
    s_and_b32 s41, s41, 3
    v_lshrrev_b32 v244, 4, v1
    v_bfe_u32 v245, v1, 2, 2
    v_and_b32 v246, 1, v244
    v_lshlrev_b32 v246, 1, v246
    v_lshrrev_b32 v247, 1, v245
    v_add_u32 v247, v247, v246
    v_xor_b32 v247, s41, v247
    v_lshlrev_b32 v247, 5, v247
    v_lshlrev_b32 v10, 7, v245
    v_add_u32 v10, v10, v247
    v_mul_u32_u24 v247, 3072, v244
    v_add_u32 v10, v10, v247
    v_and_b32 v247, 3, v1
    v_lshlrev_b32 v247, 3, v247
    v_add_u32 v10, v10, v247
    v_add_u32 v10, s42, v10
    s_lshl_b32 s41, s49, 2
    s_lshr_b32 s41, 38962, s41
    s_and_b32 s41, s41, 15
    s_lshr_b32 s42, s41, 2
    s_lshl_b32 s42, s42, 10
    s_add_u32 s42, s42, 55296
    s_and_b32 s41, s41, 3
    v_lshrrev_b32 v244, 4, v1
    v_bfe_u32 v245, v1, 2, 2
    v_and_b32 v246, 1, v244
    v_lshlrev_b32 v246, 1, v246
    v_lshrrev_b32 v247, 1, v245
    v_add_u32 v247, v247, v246
    v_xor_b32 v247, s41, v247
    v_lshlrev_b32 v247, 5, v247
    v_lshlrev_b32 v11, 7, v245
    v_add_u32 v11, v11, v247
    v_mul_u32_u24 v247, 3072, v244
    v_add_u32 v11, v11, v247
    v_and_b32 v247, 3, v1
    v_lshlrev_b32 v247, 3, v247
    v_add_u32 v11, v11, v247
    v_add_u32 v11, s42, v11
    s_lshl_b32 s41, s49, 2
    s_lshr_b32 s41, 42560, s41
    s_and_b32 s41, s41, 15
    s_lshr_b32 s42, s41, 1
    s_mul_i32 s42, s42, 9216
    s_and_b32 s41, s41, 1
    s_lshl_b32 s41, s41, 3
    s_add_u32 s41, s41, s42
    s_add_u32 s41, s41, 0
    v_lshl_add_u32 v12, v1, 4, s41
    s_lshl_b32 s41, s49, 2
    s_lshr_b32 s41, 38962, s41
    s_and_b32 s41, s41, 15
    s_lshr_b32 s42, s41, 1
    s_mul_i32 s42, s42, 9216
    s_and_b32 s41, s41, 1
    s_lshl_b32 s41, s41, 3
    s_add_u32 s41, s41, s42
    s_add_u32 s41, s41, 0
    v_lshl_add_u32 v14, v1, 4, s41
    v_lshlrev_b32 v240, 4, v1
    s_lshl_b32 s41, s36, 2
    s_lshr_b32 s42, 0x10543210, s41
    s_and_b32 s42, s42, 15
    s_mul_i32 s42, s42, 9216
    v_add_u32 v242, s42, v240
    v_add_u32 v240, 0, v240
    s_waitcnt vmcnt(5) lgkmcnt(0)
    s_barrier
    s_add_u32 s88, s88, 1
    ds_read_b64_tr_b16 v[176:177], v9 offset:0
    ds_read_b64_tr_b16 v[178:179], v9 offset:512
    ds_read_b128 v[200:203], v7 offset:0
    ds_read_b64_tr_b16 v[180:181], v10 offset:0
    ds_read_b64_tr_b16 v[182:183], v10 offset:512
    ds_read_b64_tr_b16 v[184:185], v11 offset:0
    ds_read_b64_tr_b16 v[186:187], v11 offset:512
    ds_read_b128 v[204:207], v7 offset:2048
    ds_read_b128 v[208:211], v7 offset:4096
    ds_read_b128 v[212:215], v7 offset:6144
    ds_read_b128 v[216:219], v7 offset:8192
    s_waitcnt lgkmcnt(8)
    v_mfma_f32_16x16x32_bf16 v[116:119], v[176:179], v[200:203], 0
    ds_read_b64_tr_b16 v[188:189], v9 offset:12288
    ds_read_b64_tr_b16 v[190:191], v9 offset:12800
    s_add_u32 m0, s37, 104448
    s_mov_b32 s3, 1572864
    buffer_load_dwordx4 v3, s[20:23], s3 offen offset:0 lds
    s_waitcnt lgkmcnt(8)
    v_mfma_f32_16x16x32_bf16 v[120:123], v[180:183], v[200:203], 0
    ds_read_b128 v[220:223], v8 offset:0
    s_waitcnt lgkmcnt(7)
    v_mfma_f32_16x16x32_bf16 v[124:127], v[184:187], v[200:203], 0
    ds_read_b64_tr_b16 v[192:193], v10 offset:12288
    s_waitcnt lgkmcnt(7)
    v_mfma_f32_16x16x32_bf16 v[128:131], v[176:179], v[204:207], 0
    ds_read_b64_tr_b16 v[194:195], v10 offset:12800
    s_add_u32 m0, s37, 105344
    s_nop 0
    buffer_load_dwordx4 v3, s[20:23], s3 offen offset:128 lds
    v_mfma_f32_16x16x32_bf16 v[132:135], v[180:183], v[204:207], 0
    ds_read_b64_tr_b16 v[196:197], v11 offset:12288
    ds_read_b64_tr_b16 v[198:199], v11 offset:12800
    v_mfma_f32_16x16x32_bf16 v[136:139], v[184:187], v[204:207], 0
    ds_read_b128 v[224:227], v8 offset:2048
    s_waitcnt lgkmcnt(10)
    v_mfma_f32_16x16x32_bf16 v[140:143], v[176:179], v[208:211], 0
    ds_read_b128 v[228:231], v8 offset:4096
    s_add_u32 m0, s37, 106240
    s_nop 0
    buffer_load_dwordx4 v3, s[20:23], s3 offen offset:256 lds
    v_mfma_f32_16x16x32_bf16 v[144:147], v[180:183], v[208:211], 0
    ds_read_b128 v[232:235], v8 offset:6144
    v_mfma_f32_16x16x32_bf16 v[148:151], v[184:187], v[208:211], 0
    ds_read_b128 v[236:239], v8 offset:8192
    s_add_u32 m0, s38, 36864
    s_mov_b32 s40, 256
    buffer_load_dwordx4 v2, s[16:19], s40 offen lds
    s_waitcnt lgkmcnt(12)
    v_mfma_f32_16x16x32_bf16 v[152:155], v[176:179], v[212:215], 0
    v_mfma_f32_16x16x32_bf16 v[156:159], v[180:183], v[212:215], 0
    v_mfma_f32_16x16x32_bf16 v[160:163], v[184:187], v[212:215], 0
    s_add_u32 m0, s38, 45056
    s_mov_b32 s40, 82176
    buffer_load_dwordx4 v2, s[16:19], s40 offen lds
    s_waitcnt lgkmcnt(11)
    v_mfma_f32_16x16x32_bf16 v[164:167], v[176:179], v[216:219], 0
    v_mfma_f32_16x16x32_bf16 v[168:171], v[180:183], v[216:219], 0
    v_mfma_f32_16x16x32_bf16 v[172:175], v[184:187], v[216:219], 0
    s_waitcnt vmcnt(5) lgkmcnt(0)
    s_barrier
    v_mfma_f32_16x16x32_bf16 v[116:119], v[188:191], v[220:223], v[116:119]
    ds_read_b64_tr_b16 v[176:177], v9 offset:24576
    ds_read_b64_tr_b16 v[178:179], v9 offset:25088
    v_mfma_f32_16x16x32_bf16 v[120:123], v[192:195], v[220:223], v[120:123]
    s_add_u32 m0, s37, 55296
    s_mov_b32 s3, 2359296
    buffer_load_dwordx4 v3, s[20:23], s3 offen offset:0 lds
    ds_read_b128 v[200:203], v7 offset:18432
    v_mfma_f32_16x16x32_bf16 v[124:127], v[196:199], v[220:223], v[124:127]
    ds_read_b64_tr_b16 v[180:181], v10 offset:24576
    v_mfma_f32_16x16x32_bf16 v[128:131], v[188:191], v[224:227], v[128:131]
    ds_read_b64_tr_b16 v[182:183], v10 offset:25088
    v_mfma_f32_16x16x32_bf16 v[132:135], v[192:195], v[224:227], v[132:135]
    ds_read_b64_tr_b16 v[184:185], v11 offset:24576
    ds_read_b64_tr_b16 v[186:187], v11 offset:25088
    v_mfma_f32_16x16x32_bf16 v[136:139], v[196:199], v[224:227], v[136:139]
    s_add_u32 m0, s37, 56192
    s_nop 0
    buffer_load_dwordx4 v3, s[20:23], s3 offen offset:128 lds
    ds_read_b128 v[204:207], v7 offset:20480
    v_mfma_f32_16x16x32_bf16 v[140:143], v[188:191], v[228:231], v[140:143]
    ds_read_b128 v[208:211], v7 offset:22528
    v_mfma_f32_16x16x32_bf16 v[144:147], v[192:195], v[228:231], v[144:147]
    ds_read_b128 v[212:215], v7 offset:24576
    v_mfma_f32_16x16x32_bf16 v[148:151], v[196:199], v[228:231], v[148:151]
    ds_read_b128 v[216:219], v7 offset:26624
    v_mfma_f32_16x16x32_bf16 v[152:155], v[188:191], v[232:235], v[152:155]
    v_mfma_f32_16x16x32_bf16 v[156:159], v[192:195], v[232:235], v[156:159]
    s_add_u32 m0, s37, 57088
    s_nop 0
    buffer_load_dwordx4 v3, s[20:23], s3 offen offset:256 lds
    v_mfma_f32_16x16x32_bf16 v[160:163], v[196:199], v[232:235], v[160:163]
    v_mfma_f32_16x16x32_bf16 v[164:167], v[188:191], v[236:239], v[164:167]
    v_mfma_f32_16x16x32_bf16 v[168:171], v[192:195], v[236:239], v[168:171]
    v_mfma_f32_16x16x32_bf16 v[172:175], v[196:199], v[236:239], v[172:175]
    s_waitcnt lgkmcnt(0)
    v_mfma_f32_16x16x32_bf16 v[116:119], v[176:179], v[200:203], v[116:119]
    ds_read_b64_tr_b16 v[188:189], v9 offset:36864
    ds_read_b64_tr_b16 v[190:191], v9 offset:37376
    s_add_u32 m0, s38, 0
    s_mov_b32 s40, 384
    buffer_load_dwordx4 v2, s[16:19], s40 offen lds
    v_mfma_f32_16x16x32_bf16 v[120:123], v[180:183], v[200:203], v[120:123]
    ds_read_b128 v[220:223], v8 offset:18432
    v_mfma_f32_16x16x32_bf16 v[124:127], v[184:187], v[200:203], v[124:127]
    ds_read_b64_tr_b16 v[192:193], v10 offset:36864
    v_mfma_f32_16x16x32_bf16 v[128:131], v[176:179], v[204:207], v[128:131]
    ds_read_b64_tr_b16 v[194:195], v10 offset:37376
    v_mfma_f32_16x16x32_bf16 v[132:135], v[180:183], v[204:207], v[132:135]
    ds_read_b64_tr_b16 v[196:197], v11 offset:36864
    ds_read_b64_tr_b16 v[198:199], v11 offset:37376
    v_mfma_f32_16x16x32_bf16 v[136:139], v[184:187], v[204:207], v[136:139]
    ds_read_b128 v[224:227], v8 offset:20480
    v_mfma_f32_16x16x32_bf16 v[140:143], v[176:179], v[208:211], v[140:143]
    ds_read_b128 v[228:231], v8 offset:22528
    v_mfma_f32_16x16x32_bf16 v[144:147], v[180:183], v[208:211], v[144:147]
    ds_read_b128 v[232:235], v8 offset:24576
    s_add_u32 m0, s38, 8192
    s_mov_b32 s40, 82304
    buffer_load_dwordx4 v2, s[16:19], s40 offen lds
    v_mfma_f32_16x16x32_bf16 v[148:151], v[184:187], v[208:211], v[148:151]
    ds_read_b128 v[236:239], v8 offset:26624
    v_mfma_f32_16x16x32_bf16 v[152:155], v[176:179], v[212:215], v[152:155]
    v_mfma_f32_16x16x32_bf16 v[156:159], v[180:183], v[212:215], v[156:159]
    v_mfma_f32_16x16x32_bf16 v[160:163], v[184:187], v[212:215], v[160:163]
    v_mfma_f32_16x16x32_bf16 v[164:167], v[176:179], v[216:219], v[164:167]
    v_mfma_f32_16x16x32_bf16 v[168:171], v[180:183], v[216:219], v[168:171]
    v_mfma_f32_16x16x32_bf16 v[172:175], v[184:187], v[216:219], v[172:175]
    s_waitcnt vmcnt(5) lgkmcnt(0)
    s_barrier
    v_mfma_f32_16x16x32_bf16 v[116:119], v[188:191], v[220:223], v[116:119]
    ds_read_b64_tr_b16 v[176:177], v9 offset:49152
    ds_read_b64_tr_b16 v[178:179], v9 offset:49664
    v_mfma_f32_16x16x32_bf16 v[120:123], v[192:195], v[220:223], v[120:123]
    s_add_u32 m0, s37, 79872
    s_mov_b32 s3, 3145728
    buffer_load_dwordx4 v3, s[20:23], s3 offen offset:0 lds
    ds_read_b128 v[200:203], v7 offset:36864
    v_mfma_f32_16x16x32_bf16 v[124:127], v[196:199], v[220:223], v[124:127]
    ds_read_b64_tr_b16 v[180:181], v10 offset:49152
    v_mfma_f32_16x16x32_bf16 v[128:131], v[188:191], v[224:227], v[128:131]
    ds_read_b64_tr_b16 v[182:183], v10 offset:49664
    v_mfma_f32_16x16x32_bf16 v[132:135], v[192:195], v[224:227], v[132:135]
    ds_read_b64_tr_b16 v[184:185], v11 offset:49152
    ds_read_b64_tr_b16 v[186:187], v11 offset:49664
    v_mfma_f32_16x16x32_bf16 v[136:139], v[196:199], v[224:227], v[136:139]
    s_add_u32 m0, s37, 80768
    s_nop 0
    buffer_load_dwordx4 v3, s[20:23], s3 offen offset:128 lds
    ds_read_b128 v[204:207], v7 offset:38912
    v_mfma_f32_16x16x32_bf16 v[140:143], v[188:191], v[228:231], v[140:143]
    ds_read_b128 v[208:211], v7 offset:40960
    v_mfma_f32_16x16x32_bf16 v[144:147], v[192:195], v[228:231], v[144:147]
    ds_read_b128 v[212:215], v7 offset:43008
    v_mfma_f32_16x16x32_bf16 v[148:151], v[196:199], v[228:231], v[148:151]
    ds_read_b128 v[216:219], v7 offset:45056
    v_mfma_f32_16x16x32_bf16 v[152:155], v[188:191], v[232:235], v[152:155]
    v_mfma_f32_16x16x32_bf16 v[156:159], v[192:195], v[232:235], v[156:159]
    s_add_u32 m0, s37, 81664
    s_nop 0
    buffer_load_dwordx4 v3, s[20:23], s3 offen offset:256 lds
    v_mfma_f32_16x16x32_bf16 v[160:163], v[196:199], v[232:235], v[160:163]
    v_mfma_f32_16x16x32_bf16 v[164:167], v[188:191], v[236:239], v[164:167]
    v_mfma_f32_16x16x32_bf16 v[168:171], v[192:195], v[236:239], v[168:171]
    v_mfma_f32_16x16x32_bf16 v[172:175], v[196:199], v[236:239], v[172:175]
    s_waitcnt lgkmcnt(0)
    v_mfma_f32_16x16x32_bf16 v[116:119], v[176:179], v[200:203], v[116:119]
    ds_read_b64_tr_b16 v[188:189], v9 offset:61440
    ds_read_b64_tr_b16 v[190:191], v9 offset:61952
    s_add_u32 m0, s38, 18432
    s_mov_b32 s40, 512
    buffer_load_dwordx4 v2, s[16:19], s40 offen lds
    v_mfma_f32_16x16x32_bf16 v[120:123], v[180:183], v[200:203], v[120:123]
    ds_read_b128 v[220:223], v8 offset:36864
    v_mfma_f32_16x16x32_bf16 v[124:127], v[184:187], v[200:203], v[124:127]
    ds_read_b64_tr_b16 v[192:193], v10 offset:61440
    v_mfma_f32_16x16x32_bf16 v[128:131], v[176:179], v[204:207], v[128:131]
    ds_read_b64_tr_b16 v[194:195], v10 offset:61952
    v_mfma_f32_16x16x32_bf16 v[132:135], v[180:183], v[204:207], v[132:135]
    ds_read_b64_tr_b16 v[196:197], v11 offset:61440
    ds_read_b64_tr_b16 v[198:199], v11 offset:61952
    v_mfma_f32_16x16x32_bf16 v[136:139], v[184:187], v[204:207], v[136:139]
    ds_read_b128 v[224:227], v8 offset:38912
    v_mfma_f32_16x16x32_bf16 v[140:143], v[176:179], v[208:211], v[140:143]
    ds_read_b128 v[228:231], v8 offset:40960
    v_mfma_f32_16x16x32_bf16 v[144:147], v[180:183], v[208:211], v[144:147]
    ds_read_b128 v[232:235], v8 offset:43008
    s_add_u32 m0, s38, 26624
    s_mov_b32 s40, 82432
    buffer_load_dwordx4 v2, s[16:19], s40 offen lds
    v_mfma_f32_16x16x32_bf16 v[148:151], v[184:187], v[208:211], v[148:151]
    ds_read_b128 v[236:239], v8 offset:45056
    v_mfma_f32_16x16x32_bf16 v[152:155], v[176:179], v[212:215], v[152:155]
    v_mfma_f32_16x16x32_bf16 v[156:159], v[180:183], v[212:215], v[156:159]
    v_mfma_f32_16x16x32_bf16 v[160:163], v[184:187], v[212:215], v[160:163]
    v_mfma_f32_16x16x32_bf16 v[164:167], v[176:179], v[216:219], v[164:167]
    v_mfma_f32_16x16x32_bf16 v[168:171], v[180:183], v[216:219], v[168:171]
    v_mfma_f32_16x16x32_bf16 v[172:175], v[184:187], v[216:219], v[172:175]
    s_waitcnt vmcnt(5) lgkmcnt(0)
    s_barrier
    v_mfma_f32_16x16x32_bf16 v[116:119], v[188:191], v[220:223], v[116:119]
    ds_read_b64_tr_b16 v[176:177], v9 offset:0
    ds_read_b64_tr_b16 v[178:179], v9 offset:512
    v_mfma_f32_16x16x32_bf16 v[120:123], v[192:195], v[220:223], v[120:123]
    s_add_u32 m0, s37, 104448
    s_mov_b32 s3, 3932160
    buffer_load_dwordx4 v3, s[20:23], s3 offen offset:0 lds
    ds_read_b128 v[200:203], v7 offset:0
    v_mfma_f32_16x16x32_bf16 v[124:127], v[196:199], v[220:223], v[124:127]
    ds_read_b64_tr_b16 v[180:181], v10 offset:0
    v_mfma_f32_16x16x32_bf16 v[128:131], v[188:191], v[224:227], v[128:131]
    ds_read_b64_tr_b16 v[182:183], v10 offset:512
    v_mfma_f32_16x16x32_bf16 v[132:135], v[192:195], v[224:227], v[132:135]
    ds_read_b64_tr_b16 v[184:185], v11 offset:0
    ds_read_b64_tr_b16 v[186:187], v11 offset:512
    v_mfma_f32_16x16x32_bf16 v[136:139], v[196:199], v[224:227], v[136:139]
    s_add_u32 m0, s37, 105344
    s_nop 0
    buffer_load_dwordx4 v3, s[20:23], s3 offen offset:128 lds
    ds_read_b128 v[204:207], v7 offset:2048
    v_mfma_f32_16x16x32_bf16 v[140:143], v[188:191], v[228:231], v[140:143]
    ds_read_b128 v[208:211], v7 offset:4096
    v_mfma_f32_16x16x32_bf16 v[144:147], v[192:195], v[228:231], v[144:147]
    ds_read_b128 v[212:215], v7 offset:6144
    v_mfma_f32_16x16x32_bf16 v[148:151], v[196:199], v[228:231], v[148:151]
    ds_read_b128 v[216:219], v7 offset:8192
    v_mfma_f32_16x16x32_bf16 v[152:155], v[188:191], v[232:235], v[152:155]
    v_mfma_f32_16x16x32_bf16 v[156:159], v[192:195], v[232:235], v[156:159]
    s_add_u32 m0, s37, 106240
    s_nop 0
    buffer_load_dwordx4 v3, s[20:23], s3 offen offset:256 lds
    v_mfma_f32_16x16x32_bf16 v[160:163], v[196:199], v[232:235], v[160:163]
    v_mfma_f32_16x16x32_bf16 v[164:167], v[188:191], v[236:239], v[164:167]
    v_mfma_f32_16x16x32_bf16 v[168:171], v[192:195], v[236:239], v[168:171]
    v_mfma_f32_16x16x32_bf16 v[172:175], v[196:199], v[236:239], v[172:175]
    s_waitcnt lgkmcnt(0)
    v_mfma_f32_16x16x32_bf16 v[116:119], v[176:179], v[200:203], v[116:119]
    ds_read_b64_tr_b16 v[188:189], v9 offset:12288
    ds_read_b64_tr_b16 v[190:191], v9 offset:12800
    s_add_u32 m0, s38, 36864
    s_mov_b32 s40, 640
    buffer_load_dwordx4 v2, s[16:19], s40 offen lds
    v_mfma_f32_16x16x32_bf16 v[120:123], v[180:183], v[200:203], v[120:123]
    ds_read_b128 v[220:223], v8 offset:0
    v_mfma_f32_16x16x32_bf16 v[124:127], v[184:187], v[200:203], v[124:127]
    ds_read_b64_tr_b16 v[192:193], v10 offset:12288
    v_mfma_f32_16x16x32_bf16 v[128:131], v[176:179], v[204:207], v[128:131]
    ds_read_b64_tr_b16 v[194:195], v10 offset:12800
    v_mfma_f32_16x16x32_bf16 v[132:135], v[180:183], v[204:207], v[132:135]
    ds_read_b64_tr_b16 v[196:197], v11 offset:12288
    ds_read_b64_tr_b16 v[198:199], v11 offset:12800
    v_mfma_f32_16x16x32_bf16 v[136:139], v[184:187], v[204:207], v[136:139]
    ds_read_b128 v[224:227], v8 offset:2048
    v_mfma_f32_16x16x32_bf16 v[140:143], v[176:179], v[208:211], v[140:143]
    ds_read_b128 v[228:231], v8 offset:4096
    v_mfma_f32_16x16x32_bf16 v[144:147], v[180:183], v[208:211], v[144:147]
    ds_read_b128 v[232:235], v8 offset:6144
    s_add_u32 m0, s38, 45056
    s_mov_b32 s40, 82560
    buffer_load_dwordx4 v2, s[16:19], s40 offen lds
    v_mfma_f32_16x16x32_bf16 v[148:151], v[184:187], v[208:211], v[148:151]
    ds_read_b128 v[236:239], v8 offset:8192
    v_mfma_f32_16x16x32_bf16 v[152:155], v[176:179], v[212:215], v[152:155]
    v_mfma_f32_16x16x32_bf16 v[156:159], v[180:183], v[212:215], v[156:159]
    v_mfma_f32_16x16x32_bf16 v[160:163], v[184:187], v[212:215], v[160:163]
    v_mfma_f32_16x16x32_bf16 v[164:167], v[176:179], v[216:219], v[164:167]
    v_mfma_f32_16x16x32_bf16 v[168:171], v[180:183], v[216:219], v[168:171]
    v_mfma_f32_16x16x32_bf16 v[172:175], v[184:187], v[216:219], v[172:175]
    s_waitcnt vmcnt(5) lgkmcnt(0)
    s_barrier
    v_mfma_f32_16x16x32_bf16 v[116:119], v[188:191], v[220:223], v[116:119]
    ds_read_b64_tr_b16 v[176:177], v9 offset:24576
    ds_read_b64_tr_b16 v[178:179], v9 offset:25088
    v_mfma_f32_16x16x32_bf16 v[120:123], v[192:195], v[220:223], v[120:123]
    s_add_u32 m0, s37, 55296
    s_mov_b32 s3, 4718592
    buffer_load_dwordx4 v3, s[20:23], s3 offen offset:0 lds
    ds_read_b128 v[200:203], v7 offset:18432
    v_mfma_f32_16x16x32_bf16 v[124:127], v[196:199], v[220:223], v[124:127]
    ds_read_b64_tr_b16 v[180:181], v10 offset:24576
    v_mfma_f32_16x16x32_bf16 v[128:131], v[188:191], v[224:227], v[128:131]
    ds_read_b64_tr_b16 v[182:183], v10 offset:25088
    v_mfma_f32_16x16x32_bf16 v[132:135], v[192:195], v[224:227], v[132:135]
    ds_read_b64_tr_b16 v[184:185], v11 offset:24576
    ds_read_b64_tr_b16 v[186:187], v11 offset:25088
    v_mfma_f32_16x16x32_bf16 v[136:139], v[196:199], v[224:227], v[136:139]
    s_add_u32 m0, s37, 56192
    s_nop 0
    buffer_load_dwordx4 v3, s[20:23], s3 offen offset:128 lds
    ds_read_b128 v[204:207], v7 offset:20480
    v_mfma_f32_16x16x32_bf16 v[140:143], v[188:191], v[228:231], v[140:143]
    ds_read_b128 v[208:211], v7 offset:22528
    v_mfma_f32_16x16x32_bf16 v[144:147], v[192:195], v[228:231], v[144:147]
    ds_read_b128 v[212:215], v7 offset:24576
    v_mfma_f32_16x16x32_bf16 v[148:151], v[196:199], v[228:231], v[148:151]
    ds_read_b128 v[216:219], v7 offset:26624
    v_mfma_f32_16x16x32_bf16 v[152:155], v[188:191], v[232:235], v[152:155]
    v_mfma_f32_16x16x32_bf16 v[156:159], v[192:195], v[232:235], v[156:159]
    s_add_u32 m0, s37, 57088
    s_nop 0
    buffer_load_dwordx4 v3, s[20:23], s3 offen offset:256 lds
    v_mfma_f32_16x16x32_bf16 v[160:163], v[196:199], v[232:235], v[160:163]
    v_mfma_f32_16x16x32_bf16 v[164:167], v[188:191], v[236:239], v[164:167]
    v_mfma_f32_16x16x32_bf16 v[168:171], v[192:195], v[236:239], v[168:171]
    v_mfma_f32_16x16x32_bf16 v[172:175], v[196:199], v[236:239], v[172:175]
    s_waitcnt lgkmcnt(0)
    v_mfma_f32_16x16x32_bf16 v[116:119], v[176:179], v[200:203], v[116:119]
    ds_read_b64_tr_b16 v[188:189], v9 offset:36864
    ds_read_b64_tr_b16 v[190:191], v9 offset:37376
    s_add_u32 m0, s38, 0
    s_mov_b32 s40, 768
    buffer_load_dwordx4 v2, s[16:19], s40 offen lds
    v_mfma_f32_16x16x32_bf16 v[120:123], v[180:183], v[200:203], v[120:123]
    ds_read_b128 v[220:223], v8 offset:18432
    v_mfma_f32_16x16x32_bf16 v[124:127], v[184:187], v[200:203], v[124:127]
    ds_read_b64_tr_b16 v[192:193], v10 offset:36864
    v_mfma_f32_16x16x32_bf16 v[128:131], v[176:179], v[204:207], v[128:131]
    ds_read_b64_tr_b16 v[194:195], v10 offset:37376
    v_mfma_f32_16x16x32_bf16 v[132:135], v[180:183], v[204:207], v[132:135]
    ds_read_b64_tr_b16 v[196:197], v11 offset:36864
    ds_read_b64_tr_b16 v[198:199], v11 offset:37376
    v_mfma_f32_16x16x32_bf16 v[136:139], v[184:187], v[204:207], v[136:139]
    ds_read_b128 v[224:227], v8 offset:20480
    v_mfma_f32_16x16x32_bf16 v[140:143], v[176:179], v[208:211], v[140:143]
    ds_read_b128 v[228:231], v8 offset:22528
    v_mfma_f32_16x16x32_bf16 v[144:147], v[180:183], v[208:211], v[144:147]
    ds_read_b128 v[232:235], v8 offset:24576
    s_add_u32 m0, s38, 8192
    s_mov_b32 s40, 82688
    buffer_load_dwordx4 v2, s[16:19], s40 offen lds
    v_mfma_f32_16x16x32_bf16 v[148:151], v[184:187], v[208:211], v[148:151]
    ds_read_b128 v[236:239], v8 offset:26624
    v_mfma_f32_16x16x32_bf16 v[152:155], v[176:179], v[212:215], v[152:155]
    v_mfma_f32_16x16x32_bf16 v[156:159], v[180:183], v[212:215], v[156:159]
    v_mfma_f32_16x16x32_bf16 v[160:163], v[184:187], v[212:215], v[160:163]
    v_mfma_f32_16x16x32_bf16 v[164:167], v[176:179], v[216:219], v[164:167]
    v_mfma_f32_16x16x32_bf16 v[168:171], v[180:183], v[216:219], v[168:171]
    v_mfma_f32_16x16x32_bf16 v[172:175], v[184:187], v[216:219], v[172:175]
    s_waitcnt vmcnt(5) lgkmcnt(0)
    s_barrier
    v_mfma_f32_16x16x32_bf16 v[116:119], v[188:191], v[220:223], v[116:119]
    ds_read_b64_tr_b16 v[176:177], v9 offset:49152
    ds_read_b64_tr_b16 v[178:179], v9 offset:49664
    v_mfma_f32_16x16x32_bf16 v[120:123], v[192:195], v[220:223], v[120:123]
    s_add_u32 m0, s37, 79872
    s_mov_b32 s3, 5505024
    buffer_load_dwordx4 v3, s[20:23], s3 offen offset:0 lds
    ds_read_b128 v[200:203], v7 offset:36864
    v_mfma_f32_16x16x32_bf16 v[124:127], v[196:199], v[220:223], v[124:127]
    ds_read_b64_tr_b16 v[180:181], v10 offset:49152
    v_mfma_f32_16x16x32_bf16 v[128:131], v[188:191], v[224:227], v[128:131]
    ds_read_b64_tr_b16 v[182:183], v10 offset:49664
    v_mfma_f32_16x16x32_bf16 v[132:135], v[192:195], v[224:227], v[132:135]
    ds_read_b64_tr_b16 v[184:185], v11 offset:49152
    ds_read_b64_tr_b16 v[186:187], v11 offset:49664
    v_mfma_f32_16x16x32_bf16 v[136:139], v[196:199], v[224:227], v[136:139]
    s_add_u32 m0, s37, 80768
    s_nop 0
    buffer_load_dwordx4 v3, s[20:23], s3 offen offset:128 lds
    ds_read_b128 v[204:207], v7 offset:38912
    v_mfma_f32_16x16x32_bf16 v[140:143], v[188:191], v[228:231], v[140:143]
    ds_read_b128 v[208:211], v7 offset:40960
    v_mfma_f32_16x16x32_bf16 v[144:147], v[192:195], v[228:231], v[144:147]
    ds_read_b128 v[212:215], v7 offset:43008
    v_mfma_f32_16x16x32_bf16 v[148:151], v[196:199], v[228:231], v[148:151]
    ds_read_b128 v[216:219], v7 offset:45056
    v_mfma_f32_16x16x32_bf16 v[152:155], v[188:191], v[232:235], v[152:155]
    v_mfma_f32_16x16x32_bf16 v[156:159], v[192:195], v[232:235], v[156:159]
    s_add_u32 m0, s37, 81664
    s_nop 0
    buffer_load_dwordx4 v3, s[20:23], s3 offen offset:256 lds
    v_mfma_f32_16x16x32_bf16 v[160:163], v[196:199], v[232:235], v[160:163]
    v_mfma_f32_16x16x32_bf16 v[164:167], v[188:191], v[236:239], v[164:167]
    v_mfma_f32_16x16x32_bf16 v[168:171], v[192:195], v[236:239], v[168:171]
    v_mfma_f32_16x16x32_bf16 v[172:175], v[196:199], v[236:239], v[172:175]
    s_waitcnt lgkmcnt(0)
    v_mfma_f32_16x16x32_bf16 v[116:119], v[176:179], v[200:203], v[116:119]
    ds_read_b64_tr_b16 v[188:189], v9 offset:61440
    ds_read_b64_tr_b16 v[190:191], v9 offset:61952
    s_add_u32 m0, s38, 18432
    s_mov_b32 s40, 896
    buffer_load_dwordx4 v2, s[16:19], s40 offen lds
    v_mfma_f32_16x16x32_bf16 v[120:123], v[180:183], v[200:203], v[120:123]
    ds_read_b128 v[220:223], v8 offset:36864
    v_mfma_f32_16x16x32_bf16 v[124:127], v[184:187], v[200:203], v[124:127]
    ds_read_b64_tr_b16 v[192:193], v10 offset:61440
    v_mfma_f32_16x16x32_bf16 v[128:131], v[176:179], v[204:207], v[128:131]
    ds_read_b64_tr_b16 v[194:195], v10 offset:61952
    v_mfma_f32_16x16x32_bf16 v[132:135], v[180:183], v[204:207], v[132:135]
    ds_read_b64_tr_b16 v[196:197], v11 offset:61440
    ds_read_b64_tr_b16 v[198:199], v11 offset:61952
    v_mfma_f32_16x16x32_bf16 v[136:139], v[184:187], v[204:207], v[136:139]
    ds_read_b128 v[224:227], v8 offset:38912
    v_mfma_f32_16x16x32_bf16 v[140:143], v[176:179], v[208:211], v[140:143]
    ds_read_b128 v[228:231], v8 offset:40960
    v_mfma_f32_16x16x32_bf16 v[144:147], v[180:183], v[208:211], v[144:147]
    ds_read_b128 v[232:235], v8 offset:43008
    s_add_u32 m0, s38, 26624
    s_mov_b32 s40, 82816
    buffer_load_dwordx4 v2, s[16:19], s40 offen lds
    v_mfma_f32_16x16x32_bf16 v[148:151], v[184:187], v[208:211], v[148:151]
    ds_read_b128 v[236:239], v8 offset:45056
    v_mfma_f32_16x16x32_bf16 v[152:155], v[176:179], v[212:215], v[152:155]
    v_mfma_f32_16x16x32_bf16 v[156:159], v[180:183], v[212:215], v[156:159]
    v_mfma_f32_16x16x32_bf16 v[160:163], v[184:187], v[212:215], v[160:163]
    v_mfma_f32_16x16x32_bf16 v[164:167], v[176:179], v[216:219], v[164:167]
    v_mfma_f32_16x16x32_bf16 v[168:171], v[180:183], v[216:219], v[168:171]
    v_mfma_f32_16x16x32_bf16 v[172:175], v[184:187], v[216:219], v[172:175]
    s_waitcnt vmcnt(5) lgkmcnt(0)
    s_barrier
    v_mfma_f32_16x16x32_bf16 v[116:119], v[188:191], v[220:223], v[116:119]
    ds_read_b64_tr_b16 v[176:177], v9 offset:0
    ds_read_b64_tr_b16 v[178:179], v9 offset:512
    v_mfma_f32_16x16x32_bf16 v[120:123], v[192:195], v[220:223], v[120:123]
    s_add_u32 m0, s37, 104448
    s_mov_b32 s3, 6291456
    buffer_load_dwordx4 v3, s[20:23], s3 offen offset:0 lds
    ds_read_b128 v[200:203], v7 offset:0
    v_mfma_f32_16x16x32_bf16 v[124:127], v[196:199], v[220:223], v[124:127]
    ds_read_b64_tr_b16 v[180:181], v10 offset:0
    v_mfma_f32_16x16x32_bf16 v[128:131], v[188:191], v[224:227], v[128:131]
    ds_read_b64_tr_b16 v[182:183], v10 offset:512
    v_mfma_f32_16x16x32_bf16 v[132:135], v[192:195], v[224:227], v[132:135]
    ds_read_b64_tr_b16 v[184:185], v11 offset:0
    ds_read_b64_tr_b16 v[186:187], v11 offset:512
    v_mfma_f32_16x16x32_bf16 v[136:139], v[196:199], v[224:227], v[136:139]
    s_add_u32 m0, s37, 105344
    s_nop 0
    buffer_load_dwordx4 v3, s[20:23], s3 offen offset:128 lds
    ds_read_b128 v[204:207], v7 offset:2048
    v_mfma_f32_16x16x32_bf16 v[140:143], v[188:191], v[228:231], v[140:143]
    ds_read_b128 v[208:211], v7 offset:4096
    v_mfma_f32_16x16x32_bf16 v[144:147], v[192:195], v[228:231], v[144:147]
    ds_read_b128 v[212:215], v7 offset:6144
    v_mfma_f32_16x16x32_bf16 v[148:151], v[196:199], v[228:231], v[148:151]
    ds_read_b128 v[216:219], v7 offset:8192
    v_mfma_f32_16x16x32_bf16 v[152:155], v[188:191], v[232:235], v[152:155]
    v_mfma_f32_16x16x32_bf16 v[156:159], v[192:195], v[232:235], v[156:159]
    s_add_u32 m0, s37, 106240
    s_nop 0
    buffer_load_dwordx4 v3, s[20:23], s3 offen offset:256 lds
    v_mfma_f32_16x16x32_bf16 v[160:163], v[196:199], v[232:235], v[160:163]
    v_mfma_f32_16x16x32_bf16 v[164:167], v[188:191], v[236:239], v[164:167]
    v_mfma_f32_16x16x32_bf16 v[168:171], v[192:195], v[236:239], v[168:171]
    v_mfma_f32_16x16x32_bf16 v[172:175], v[196:199], v[236:239], v[172:175]
    s_waitcnt lgkmcnt(0)
    v_mfma_f32_16x16x32_bf16 v[116:119], v[176:179], v[200:203], v[116:119]
    ds_read_b64_tr_b16 v[188:189], v9 offset:12288
    ds_read_b64_tr_b16 v[190:191], v9 offset:12800
    s_add_u32 m0, s38, 36864
    s_mov_b32 s40, 1024
    buffer_load_dwordx4 v2, s[16:19], s40 offen lds
    v_mfma_f32_16x16x32_bf16 v[120:123], v[180:183], v[200:203], v[120:123]
    ds_read_b128 v[220:223], v8 offset:0
    v_mfma_f32_16x16x32_bf16 v[124:127], v[184:187], v[200:203], v[124:127]
    ds_read_b64_tr_b16 v[192:193], v10 offset:12288
    v_mfma_f32_16x16x32_bf16 v[128:131], v[176:179], v[204:207], v[128:131]
    ds_read_b64_tr_b16 v[194:195], v10 offset:12800
    v_mfma_f32_16x16x32_bf16 v[132:135], v[180:183], v[204:207], v[132:135]
    ds_read_b64_tr_b16 v[196:197], v11 offset:12288
    ds_read_b64_tr_b16 v[198:199], v11 offset:12800
    v_mfma_f32_16x16x32_bf16 v[136:139], v[184:187], v[204:207], v[136:139]
    ds_read_b128 v[224:227], v8 offset:2048
    v_mfma_f32_16x16x32_bf16 v[140:143], v[176:179], v[208:211], v[140:143]
    ds_read_b128 v[228:231], v8 offset:4096
    v_mfma_f32_16x16x32_bf16 v[144:147], v[180:183], v[208:211], v[144:147]
    ds_read_b128 v[232:235], v8 offset:6144
    s_add_u32 m0, s38, 45056
    s_mov_b32 s40, 82944
    buffer_load_dwordx4 v2, s[16:19], s40 offen lds
    v_mfma_f32_16x16x32_bf16 v[148:151], v[184:187], v[208:211], v[148:151]
    ds_read_b128 v[236:239], v8 offset:8192
    v_mfma_f32_16x16x32_bf16 v[152:155], v[176:179], v[212:215], v[152:155]
    v_mfma_f32_16x16x32_bf16 v[156:159], v[180:183], v[212:215], v[156:159]
    v_mfma_f32_16x16x32_bf16 v[160:163], v[184:187], v[212:215], v[160:163]
    v_mfma_f32_16x16x32_bf16 v[164:167], v[176:179], v[216:219], v[164:167]
    v_mfma_f32_16x16x32_bf16 v[168:171], v[180:183], v[216:219], v[168:171]
    v_mfma_f32_16x16x32_bf16 v[172:175], v[184:187], v[216:219], v[172:175]
    s_waitcnt vmcnt(5) lgkmcnt(0)
    s_barrier
    v_mfma_f32_16x16x32_bf16 v[116:119], v[188:191], v[220:223], v[116:119]
    ds_read_b64_tr_b16 v[176:177], v9 offset:24576
    ds_read_b64_tr_b16 v[178:179], v9 offset:25088
    v_mfma_f32_16x16x32_bf16 v[120:123], v[192:195], v[220:223], v[120:123]
    s_add_u32 m0, s37, 55296
    s_mov_b32 s3, 7077888
    buffer_load_dwordx4 v3, s[20:23], s3 offen offset:0 lds
    ds_read_b128 v[200:203], v7 offset:18432
    v_mfma_f32_16x16x32_bf16 v[124:127], v[196:199], v[220:223], v[124:127]
    ds_read_b64_tr_b16 v[180:181], v10 offset:24576
    v_mfma_f32_16x16x32_bf16 v[128:131], v[188:191], v[224:227], v[128:131]
    ds_read_b64_tr_b16 v[182:183], v10 offset:25088
    v_mfma_f32_16x16x32_bf16 v[132:135], v[192:195], v[224:227], v[132:135]
    ds_read_b64_tr_b16 v[184:185], v11 offset:24576
    ds_read_b64_tr_b16 v[186:187], v11 offset:25088
    v_mfma_f32_16x16x32_bf16 v[136:139], v[196:199], v[224:227], v[136:139]
    s_add_u32 m0, s37, 56192
    s_nop 0
    buffer_load_dwordx4 v3, s[20:23], s3 offen offset:128 lds
    ds_read_b128 v[204:207], v7 offset:20480
    v_mfma_f32_16x16x32_bf16 v[140:143], v[188:191], v[228:231], v[140:143]
    ds_read_b128 v[208:211], v7 offset:22528
    v_mfma_f32_16x16x32_bf16 v[144:147], v[192:195], v[228:231], v[144:147]
    ds_read_b128 v[212:215], v7 offset:24576
    v_mfma_f32_16x16x32_bf16 v[148:151], v[196:199], v[228:231], v[148:151]
    ds_read_b128 v[216:219], v7 offset:26624
    v_mfma_f32_16x16x32_bf16 v[152:155], v[188:191], v[232:235], v[152:155]
    v_mfma_f32_16x16x32_bf16 v[156:159], v[192:195], v[232:235], v[156:159]
    s_add_u32 m0, s37, 57088
    s_nop 0
    buffer_load_dwordx4 v3, s[20:23], s3 offen offset:256 lds
    v_mfma_f32_16x16x32_bf16 v[160:163], v[196:199], v[232:235], v[160:163]
    v_mfma_f32_16x16x32_bf16 v[164:167], v[188:191], v[236:239], v[164:167]
    v_mfma_f32_16x16x32_bf16 v[168:171], v[192:195], v[236:239], v[168:171]
    v_mfma_f32_16x16x32_bf16 v[172:175], v[196:199], v[236:239], v[172:175]
    s_waitcnt lgkmcnt(0)
    v_mfma_f32_16x16x32_bf16 v[116:119], v[176:179], v[200:203], v[116:119]
    ds_read_b64_tr_b16 v[188:189], v9 offset:36864
    ds_read_b64_tr_b16 v[190:191], v9 offset:37376
    s_add_u32 m0, s38, 0
    s_mov_b32 s40, 1152
    buffer_load_dwordx4 v2, s[16:19], s40 offen lds
    v_mfma_f32_16x16x32_bf16 v[120:123], v[180:183], v[200:203], v[120:123]
    ds_read_b128 v[220:223], v8 offset:18432
    v_mfma_f32_16x16x32_bf16 v[124:127], v[184:187], v[200:203], v[124:127]
    ds_read_b64_tr_b16 v[192:193], v10 offset:36864
    v_mfma_f32_16x16x32_bf16 v[128:131], v[176:179], v[204:207], v[128:131]
    ds_read_b64_tr_b16 v[194:195], v10 offset:37376
    v_mfma_f32_16x16x32_bf16 v[132:135], v[180:183], v[204:207], v[132:135]
    ds_read_b64_tr_b16 v[196:197], v11 offset:36864
    ds_read_b64_tr_b16 v[198:199], v11 offset:37376
    v_mfma_f32_16x16x32_bf16 v[136:139], v[184:187], v[204:207], v[136:139]
    ds_read_b128 v[224:227], v8 offset:20480
    v_mfma_f32_16x16x32_bf16 v[140:143], v[176:179], v[208:211], v[140:143]
    ds_read_b128 v[228:231], v8 offset:22528
    v_mfma_f32_16x16x32_bf16 v[144:147], v[180:183], v[208:211], v[144:147]
    ds_read_b128 v[232:235], v8 offset:24576
    s_add_u32 m0, s38, 8192
    s_mov_b32 s40, 83072
    buffer_load_dwordx4 v2, s[16:19], s40 offen lds
    v_mfma_f32_16x16x32_bf16 v[148:151], v[184:187], v[208:211], v[148:151]
    ds_read_b128 v[236:239], v8 offset:26624
    v_mfma_f32_16x16x32_bf16 v[152:155], v[176:179], v[212:215], v[152:155]
    v_mfma_f32_16x16x32_bf16 v[156:159], v[180:183], v[212:215], v[156:159]
    v_mfma_f32_16x16x32_bf16 v[160:163], v[184:187], v[212:215], v[160:163]
    v_mfma_f32_16x16x32_bf16 v[164:167], v[176:179], v[216:219], v[164:167]
    v_mfma_f32_16x16x32_bf16 v[168:171], v[180:183], v[216:219], v[168:171]
    v_mfma_f32_16x16x32_bf16 v[172:175], v[184:187], v[216:219], v[172:175]
    s_waitcnt vmcnt(5) lgkmcnt(0)
    s_barrier
    v_mfma_f32_16x16x32_bf16 v[116:119], v[188:191], v[220:223], v[116:119]
    ds_read_b64_tr_b16 v[176:177], v9 offset:49152
    ds_read_b64_tr_b16 v[178:179], v9 offset:49664
    s_lshl_b32 s41, s49, 2
    s_lshr_b32 s41, 42560, s41
    s_and_b32 s41, s41, 15
    s_lshr_b32 s42, s41, 2
    s_lshl_b32 s42, s42, 10
    s_add_u32 s42, s42, 55296
    s_add_u32 m0, s57, 0
    s_mov_b32 s40, 0
    buffer_load_dwordx4 v4, s[24:27], s40 offen offset:0 nt lds
    v_mfma_f32_16x16x32_bf16 v[120:123], v[192:195], v[220:223], v[120:123]
    ds_read_b128 v[200:203], v7 offset:36864
    s_and_b32 s41, s41, 3
    v_lshrrev_b32 v244, 4, v1
    v_bfe_u32 v245, v1, 2, 2
    v_and_b32 v246, 1, v244
    v_lshlrev_b32 v246, 1, v246
    v_mfma_f32_16x16x32_bf16 v[124:127], v[196:199], v[220:223], v[124:127]
    ds_read_b64_tr_b16 v[180:181], v10 offset:49152
    v_lshrrev_b32 v247, 1, v245
    v_add_u32 v247, v247, v246
    v_xor_b32 v247, s41, v247
    v_lshlrev_b32 v247, 5, v247
    v_lshlrev_b32 v248, 7, v245
    v_mfma_f32_16x16x32_bf16 v[128:131], v[188:191], v[224:227], v[128:131]
    ds_read_b64_tr_b16 v[182:183], v10 offset:49664
    v_add_u32 v248, v248, v247
    v_lshlrev_b32 v246, 8, v246
    v_add_u32 v248, v248, v246
    v_lshrrev_b32 v247, 1, v244
    v_mul_u32_u24 v247, 3072, v247
    s_add_u32 m0, s57, 1024
    s_mov_b32 s40, 0
    buffer_load_dwordx4 v5, s[24:27], s40 offen offset:0 nt lds
    v_mfma_f32_16x16x32_bf16 v[132:135], v[192:195], v[224:227], v[132:135]
    ds_read_b64_tr_b16 v[184:185], v11 offset:49152
    ds_read_b64_tr_b16 v[186:187], v11 offset:49664
    v_add_u32 v248, v248, v247
    v_and_b32 v247, 3, v1
    v_lshlrev_b32 v247, 3, v247
    v_add_u32 v248, v248, v247
    v_add_u32 v248, s42, v248
    v_mfma_f32_16x16x32_bf16 v[136:139], v[196:199], v[224:227], v[136:139]
    ds_read_b128 v[204:207], v7 offset:38912
    s_lshl_b32 s41, s49, 2
    s_lshr_b32 s41, 46929, s41
    s_and_b32 s41, s41, 15
    s_lshr_b32 s42, s41, 2
    s_lshl_b32 s42, s42, 10
    s_add_u32 s42, s42, 55296
    v_mfma_f32_16x16x32_bf16 v[140:143], v[188:191], v[228:231], v[140:143]
    ds_read_b128 v[208:211], v7 offset:40960
    s_and_b32 s41, s41, 3
    v_lshrrev_b32 v244, 4, v1
    v_bfe_u32 v245, v1, 2, 2
    v_and_b32 v246, 1, v244
    v_lshlrev_b32 v246, 1, v246
    s_add_u32 m0, s57, 6144
    s_mov_b32 s40, 6144
    buffer_load_dwordx4 v4, s[24:27], s40 offen offset:0 nt lds
    v_mfma_f32_16x16x32_bf16 v[144:147], v[192:195], v[228:231], v[144:147]
    ds_read_b128 v[212:215], v7 offset:43008
    v_lshrrev_b32 v247, 1, v245
    v_add_u32 v247, v247, v246
    v_xor_b32 v247, s41, v247
    v_lshlrev_b32 v247, 5, v247
    v_lshlrev_b32 v249, 7, v245
    v_mfma_f32_16x16x32_bf16 v[148:151], v[196:199], v[228:231], v[148:151]
    ds_read_b128 v[216:219], v7 offset:45056
    v_add_u32 v249, v249, v247
    v_lshlrev_b32 v246, 8, v246
    v_add_u32 v249, v249, v246
    v_lshrrev_b32 v247, 1, v244
    v_mul_u32_u24 v247, 3072, v247
    v_mfma_f32_16x16x32_bf16 v[152:155], v[188:191], v[232:235], v[152:155]
    v_add_u32 v249, v249, v247
    v_and_b32 v247, 3, v1
    v_lshlrev_b32 v247, 3, v247
    v_add_u32 v249, v249, v247
    v_add_u32 v249, s42, v249
    v_mfma_f32_16x16x32_bf16 v[156:159], v[192:195], v[232:235], v[156:159]
    s_lshl_b32 s41, s49, 2
    s_lshr_b32 s41, 38962, s41
    s_and_b32 s41, s41, 15
    s_lshr_b32 s42, s41, 2
    s_lshl_b32 s42, s42, 10
    s_add_u32 s42, s42, 55296
    s_add_u32 m0, s57, 7168
    s_mov_b32 s40, 6144
    buffer_load_dwordx4 v5, s[24:27], s40 offen offset:0 nt lds
    v_mfma_f32_16x16x32_bf16 v[160:163], v[196:199], v[232:235], v[160:163]
    s_and_b32 s41, s41, 3
    v_lshrrev_b32 v244, 4, v1
    v_bfe_u32 v245, v1, 2, 2
    v_and_b32 v246, 1, v244
    v_lshlrev_b32 v246, 1, v246
    v_mfma_f32_16x16x32_bf16 v[164:167], v[188:191], v[236:239], v[164:167]
    v_lshrrev_b32 v247, 1, v245
    v_add_u32 v247, v247, v246
    v_xor_b32 v247, s41, v247
    v_lshlrev_b32 v247, 5, v247
    v_lshlrev_b32 v253, 7, v245
    v_mfma_f32_16x16x32_bf16 v[168:171], v[192:195], v[236:239], v[168:171]
    v_add_u32 v253, v253, v247
    v_lshlrev_b32 v246, 8, v246
    v_add_u32 v253, v253, v246
    v_lshrrev_b32 v247, 1, v244
    v_mul_u32_u24 v247, 3072, v247
    v_mfma_f32_16x16x32_bf16 v[172:175], v[196:199], v[236:239], v[172:175]
    v_add_u32 v253, v253, v247
    v_and_b32 v247, 3, v1
    v_lshlrev_b32 v247, 3, v247
    v_add_u32 v253, v253, v247
    v_add_u32 v253, s42, v253
    s_waitcnt lgkmcnt(0)
    v_mfma_f32_16x16x32_bf16 v[116:119], v[176:179], v[200:203], v[116:119]
    ds_read_b64_tr_b16 v[188:189], v9 offset:61440
    ds_read_b64_tr_b16 v[190:191], v9 offset:61952
    v_mfma_f32_16x16x32_bf16 v[120:123], v[180:183], v[200:203], v[120:123]
    ds_read_b128 v[220:223], v8 offset:36864
    s_add_u32 m0, s57, 1920
    s_mov_b32 s40, 0
    buffer_load_dwordx4 v4, s[24:27], s40 offen offset:128 nt lds
    v_mfma_f32_16x16x32_bf16 v[124:127], v[184:187], v[200:203], v[124:127]
    ds_read_b64_tr_b16 v[192:193], v10 offset:61440
    v_mfma_f32_16x16x32_bf16 v[128:131], v[176:179], v[204:207], v[128:131]
    ds_read_b64_tr_b16 v[194:195], v10 offset:61952
    v_mfma_f32_16x16x32_bf16 v[132:135], v[180:183], v[204:207], v[132:135]
    ds_read_b64_tr_b16 v[196:197], v11 offset:61440
    ds_read_b64_tr_b16 v[198:199], v11 offset:61952
    v_mfma_f32_16x16x32_bf16 v[136:139], v[184:187], v[204:207], v[136:139]
    ds_read_b128 v[224:227], v8 offset:38912
    v_mfma_f32_16x16x32_bf16 v[140:143], v[176:179], v[208:211], v[140:143]
    ds_read_b128 v[228:231], v8 offset:40960
    s_add_u32 m0, s57, 2944
    s_mov_b32 s40, 0
    buffer_load_dwordx4 v5, s[24:27], s40 offen offset:128 nt lds
    v_mfma_f32_16x16x32_bf16 v[144:147], v[180:183], v[208:211], v[144:147]
    ds_read_b128 v[232:235], v8 offset:43008
    v_mfma_f32_16x16x32_bf16 v[148:151], v[184:187], v[208:211], v[148:151]
    ds_read_b128 v[236:239], v8 offset:45056
    v_mfma_f32_16x16x32_bf16 v[152:155], v[176:179], v[212:215], v[152:155]
    v_mfma_f32_16x16x32_bf16 v[156:159], v[180:183], v[212:215], v[156:159]
    s_add_u32 m0, s57, 8064
    s_mov_b32 s40, 6144
    buffer_load_dwordx4 v4, s[24:27], s40 offen offset:128 nt lds
    v_mfma_f32_16x16x32_bf16 v[160:163], v[184:187], v[212:215], v[160:163]
    v_mfma_f32_16x16x32_bf16 v[164:167], v[176:179], v[216:219], v[164:167]
    v_mfma_f32_16x16x32_bf16 v[168:171], v[180:183], v[216:219], v[168:171]
    v_mfma_f32_16x16x32_bf16 v[172:175], v[184:187], v[216:219], v[172:175]
    s_waitcnt vmcnt(7) lgkmcnt(0)
    s_barrier
    v_mfma_f32_16x16x32_bf16 v[116:119], v[188:191], v[220:223], v[116:119]
    ds_read_b64_tr_b16 v[176:177], v9 offset:0
    ds_read_b64_tr_b16 v[178:179], v9 offset:512
    s_add_u32 m0, s57, 9088
    s_mov_b32 s40, 6144
    buffer_load_dwordx4 v5, s[24:27], s40 offen offset:128 nt lds
    v_mfma_f32_16x16x32_bf16 v[120:123], v[192:195], v[220:223], v[120:123]
    ds_read_b128 v[200:203], v7 offset:0
    v_mfma_f32_16x16x32_bf16 v[124:127], v[196:199], v[220:223], v[124:127]
    ds_read_b64_tr_b16 v[180:181], v10 offset:0
    v_mfma_f32_16x16x32_bf16 v[128:131], v[188:191], v[224:227], v[128:131]
    ds_read_b64_tr_b16 v[182:183], v10 offset:512
    v_mfma_f32_16x16x32_bf16 v[132:135], v[192:195], v[224:227], v[132:135]
    ds_read_b64_tr_b16 v[184:185], v11 offset:0
    ds_read_b64_tr_b16 v[186:187], v11 offset:512
    s_add_u32 m0, s57, 3840
    s_mov_b32 s40, 0
    buffer_load_dwordx4 v4, s[24:27], s40 offen offset:256 nt lds
    v_mfma_f32_16x16x32_bf16 v[136:139], v[196:199], v[224:227], v[136:139]
    ds_read_b128 v[204:207], v7 offset:2048
    v_mfma_f32_16x16x32_bf16 v[140:143], v[188:191], v[228:231], v[140:143]
    ds_read_b128 v[208:211], v7 offset:4096
    v_mfma_f32_16x16x32_bf16 v[144:147], v[192:195], v[228:231], v[144:147]
    ds_read_b128 v[212:215], v7 offset:6144
    v_mfma_f32_16x16x32_bf16 v[148:151], v[196:199], v[228:231], v[148:151]
    ds_read_b128 v[216:219], v7 offset:8192
    v_mfma_f32_16x16x32_bf16 v[152:155], v[188:191], v[232:235], v[152:155]
    s_add_u32 m0, s57, 4864
    s_mov_b32 s40, 0
    buffer_load_dwordx4 v5, s[24:27], s40 offen offset:256 nt lds
    v_mfma_f32_16x16x32_bf16 v[156:159], v[192:195], v[232:235], v[156:159]
    v_mfma_f32_16x16x32_bf16 v[160:163], v[196:199], v[232:235], v[160:163]
    v_mfma_f32_16x16x32_bf16 v[164:167], v[188:191], v[236:239], v[164:167]
    v_mfma_f32_16x16x32_bf16 v[168:171], v[192:195], v[236:239], v[168:171]
    v_mfma_f32_16x16x32_bf16 v[172:175], v[196:199], v[236:239], v[172:175]
    s_waitcnt lgkmcnt(0)
    v_mfma_f32_16x16x32_bf16 v[116:119], v[176:179], v[200:203], v[116:119]
    ds_read_b64_tr_b16 v[188:189], v9 offset:12288
    ds_read_b64_tr_b16 v[190:191], v9 offset:12800
    v_mfma_f32_16x16x32_bf16 v[120:123], v[180:183], v[200:203], v[120:123]
    ds_read_b128 v[220:223], v8 offset:0
    s_add_u32 m0, s57, 9984
    s_mov_b32 s40, 6144
    buffer_load_dwordx4 v4, s[24:27], s40 offen offset:256 nt lds
    v_mfma_f32_16x16x32_bf16 v[124:127], v[184:187], v[200:203], v[124:127]
    ds_read_b64_tr_b16 v[192:193], v10 offset:12288
    v_mfma_f32_16x16x32_bf16 v[128:131], v[176:179], v[204:207], v[128:131]
    ds_read_b64_tr_b16 v[194:195], v10 offset:12800
    v_mfma_f32_16x16x32_bf16 v[132:135], v[180:183], v[204:207], v[132:135]
    ds_read_b64_tr_b16 v[196:197], v11 offset:12288
    ds_read_b64_tr_b16 v[198:199], v11 offset:12800
    v_mfma_f32_16x16x32_bf16 v[136:139], v[184:187], v[204:207], v[136:139]
    ds_read_b128 v[224:227], v8 offset:2048
    v_mfma_f32_16x16x32_bf16 v[140:143], v[176:179], v[208:211], v[140:143]
    ds_read_b128 v[228:231], v8 offset:4096
    v_mfma_f32_16x16x32_bf16 v[144:147], v[180:183], v[208:211], v[144:147]
    ds_read_b128 v[232:235], v8 offset:6144
    v_mfma_f32_16x16x32_bf16 v[148:151], v[184:187], v[208:211], v[148:151]
    ds_read_b128 v[236:239], v8 offset:8192
    s_add_u32 m0, s57, 11008
    s_mov_b32 s40, 6144
    buffer_load_dwordx4 v5, s[24:27], s40 offen offset:256 nt lds
    v_mfma_f32_16x16x32_bf16 v[152:155], v[176:179], v[212:215], v[152:155]
    v_mfma_f32_16x16x32_bf16 v[156:159], v[180:183], v[212:215], v[156:159]
    v_mfma_f32_16x16x32_bf16 v[160:163], v[184:187], v[212:215], v[160:163]
    v_mfma_f32_16x16x32_bf16 v[164:167], v[176:179], v[216:219], v[164:167]
    v_mfma_f32_16x16x32_bf16 v[168:171], v[180:183], v[216:219], v[168:171]
    v_mfma_f32_16x16x32_bf16 v[172:175], v[184:187], v[216:219], v[172:175]
    s_waitcnt lgkmcnt(0)
    s_barrier
    v_mfma_f32_16x16x32_bf16 v[116:119], v[188:191], v[220:223], v[116:119]
    v_mfma_f32_16x16x32_bf16 v[120:123], v[192:195], v[220:223], v[120:123]
    v_mfma_f32_16x16x32_bf16 v[124:127], v[196:199], v[220:223], v[124:127]
    v_mfma_f32_16x16x32_bf16 v[128:131], v[188:191], v[224:227], v[128:131]
    v_mfma_f32_16x16x32_bf16 v[132:135], v[192:195], v[224:227], v[132:135]
    s_nop 3
    v_cvt_pk_bf16_f32 v116, v116, v117
    v_cvt_pk_bf16_f32 v117, v118, v119
    v_cvt_pk_bf16_f32 v118, v120, v121
    v_cvt_pk_bf16_f32 v119, v122, v123
    ds_write_b128 v12, v[116:119] offset:0
    v_mfma_f32_16x16x32_bf16 v[136:139], v[196:199], v[224:227], v[136:139]
    v_cvt_pk_bf16_f32 v124, v124, v125
    v_cvt_pk_bf16_f32 v125, v126, v127
    ds_write_b64 v14, v[124:125] offset:0
    v_mfma_f32_16x16x32_bf16 v[140:143], v[188:191], v[228:231], v[140:143]
    v_mfma_f32_16x16x32_bf16 v[144:147], v[192:195], v[228:231], v[144:147]
    v_cvt_pk_bf16_f32 v128, v128, v129
    v_cvt_pk_bf16_f32 v129, v130, v131
    v_cvt_pk_bf16_f32 v130, v132, v133
    v_cvt_pk_bf16_f32 v131, v134, v135
    ds_write_b128 v12, v[128:131] offset:1024
    v_mfma_f32_16x16x32_bf16 v[148:151], v[196:199], v[228:231], v[148:151]
    v_cvt_pk_bf16_f32 v136, v136, v137
    v_cvt_pk_bf16_f32 v137, v138, v139
    ds_write_b64 v14, v[136:137] offset:1024
    v_mfma_f32_16x16x32_bf16 v[152:155], v[188:191], v[232:235], v[152:155]
    v_mfma_f32_16x16x32_bf16 v[156:159], v[192:195], v[232:235], v[156:159]
    v_cvt_pk_bf16_f32 v140, v140, v141
    v_cvt_pk_bf16_f32 v141, v142, v143
    v_cvt_pk_bf16_f32 v142, v144, v145
    v_cvt_pk_bf16_f32 v143, v146, v147
    ds_write_b128 v12, v[140:143] offset:2048
    v_mfma_f32_16x16x32_bf16 v[160:163], v[196:199], v[232:235], v[160:163]
    v_cvt_pk_bf16_f32 v148, v148, v149
    v_cvt_pk_bf16_f32 v149, v150, v151
    ds_write_b64 v14, v[148:149] offset:2048
    v_mfma_f32_16x16x32_bf16 v[164:167], v[188:191], v[236:239], v[164:167]
    v_mfma_f32_16x16x32_bf16 v[168:171], v[192:195], v[236:239], v[168:171]
    v_cvt_pk_bf16_f32 v152, v152, v153
    v_cvt_pk_bf16_f32 v153, v154, v155
    v_cvt_pk_bf16_f32 v154, v156, v157
    v_cvt_pk_bf16_f32 v155, v158, v159
    ds_write_b128 v12, v[152:155] offset:3072
    v_mfma_f32_16x16x32_bf16 v[172:175], v[196:199], v[236:239], v[172:175]
    v_cvt_pk_bf16_f32 v160, v160, v161
    v_cvt_pk_bf16_f32 v161, v162, v163
    ds_write_b64 v14, v[160:161] offset:3072
    v_cvt_pk_bf16_f32 v164, v164, v165
    v_cvt_pk_bf16_f32 v165, v166, v167
    v_cvt_pk_bf16_f32 v166, v168, v169
    v_cvt_pk_bf16_f32 v167, v170, v171
    ds_write_b128 v12, v[164:167] offset:4096
    v_cvt_pk_bf16_f32 v172, v172, v173
    v_cvt_pk_bf16_f32 v173, v174, v175
    ds_write_b64 v14, v[172:173] offset:4096
    v_lshlrev_b32 v7, 4, v1
    v_mov_b32 v9, v248
    v_mov_b32 v10, v249
    v_mov_b32 v11, v253
    s_waitcnt lgkmcnt(0)
    s_barrier
    v_add_u32 v12, 49152, v9
    v_add_u32 v13, 49152, v10
    v_add_u32 v14, 49152, v11
    s_lshl_b32 s41, s36, 2
    s_lshr_b32 s42, 0x32105432, s41
    s_and_b32 s42, s42, 15
    s_mul_i32 s42, s42, 9216
    v_lshlrev_b32 v241, 4, v1
    v_add_u32 v241, s42, v241
    v_xor_b32 v246, 32, v250
    v_xor_b32 v247, 32, v251
    s_waitcnt vmcnt(10)
    ds_read_b64 v[16:17], v250 offset:0
    ds_read_b64 v[18:19], v246 offset:0
    ds_read_b64 v[20:21], v251 offset:0
    ds_read_b64 v[22:23], v247 offset:0
    s_waitcnt vmcnt(8)
    ds_read_b64 v[40:41], v250 offset:6144
    ds_read_b64 v[42:43], v246 offset:6144
    ds_read_b64 v[44:45], v251 offset:6144
    ds_read_b64 v[46:47], v247 offset:6144
    s_waitcnt lgkmcnt(4)
    s_add_u32 m0, s57, 0
    s_mov_b32 s40, 12288
    buffer_load_dwordx4 v4, s[24:27], s40 offen offset:0 nt lds
    s_add_u32 m0, s57, 1024
    s_mov_b32 s40, 12288
    buffer_load_dwordx4 v5, s[24:27], s40 offen offset:0 nt lds
    s_waitcnt vmcnt(8)
    ds_read_b64 v[24:25], v250 offset:2048
    ds_read_b64 v[26:27], v246 offset:2048
    ds_read_b64 v[28:29], v251 offset:2048
    ds_read_b64 v[30:31], v247 offset:2048
    s_waitcnt lgkmcnt(4)
    s_add_u32 m0, s57, 6144
    s_mov_b32 s40, 18432
    buffer_load_dwordx4 v4, s[24:27], s40 offen offset:0 nt lds
    s_add_u32 m0, s57, 7168
    s_mov_b32 s40, 18432
    buffer_load_dwordx4 v5, s[24:27], s40 offen offset:0 nt lds
    s_waitcnt vmcnt(8)
    ds_read_b64 v[48:49], v250 offset:8192
    ds_read_b64 v[50:51], v246 offset:8192
    ds_read_b64 v[52:53], v251 offset:8192
    ds_read_b64 v[54:55], v247 offset:8192
    s_waitcnt lgkmcnt(4)
    s_add_u32 m0, s57, 1920
    s_mov_b32 s40, 12288
    buffer_load_dwordx4 v4, s[24:27], s40 offen offset:128 nt lds
    s_add_u32 m0, s57, 2944
    s_mov_b32 s40, 12288
    buffer_load_dwordx4 v5, s[24:27], s40 offen offset:128 nt lds
    s_waitcnt vmcnt(8)
    ds_read_b64 v[32:33], v250 offset:4096
    ds_read_b64 v[34:35], v246 offset:4096
    ds_read_b64 v[36:37], v251 offset:4096
    ds_read_b64 v[38:39], v247 offset:4096
    s_waitcnt lgkmcnt(4)
    s_add_u32 m0, s57, 8064
    s_mov_b32 s40, 18432
    buffer_load_dwordx4 v4, s[24:27], s40 offen offset:128 nt lds
    s_add_u32 m0, s57, 9088
    s_mov_b32 s40, 18432
    buffer_load_dwordx4 v5, s[24:27], s40 offen offset:128 nt lds
    s_waitcnt vmcnt(8)
    ds_read_b64 v[56:57], v250 offset:10240
    ds_read_b64 v[58:59], v246 offset:10240
    ds_read_b64 v[60:61], v251 offset:10240
    ds_read_b64 v[62:63], v247 offset:10240
    s_waitcnt lgkmcnt(4)
    s_add_u32 m0, s57, 3840
    s_mov_b32 s40, 12288
    buffer_load_dwordx4 v4, s[24:27], s40 offen offset:256 nt lds
    s_add_u32 m0, s57, 4864
    s_mov_b32 s40, 12288
    buffer_load_dwordx4 v5, s[24:27], s40 offen offset:256 nt lds
    s_waitcnt lgkmcnt(0)
    s_add_u32 m0, s57, 9984
    s_mov_b32 s40, 18432
    buffer_load_dwordx4 v4, s[24:27], s40 offen offset:256 nt lds
    s_add_u32 m0, s57, 11008
    s_mov_b32 s40, 18432
    buffer_load_dwordx4 v5, s[24:27], s40 offen offset:256 nt lds
    ds_read_b128 v[224:227], v7 offset:0
    ds_read_b128 v[228:231], v7 offset:9216
    ds_read_b128 v[232:235], v7 offset:18432
    ds_read_b128 v[236:239], v7 offset:27648
    s_waitcnt lgkmcnt(3)
    v_mfma_f32_16x16x32_bf16 v[116:119], v[16:19], v[224:227], 0
    v_mfma_f32_16x16x32_bf16 v[120:123], v[40:43], v[224:227], 0
    ds_read_b128 v[224:227], v7 offset:36864
    s_waitcnt lgkmcnt(3)
    v_mfma_f32_16x16x32_bf16 v[116:119], v[20:23], v[228:231], v[116:119]
    v_mfma_f32_16x16x32_bf16 v[120:123], v[44:47], v[228:231], v[120:123]
    ds_read_b128 v[228:231], v7 offset:46080
    s_waitcnt lgkmcnt(3)
    v_mfma_f32_16x16x32_bf16 v[116:119], v[24:27], v[232:235], v[116:119]
    v_mfma_f32_16x16x32_bf16 v[120:123], v[48:51], v[232:235], v[120:123]
    ds_read_b128 v[232:235], v7 offset:1024
    s_waitcnt lgkmcnt(3)
    v_mfma_f32_16x16x32_bf16 v[116:119], v[28:31], v[236:239], v[116:119]
    v_mfma_f32_16x16x32_bf16 v[120:123], v[52:55], v[236:239], v[120:123]
    ds_read_b128 v[236:239], v7 offset:10240
    s_waitcnt lgkmcnt(3)
    v_mfma_f32_16x16x32_bf16 v[116:119], v[32:35], v[224:227], v[116:119]
    v_mfma_f32_16x16x32_bf16 v[120:123], v[56:59], v[224:227], v[120:123]
    ds_read_b128 v[224:227], v7 offset:19456
    s_waitcnt lgkmcnt(3)
    v_mfma_f32_16x16x32_bf16 v[116:119], v[36:39], v[228:231], v[116:119]
    v_mfma_f32_16x16x32_bf16 v[120:123], v[60:63], v[228:231], v[120:123]
    ds_read_b128 v[228:231], v7 offset:28672
    s_waitcnt lgkmcnt(3)
    v_mfma_f32_16x16x32_bf16 v[124:127], v[16:19], v[232:235], 0
    v_mfma_f32_16x16x32_bf16 v[128:131], v[40:43], v[232:235], 0
    ds_read_b128 v[232:235], v7 offset:37888
    s_waitcnt lgkmcnt(3)
    v_mfma_f32_16x16x32_bf16 v[124:127], v[20:23], v[236:239], v[124:127]
    v_mfma_f32_16x16x32_bf16 v[128:131], v[44:47], v[236:239], v[128:131]
    ds_read_b128 v[236:239], v7 offset:47104
    s_waitcnt lgkmcnt(3)
    v_mfma_f32_16x16x32_bf16 v[124:127], v[24:27], v[224:227], v[124:127]
    v_mfma_f32_16x16x32_bf16 v[128:131], v[48:51], v[224:227], v[128:131]
    ds_read_b128 v[224:227], v7 offset:2048
    s_waitcnt lgkmcnt(3)
    v_mfma_f32_16x16x32_bf16 v[124:127], v[28:31], v[228:231], v[124:127]
    v_mfma_f32_16x16x32_bf16 v[128:131], v[52:55], v[228:231], v[128:131]
    ds_read_b128 v[228:231], v7 offset:11264
    s_waitcnt lgkmcnt(3)
    v_mfma_f32_16x16x32_bf16 v[124:127], v[32:35], v[232:235], v[124:127]
    v_mfma_f32_16x16x32_bf16 v[128:131], v[56:59], v[232:235], v[128:131]
    ds_read_b128 v[232:235], v7 offset:20480
    s_waitcnt lgkmcnt(3)
    v_mfma_f32_16x16x32_bf16 v[124:127], v[36:39], v[236:239], v[124:127]
    v_mfma_f32_16x16x32_bf16 v[128:131], v[60:63], v[236:239], v[128:131]
    ds_read_b128 v[236:239], v7 offset:29696
    s_waitcnt lgkmcnt(3)
    v_mfma_f32_16x16x32_bf16 v[132:135], v[16:19], v[224:227], 0
    v_mfma_f32_16x16x32_bf16 v[136:139], v[40:43], v[224:227], 0
    ds_read_b128 v[224:227], v7 offset:38912
    s_waitcnt lgkmcnt(3)
    v_mfma_f32_16x16x32_bf16 v[132:135], v[20:23], v[228:231], v[132:135]
    v_mfma_f32_16x16x32_bf16 v[136:139], v[44:47], v[228:231], v[136:139]
    ds_read_b128 v[228:231], v7 offset:48128
    s_waitcnt lgkmcnt(3)
    v_mfma_f32_16x16x32_bf16 v[132:135], v[24:27], v[232:235], v[132:135]
    v_mfma_f32_16x16x32_bf16 v[136:139], v[48:51], v[232:235], v[136:139]
    ds_read_b128 v[232:235], v7 offset:3072
    s_waitcnt lgkmcnt(3)
    v_mfma_f32_16x16x32_bf16 v[132:135], v[28:31], v[236:239], v[132:135]
    v_mfma_f32_16x16x32_bf16 v[136:139], v[52:55], v[236:239], v[136:139]
    ds_read_b128 v[236:239], v7 offset:12288
    s_waitcnt lgkmcnt(3)
    v_mfma_f32_16x16x32_bf16 v[132:135], v[32:35], v[224:227], v[132:135]
    v_mfma_f32_16x16x32_bf16 v[136:139], v[56:59], v[224:227], v[136:139]
    ds_read_b128 v[224:227], v7 offset:21504
    s_waitcnt lgkmcnt(3)
    v_mfma_f32_16x16x32_bf16 v[132:135], v[36:39], v[228:231], v[132:135]
    v_mfma_f32_16x16x32_bf16 v[136:139], v[60:63], v[228:231], v[136:139]
    ds_read_b128 v[228:231], v7 offset:30720
    s_waitcnt lgkmcnt(3)
    v_mfma_f32_16x16x32_bf16 v[140:143], v[16:19], v[232:235], 0
    v_mfma_f32_16x16x32_bf16 v[144:147], v[40:43], v[232:235], 0
    ds_read_b128 v[232:235], v7 offset:39936
    s_waitcnt lgkmcnt(3)
    v_mfma_f32_16x16x32_bf16 v[140:143], v[20:23], v[236:239], v[140:143]
    v_mfma_f32_16x16x32_bf16 v[144:147], v[44:47], v[236:239], v[144:147]
    ds_read_b128 v[236:239], v7 offset:49152
    s_waitcnt lgkmcnt(3)
    v_mfma_f32_16x16x32_bf16 v[140:143], v[24:27], v[224:227], v[140:143]
    v_mfma_f32_16x16x32_bf16 v[144:147], v[48:51], v[224:227], v[144:147]
    ds_read_b128 v[224:227], v7 offset:4096
    s_waitcnt lgkmcnt(3)
    v_mfma_f32_16x16x32_bf16 v[140:143], v[28:31], v[228:231], v[140:143]
    v_mfma_f32_16x16x32_bf16 v[144:147], v[52:55], v[228:231], v[144:147]
    ds_read_b128 v[228:231], v7 offset:13312
    s_waitcnt lgkmcnt(3)
    v_mfma_f32_16x16x32_bf16 v[140:143], v[32:35], v[232:235], v[140:143]
    v_mfma_f32_16x16x32_bf16 v[144:147], v[56:59], v[232:235], v[144:147]
    ds_read_b128 v[232:235], v7 offset:22528
    s_waitcnt lgkmcnt(3)
    v_mfma_f32_16x16x32_bf16 v[140:143], v[36:39], v[236:239], v[140:143]
    v_mfma_f32_16x16x32_bf16 v[144:147], v[60:63], v[236:239], v[144:147]
    ds_read_b128 v[236:239], v7 offset:31744
    s_waitcnt lgkmcnt(3)
    v_mfma_f32_16x16x32_bf16 v[148:151], v[16:19], v[224:227], 0
    v_mfma_f32_16x16x32_bf16 v[152:155], v[40:43], v[224:227], 0
    ds_read_b128 v[224:227], v7 offset:40960
    s_waitcnt lgkmcnt(3)
    v_mfma_f32_16x16x32_bf16 v[148:151], v[20:23], v[228:231], v[148:151]
    v_mfma_f32_16x16x32_bf16 v[152:155], v[44:47], v[228:231], v[152:155]
    ds_read_b128 v[228:231], v7 offset:50176
    s_waitcnt lgkmcnt(3)
    v_mfma_f32_16x16x32_bf16 v[148:151], v[24:27], v[232:235], v[148:151]
    v_mfma_f32_16x16x32_bf16 v[152:155], v[48:51], v[232:235], v[152:155]
    ds_read_b128 v[232:235], v7 offset:5120
    s_waitcnt lgkmcnt(3)
    v_mfma_f32_16x16x32_bf16 v[148:151], v[28:31], v[236:239], v[148:151]
    v_mfma_f32_16x16x32_bf16 v[152:155], v[52:55], v[236:239], v[152:155]
    ds_read_b128 v[236:239], v7 offset:14336
    s_waitcnt lgkmcnt(3)
    v_mfma_f32_16x16x32_bf16 v[148:151], v[32:35], v[224:227], v[148:151]
    v_mfma_f32_16x16x32_bf16 v[152:155], v[56:59], v[224:227], v[152:155]
    ds_read_b128 v[224:227], v7 offset:23552
    s_waitcnt lgkmcnt(3)
    v_mfma_f32_16x16x32_bf16 v[148:151], v[36:39], v[228:231], v[148:151]
    v_mfma_f32_16x16x32_bf16 v[152:155], v[60:63], v[228:231], v[152:155]
    ds_read_b128 v[228:231], v7 offset:32768
    s_waitcnt lgkmcnt(3)
    v_mfma_f32_16x16x32_bf16 v[156:159], v[16:19], v[232:235], 0
    v_mfma_f32_16x16x32_bf16 v[160:163], v[40:43], v[232:235], 0
    ds_read_b128 v[232:235], v7 offset:41984
    s_waitcnt lgkmcnt(3)
    v_mfma_f32_16x16x32_bf16 v[156:159], v[20:23], v[236:239], v[156:159]
    v_mfma_f32_16x16x32_bf16 v[160:163], v[44:47], v[236:239], v[160:163]
    ds_read_b128 v[236:239], v7 offset:51200
    s_waitcnt lgkmcnt(3)
    v_mfma_f32_16x16x32_bf16 v[156:159], v[24:27], v[224:227], v[156:159]
    v_mfma_f32_16x16x32_bf16 v[160:163], v[48:51], v[224:227], v[160:163]
    ds_read_b128 v[224:227], v7 offset:6144
    s_waitcnt lgkmcnt(3)
    v_mfma_f32_16x16x32_bf16 v[156:159], v[28:31], v[228:231], v[156:159]
    v_mfma_f32_16x16x32_bf16 v[160:163], v[52:55], v[228:231], v[160:163]
    ds_read_b128 v[228:231], v7 offset:15360
    s_waitcnt lgkmcnt(3)
    v_mfma_f32_16x16x32_bf16 v[156:159], v[32:35], v[232:235], v[156:159]
    v_mfma_f32_16x16x32_bf16 v[160:163], v[56:59], v[232:235], v[160:163]
    ds_read_b128 v[232:235], v7 offset:24576
    s_waitcnt lgkmcnt(3)
    v_mfma_f32_16x16x32_bf16 v[156:159], v[36:39], v[236:239], v[156:159]
    v_mfma_f32_16x16x32_bf16 v[160:163], v[60:63], v[236:239], v[160:163]
    ds_read_b128 v[236:239], v7 offset:33792
    s_waitcnt lgkmcnt(3)
    v_mfma_f32_16x16x32_bf16 v[164:167], v[16:19], v[224:227], 0
    v_mfma_f32_16x16x32_bf16 v[168:171], v[40:43], v[224:227], 0
    ds_read_b128 v[224:227], v7 offset:43008
    s_waitcnt lgkmcnt(3)
    v_mfma_f32_16x16x32_bf16 v[164:167], v[20:23], v[228:231], v[164:167]
    v_mfma_f32_16x16x32_bf16 v[168:171], v[44:47], v[228:231], v[168:171]
    ds_read_b128 v[228:231], v7 offset:52224
    s_waitcnt lgkmcnt(3)
    v_mfma_f32_16x16x32_bf16 v[164:167], v[24:27], v[232:235], v[164:167]
    v_mfma_f32_16x16x32_bf16 v[168:171], v[48:51], v[232:235], v[168:171]
    ds_read_b128 v[232:235], v7 offset:7168
    s_waitcnt lgkmcnt(3)
    v_mfma_f32_16x16x32_bf16 v[164:167], v[28:31], v[236:239], v[164:167]
    v_mfma_f32_16x16x32_bf16 v[168:171], v[52:55], v[236:239], v[168:171]
    ds_read_b128 v[236:239], v7 offset:16384
    s_waitcnt lgkmcnt(3)
    v_mfma_f32_16x16x32_bf16 v[164:167], v[32:35], v[224:227], v[164:167]
    v_mfma_f32_16x16x32_bf16 v[168:171], v[56:59], v[224:227], v[168:171]
    ds_read_b128 v[224:227], v7 offset:25600
    s_waitcnt lgkmcnt(3)
    v_mfma_f32_16x16x32_bf16 v[164:167], v[36:39], v[228:231], v[164:167]
    v_mfma_f32_16x16x32_bf16 v[168:171], v[60:63], v[228:231], v[168:171]
    ds_read_b128 v[228:231], v7 offset:34816
    s_waitcnt lgkmcnt(3)
    v_mfma_f32_16x16x32_bf16 v[172:175], v[16:19], v[232:235], 0
    v_mfma_f32_16x16x32_bf16 v[176:179], v[40:43], v[232:235], 0
    ds_read_b128 v[232:235], v7 offset:44032
    s_waitcnt lgkmcnt(3)
    v_mfma_f32_16x16x32_bf16 v[172:175], v[20:23], v[236:239], v[172:175]
    v_mfma_f32_16x16x32_bf16 v[176:179], v[44:47], v[236:239], v[176:179]
    ds_read_b128 v[236:239], v7 offset:53248
    s_waitcnt lgkmcnt(3)
    v_mfma_f32_16x16x32_bf16 v[172:175], v[24:27], v[224:227], v[172:175]
    v_mfma_f32_16x16x32_bf16 v[176:179], v[48:51], v[224:227], v[176:179]
    ds_read_b128 v[224:227], v7 offset:8192
    s_waitcnt lgkmcnt(3)
    v_mfma_f32_16x16x32_bf16 v[172:175], v[28:31], v[228:231], v[172:175]
    v_mfma_f32_16x16x32_bf16 v[176:179], v[52:55], v[228:231], v[176:179]
    ds_read_b128 v[228:231], v7 offset:17408
    s_waitcnt lgkmcnt(3)
    v_mfma_f32_16x16x32_bf16 v[172:175], v[32:35], v[232:235], v[172:175]
    v_mfma_f32_16x16x32_bf16 v[176:179], v[56:59], v[232:235], v[176:179]
    ds_read_b128 v[232:235], v7 offset:26624
    s_waitcnt lgkmcnt(3)
    v_mfma_f32_16x16x32_bf16 v[172:175], v[36:39], v[236:239], v[172:175]
    v_mfma_f32_16x16x32_bf16 v[176:179], v[60:63], v[236:239], v[176:179]
    ds_read_b128 v[236:239], v7 offset:35840
    s_waitcnt lgkmcnt(3)
    v_mfma_f32_16x16x32_bf16 v[180:183], v[16:19], v[224:227], 0
    v_mfma_f32_16x16x32_bf16 v[184:187], v[40:43], v[224:227], 0
    ds_read_b128 v[224:227], v7 offset:45056
    s_waitcnt lgkmcnt(3)
    v_mfma_f32_16x16x32_bf16 v[180:183], v[20:23], v[228:231], v[180:183]
    v_mfma_f32_16x16x32_bf16 v[184:187], v[44:47], v[228:231], v[184:187]
    ds_read_b128 v[228:231], v7 offset:54272
    s_waitcnt lgkmcnt(3)
    v_mfma_f32_16x16x32_bf16 v[180:183], v[24:27], v[232:235], v[180:183]
    v_mfma_f32_16x16x32_bf16 v[184:187], v[48:51], v[232:235], v[184:187]
    s_waitcnt lgkmcnt(2)
    v_mfma_f32_16x16x32_bf16 v[180:183], v[28:31], v[236:239], v[180:183]
    v_mfma_f32_16x16x32_bf16 v[184:187], v[52:55], v[236:239], v[184:187]
    s_waitcnt lgkmcnt(1)
    v_mfma_f32_16x16x32_bf16 v[180:183], v[32:35], v[224:227], v[180:183]
    v_mfma_f32_16x16x32_bf16 v[184:187], v[56:59], v[224:227], v[184:187]
    s_waitcnt lgkmcnt(0)
    v_mfma_f32_16x16x32_bf16 v[180:183], v[36:39], v[228:231], v[180:183]
    v_mfma_f32_16x16x32_bf16 v[184:187], v[60:63], v[228:231], v[184:187]
    v_xor_b32 v246, 32, v250
    v_xor_b32 v247, 32, v251
    s_waitcnt vmcnt(10)
    ds_read_b64 v[64:65], v250 offset:0
    ds_read_b64 v[66:67], v246 offset:0
    ds_read_b64 v[68:69], v251 offset:0
    ds_read_b64 v[70:71], v247 offset:0
    s_waitcnt vmcnt(8)
    ds_read_b64 v[88:89], v250 offset:6144
    ds_read_b64 v[90:91], v246 offset:6144
    ds_read_b64 v[92:93], v251 offset:6144
    ds_read_b64 v[94:95], v247 offset:6144
    s_waitcnt vmcnt(6)
    ds_read_b64 v[72:73], v250 offset:2048
    ds_read_b64 v[74:75], v246 offset:2048
    ds_read_b64 v[76:77], v251 offset:2048
    ds_read_b64 v[78:79], v247 offset:2048
    s_waitcnt vmcnt(4)
    ds_read_b64 v[96:97], v250 offset:8192
    ds_read_b64 v[98:99], v246 offset:8192
    ds_read_b64 v[100:101], v251 offset:8192
    ds_read_b64 v[102:103], v247 offset:8192
    s_waitcnt vmcnt(2)
    ds_read_b64 v[80:81], v250 offset:4096
    ds_read_b64 v[82:83], v246 offset:4096
    ds_read_b64 v[84:85], v251 offset:4096
    ds_read_b64 v[86:87], v247 offset:4096
    s_waitcnt vmcnt(0)
    ds_read_b64 v[104:105], v250 offset:10240
    ds_read_b64 v[106:107], v246 offset:10240
    ds_read_b64 v[108:109], v251 offset:10240
    ds_read_b64 v[110:111], v247 offset:10240
    s_waitcnt lgkmcnt(0)
    ds_read_b128 v[224:227], v7 offset:0
    ds_read_b128 v[228:231], v7 offset:9216
    ds_read_b128 v[232:235], v7 offset:18432
    ds_read_b128 v[236:239], v7 offset:27648
    s_add_u32 m0, s57, 0
    s_mov_b32 s40, 0
    buffer_load_dwordx4 v252, s[28:31], s40 offen offset:0 nt lds
    s_waitcnt lgkmcnt(3)
    v_mfma_f32_16x16x32_bf16 v[16:19], v[64:67], v[224:227], 0
    v_mfma_f32_16x16x32_bf16 v[20:23], v[88:91], v[224:227], 0
    ds_read_b128 v[224:227], v7 offset:36864
    v_max3_f32 v212, v116, v117, v118
    s_waitcnt lgkmcnt(3)
    v_mfma_f32_16x16x32_bf16 v[16:19], v[68:71], v[228:231], v[16:19]
    v_mfma_f32_16x16x32_bf16 v[20:23], v[92:95], v[228:231], v[20:23]
    v_max3_f32 v212, v212, v119, v120
    ds_read_b128 v[228:231], v7 offset:46080
    s_waitcnt lgkmcnt(3)
    v_mfma_f32_16x16x32_bf16 v[16:19], v[72:75], v[232:235], v[16:19]
    v_max3_f32 v212, v212, v121, v122
    s_add_u32 m0, s57, 896
    s_mov_b32 s40, 0
    buffer_load_dwordx4 v252, s[28:31], s40 offen offset:128 nt lds
    v_mfma_f32_16x16x32_bf16 v[20:23], v[96:99], v[232:235], v[20:23]
    ds_read_b128 v[232:235], v7 offset:1024
    v_max_f32 v212, v212, v123
    s_waitcnt lgkmcnt(3)
    v_mfma_f32_16x16x32_bf16 v[16:19], v[76:79], v[236:239], v[16:19]
    v_mfma_f32_16x16x32_bf16 v[20:23], v[100:103], v[236:239], v[20:23]
    v_max3_f32 v213, v124, v125, v126
    ds_read_b128 v[236:239], v7 offset:10240
    s_waitcnt lgkmcnt(3)
    v_mfma_f32_16x16x32_bf16 v[16:19], v[80:83], v[224:227], v[16:19]
    v_max3_f32 v213, v213, v127, v128
    v_mfma_f32_16x16x32_bf16 v[20:23], v[104:107], v[224:227], v[20:23]
    ds_read_b128 v[224:227], v7 offset:19456
    v_max3_f32 v213, v213, v129, v130
    s_add_u32 m0, s57, 1792
    s_mov_b32 s40, 0
    buffer_load_dwordx4 v252, s[28:31], s40 offen offset:256 nt lds
    s_waitcnt lgkmcnt(3)
    v_mfma_f32_16x16x32_bf16 v[16:19], v[84:87], v[228:231], v[16:19]
    v_mfma_f32_16x16x32_bf16 v[20:23], v[108:111], v[228:231], v[20:23]
    ds_read_b128 v[228:231], v7 offset:28672
    v_max_f32 v213, v213, v131
    s_waitcnt lgkmcnt(3)
    v_mfma_f32_16x16x32_bf16 v[24:27], v[64:67], v[232:235], 0
    v_mfma_f32_16x16x32_bf16 v[28:31], v[88:91], v[232:235], 0
    v_max3_f32 v214, v132, v133, v134
    ds_read_b128 v[232:235], v7 offset:37888
    s_waitcnt lgkmcnt(3)
    v_mfma_f32_16x16x32_bf16 v[24:27], v[68:71], v[236:239], v[24:27]
    v_max3_f32 v214, v214, v135, v136
    v_mfma_f32_16x16x32_bf16 v[28:31], v[92:95], v[236:239], v[28:31]
    s_add_u32 m0, s57, 3072
    s_mov_b32 s40, 3072
    buffer_load_dwordx4 v252, s[28:31], s40 offen offset:0 nt lds
    ds_read_b128 v[236:239], v7 offset:47104
    v_max3_f32 v214, v214, v137, v138
    s_waitcnt lgkmcnt(3)
    v_mfma_f32_16x16x32_bf16 v[24:27], v[72:75], v[224:227], v[24:27]
    v_mfma_f32_16x16x32_bf16 v[28:31], v[96:99], v[224:227], v[28:31]
    v_max_f32 v214, v214, v139
    ds_read_b128 v[224:227], v7 offset:2048
    s_waitcnt lgkmcnt(3)
    v_mfma_f32_16x16x32_bf16 v[24:27], v[76:79], v[228:231], v[24:27]
    v_max3_f32 v215, v140, v141, v142
    v_mfma_f32_16x16x32_bf16 v[28:31], v[100:103], v[228:231], v[28:31]
    ds_read_b128 v[228:231], v7 offset:11264
    v_max3_f32 v215, v215, v143, v144
    s_waitcnt lgkmcnt(3)
    v_mfma_f32_16x16x32_bf16 v[24:27], v[80:83], v[232:235], v[24:27]
    s_add_u32 m0, s57, 3968
    s_mov_b32 s40, 3072
    buffer_load_dwordx4 v252, s[28:31], s40 offen offset:128 nt lds
    v_mfma_f32_16x16x32_bf16 v[28:31], v[104:107], v[232:235], v[28:31]
    v_max3_f32 v215, v215, v145, v146
    ds_read_b128 v[232:235], v7 offset:20480
    s_waitcnt lgkmcnt(3)
    v_mfma_f32_16x16x32_bf16 v[24:27], v[84:87], v[236:239], v[24:27]
    v_max_f32 v215, v215, v147
    v_mfma_f32_16x16x32_bf16 v[28:31], v[108:111], v[236:239], v[28:31]
    ds_read_b128 v[236:239], v7 offset:29696
    s_waitcnt lgkmcnt(3)
    v_mfma_f32_16x16x32_bf16 v[32:35], v[64:67], v[224:227], 0
    v_max3_f32 v216, v148, v149, v150
    v_mfma_f32_16x16x32_bf16 v[36:39], v[88:91], v[224:227], 0
    ds_read_b128 v[224:227], v7 offset:38912
    v_max3_f32 v216, v216, v151, v152
    s_add_u32 m0, s57, 4864
    s_mov_b32 s40, 3072
    buffer_load_dwordx4 v252, s[28:31], s40 offen offset:256 nt lds
    s_waitcnt lgkmcnt(3)
    v_mfma_f32_16x16x32_bf16 v[32:35], v[68:71], v[228:231], v[32:35]
    v_mfma_f32_16x16x32_bf16 v[36:39], v[92:95], v[228:231], v[36:39]
    v_max3_f32 v216, v216, v153, v154
    ds_read_b128 v[228:231], v7 offset:48128
    s_waitcnt lgkmcnt(3)
    v_mfma_f32_16x16x32_bf16 v[32:35], v[72:75], v[232:235], v[32:35]
    v_max_f32 v216, v216, v155
    v_mfma_f32_16x16x32_bf16 v[36:39], v[96:99], v[232:235], v[36:39]
    ds_read_b128 v[232:235], v7 offset:3072
    v_max3_f32 v217, v156, v157, v158
    s_waitcnt lgkmcnt(3)
    v_mfma_f32_16x16x32_bf16 v[32:35], v[76:79], v[236:239], v[32:35]
    v_mfma_f32_16x16x32_bf16 v[36:39], v[100:103], v[236:239], v[36:39]
    v_max3_f32 v217, v217, v159, v160
    s_add_u32 m0, s57, 6144
    s_mov_b32 s40, 6144
    buffer_load_dwordx4 v252, s[28:31], s40 offen offset:0 nt lds
    ds_read_b128 v[236:239], v7 offset:12288
    s_waitcnt lgkmcnt(3)
    v_mfma_f32_16x16x32_bf16 v[32:35], v[80:83], v[224:227], v[32:35]
    v_max3_f32 v217, v217, v161, v162
    v_mfma_f32_16x16x32_bf16 v[36:39], v[104:107], v[224:227], v[36:39]
    ds_read_b128 v[224:227], v7 offset:21504
    v_max_f32 v217, v217, v163
    s_waitcnt lgkmcnt(3)
    v_mfma_f32_16x16x32_bf16 v[32:35], v[84:87], v[228:231], v[32:35]
    v_mfma_f32_16x16x32_bf16 v[36:39], v[108:111], v[228:231], v[36:39]
    ds_read_b128 v[228:231], v7 offset:30720
    v_max3_f32 v218, v164, v165, v166
    s_waitcnt lgkmcnt(3)
    v_mfma_f32_16x16x32_bf16 v[40:43], v[64:67], v[232:235], 0
    s_add_u32 m0, s57, 7040
    s_mov_b32 s40, 6144
    buffer_load_dwordx4 v252, s[28:31], s40 offen offset:128 nt lds
    v_mfma_f32_16x16x32_bf16 v[44:47], v[88:91], v[232:235], 0
    v_max3_f32 v218, v218, v167, v168
    ds_read_b128 v[232:235], v7 offset:39936
    s_waitcnt lgkmcnt(3)
    v_mfma_f32_16x16x32_bf16 v[40:43], v[68:71], v[236:239], v[40:43]
    v_max3_f32 v218, v218, v169, v170
    v_mfma_f32_16x16x32_bf16 v[44:47], v[92:95], v[236:239], v[44:47]
    ds_read_b128 v[236:239], v7 offset:49152
    v_max_f32 v218, v218, v171
    s_waitcnt lgkmcnt(3)
    v_mfma_f32_16x16x32_bf16 v[40:43], v[72:75], v[224:227], v[40:43]
    v_mfma_f32_16x16x32_bf16 v[44:47], v[96:99], v[224:227], v[44:47]
    v_max3_f32 v219, v172, v173, v174
    ds_read_b128 v[224:227], v7 offset:4096
    s_add_u32 m0, s57, 7936
    s_mov_b32 s40, 6144
    buffer_load_dwordx4 v252, s[28:31], s40 offen offset:256 nt lds
    s_waitcnt lgkmcnt(3)
    v_mfma_f32_16x16x32_bf16 v[40:43], v[76:79], v[228:231], v[40:43]
    v_max3_f32 v219, v219, v175, v176
    v_mfma_f32_16x16x32_bf16 v[44:47], v[100:103], v[228:231], v[44:47]
    ds_read_b128 v[228:231], v7 offset:13312
    v_max3_f32 v219, v219, v177, v178
    s_waitcnt lgkmcnt(3)
    v_mfma_f32_16x16x32_bf16 v[40:43], v[80:83], v[232:235], v[40:43]
    v_mfma_f32_16x16x32_bf16 v[44:47], v[104:107], v[232:235], v[44:47]
    v_max_f32 v219, v219, v179
    ds_read_b128 v[232:235], v7 offset:22528
    s_waitcnt lgkmcnt(3)
    v_mfma_f32_16x16x32_bf16 v[40:43], v[84:87], v[236:239], v[40:43]
    v_mfma_f32_16x16x32_bf16 v[44:47], v[108:111], v[236:239], v[44:47]
    v_max3_f32 v220, v180, v181, v182
    s_add_u32 m0, s57, 9216
    s_mov_b32 s40, 9216
    buffer_load_dwordx4 v252, s[28:31], s40 offen offset:0 nt lds
    ds_read_b128 v[236:239], v7 offset:31744
    s_waitcnt lgkmcnt(3)
    v_mfma_f32_16x16x32_bf16 v[48:51], v[64:67], v[224:227], 0
    v_max3_f32 v220, v220, v183, v184
    v_mfma_f32_16x16x32_bf16 v[52:55], v[88:91], v[224:227], 0
    ds_read_b128 v[224:227], v7 offset:40960
    v_max3_f32 v220, v220, v185, v186
    s_waitcnt lgkmcnt(3)
    v_mfma_f32_16x16x32_bf16 v[48:51], v[68:71], v[228:231], v[48:51]
    v_mfma_f32_16x16x32_bf16 v[52:55], v[92:95], v[228:231], v[52:55]
    v_max_f32 v220, v220, v187
    ds_read_b128 v[228:231], v7 offset:50176
    s_waitcnt lgkmcnt(3)
    v_mfma_f32_16x16x32_bf16 v[48:51], v[72:75], v[232:235], v[48:51]
    v_max3_f32 v212, v212, v16, v17
    s_add_u32 m0, s57, 10112
    s_mov_b32 s40, 9216
    buffer_load_dwordx4 v252, s[28:31], s40 offen offset:128 nt lds
    v_mfma_f32_16x16x32_bf16 v[52:55], v[96:99], v[232:235], v[52:55]
    ds_read_b128 v[232:235], v7 offset:5120
    v_max3_f32 v212, v212, v18, v19
    s_waitcnt lgkmcnt(3)
    v_mfma_f32_16x16x32_bf16 v[48:51], v[76:79], v[236:239], v[48:51]
    v_mfma_f32_16x16x32_bf16 v[52:55], v[100:103], v[236:239], v[52:55]
    v_max3_f32 v212, v212, v20, v21
    ds_read_b128 v[236:239], v7 offset:14336
    s_waitcnt lgkmcnt(3)
    v_mfma_f32_16x16x32_bf16 v[48:51], v[80:83], v[224:227], v[48:51]
    v_max3_f32 v212, v212, v22, v23
    v_mfma_f32_16x16x32_bf16 v[52:55], v[104:107], v[224:227], v[52:55]
    ds_read_b128 v[224:227], v7 offset:23552
    v_max3_f32 v213, v213, v24, v25
    s_add_u32 m0, s57, 11008
    s_mov_b32 s40, 9216
    buffer_load_dwordx4 v252, s[28:31], s40 offen offset:256 nt lds
    s_waitcnt lgkmcnt(3)
    v_mfma_f32_16x16x32_bf16 v[48:51], v[84:87], v[228:231], v[48:51]
    v_mfma_f32_16x16x32_bf16 v[52:55], v[108:111], v[228:231], v[52:55]
    v_max3_f32 v213, v213, v26, v27
    ds_read_b128 v[228:231], v7 offset:32768
    s_waitcnt lgkmcnt(3)
    v_mfma_f32_16x16x32_bf16 v[56:59], v[64:67], v[232:235], 0
    v_max3_f32 v213, v213, v28, v29
    v_mfma_f32_16x16x32_bf16 v[60:63], v[88:91], v[232:235], 0
    ds_read_b128 v[232:235], v7 offset:41984
    v_max3_f32 v213, v213, v30, v31
    s_waitcnt lgkmcnt(3)
    v_mfma_f32_16x16x32_bf16 v[56:59], v[68:71], v[236:239], v[56:59]
    v_mfma_f32_16x16x32_bf16 v[60:63], v[92:95], v[236:239], v[60:63]
    v_max3_f32 v214, v214, v32, v33
    ds_read_b128 v[236:239], v7 offset:51200
    s_waitcnt lgkmcnt(3)
    v_mfma_f32_16x16x32_bf16 v[56:59], v[72:75], v[224:227], v[56:59]
    v_max3_f32 v214, v214, v34, v35
    v_mfma_f32_16x16x32_bf16 v[60:63], v[96:99], v[224:227], v[60:63]
    ds_read_b128 v[224:227], v7 offset:6144
    v_max3_f32 v214, v214, v36, v37
    s_waitcnt lgkmcnt(3)
    v_mfma_f32_16x16x32_bf16 v[56:59], v[76:79], v[228:231], v[56:59]
    v_mfma_f32_16x16x32_bf16 v[60:63], v[100:103], v[228:231], v[60:63]
    v_max3_f32 v214, v214, v38, v39
    ds_read_b128 v[228:231], v7 offset:15360
    s_waitcnt lgkmcnt(3)
    v_mfma_f32_16x16x32_bf16 v[56:59], v[80:83], v[232:235], v[56:59]
    v_max3_f32 v215, v215, v40, v41
    v_mfma_f32_16x16x32_bf16 v[60:63], v[104:107], v[232:235], v[60:63]
    ds_read_b128 v[232:235], v7 offset:24576
    v_max3_f32 v215, v215, v42, v43
    s_waitcnt lgkmcnt(3)
    v_mfma_f32_16x16x32_bf16 v[56:59], v[84:87], v[236:239], v[56:59]
    v_mfma_f32_16x16x32_bf16 v[60:63], v[108:111], v[236:239], v[60:63]
    v_max3_f32 v215, v215, v44, v45
    ds_read_b128 v[236:239], v7 offset:33792
    s_waitcnt lgkmcnt(3)
    v_mfma_f32_16x16x32_bf16 v[188:191], v[64:67], v[224:227], 0
    v_max3_f32 v215, v215, v46, v47
    v_mfma_f32_16x16x32_bf16 v[192:195], v[88:91], v[224:227], 0
    ds_read_b128 v[224:227], v7 offset:43008
    v_max3_f32 v216, v216, v48, v49
    s_waitcnt lgkmcnt(3)
    v_mfma_f32_16x16x32_bf16 v[188:191], v[68:71], v[228:231], v[188:191]
    v_mfma_f32_16x16x32_bf16 v[192:195], v[92:95], v[228:231], v[192:195]
    v_max3_f32 v216, v216, v50, v51
    ds_read_b128 v[228:231], v7 offset:52224
    s_waitcnt lgkmcnt(3)
    v_mfma_f32_16x16x32_bf16 v[188:191], v[72:75], v[232:235], v[188:191]
    v_max3_f32 v216, v216, v52, v53
    v_mfma_f32_16x16x32_bf16 v[192:195], v[96:99], v[232:235], v[192:195]
    ds_read_b128 v[232:235], v7 offset:7168
    v_max3_f32 v216, v216, v54, v55
    s_waitcnt lgkmcnt(3)
    v_mfma_f32_16x16x32_bf16 v[188:191], v[76:79], v[236:239], v[188:191]
    v_mfma_f32_16x16x32_bf16 v[192:195], v[100:103], v[236:239], v[192:195]
    v_max3_f32 v217, v217, v56, v57
    ds_read_b128 v[236:239], v7 offset:16384
    s_waitcnt lgkmcnt(3)
    v_mfma_f32_16x16x32_bf16 v[188:191], v[80:83], v[224:227], v[188:191]
    v_max3_f32 v217, v217, v58, v59
    v_mfma_f32_16x16x32_bf16 v[192:195], v[104:107], v[224:227], v[192:195]
    ds_read_b128 v[224:227], v7 offset:25600
    v_max3_f32 v217, v217, v60, v61
    s_waitcnt lgkmcnt(3)
    v_mfma_f32_16x16x32_bf16 v[188:191], v[84:87], v[228:231], v[188:191]
    v_mfma_f32_16x16x32_bf16 v[192:195], v[108:111], v[228:231], v[192:195]
    v_max3_f32 v217, v217, v62, v63
    ds_read_b128 v[228:231], v7 offset:34816
    s_waitcnt lgkmcnt(3)
    v_mfma_f32_16x16x32_bf16 v[196:199], v[64:67], v[232:235], 0
    v_mfma_f32_16x16x32_bf16 v[200:203], v[88:91], v[232:235], 0
    ds_read_b128 v[232:235], v7 offset:44032
    s_waitcnt lgkmcnt(3)
    v_mfma_f32_16x16x32_bf16 v[196:199], v[68:71], v[236:239], v[196:199]
    v_mfma_f32_16x16x32_bf16 v[200:203], v[92:95], v[236:239], v[200:203]
    ds_read_b128 v[236:239], v7 offset:53248
    v_max3_f32 v218, v218, v188, v189
    s_waitcnt lgkmcnt(3)
    v_mfma_f32_16x16x32_bf16 v[196:199], v[72:75], v[224:227], v[196:199]
    v_mfma_f32_16x16x32_bf16 v[200:203], v[96:99], v[224:227], v[200:203]
    v_max3_f32 v218, v218, v190, v191
    ds_read_b128 v[224:227], v7 offset:8192
    s_waitcnt lgkmcnt(3)
    v_mfma_f32_16x16x32_bf16 v[196:199], v[76:79], v[228:231], v[196:199]
    v_max3_f32 v218, v218, v192, v193
    v_mfma_f32_16x16x32_bf16 v[200:203], v[100:103], v[228:231], v[200:203]
    v_max3_f32 v218, v218, v194, v195
    ds_read_b128 v[228:231], v7 offset:17408
    s_waitcnt lgkmcnt(3)
    v_mfma_f32_16x16x32_bf16 v[196:199], v[80:83], v[232:235], v[196:199]
    v_mfma_f32_16x16x32_bf16 v[200:203], v[104:107], v[232:235], v[200:203]
    ds_read_b128 v[232:235], v7 offset:26624
    s_waitcnt lgkmcnt(3)
    v_mfma_f32_16x16x32_bf16 v[196:199], v[84:87], v[236:239], v[196:199]
    v_mfma_f32_16x16x32_bf16 v[200:203], v[108:111], v[236:239], v[200:203]
    ds_read_b128 v[236:239], v7 offset:35840
    s_waitcnt lgkmcnt(3)
    v_mfma_f32_16x16x32_bf16 v[204:207], v[64:67], v[224:227], 0
    v_mfma_f32_16x16x32_bf16 v[208:211], v[88:91], v[224:227], 0
    ds_read_b128 v[224:227], v7 offset:45056
    s_waitcnt lgkmcnt(3)
    v_mfma_f32_16x16x32_bf16 v[204:207], v[68:71], v[228:231], v[204:207]
    v_mfma_f32_16x16x32_bf16 v[208:211], v[92:95], v[228:231], v[208:211]
    ds_read_b128 v[228:231], v7 offset:54272
    v_max3_f32 v219, v219, v196, v197
    s_waitcnt lgkmcnt(3)
    v_mfma_f32_16x16x32_bf16 v[204:207], v[72:75], v[232:235], v[204:207]
    v_max3_f32 v219, v219, v198, v199
    v_mfma_f32_16x16x32_bf16 v[208:211], v[96:99], v[232:235], v[208:211]
    s_waitcnt lgkmcnt(2)
    v_mfma_f32_16x16x32_bf16 v[204:207], v[76:79], v[236:239], v[204:207]
    v_max3_f32 v219, v219, v200, v201
    v_mfma_f32_16x16x32_bf16 v[208:211], v[100:103], v[236:239], v[208:211]
    s_waitcnt lgkmcnt(1)
    v_mfma_f32_16x16x32_bf16 v[204:207], v[80:83], v[224:227], v[204:207]
    v_max3_f32 v219, v219, v202, v203
    v_mfma_f32_16x16x32_bf16 v[208:211], v[104:107], v[224:227], v[208:211]
    s_waitcnt lgkmcnt(0)
    v_mfma_f32_16x16x32_bf16 v[204:207], v[84:87], v[228:231], v[204:207]
    v_mfma_f32_16x16x32_bf16 v[208:211], v[108:111], v[228:231], v[208:211]
    s_nop 6
    v_max3_f32 v220, v220, v204, v205
    v_max3_f32 v220, v220, v206, v207
    v_max3_f32 v220, v220, v208, v209
    v_max3_f32 v220, v220, v210, v211
    ds_max_f32 v243, v212 offset:0
    ds_max_f32 v243, v213 offset:64
    ds_max_f32 v243, v214 offset:128
    ds_max_f32 v243, v215 offset:192
    ds_max_f32 v243, v216 offset:256
    ds_max_f32 v243, v217 offset:320
    ds_max_f32 v243, v218 offset:384
    ds_max_f32 v243, v219 offset:448
    ds_max_f32 v243, v220 offset:512
    v_mov_b32 v112, v252
    s_and_b32 s42, s36, 2
    s_lshr_b32 s50, 2, s42
    s_and_b32 s50, s50, 3
    s_lshl_b32 s50, s50, 1
    s_and_b32 s42, s36, 1
    s_add_u32 s50, s50, s42
    s_mul_i32 s50, s50, 12288
    s_add_u32 s50, s50, 55296
    s_mul_i32 s41, s53, 983040
    s_mul_i32 s42, s47, 320
    s_add_u32 s41, s41, s42
    s_add_u32 s16, s14, s41
    s_addc_u32 s17, s15, 0
    s_mov_b32 s18, 7864320
    s_mov_b32 s19, 0x20000
    s_sub_u32 s18, s18, s41
    s_mov_b32 s89, 81920
    s_lshl_b32 s43, s36, 4
    s_mov_b32 s42, 52429
    v_add_u32 v252, 0, v1
    v_mul_lo_u32 v253, v252, s42
    v_lshrrev_b32 v253, 20, v253
    v_mul_u32_u24 v244, 20, v253
    v_sub_u32 v244, v252, v244
    v_bfe_u32 v245, v253, 2, 1
    v_lshlrev_b32 v245, 1, v245
    v_xor_b32 v244, v244, v245
    v_add_u32 v253, s43, v253
    v_mul_u32_u24 v253, 1280, v253
    v_lshl_add_u32 v2, v244, 4, v253
    v_add_u32 v252, 64, v1
    v_mul_lo_u32 v253, v252, s42
    v_lshrrev_b32 v253, 20, v253
    v_mul_u32_u24 v244, 20, v253
    v_sub_u32 v244, v252, v244
    v_bfe_u32 v245, v253, 2, 1
    v_lshlrev_b32 v245, 1, v245
    v_xor_b32 v244, v244, v245
    v_add_u32 v253, s43, v253
    v_mul_u32_u24 v253, 1280, v253
    v_lshl_add_u32 v3, v244, 4, v253
    v_add_u32 v252, 128, v1
    v_mul_lo_u32 v253, v252, s42
    v_lshrrev_b32 v253, 20, v253
    v_mul_u32_u24 v244, 20, v253
    v_sub_u32 v244, v252, v244
    v_bfe_u32 v245, v253, 2, 1
    v_lshlrev_b32 v245, 1, v245
    v_xor_b32 v244, v244, v245
    v_add_u32 v253, s43, v253
    v_mul_u32_u24 v253, 1280, v253
    v_lshl_add_u32 v4, v244, 4, v253
    v_add_u32 v252, 192, v1
    v_mul_lo_u32 v253, v252, s42
    v_lshrrev_b32 v253, 20, v253
    v_mul_u32_u24 v244, 20, v253
    v_sub_u32 v244, v252, v244
    v_bfe_u32 v245, v253, 2, 1
    v_lshlrev_b32 v245, 1, v245
    v_xor_b32 v244, v244, v245
    v_add_u32 v253, s43, v253
    v_mul_u32_u24 v253, 1280, v253
    v_lshl_add_u32 v5, v244, 4, v253
    v_add_u32 v252, 256, v1
    v_mul_lo_u32 v253, v252, s42
    v_lshrrev_b32 v253, 20, v253
    v_mul_u32_u24 v244, 20, v253
    v_sub_u32 v244, v252, v244
    v_bfe_u32 v245, v253, 2, 1
    v_lshlrev_b32 v245, 1, v245
    v_xor_b32 v244, v244, v245
    v_add_u32 v253, s43, v253
    v_mul_u32_u24 v253, 1280, v253
    v_lshl_add_u32 v7, v244, 4, v253
    s_and_b32 s100, s36, 1
    s_mul_i32 s100, s100, 3
    s_bfe_u32 s99, s36, 0x10001
    s_mul_i32 s99, s99, 5
    s_lshr_b32 s41, s36, 1
    s_mul_i32 s41, s41, 40960
    s_mov_b32 s81, s41
    s_add_u32 s82, s41, 122880
    s_lshl_b32 s41, s41, 1
    s_add_u32 s83, s41, 40960
    s_mul_i32 s98, s49, 5120
    s_add_u32 s98, s98, 79872
    s_add_u32 s41, s47, 0
    s_and_b32 s41, s41, 3
    s_mul_i32 s94, s41, 245760
    s_add_u32 s41, s47, 1
    s_and_b32 s41, s41, 3
    s_mul_i32 s95, s41, 245760
    s_add_u32 s41, s47, 2
    s_and_b32 s41, s41, 3
    s_mul_i32 s96, s41, 245760
    s_add_u32 s41, s47, 3
    s_and_b32 s41, s41, 3
    s_mul_i32 s97, s41, 245760
    v_lshrrev_b32 v252, 2, v1
    v_mul_u32_u24 v252, 320, v252
    v_and_b32 v253, 3, v1
    v_lshl_add_u32 v252, v253, 3, v252
    v_add_u32 v252, 79872, v252
    v_bfe_u32 v253, v1, 4, 1
    s_add_u32 s42, s100, 0
    v_xor_b32 v244, s42, v253
    v_lshl_add_u32 v248, v244, 5, v252
    s_add_u32 s42, s100, 1
    v_xor_b32 v244, s42, v253
    v_lshl_add_u32 v249, v244, 5, v252
    s_add_u32 s42, s100, 2
    v_xor_b32 v244, s42, v253
    v_lshl_add_u32 v250, v244, 5, v252
    s_lshl_b32 s41, s99, 10
    s_add_u32 s41, s41, 0
    v_lshl_add_u32 v251, v1, 4, s41
    s_lshl_b32 s41, s49, 2
    s_lshr_b32 s41, 42560, s41
    s_and_b32 s41, s41, 15
    s_lshl_b32 s42, s41, 1
    s_and_b32 s42, s42, 0x1c
    s_lshr_b32 s42, 0x352140, s42
    s_and_b32 s42, s42, 15
    s_mul_i32 s43, s42, 9216
    v_add_u32 v254, s43, v240
    s_and_b32 s41, s41, 1
    s_lshl_b32 s42, s42, 1
    s_add_u32 s41, s41, s42
    s_lshr_b32 s42, s41, 2
    s_mul_i32 s42, s42, 20480
    s_bfe_u32 s43, s41, 0x10001
    s_mul_i32 s43, s43, 9216
    s_add_u32 s42, s42, s43
    s_and_b32 s41, s41, 1
    s_lshl_b32 s41, s41, 3
    s_add_u32 s41, s41, s42
    s_add_u32 s41, s41, 0
    v_add_u32 v8, s41, v240
    s_lshl_b32 s41, s49, 2
    s_lshr_b32 s41, 38962, s41
    s_and_b32 s41, s41, 15
    s_lshl_b32 s42, s41, 1
    s_and_b32 s42, s42, 0x1c
    s_lshr_b32 s42, 0x352140, s42
    s_and_b32 s42, s42, 15
    s_and_b32 s41, s41, 1
    s_lshl_b32 s42, s42, 1
    s_add_u32 s41, s41, s42
    s_lshr_b32 s42, s41, 2
    s_mul_i32 s42, s42, 20480
    s_bfe_u32 s43, s41, 0x10001
    s_mul_i32 s43, s43, 9216
    s_add_u32 s42, s42, s43
    s_and_b32 s41, s41, 1
    s_lshl_b32 s41, s41, 3
    s_add_u32 s41, s41, s42
    s_add_u32 s41, s41, 0
    v_add_u32 v255, s41, v240
    s_lshl_b32 s41, s52, 3
    s_add_u32 s41, s41, s53
    s_lshl_b32 s41, s41, 7
    s_add_u32 s41, s41, 29364224
    s_add_u32 s90, s12, s41
    s_addc_u32 s91, s13, 0
    s_lshl_b32 s41, s48, 7
    s_add_u32 s41, s41, 29376512
    s_add_u32 s92, s12, s41
    s_addc_u32 s93, s13, 0
    s_mul_i32 s41, s48, 376832
    s_add_u32 s41, s41, 16777216
    s_add_u32 s24, s12, s41
    s_addc_u32 s25, s13, 0
    s_mov_b32 s26, 376832
    s_mov_b32 s27, 0x20000
    s_mul_i32 s42, s53, 47104
    s_add_u32 s41, s41, s42
    s_add_u32 s20, s12, s41
    s_addc_u32 s21, s13, 0
    s_mov_b32 s22, 47104
    s_mov_b32 s23, 0x20000
    s_mov_b32 s84, s54
    s_mov_b32 s85, s55
    s_mov_b32 s86, 1474560
    s_mov_b32 s87, 0x20000
    s_lshl_b32 s41, s49, 2
    s_add_u32 s41, s41, 154176
    v_mov_b32 v113, s41
    s_mov_b32 s101, 0x100000
    s_waitcnt lgkmcnt(0)
L_vf2:
    ds_read_b32 v114, v113
    s_sub_u32 s101, s101, 1
    s_cbranch_scc1 L_vfd2
    s_waitcnt lgkmcnt(0)
    v_cmp_ne_u32 vcc, 1, v114
    s_nop 4
    s_cbranch_vccz L_vfd2
    s_sleep 1
    s_branch L_vf2
L_vfd2:
    s_waitcnt lgkmcnt(0)
    s_add_u32 m0, s50, 0
    s_mov_b32 s40, 98304
    buffer_load_dwordx4 v112, s[28:31], s40 offen offset:0 nt lds
    s_add_u32 m0, s50, 896
    s_mov_b32 s40, 98304
    buffer_load_dwordx4 v112, s[28:31], s40 offen offset:128 nt lds
    s_add_u32 m0, s50, 1792
    s_mov_b32 s40, 98304
    buffer_load_dwordx4 v112, s[28:31], s40 offen offset:256 nt lds
    s_add_u32 m0, s50, 3072
    s_mov_b32 s40, 101376
    buffer_load_dwordx4 v112, s[28:31], s40 offen offset:0 nt lds
    s_add_u32 m0, s50, 3968
    s_mov_b32 s40, 101376
    buffer_load_dwordx4 v112, s[28:31], s40 offen offset:128 nt lds
    s_add_u32 m0, s50, 4864
    s_mov_b32 s40, 101376
    buffer_load_dwordx4 v112, s[28:31], s40 offen offset:256 nt lds
    s_add_u32 m0, s50, 6144
    s_mov_b32 s40, 104448
    buffer_load_dwordx4 v112, s[28:31], s40 offen offset:0 nt lds
    s_add_u32 m0, s50, 7040
    s_mov_b32 s40, 104448
    buffer_load_dwordx4 v112, s[28:31], s40 offen offset:128 nt lds
    s_add_u32 m0, s50, 7936
    s_mov_b32 s40, 104448
    buffer_load_dwordx4 v112, s[28:31], s40 offen offset:256 nt lds
    s_add_u32 m0, s50, 9216
    s_mov_b32 s40, 107520
    buffer_load_dwordx4 v112, s[28:31], s40 offen offset:0 nt lds
    s_add_u32 m0, s50, 10112
    s_mov_b32 s40, 107520
    buffer_load_dwordx4 v112, s[28:31], s40 offen offset:128 nt lds
    s_add_u32 m0, s50, 11008
    s_mov_b32 s40, 107520
    buffer_load_dwordx4 v112, s[28:31], s40 offen offset:256 nt lds
    s_barrier
L_sm0:
    ds_read_b32 v212, v243 offset:0
    ds_read_b32 v213, v243 offset:64
    ds_read_b32 v214, v243 offset:128
    ds_read_b32 v215, v243 offset:192
    ds_read_b32 v216, v243 offset:256
    ds_read_b32 v217, v243 offset:320
    ds_read_b32 v218, v243 offset:384
    ds_read_b32 v219, v243 offset:448
    ds_read_b32 v220, v243 offset:512
    s_waitcnt lgkmcnt(8)
    v_mul_f32 v212, s44, v212
    s_waitcnt lgkmcnt(7)
    v_mul_f32 v213, s44, v213
    s_waitcnt lgkmcnt(6)
    v_mul_f32 v214, s44, v214
    s_waitcnt lgkmcnt(5)
    v_mul_f32 v215, s44, v215
    s_waitcnt lgkmcnt(4)
    v_mul_f32 v216, s44, v216
    s_waitcnt lgkmcnt(3)
    v_mul_f32 v217, s44, v217
    s_waitcnt lgkmcnt(2)
    v_mul_f32 v218, s44, v218
    s_waitcnt lgkmcnt(1)
    v_mul_f32 v219, s44, v219
    s_waitcnt lgkmcnt(0)
    v_mul_f32 v220, s44, v220
    s_andn2_b32 s42, s48, 4
    s_mul_i32 s42, s42, 30720
    s_mul_i32 s41, s53, 983040
    s_add_u32 s41, s41, s42
    v_lshl_add_u32 v64, v0, 4, s41
    v_pk_fma_f32 v[116:117], v[116:117], s[44:45], v[212:213] op_sel:[0,0,0] op_sel_hi:[1,0,0] neg_lo:[0,0,1] neg_hi:[0,0,1]
    v_pk_fma_f32 v[118:119], v[118:119], s[44:45], v[212:213] op_sel:[0,0,0] op_sel_hi:[1,0,0] neg_lo:[0,0,1] neg_hi:[0,0,1]
    v_pk_fma_f32 v[120:121], v[120:121], s[44:45], v[212:213] op_sel:[0,0,0] op_sel_hi:[1,0,0] neg_lo:[0,0,1] neg_hi:[0,0,1]
    v_pk_fma_f32 v[122:123], v[122:123], s[44:45], v[212:213] op_sel:[0,0,0] op_sel_hi:[1,0,0] neg_lo:[0,0,1] neg_hi:[0,0,1]
    v_exp_f32 v116, v116
    v_exp_f32 v117, v117
    v_exp_f32 v118, v118
    v_exp_f32 v119, v119
    v_exp_f32 v120, v120
    v_exp_f32 v121, v121
    v_exp_f32 v122, v122
    v_exp_f32 v123, v123
    v_pk_add_f32 v[244:245], v[116:117], v[118:119]
    v_pk_add_f32 v[246:247], v[120:121], v[122:123]
    v_cvt_pk_bf16_f32 v116, v116, v117
    v_cvt_pk_bf16_f32 v117, v118, v119
    v_cvt_pk_bf16_f32 v118, v120, v121
    v_cvt_pk_bf16_f32 v119, v122, v123
    v_pk_add_f32 v[222:223], v[244:245], v[246:247]
    ds_write_b128 v242, v[116:119] offset:0
    v_pk_fma_f32 v[124:125], v[124:125], s[44:45], v[212:213] op_sel:[0,0,1] op_sel_hi:[1,0,1] neg_lo:[0,0,1] neg_hi:[0,0,1]
    v_pk_fma_f32 v[126:127], v[126:127], s[44:45], v[212:213] op_sel:[0,0,1] op_sel_hi:[1,0,1] neg_lo:[0,0,1] neg_hi:[0,0,1]
    v_pk_fma_f32 v[128:129], v[128:129], s[44:45], v[212:213] op_sel:[0,0,1] op_sel_hi:[1,0,1] neg_lo:[0,0,1] neg_hi:[0,0,1]
    v_pk_fma_f32 v[130:131], v[130:131], s[44:45], v[212:213] op_sel:[0,0,1] op_sel_hi:[1,0,1] neg_lo:[0,0,1] neg_hi:[0,0,1]
    v_exp_f32 v124, v124
    v_exp_f32 v125, v125
    v_exp_f32 v126, v126
    v_exp_f32 v127, v127
    v_exp_f32 v128, v128
    v_exp_f32 v129, v129
    v_exp_f32 v130, v130
    v_exp_f32 v131, v131
    v_pk_add_f32 v[244:245], v[124:125], v[126:127]
    v_pk_add_f32 v[246:247], v[128:129], v[130:131]
    v_cvt_pk_bf16_f32 v124, v124, v125
    v_cvt_pk_bf16_f32 v125, v126, v127
    v_cvt_pk_bf16_f32 v126, v128, v129
    s_cmp_eq_u32 s39, 0
    s_cbranch_scc0 L_ws3
    s_mov_b32 m0, 154240
    v_min_u32 v65, 7864304, v64
    global_load_lds_dwordx4 v65, s[14:15]
    v_add_u32 v64, 8192, v64
L_ws3:
    v_cvt_pk_bf16_f32 v127, v130, v131
    v_pk_add_f32 v[224:225], v[244:245], v[246:247]
    ds_write_b128 v242, v[124:127] offset:1024
    v_pk_fma_f32 v[132:133], v[132:133], s[44:45], v[214:215] op_sel:[0,0,0] op_sel_hi:[1,0,0] neg_lo:[0,0,1] neg_hi:[0,0,1]
    v_pk_fma_f32 v[134:135], v[134:135], s[44:45], v[214:215] op_sel:[0,0,0] op_sel_hi:[1,0,0] neg_lo:[0,0,1] neg_hi:[0,0,1]
    v_pk_fma_f32 v[136:137], v[136:137], s[44:45], v[214:215] op_sel:[0,0,0] op_sel_hi:[1,0,0] neg_lo:[0,0,1] neg_hi:[0,0,1]
    v_pk_fma_f32 v[138:139], v[138:139], s[44:45], v[214:215] op_sel:[0,0,0] op_sel_hi:[1,0,0] neg_lo:[0,0,1] neg_hi:[0,0,1]
    v_exp_f32 v132, v132
    v_exp_f32 v133, v133
    v_exp_f32 v134, v134
    v_exp_f32 v135, v135
    v_exp_f32 v136, v136
    v_exp_f32 v137, v137
    v_exp_f32 v138, v138
    v_exp_f32 v139, v139
    v_pk_add_f32 v[244:245], v[132:133], v[134:135]
    v_pk_add_f32 v[246:247], v[136:137], v[138:139]
    v_cvt_pk_bf16_f32 v132, v132, v133
    v_cvt_pk_bf16_f32 v133, v134, v135
    v_cvt_pk_bf16_f32 v134, v136, v137
    v_cvt_pk_bf16_f32 v135, v138, v139
    v_pk_add_f32 v[226:227], v[244:245], v[246:247]
    ds_write_b128 v242, v[132:135] offset:2048
    v_pk_fma_f32 v[140:141], v[140:141], s[44:45], v[214:215] op_sel:[0,0,1] op_sel_hi:[1,0,1] neg_lo:[0,0,1] neg_hi:[0,0,1]
    v_pk_fma_f32 v[142:143], v[142:143], s[44:45], v[214:215] op_sel:[0,0,1] op_sel_hi:[1,0,1] neg_lo:[0,0,1] neg_hi:[0,0,1]
    v_pk_fma_f32 v[144:145], v[144:145], s[44:45], v[214:215] op_sel:[0,0,1] op_sel_hi:[1,0,1] neg_lo:[0,0,1] neg_hi:[0,0,1]
    v_pk_fma_f32 v[146:147], v[146:147], s[44:45], v[214:215] op_sel:[0,0,1] op_sel_hi:[1,0,1] neg_lo:[0,0,1] neg_hi:[0,0,1]
    v_exp_f32 v140, v140
    v_exp_f32 v141, v141
    v_exp_f32 v142, v142
    v_exp_f32 v143, v143
    v_exp_f32 v144, v144
    v_exp_f32 v145, v145
    v_exp_f32 v146, v146
    v_exp_f32 v147, v147
    v_pk_add_f32 v[244:245], v[140:141], v[142:143]
    v_pk_add_f32 v[246:247], v[144:145], v[146:147]
    v_cvt_pk_bf16_f32 v140, v140, v141
    s_cmp_eq_u32 s39, 0
    s_cbranch_scc0 L_ws4
    s_mov_b32 m0, 154240
    v_min_u32 v65, 7864304, v64
    global_load_lds_dwordx4 v65, s[14:15]
    v_add_u32 v64, 8192, v64
L_ws4:
    v_cvt_pk_bf16_f32 v141, v142, v143
    v_cvt_pk_bf16_f32 v142, v144, v145
    v_cvt_pk_bf16_f32 v143, v146, v147
    v_pk_add_f32 v[228:229], v[244:245], v[246:247]
    ds_write_b128 v242, v[140:143] offset:3072
    v_pk_fma_f32 v[148:149], v[148:149], s[44:45], v[216:217] op_sel:[0,0,0] op_sel_hi:[1,0,0] neg_lo:[0,0,1] neg_hi:[0,0,1]
    v_pk_fma_f32 v[150:151], v[150:151], s[44:45], v[216:217] op_sel:[0,0,0] op_sel_hi:[1,0,0] neg_lo:[0,0,1] neg_hi:[0,0,1]
    v_pk_fma_f32 v[152:153], v[152:153], s[44:45], v[216:217] op_sel:[0,0,0] op_sel_hi:[1,0,0] neg_lo:[0,0,1] neg_hi:[0,0,1]
    v_pk_fma_f32 v[154:155], v[154:155], s[44:45], v[216:217] op_sel:[0,0,0] op_sel_hi:[1,0,0] neg_lo:[0,0,1] neg_hi:[0,0,1]
    v_exp_f32 v148, v148
    v_exp_f32 v149, v149
    v_exp_f32 v150, v150
    v_exp_f32 v151, v151
    v_exp_f32 v152, v152
    v_exp_f32 v153, v153
    v_exp_f32 v154, v154
    v_exp_f32 v155, v155
    v_pk_add_f32 v[244:245], v[148:149], v[150:151]
    v_pk_add_f32 v[246:247], v[152:153], v[154:155]
    v_cvt_pk_bf16_f32 v148, v148, v149
    v_cvt_pk_bf16_f32 v149, v150, v151
    v_cvt_pk_bf16_f32 v150, v152, v153
    v_cvt_pk_bf16_f32 v151, v154, v155
    v_pk_add_f32 v[230:231], v[244:245], v[246:247]
    ds_write_b128 v242, v[148:151] offset:4096
    v_pk_fma_f32 v[156:157], v[156:157], s[44:45], v[216:217] op_sel:[0,0,1] op_sel_hi:[1,0,1] neg_lo:[0,0,1] neg_hi:[0,0,1]
    v_pk_fma_f32 v[158:159], v[158:159], s[44:45], v[216:217] op_sel:[0,0,1] op_sel_hi:[1,0,1] neg_lo:[0,0,1] neg_hi:[0,0,1]
    v_pk_fma_f32 v[160:161], v[160:161], s[44:45], v[216:217] op_sel:[0,0,1] op_sel_hi:[1,0,1] neg_lo:[0,0,1] neg_hi:[0,0,1]
    v_pk_fma_f32 v[162:163], v[162:163], s[44:45], v[216:217] op_sel:[0,0,1] op_sel_hi:[1,0,1] neg_lo:[0,0,1] neg_hi:[0,0,1]
    v_exp_f32 v156, v156
    v_exp_f32 v157, v157
    v_exp_f32 v158, v158
    v_exp_f32 v159, v159
    v_exp_f32 v160, v160
    v_exp_f32 v161, v161
    v_exp_f32 v162, v162
    v_exp_f32 v163, v163
    v_pk_add_f32 v[244:245], v[156:157], v[158:159]
    s_cmp_eq_u32 s39, 0
    s_cbranch_scc0 L_ws5
    s_mov_b32 m0, 154240
    v_min_u32 v65, 7864304, v64
    global_load_lds_dwordx4 v65, s[14:15]
    v_add_u32 v64, 8192, v64
L_ws5:
    v_pk_add_f32 v[246:247], v[160:161], v[162:163]
    v_cvt_pk_bf16_f32 v156, v156, v157
    v_cvt_pk_bf16_f32 v157, v158, v159
    v_cvt_pk_bf16_f32 v158, v160, v161
    v_cvt_pk_bf16_f32 v159, v162, v163
    v_pk_add_f32 v[232:233], v[244:245], v[246:247]
    ds_write_b128 v242, v[156:159] offset:5120
    v_pk_fma_f32 v[164:165], v[164:165], s[44:45], v[218:219] op_sel:[0,0,0] op_sel_hi:[1,0,0] neg_lo:[0,0,1] neg_hi:[0,0,1]
    v_pk_fma_f32 v[166:167], v[166:167], s[44:45], v[218:219] op_sel:[0,0,0] op_sel_hi:[1,0,0] neg_lo:[0,0,1] neg_hi:[0,0,1]
    v_pk_fma_f32 v[168:169], v[168:169], s[44:45], v[218:219] op_sel:[0,0,0] op_sel_hi:[1,0,0] neg_lo:[0,0,1] neg_hi:[0,0,1]
    v_pk_fma_f32 v[170:171], v[170:171], s[44:45], v[218:219] op_sel:[0,0,0] op_sel_hi:[1,0,0] neg_lo:[0,0,1] neg_hi:[0,0,1]
    v_exp_f32 v164, v164
    v_exp_f32 v165, v165
    v_exp_f32 v166, v166
    v_exp_f32 v167, v167
    v_exp_f32 v168, v168
    v_exp_f32 v169, v169
    v_exp_f32 v170, v170
    v_exp_f32 v171, v171
    v_pk_add_f32 v[244:245], v[164:165], v[166:167]
    v_pk_add_f32 v[246:247], v[168:169], v[170:171]
    v_cvt_pk_bf16_f32 v164, v164, v165
    v_cvt_pk_bf16_f32 v165, v166, v167
    v_cvt_pk_bf16_f32 v166, v168, v169
    v_cvt_pk_bf16_f32 v167, v170, v171
    v_pk_add_f32 v[234:235], v[244:245], v[246:247]
    ds_write_b128 v242, v[164:167] offset:6144
    v_pk_fma_f32 v[172:173], v[172:173], s[44:45], v[218:219] op_sel:[0,0,1] op_sel_hi:[1,0,1] neg_lo:[0,0,1] neg_hi:[0,0,1]
    v_pk_fma_f32 v[174:175], v[174:175], s[44:45], v[218:219] op_sel:[0,0,1] op_sel_hi:[1,0,1] neg_lo:[0,0,1] neg_hi:[0,0,1]
    v_pk_fma_f32 v[176:177], v[176:177], s[44:45], v[218:219] op_sel:[0,0,1] op_sel_hi:[1,0,1] neg_lo:[0,0,1] neg_hi:[0,0,1]
    v_pk_fma_f32 v[178:179], v[178:179], s[44:45], v[218:219] op_sel:[0,0,1] op_sel_hi:[1,0,1] neg_lo:[0,0,1] neg_hi:[0,0,1]
    v_exp_f32 v172, v172
    v_exp_f32 v173, v173
    v_exp_f32 v174, v174
    v_exp_f32 v175, v175
    v_exp_f32 v176, v176
    v_exp_f32 v177, v177
    v_exp_f32 v178, v178
    s_cmp_eq_u32 s39, 0
    s_cbranch_scc0 L_ws6
    s_mov_b32 m0, 154240
    v_min_u32 v65, 7864304, v64
    global_load_lds_dwordx4 v65, s[14:15]
    v_add_u32 v64, 98304, v64
L_ws6:
    v_exp_f32 v179, v179
    v_pk_add_f32 v[244:245], v[172:173], v[174:175]
    v_pk_add_f32 v[246:247], v[176:177], v[178:179]
    v_cvt_pk_bf16_f32 v172, v172, v173
    v_cvt_pk_bf16_f32 v173, v174, v175
    v_cvt_pk_bf16_f32 v174, v176, v177
    v_cvt_pk_bf16_f32 v175, v178, v179
    v_pk_add_f32 v[236:237], v[244:245], v[246:247]
    ds_write_b128 v242, v[172:175] offset:7168
    v_pk_fma_f32 v[180:181], v[180:181], s[44:45], v[220:221] op_sel:[0,0,0] op_sel_hi:[1,0,0] neg_lo:[0,0,1] neg_hi:[0,0,1]
    v_pk_fma_f32 v[182:183], v[182:183], s[44:45], v[220:221] op_sel:[0,0,0] op_sel_hi:[1,0,0] neg_lo:[0,0,1] neg_hi:[0,0,1]
    v_pk_fma_f32 v[184:185], v[184:185], s[44:45], v[220:221] op_sel:[0,0,0] op_sel_hi:[1,0,0] neg_lo:[0,0,1] neg_hi:[0,0,1]
    v_pk_fma_f32 v[186:187], v[186:187], s[44:45], v[220:221] op_sel:[0,0,0] op_sel_hi:[1,0,0] neg_lo:[0,0,1] neg_hi:[0,0,1]
    v_exp_f32 v180, v180
    v_exp_f32 v181, v181
    v_exp_f32 v182, v182
    v_exp_f32 v183, v183
    v_exp_f32 v184, v184
    v_exp_f32 v185, v185
    v_exp_f32 v186, v186
    v_exp_f32 v187, v187
    v_pk_add_f32 v[244:245], v[180:181], v[182:183]
    v_pk_add_f32 v[246:247], v[184:185], v[186:187]
    v_cvt_pk_bf16_f32 v180, v180, v181
    v_cvt_pk_bf16_f32 v181, v182, v183
    v_cvt_pk_bf16_f32 v182, v184, v185
    v_cvt_pk_bf16_f32 v183, v186, v187
    v_pk_add_f32 v[238:239], v[244:245], v[246:247]
    ds_write_b128 v242, v[180:183] offset:8192
    v_pk_fma_f32 v[16:17], v[16:17], s[44:45], v[212:213] op_sel:[0,0,0] op_sel_hi:[1,0,0] neg_lo:[0,0,1] neg_hi:[0,0,1]
    v_pk_fma_f32 v[18:19], v[18:19], s[44:45], v[212:213] op_sel:[0,0,0] op_sel_hi:[1,0,0] neg_lo:[0,0,1] neg_hi:[0,0,1]
    v_pk_fma_f32 v[20:21], v[20:21], s[44:45], v[212:213] op_sel:[0,0,0] op_sel_hi:[1,0,0] neg_lo:[0,0,1] neg_hi:[0,0,1]
    v_pk_fma_f32 v[22:23], v[22:23], s[44:45], v[212:213] op_sel:[0,0,0] op_sel_hi:[1,0,0] neg_lo:[0,0,1] neg_hi:[0,0,1]
    v_exp_f32 v16, v16
    v_exp_f32 v17, v17
    v_exp_f32 v18, v18
    v_exp_f32 v19, v19
    v_exp_f32 v20, v20
    v_exp_f32 v21, v21
    s_cmp_eq_u32 s39, 0
    s_cbranch_scc0 L_ws7
    s_mov_b32 m0, 154240
    v_min_u32 v65, 7864304, v64
    global_load_lds_dwordx4 v65, s[14:15]
    v_add_u32 v64, 8192, v64
L_ws7:
    v_exp_f32 v22, v22
    v_exp_f32 v23, v23
    v_pk_add_f32 v[244:245], v[16:17], v[18:19]
    v_pk_add_f32 v[246:247], v[20:21], v[22:23]
    v_cvt_pk_bf16_f32 v16, v16, v17
    v_cvt_pk_bf16_f32 v17, v18, v19
    v_cvt_pk_bf16_f32 v18, v20, v21
    v_cvt_pk_bf16_f32 v19, v22, v23
    v_pk_add_f32 v[244:245], v[244:245], v[246:247]
    v_pk_add_f32 v[222:223], v[222:223], v[244:245]
    v_pk_fma_f32 v[24:25], v[24:25], s[44:45], v[212:213] op_sel:[0,0,1] op_sel_hi:[1,0,1] neg_lo:[0,0,1] neg_hi:[0,0,1]
    v_pk_fma_f32 v[26:27], v[26:27], s[44:45], v[212:213] op_sel:[0,0,1] op_sel_hi:[1,0,1] neg_lo:[0,0,1] neg_hi:[0,0,1]
    v_pk_fma_f32 v[28:29], v[28:29], s[44:45], v[212:213] op_sel:[0,0,1] op_sel_hi:[1,0,1] neg_lo:[0,0,1] neg_hi:[0,0,1]
    v_pk_fma_f32 v[30:31], v[30:31], s[44:45], v[212:213] op_sel:[0,0,1] op_sel_hi:[1,0,1] neg_lo:[0,0,1] neg_hi:[0,0,1]
    v_exp_f32 v24, v24
    v_exp_f32 v25, v25
    v_exp_f32 v26, v26
    v_exp_f32 v27, v27
    v_exp_f32 v28, v28
    v_exp_f32 v29, v29
    v_exp_f32 v30, v30
    v_exp_f32 v31, v31
    v_pk_add_f32 v[244:245], v[24:25], v[26:27]
    v_pk_add_f32 v[246:247], v[28:29], v[30:31]
    v_cvt_pk_bf16_f32 v24, v24, v25
    v_cvt_pk_bf16_f32 v25, v26, v27
    v_cvt_pk_bf16_f32 v26, v28, v29
    v_cvt_pk_bf16_f32 v27, v30, v31
    v_pk_add_f32 v[244:245], v[244:245], v[246:247]
    v_pk_add_f32 v[224:225], v[224:225], v[244:245]
    v_pk_fma_f32 v[32:33], v[32:33], s[44:45], v[214:215] op_sel:[0,0,0] op_sel_hi:[1,0,0] neg_lo:[0,0,1] neg_hi:[0,0,1]
    v_pk_fma_f32 v[34:35], v[34:35], s[44:45], v[214:215] op_sel:[0,0,0] op_sel_hi:[1,0,0] neg_lo:[0,0,1] neg_hi:[0,0,1]
    v_pk_fma_f32 v[36:37], v[36:37], s[44:45], v[214:215] op_sel:[0,0,0] op_sel_hi:[1,0,0] neg_lo:[0,0,1] neg_hi:[0,0,1]
    v_pk_fma_f32 v[38:39], v[38:39], s[44:45], v[214:215] op_sel:[0,0,0] op_sel_hi:[1,0,0] neg_lo:[0,0,1] neg_hi:[0,0,1]
    v_exp_f32 v32, v32
    v_exp_f32 v33, v33
    v_exp_f32 v34, v34
    v_exp_f32 v35, v35
    s_cmp_eq_u32 s39, 0
    s_cbranch_scc0 L_ws8
    s_mov_b32 m0, 154240
    v_min_u32 v65, 7864304, v64
    global_load_lds_dwordx4 v65, s[14:15]
    v_add_u32 v64, 8192, v64
L_ws8:
    v_exp_f32 v36, v36
    v_exp_f32 v37, v37
    v_exp_f32 v38, v38
    v_exp_f32 v39, v39
    v_pk_add_f32 v[244:245], v[32:33], v[34:35]
    v_pk_add_f32 v[246:247], v[36:37], v[38:39]
    v_cvt_pk_bf16_f32 v32, v32, v33
    v_cvt_pk_bf16_f32 v33, v34, v35
    v_cvt_pk_bf16_f32 v34, v36, v37
    v_cvt_pk_bf16_f32 v35, v38, v39
    v_pk_add_f32 v[244:245], v[244:245], v[246:247]
    v_pk_add_f32 v[226:227], v[226:227], v[244:245]
    v_pk_fma_f32 v[40:41], v[40:41], s[44:45], v[214:215] op_sel:[0,0,1] op_sel_hi:[1,0,1] neg_lo:[0,0,1] neg_hi:[0,0,1]
    v_pk_fma_f32 v[42:43], v[42:43], s[44:45], v[214:215] op_sel:[0,0,1] op_sel_hi:[1,0,1] neg_lo:[0,0,1] neg_hi:[0,0,1]
    v_pk_fma_f32 v[44:45], v[44:45], s[44:45], v[214:215] op_sel:[0,0,1] op_sel_hi:[1,0,1] neg_lo:[0,0,1] neg_hi:[0,0,1]
    v_pk_fma_f32 v[46:47], v[46:47], s[44:45], v[214:215] op_sel:[0,0,1] op_sel_hi:[1,0,1] neg_lo:[0,0,1] neg_hi:[0,0,1]
    v_exp_f32 v40, v40
    v_exp_f32 v41, v41
    v_exp_f32 v42, v42
    v_exp_f32 v43, v43
    v_exp_f32 v44, v44
    v_exp_f32 v45, v45
    v_exp_f32 v46, v46
    v_exp_f32 v47, v47
    v_pk_add_f32 v[244:245], v[40:41], v[42:43]
    v_pk_add_f32 v[246:247], v[44:45], v[46:47]
    v_cvt_pk_bf16_f32 v40, v40, v41
    v_cvt_pk_bf16_f32 v41, v42, v43
    v_cvt_pk_bf16_f32 v42, v44, v45
    v_cvt_pk_bf16_f32 v43, v46, v47
    v_pk_add_f32 v[244:245], v[244:245], v[246:247]
    v_pk_add_f32 v[228:229], v[228:229], v[244:245]
    v_pk_fma_f32 v[48:49], v[48:49], s[44:45], v[216:217] op_sel:[0,0,0] op_sel_hi:[1,0,0] neg_lo:[0,0,1] neg_hi:[0,0,1]
    v_pk_fma_f32 v[50:51], v[50:51], s[44:45], v[216:217] op_sel:[0,0,0] op_sel_hi:[1,0,0] neg_lo:[0,0,1] neg_hi:[0,0,1]
    v_pk_fma_f32 v[52:53], v[52:53], s[44:45], v[216:217] op_sel:[0,0,0] op_sel_hi:[1,0,0] neg_lo:[0,0,1] neg_hi:[0,0,1]
    v_pk_fma_f32 v[54:55], v[54:55], s[44:45], v[216:217] op_sel:[0,0,0] op_sel_hi:[1,0,0] neg_lo:[0,0,1] neg_hi:[0,0,1]
    v_exp_f32 v48, v48
    v_exp_f32 v49, v49
    s_cmp_eq_u32 s39, 0
    s_cbranch_scc0 L_ws9
    s_mov_b32 m0, 154240
    v_min_u32 v65, 7864304, v64
    global_load_lds_dwordx4 v65, s[14:15]
    v_add_u32 v64, 8192, v64
L_ws9:
    v_exp_f32 v50, v50
    v_exp_f32 v51, v51
    v_exp_f32 v52, v52
    v_exp_f32 v53, v53
    v_exp_f32 v54, v54
    v_exp_f32 v55, v55
    v_pk_add_f32 v[244:245], v[48:49], v[50:51]
    v_pk_add_f32 v[246:247], v[52:53], v[54:55]
    v_cvt_pk_bf16_f32 v48, v48, v49
    v_cvt_pk_bf16_f32 v49, v50, v51
    v_cvt_pk_bf16_f32 v50, v52, v53
    v_cvt_pk_bf16_f32 v51, v54, v55
    v_pk_add_f32 v[244:245], v[244:245], v[246:247]
    v_pk_add_f32 v[230:231], v[230:231], v[244:245]
    v_pk_fma_f32 v[56:57], v[56:57], s[44:45], v[216:217] op_sel:[0,0,1] op_sel_hi:[1,0,1] neg_lo:[0,0,1] neg_hi:[0,0,1]
    v_pk_fma_f32 v[58:59], v[58:59], s[44:45], v[216:217] op_sel:[0,0,1] op_sel_hi:[1,0,1] neg_lo:[0,0,1] neg_hi:[0,0,1]
    v_pk_fma_f32 v[60:61], v[60:61], s[44:45], v[216:217] op_sel:[0,0,1] op_sel_hi:[1,0,1] neg_lo:[0,0,1] neg_hi:[0,0,1]
    v_pk_fma_f32 v[62:63], v[62:63], s[44:45], v[216:217] op_sel:[0,0,1] op_sel_hi:[1,0,1] neg_lo:[0,0,1] neg_hi:[0,0,1]
    v_exp_f32 v56, v56
    v_exp_f32 v57, v57
    v_exp_f32 v58, v58
    v_exp_f32 v59, v59
    v_exp_f32 v60, v60
    v_exp_f32 v61, v61
    v_exp_f32 v62, v62
    v_exp_f32 v63, v63
    v_pk_add_f32 v[244:245], v[56:57], v[58:59]
    v_pk_add_f32 v[246:247], v[60:61], v[62:63]
    v_cvt_pk_bf16_f32 v56, v56, v57
    v_cvt_pk_bf16_f32 v57, v58, v59
    v_cvt_pk_bf16_f32 v58, v60, v61
    v_cvt_pk_bf16_f32 v59, v62, v63
    v_pk_add_f32 v[244:245], v[244:245], v[246:247]
    v_pk_add_f32 v[232:233], v[232:233], v[244:245]
    v_pk_fma_f32 v[188:189], v[188:189], s[44:45], v[218:219] op_sel:[0,0,0] op_sel_hi:[1,0,0] neg_lo:[0,0,1] neg_hi:[0,0,1]
    v_pk_fma_f32 v[190:191], v[190:191], s[44:45], v[218:219] op_sel:[0,0,0] op_sel_hi:[1,0,0] neg_lo:[0,0,1] neg_hi:[0,0,1]
    v_pk_fma_f32 v[192:193], v[192:193], s[44:45], v[218:219] op_sel:[0,0,0] op_sel_hi:[1,0,0] neg_lo:[0,0,1] neg_hi:[0,0,1]
    v_pk_fma_f32 v[194:195], v[194:195], s[44:45], v[218:219] op_sel:[0,0,0] op_sel_hi:[1,0,0] neg_lo:[0,0,1] neg_hi:[0,0,1]
    s_cmp_eq_u32 s39, 0
    s_cbranch_scc0 L_ws10
    s_mov_b32 m0, 154240
    v_min_u32 v65, 7864304, v64
    global_load_lds_dwordx4 v65, s[14:15]
    v_add_u32 v64, 8192, v64
L_ws10:
    v_exp_f32 v188, v188
    v_exp_f32 v189, v189
    v_exp_f32 v190, v190
    v_exp_f32 v191, v191
    v_exp_f32 v192, v192
    v_exp_f32 v193, v193
    v_exp_f32 v194, v194
    v_exp_f32 v195, v195
    v_pk_add_f32 v[244:245], v[188:189], v[190:191]
    v_pk_add_f32 v[246:247], v[192:193], v[194:195]
    v_cvt_pk_bf16_f32 v188, v188, v189
    v_cvt_pk_bf16_f32 v189, v190, v191
    v_cvt_pk_bf16_f32 v190, v192, v193
    v_cvt_pk_bf16_f32 v191, v194, v195
    v_pk_add_f32 v[244:245], v[244:245], v[246:247]
    v_pk_add_f32 v[234:235], v[234:235], v[244:245]
    v_pk_fma_f32 v[196:197], v[196:197], s[44:45], v[218:219] op_sel:[0,0,1] op_sel_hi:[1,0,1] neg_lo:[0,0,1] neg_hi:[0,0,1]
    v_pk_fma_f32 v[198:199], v[198:199], s[44:45], v[218:219] op_sel:[0,0,1] op_sel_hi:[1,0,1] neg_lo:[0,0,1] neg_hi:[0,0,1]
    v_pk_fma_f32 v[200:201], v[200:201], s[44:45], v[218:219] op_sel:[0,0,1] op_sel_hi:[1,0,1] neg_lo:[0,0,1] neg_hi:[0,0,1]
    v_pk_fma_f32 v[202:203], v[202:203], s[44:45], v[218:219] op_sel:[0,0,1] op_sel_hi:[1,0,1] neg_lo:[0,0,1] neg_hi:[0,0,1]
    v_exp_f32 v196, v196
    v_exp_f32 v197, v197
    v_exp_f32 v198, v198
    v_exp_f32 v199, v199
    v_exp_f32 v200, v200
    v_exp_f32 v201, v201
    v_exp_f32 v202, v202
    v_exp_f32 v203, v203
    v_pk_add_f32 v[244:245], v[196:197], v[198:199]
    v_pk_add_f32 v[246:247], v[200:201], v[202:203]
    v_cvt_pk_bf16_f32 v196, v196, v197
    v_cvt_pk_bf16_f32 v197, v198, v199
    v_cvt_pk_bf16_f32 v198, v200, v201
    v_cvt_pk_bf16_f32 v199, v202, v203
    v_pk_add_f32 v[244:245], v[244:245], v[246:247]
    v_pk_add_f32 v[236:237], v[236:237], v[244:245]
    v_pk_fma_f32 v[204:205], v[204:205], s[44:45], v[220:221] op_sel:[0,0,0] op_sel_hi:[1,0,0] neg_lo:[0,0,1] neg_hi:[0,0,1]
    v_pk_fma_f32 v[206:207], v[206:207], s[44:45], v[220:221] op_sel:[0,0,0] op_sel_hi:[1,0,0] neg_lo:[0,0,1] neg_hi:[0,0,1]
    v_pk_fma_f32 v[208:209], v[208:209], s[44:45], v[220:221] op_sel:[0,0,0] op_sel_hi:[1,0,0] neg_lo:[0,0,1] neg_hi:[0,0,1]
    v_pk_fma_f32 v[210:211], v[210:211], s[44:45], v[220:221] op_sel:[0,0,0] op_sel_hi:[1,0,0] neg_lo:[0,0,1] neg_hi:[0,0,1]
    v_exp_f32 v204, v204
    v_exp_f32 v205, v205
    v_exp_f32 v206, v206
    v_exp_f32 v207, v207
    v_exp_f32 v208, v208
    v_exp_f32 v209, v209
    v_exp_f32 v210, v210
    v_exp_f32 v211, v211
    v_pk_add_f32 v[244:245], v[204:205], v[206:207]
    v_pk_add_f32 v[246:247], v[208:209], v[210:211]
    v_cvt_pk_bf16_f32 v204, v204, v205
    v_cvt_pk_bf16_f32 v205, v206, v207
    v_cvt_pk_bf16_f32 v206, v208, v209
    v_cvt_pk_bf16_f32 v207, v210, v211
    v_pk_add_f32 v[244:245], v[244:245], v[246:247]
    v_pk_add_f32 v[238:239], v[238:239], v[244:245]
    s_waitcnt vmcnt(12) lgkmcnt(0)
    s_barrier
    ds_read_b64_tr_b16 v[176:177], v12 offset:24576
    ds_read_b64_tr_b16 v[178:179], v12 offset:30720
    ds_read_b128 v[64:67], v240 offset:0
    ds_read_b64_tr_b16 v[180:181], v13 offset:24576
    ds_read_b64_tr_b16 v[182:183], v13 offset:30720
    ds_read_b64_tr_b16 v[184:185], v14 offset:24576
    ds_read_b64_tr_b16 v[186:187], v14 offset:30720
    ds_read_b128 v[68:71], v240 offset:1024
    ds_read_b128 v[72:75], v240 offset:2048
    ds_read_b128 v[76:79], v240 offset:3072
    ds_read_b128 v[80:83], v240 offset:4096
    s_waitcnt lgkmcnt(8)
    v_mfma_f32_16x16x32_bf16 v[116:119], v[176:179], v[64:67], 0
    ds_read_b64_tr_b16 v[104:105], v12 offset:36864
    ds_read_b64_tr_b16 v[106:107], v12 offset:43008
    s_waitcnt lgkmcnt(8)
    v_mfma_f32_16x16x32_bf16 v[120:123], v[180:183], v[64:67], 0
    ds_read_b128 v[84:87], v240 offset:9216
    s_waitcnt lgkmcnt(7)
    v_mfma_f32_16x16x32_bf16 v[124:127], v[184:187], v[64:67], 0
    ds_read_b64_tr_b16 v[108:109], v13 offset:36864
    s_waitcnt lgkmcnt(7)
    v_mfma_f32_16x16x32_bf16 v[128:131], v[176:179], v[68:71], 0
    ds_read_b64_tr_b16 v[110:111], v13 offset:43008
    v_mfma_f32_16x16x32_bf16 v[132:135], v[180:183], v[68:71], 0
    ds_read_b64_tr_b16 v[112:113], v14 offset:36864
    ds_read_b64_tr_b16 v[114:115], v14 offset:43008
    v_mfma_f32_16x16x32_bf16 v[136:139], v[184:187], v[68:71], 0
    ds_read_b128 v[88:91], v240 offset:10240
    s_waitcnt lgkmcnt(10)
    v_mfma_f32_16x16x32_bf16 v[140:143], v[176:179], v[72:75], 0
    ds_read_b128 v[92:95], v240 offset:11264
    v_mfma_f32_16x16x32_bf16 v[144:147], v[180:183], v[72:75], 0
    ds_read_b128 v[96:99], v240 offset:12288
    v_mfma_f32_16x16x32_bf16 v[148:151], v[184:187], v[72:75], 0
    ds_read_b128 v[100:103], v240 offset:13312
    s_waitcnt lgkmcnt(12)
    v_mfma_f32_16x16x32_bf16 v[152:155], v[176:179], v[76:79], 0
    v_mfma_f32_16x16x32_bf16 v[156:159], v[180:183], v[76:79], 0
    v_mfma_f32_16x16x32_bf16 v[160:163], v[184:187], v[76:79], 0
    s_waitcnt lgkmcnt(11)
    v_mfma_f32_16x16x32_bf16 v[164:167], v[176:179], v[80:83], 0
    v_mfma_f32_16x16x32_bf16 v[168:171], v[180:183], v[80:83], 0
    v_mfma_f32_16x16x32_bf16 v[172:175], v[184:187], v[80:83], 0
    s_waitcnt lgkmcnt(0)
    s_barrier
    v_mfma_f32_16x16x32_bf16 v[116:119], v[104:107], v[84:87], v[116:119]
    s_add_u32 m0, s37, 129024
    s_mov_b32 s40, 12288
    buffer_load_dwordx4 v6, s[28:31], s40 offen offset:0 nt lds
    ds_read_b64_tr_b16 v[176:177], v9 offset:24576
    ds_read_b64_tr_b16 v[178:179], v9 offset:30720
    v_mfma_f32_16x16x32_bf16 v[120:123], v[108:111], v[84:87], v[120:123]
    ds_read_b128 v[64:67], v240 offset:18432
    v_mfma_f32_16x16x32_bf16 v[124:127], v[112:115], v[84:87], v[124:127]
    s_add_u32 m0, s37, 129920
    s_mov_b32 s40, 12288
    buffer_load_dwordx4 v6, s[28:31], s40 offen offset:128 nt lds
    ds_read_b64_tr_b16 v[180:181], v10 offset:24576
    v_mfma_f32_16x16x32_bf16 v[128:131], v[104:107], v[88:91], v[128:131]
    ds_read_b64_tr_b16 v[182:183], v10 offset:30720
    v_mfma_f32_16x16x32_bf16 v[132:135], v[108:111], v[88:91], v[132:135]
    s_add_u32 m0, s37, 130816
    s_mov_b32 s40, 12288
    buffer_load_dwordx4 v6, s[28:31], s40 offen offset:256 nt lds
    ds_read_b64_tr_b16 v[184:185], v11 offset:24576
    v_mfma_f32_16x16x32_bf16 v[136:139], v[112:115], v[88:91], v[136:139]
    ds_read_b64_tr_b16 v[186:187], v11 offset:30720
    v_mfma_f32_16x16x32_bf16 v[140:143], v[104:107], v[92:95], v[140:143]
    ds_read_b128 v[68:71], v240 offset:19456
    v_mfma_f32_16x16x32_bf16 v[144:147], v[108:111], v[92:95], v[144:147]
    ds_read_b128 v[72:75], v240 offset:20480
    v_mfma_f32_16x16x32_bf16 v[148:151], v[112:115], v[92:95], v[148:151]
    ds_read_b128 v[76:79], v240 offset:21504
    v_mfma_f32_16x16x32_bf16 v[152:155], v[104:107], v[96:99], v[152:155]
    ds_read_b128 v[80:83], v240 offset:22528
    v_mfma_f32_16x16x32_bf16 v[156:159], v[108:111], v[96:99], v[156:159]
    v_mfma_f32_16x16x32_bf16 v[160:163], v[112:115], v[96:99], v[160:163]
    v_mfma_f32_16x16x32_bf16 v[164:167], v[104:107], v[100:103], v[164:167]
    v_mfma_f32_16x16x32_bf16 v[168:171], v[108:111], v[100:103], v[168:171]
    v_mfma_f32_16x16x32_bf16 v[172:175], v[112:115], v[100:103], v[172:175]
    s_waitcnt lgkmcnt(0)
    v_mfma_f32_16x16x32_bf16 v[116:119], v[176:179], v[64:67], v[116:119]
    ds_read_b64_tr_b16 v[104:105], v9 offset:36864
    ds_read_b64_tr_b16 v[106:107], v9 offset:43008
    v_mfma_f32_16x16x32_bf16 v[120:123], v[180:183], v[64:67], v[120:123]
    ds_read_b128 v[84:87], v240 offset:27648
    v_mfma_f32_16x16x32_bf16 v[124:127], v[184:187], v[64:67], v[124:127]
    ds_read_b64_tr_b16 v[108:109], v10 offset:36864
    v_mfma_f32_16x16x32_bf16 v[128:131], v[176:179], v[68:71], v[128:131]
    ds_read_b64_tr_b16 v[110:111], v10 offset:43008
    v_mfma_f32_16x16x32_bf16 v[132:135], v[180:183], v[68:71], v[132:135]
    ds_read_b64_tr_b16 v[112:113], v11 offset:36864
    ds_read_b64_tr_b16 v[114:115], v11 offset:43008
    v_mfma_f32_16x16x32_bf16 v[136:139], v[184:187], v[68:71], v[136:139]
    ds_read_b128 v[88:91], v240 offset:28672
    v_mfma_f32_16x16x32_bf16 v[140:143], v[176:179], v[72:75], v[140:143]
    ds_read_b128 v[92:95], v240 offset:29696
    v_mfma_f32_16x16x32_bf16 v[144:147], v[180:183], v[72:75], v[144:147]
    ds_read_b128 v[96:99], v240 offset:30720
    v_mfma_f32_16x16x32_bf16 v[148:151], v[184:187], v[72:75], v[148:151]
    ds_read_b128 v[100:103], v240 offset:31744
    v_mfma_f32_16x16x32_bf16 v[152:155], v[176:179], v[76:79], v[152:155]
    v_mfma_f32_16x16x32_bf16 v[156:159], v[180:183], v[76:79], v[156:159]
    v_mfma_f32_16x16x32_bf16 v[160:163], v[184:187], v[76:79], v[160:163]
    v_mfma_f32_16x16x32_bf16 v[164:167], v[176:179], v[80:83], v[164:167]
    v_mfma_f32_16x16x32_bf16 v[168:171], v[180:183], v[80:83], v[168:171]
    v_mfma_f32_16x16x32_bf16 v[172:175], v[184:187], v[80:83], v[172:175]
    s_waitcnt vmcnt(3) lgkmcnt(0)
    s_barrier
    v_mfma_f32_16x16x32_bf16 v[116:119], v[104:107], v[84:87], v[116:119]
    s_add_u32 m0, s37, 79872
    s_mov_b32 s40, 61440
    buffer_load_dwordx4 v6, s[28:31], s40 offen offset:0 nt lds
    ds_read_b64_tr_b16 v[176:177], v12 offset:0
    ds_read_b64_tr_b16 v[178:179], v12 offset:6144
    v_mfma_f32_16x16x32_bf16 v[120:123], v[108:111], v[84:87], v[120:123]
    ds_read_b128 v[64:67], v240 offset:36864
    v_mfma_f32_16x16x32_bf16 v[124:127], v[112:115], v[84:87], v[124:127]
    s_add_u32 m0, s37, 80768
    s_mov_b32 s40, 61440
    buffer_load_dwordx4 v6, s[28:31], s40 offen offset:128 nt lds
    ds_read_b64_tr_b16 v[180:181], v13 offset:0
    v_mfma_f32_16x16x32_bf16 v[128:131], v[104:107], v[88:91], v[128:131]
    ds_read_b64_tr_b16 v[182:183], v13 offset:6144
    v_mfma_f32_16x16x32_bf16 v[132:135], v[108:111], v[88:91], v[132:135]
    s_add_u32 m0, s37, 81664
    s_mov_b32 s40, 61440
    buffer_load_dwordx4 v6, s[28:31], s40 offen offset:256 nt lds
    ds_read_b64_tr_b16 v[184:185], v14 offset:0
    v_mfma_f32_16x16x32_bf16 v[136:139], v[112:115], v[88:91], v[136:139]
    ds_read_b64_tr_b16 v[186:187], v14 offset:6144
    v_mfma_f32_16x16x32_bf16 v[140:143], v[104:107], v[92:95], v[140:143]
    ds_read_b128 v[68:71], v240 offset:37888
    v_mfma_f32_16x16x32_bf16 v[144:147], v[108:111], v[92:95], v[144:147]
    ds_read_b128 v[72:75], v240 offset:38912
    v_mfma_f32_16x16x32_bf16 v[148:151], v[112:115], v[92:95], v[148:151]
    ds_read_b128 v[76:79], v240 offset:39936
    v_mfma_f32_16x16x32_bf16 v[152:155], v[104:107], v[96:99], v[152:155]
    ds_read_b128 v[80:83], v240 offset:40960
    v_mfma_f32_16x16x32_bf16 v[156:159], v[108:111], v[96:99], v[156:159]
    v_mfma_f32_16x16x32_bf16 v[160:163], v[112:115], v[96:99], v[160:163]
    v_mfma_f32_16x16x32_bf16 v[164:167], v[104:107], v[100:103], v[164:167]
    v_mfma_f32_16x16x32_bf16 v[168:171], v[108:111], v[100:103], v[168:171]
    v_mfma_f32_16x16x32_bf16 v[172:175], v[112:115], v[100:103], v[172:175]
    s_waitcnt lgkmcnt(0)
    v_mfma_f32_16x16x32_bf16 v[116:119], v[176:179], v[64:67], v[116:119]
    ds_read_b64_tr_b16 v[104:105], v12 offset:12288
    ds_read_b64_tr_b16 v[106:107], v12 offset:18432
    v_mfma_f32_16x16x32_bf16 v[120:123], v[180:183], v[64:67], v[120:123]
    ds_read_b128 v[84:87], v240 offset:46080
    v_mfma_f32_16x16x32_bf16 v[124:127], v[184:187], v[64:67], v[124:127]
    ds_read_b64_tr_b16 v[108:109], v13 offset:12288
    v_mfma_f32_16x16x32_bf16 v[128:131], v[176:179], v[68:71], v[128:131]
    ds_read_b64_tr_b16 v[110:111], v13 offset:18432
    v_mfma_f32_16x16x32_bf16 v[132:135], v[180:183], v[68:71], v[132:135]
    ds_read_b64_tr_b16 v[112:113], v14 offset:12288
    ds_read_b64_tr_b16 v[114:115], v14 offset:18432
    v_mfma_f32_16x16x32_bf16 v[136:139], v[184:187], v[68:71], v[136:139]
    ds_read_b128 v[88:91], v240 offset:47104
    v_mfma_f32_16x16x32_bf16 v[140:143], v[176:179], v[72:75], v[140:143]
    ds_read_b128 v[92:95], v240 offset:48128
    v_mfma_f32_16x16x32_bf16 v[144:147], v[180:183], v[72:75], v[144:147]
    ds_read_b128 v[96:99], v240 offset:49152
    v_mfma_f32_16x16x32_bf16 v[148:151], v[184:187], v[72:75], v[148:151]
    ds_read_b128 v[100:103], v240 offset:50176
    v_mfma_f32_16x16x32_bf16 v[152:155], v[176:179], v[76:79], v[152:155]
    v_mfma_f32_16x16x32_bf16 v[156:159], v[180:183], v[76:79], v[156:159]
    v_mfma_f32_16x16x32_bf16 v[160:163], v[184:187], v[76:79], v[160:163]
    v_mfma_f32_16x16x32_bf16 v[164:167], v[176:179], v[80:83], v[164:167]
    v_mfma_f32_16x16x32_bf16 v[168:171], v[180:183], v[80:83], v[168:171]
    v_mfma_f32_16x16x32_bf16 v[172:175], v[184:187], v[80:83], v[172:175]
    s_waitcnt lgkmcnt(0)
    s_barrier
    v_mfma_f32_16x16x32_bf16 v[116:119], v[104:107], v[84:87], v[116:119]
    s_add_u32 m0, s37, 104448
    s_mov_b32 s40, 110592
    buffer_load_dwordx4 v6, s[28:31], s40 offen offset:0 nt lds
    ds_read_b64_tr_b16 v[176:177], v9 offset:0
    ds_read_b64_tr_b16 v[178:179], v9 offset:6144
    ds_write_b128 v241, v[48:51] offset:4096
    v_mfma_f32_16x16x32_bf16 v[120:123], v[108:111], v[84:87], v[120:123]
    ds_read_b128 v[64:67], v240 offset:0
    v_mfma_f32_16x16x32_bf16 v[124:127], v[112:115], v[84:87], v[124:127]
    s_add_u32 m0, s37, 105344
    s_mov_b32 s40, 110592
    buffer_load_dwordx4 v6, s[28:31], s40 offen offset:128 nt lds
    ds_read_b64_tr_b16 v[180:181], v10 offset:0
    v_mfma_f32_16x16x32_bf16 v[128:131], v[104:107], v[88:91], v[128:131]
    ds_read_b64_tr_b16 v[182:183], v10 offset:6144
    ds_write_b128 v241, v[56:59] offset:5120
    v_mfma_f32_16x16x32_bf16 v[132:135], v[108:111], v[88:91], v[132:135]
    s_add_u32 m0, s37, 106240
    s_mov_b32 s40, 110592
    buffer_load_dwordx4 v6, s[28:31], s40 offen offset:256 nt lds
    ds_read_b64_tr_b16 v[184:185], v11 offset:0
    v_mfma_f32_16x16x32_bf16 v[136:139], v[112:115], v[88:91], v[136:139]
    ds_read_b64_tr_b16 v[186:187], v11 offset:6144
    v_mfma_f32_16x16x32_bf16 v[140:143], v[104:107], v[92:95], v[140:143]
    ds_read_b128 v[68:71], v240 offset:1024
    ds_write_b128 v241, v[188:191] offset:6144
    v_mfma_f32_16x16x32_bf16 v[144:147], v[108:111], v[92:95], v[144:147]
    ds_read_b128 v[72:75], v240 offset:2048
    v_mfma_f32_16x16x32_bf16 v[148:151], v[112:115], v[92:95], v[148:151]
    ds_read_b128 v[76:79], v240 offset:3072
    v_mfma_f32_16x16x32_bf16 v[152:155], v[104:107], v[96:99], v[152:155]
    ds_read_b128 v[80:83], v240 offset:4096
    ds_write_b128 v241, v[196:199] offset:7168
    v_mfma_f32_16x16x32_bf16 v[156:159], v[108:111], v[96:99], v[156:159]
    v_mfma_f32_16x16x32_bf16 v[160:163], v[112:115], v[96:99], v[160:163]
    v_mfma_f32_16x16x32_bf16 v[164:167], v[104:107], v[100:103], v[164:167]
    ds_write_b128 v241, v[204:207] offset:8192
    v_mfma_f32_16x16x32_bf16 v[168:171], v[108:111], v[100:103], v[168:171]
    v_mfma_f32_16x16x32_bf16 v[172:175], v[112:115], v[100:103], v[172:175]
    s_waitcnt lgkmcnt(0)
    v_mfma_f32_16x16x32_bf16 v[116:119], v[176:179], v[64:67], v[116:119]
    ds_read_b64_tr_b16 v[104:105], v9 offset:12288
    ds_read_b64_tr_b16 v[106:107], v9 offset:18432
    ds_write_b128 v241, v[16:19] offset:0
    v_mfma_f32_16x16x32_bf16 v[120:123], v[180:183], v[64:67], v[120:123]
    ds_read_b128 v[84:87], v240 offset:9216
    v_mfma_f32_16x16x32_bf16 v[124:127], v[184:187], v[64:67], v[124:127]
    ds_read_b64_tr_b16 v[108:109], v10 offset:12288
    v_mfma_f32_16x16x32_bf16 v[128:131], v[176:179], v[68:71], v[128:131]
    ds_read_b64_tr_b16 v[110:111], v10 offset:18432
    ds_write_b128 v241, v[24:27] offset:1024
    v_mfma_f32_16x16x32_bf16 v[132:135], v[180:183], v[68:71], v[132:135]
    ds_read_b64_tr_b16 v[112:113], v11 offset:12288
    ds_read_b64_tr_b16 v[114:115], v11 offset:18432
    v_mfma_f32_16x16x32_bf16 v[136:139], v[184:187], v[68:71], v[136:139]
    ds_read_b128 v[88:91], v240 offset:10240
    v_mfma_f32_16x16x32_bf16 v[140:143], v[176:179], v[72:75], v[140:143]
    ds_read_b128 v[92:95], v240 offset:11264
    v_mfma_f32_16x16x32_bf16 v[144:147], v[180:183], v[72:75], v[144:147]
    ds_read_b128 v[96:99], v240 offset:12288
    ds_write_b128 v241, v[32:35] offset:2048
    v_mfma_f32_16x16x32_bf16 v[148:151], v[184:187], v[72:75], v[148:151]
    ds_read_b128 v[100:103], v240 offset:13312
    v_mfma_f32_16x16x32_bf16 v[152:155], v[176:179], v[76:79], v[152:155]
    v_mfma_f32_16x16x32_bf16 v[156:159], v[180:183], v[76:79], v[156:159]
    ds_write_b128 v241, v[40:43] offset:3072
    v_mfma_f32_16x16x32_bf16 v[160:163], v[184:187], v[76:79], v[160:163]
    v_mfma_f32_16x16x32_bf16 v[164:167], v[176:179], v[80:83], v[164:167]
    v_mfma_f32_16x16x32_bf16 v[168:171], v[180:183], v[80:83], v[168:171]
    v_mfma_f32_16x16x32_bf16 v[172:175], v[184:187], v[80:83], v[172:175]
    s_waitcnt vmcnt(6) lgkmcnt(0)
    s_barrier
    v_mfma_f32_16x16x32_bf16 v[116:119], v[104:107], v[84:87], v[116:119]
    s_add_u32 m0, s37, 55296
    s_mov_b32 s40, 159744
    buffer_load_dwordx4 v6, s[28:31], s40 offen offset:0 nt lds
    ds_read_b64_tr_b16 v[176:177], v12 offset:24576
    ds_read_b64_tr_b16 v[178:179], v12 offset:30720
    v_add_f32 v221, v222, v223
    v_add_f32 v222, v224, v225
    v_add_f32 v223, v226, v227
    v_mfma_f32_16x16x32_bf16 v[120:123], v[108:111], v[84:87], v[120:123]
    ds_read_b128 v[64:67], v240 offset:18432
    v_add_f32 v224, v228, v229
    v_add_f32 v225, v230, v231
    v_add_f32 v226, v232, v233
    v_mfma_f32_16x16x32_bf16 v[124:127], v[112:115], v[84:87], v[124:127]
    s_add_u32 m0, s37, 56192
    s_mov_b32 s40, 159744
    buffer_load_dwordx4 v6, s[28:31], s40 offen offset:128 nt lds
    ds_read_b64_tr_b16 v[180:181], v13 offset:24576
    v_add_f32 v227, v234, v235
    v_add_f32 v228, v236, v237
    v_add_f32 v229, v238, v239
    v_mfma_f32_16x16x32_bf16 v[128:131], v[104:107], v[88:91], v[128:131]
    ds_read_b64_tr_b16 v[182:183], v13 offset:30720
    v_mov_b32 v212, 0
    v_mov_b32 v213, 0
    v_mfma_f32_16x16x32_bf16 v[132:135], v[108:111], v[88:91], v[132:135]
    s_add_u32 m0, s37, 57088
    s_mov_b32 s40, 159744
    buffer_load_dwordx4 v6, s[28:31], s40 offen offset:256 nt lds
    ds_read_b64_tr_b16 v[184:185], v14 offset:24576
    v_bfe_u32 v246, v1, 4, 1
    v_lshlrev_b32 v246, 10, v246
    v_bfe_u32 v247, v1, 5, 1
    v_mfma_f32_16x16x32_bf16 v[136:139], v[112:115], v[88:91], v[136:139]
    ds_read_b64_tr_b16 v[186:187], v14 offset:30720
    v_lshlrev_b32 v247, 9, v247
    v_add_u32 v246, v246, v247
    v_and_b32 v247, 15, v1
    v_mfma_f32_16x16x32_bf16 v[140:143], v[104:107], v[92:95], v[140:143]
    ds_read_b128 v[68:71], v240 offset:19456
    v_lshlrev_b32 v247, 5, v247
    v_add_u32 v246, v246, v247
    s_lshl_b32 s41, s36, 2
    v_mfma_f32_16x16x32_bf16 v[144:147], v[108:111], v[92:95], v[144:147]
    ds_read_b128 v[72:75], v240 offset:20480
    s_add_u32 s41, s41, 155648
    v_add_u32 v246, s41, v246
    v_mfma_f32_16x16x32_bf16 v[148:151], v[112:115], v[92:95], v[148:151]
    ds_read_b128 v[76:79], v240 offset:21504
    v_permlane32_swap_b32 v221, v222
    v_permlane32_swap_b32 v223, v224
    v_permlane32_swap_b32 v225, v226
    v_mfma_f32_16x16x32_bf16 v[152:155], v[104:107], v[96:99], v[152:155]
    ds_read_b128 v[80:83], v240 offset:22528
    v_permlane32_swap_b32 v227, v228
    v_permlane32_swap_b32 v229, v212
    v_add_f32 v221, v221, v222
    v_mfma_f32_16x16x32_bf16 v[156:159], v[108:111], v[96:99], v[156:159]
    v_add_f32 v223, v223, v224
    v_add_f32 v225, v225, v226
    v_add_f32 v227, v227, v228
    v_mfma_f32_16x16x32_bf16 v[160:163], v[112:115], v[96:99], v[160:163]
    v_add_f32 v229, v229, v212
    v_permlane16_swap_b32 v221, v223
    v_mfma_f32_16x16x32_bf16 v[164:167], v[104:107], v[100:103], v[164:167]
    v_permlane16_swap_b32 v225, v227
    v_permlane16_swap_b32 v229, v213
    v_add_f32 v221, v221, v223
    v_mfma_f32_16x16x32_bf16 v[168:171], v[108:111], v[100:103], v[168:171]
    v_add_f32 v225, v225, v227
    v_add_f32 v229, v229, v213
    ds_write_b32 v246, v221 offset:0
    v_mfma_f32_16x16x32_bf16 v[172:175], v[112:115], v[100:103], v[172:175]
    ds_write_b32 v246, v225 offset:2048
    ds_write_b32 v246, v229 offset:4096
    s_waitcnt lgkmcnt(0)
    v_mfma_f32_16x16x32_bf16 v[116:119], v[176:179], v[64:67], v[116:119]
    ds_read_b64_tr_b16 v[104:105], v12 offset:36864
    ds_read_b64_tr_b16 v[106:107], v12 offset:43008
    v_mfma_f32_16x16x32_bf16 v[120:123], v[180:183], v[64:67], v[120:123]
    ds_read_b128 v[84:87], v240 offset:27648
    v_mfma_f32_16x16x32_bf16 v[124:127], v[184:187], v[64:67], v[124:127]
    ds_read_b64_tr_b16 v[108:109], v13 offset:36864
    v_mfma_f32_16x16x32_bf16 v[128:131], v[176:179], v[68:71], v[128:131]
    ds_read_b64_tr_b16 v[110:111], v13 offset:43008
    v_mfma_f32_16x16x32_bf16 v[132:135], v[180:183], v[68:71], v[132:135]
    ds_read_b64_tr_b16 v[112:113], v14 offset:36864
    ds_read_b64_tr_b16 v[114:115], v14 offset:43008
    v_mfma_f32_16x16x32_bf16 v[136:139], v[184:187], v[68:71], v[136:139]
    ds_read_b128 v[88:91], v240 offset:28672
    v_mfma_f32_16x16x32_bf16 v[140:143], v[176:179], v[72:75], v[140:143]
    ds_read_b128 v[92:95], v240 offset:29696
    v_mfma_f32_16x16x32_bf16 v[144:147], v[180:183], v[72:75], v[144:147]
    ds_read_b128 v[96:99], v240 offset:30720
    v_mfma_f32_16x16x32_bf16 v[148:151], v[184:187], v[72:75], v[148:151]
    ds_read_b128 v[100:103], v240 offset:31744
    v_mfma_f32_16x16x32_bf16 v[152:155], v[176:179], v[76:79], v[152:155]
    v_mfma_f32_16x16x32_bf16 v[156:159], v[180:183], v[76:79], v[156:159]
    v_mfma_f32_16x16x32_bf16 v[160:163], v[184:187], v[76:79], v[160:163]
    v_mfma_f32_16x16x32_bf16 v[164:167], v[176:179], v[80:83], v[164:167]
    v_mfma_f32_16x16x32_bf16 v[168:171], v[180:183], v[80:83], v[168:171]
    v_mfma_f32_16x16x32_bf16 v[172:175], v[184:187], v[80:83], v[172:175]
    s_waitcnt vmcnt(6) lgkmcnt(0)
    s_barrier
    v_mfma_f32_16x16x32_bf16 v[116:119], v[104:107], v[84:87], v[116:119]
    s_add_u32 m0, s98, 49152
    s_add_u32 s40, s81, s94
    buffer_load_dwordx4 v2, s[16:19], s40 offen lds
    ds_read_b64_tr_b16 v[176:177], v9 offset:24576
    ds_read_b64_tr_b16 v[178:179], v9 offset:30720
    v_mfma_f32_16x16x32_bf16 v[120:123], v[108:111], v[84:87], v[120:123]
    ds_read_b128 v[64:67], v240 offset:36864
    v_mfma_f32_16x16x32_bf16 v[124:127], v[112:115], v[84:87], v[124:127]
    ds_read_b64_tr_b16 v[180:181], v10 offset:24576
    v_mfma_f32_16x16x32_bf16 v[128:131], v[104:107], v[88:91], v[128:131]
    s_add_u32 m0, s98, 50176
    s_nop 0
    buffer_load_dwordx4 v3, s[16:19], s40 offen lds
    ds_read_b64_tr_b16 v[182:183], v10 offset:30720
    v_mfma_f32_16x16x32_bf16 v[132:135], v[108:111], v[88:91], v[132:135]
    ds_read_b64_tr_b16 v[184:185], v11 offset:24576
    v_mfma_f32_16x16x32_bf16 v[136:139], v[112:115], v[88:91], v[136:139]
    ds_read_b64_tr_b16 v[186:187], v11 offset:30720
    v_mfma_f32_16x16x32_bf16 v[140:143], v[104:107], v[92:95], v[140:143]
    s_add_u32 m0, s98, 51200
    s_nop 0
    buffer_load_dwordx4 v4, s[16:19], s40 offen lds
    ds_read_b128 v[68:71], v240 offset:37888
    v_mfma_f32_16x16x32_bf16 v[144:147], v[108:111], v[92:95], v[144:147]
    ds_read_b128 v[72:75], v240 offset:38912
    v_mfma_f32_16x16x32_bf16 v[148:151], v[112:115], v[92:95], v[148:151]
    ds_read_b128 v[76:79], v240 offset:39936
    v_mfma_f32_16x16x32_bf16 v[152:155], v[104:107], v[96:99], v[152:155]
    s_add_u32 m0, s98, 52224
    s_nop 0
    buffer_load_dwordx4 v5, s[16:19], s40 offen lds
    ds_read_b128 v[80:83], v240 offset:40960
    v_mfma_f32_16x16x32_bf16 v[156:159], v[108:111], v[96:99], v[156:159]
    v_mfma_f32_16x16x32_bf16 v[160:163], v[112:115], v[96:99], v[160:163]
    v_mfma_f32_16x16x32_bf16 v[164:167], v[104:107], v[100:103], v[164:167]
    s_add_u32 m0, s98, 53248
    s_nop 0
    buffer_load_dwordx4 v7, s[16:19], s40 offen lds
    v_mfma_f32_16x16x32_bf16 v[168:171], v[108:111], v[100:103], v[168:171]
    v_mfma_f32_16x16x32_bf16 v[172:175], v[112:115], v[100:103], v[172:175]
    s_waitcnt lgkmcnt(0)
    v_mfma_f32_16x16x32_bf16 v[116:119], v[176:179], v[64:67], v[116:119]
    ds_read_b64_tr_b16 v[104:105], v9 offset:36864
    ds_read_b64_tr_b16 v[106:107], v9 offset:43008
    v_mfma_f32_16x16x32_bf16 v[120:123], v[180:183], v[64:67], v[120:123]
    ds_read_b128 v[84:87], v240 offset:46080
    v_mfma_f32_16x16x32_bf16 v[124:127], v[184:187], v[64:67], v[124:127]
    ds_read_b64_tr_b16 v[108:109], v10 offset:36864
    v_mfma_f32_16x16x32_bf16 v[128:131], v[176:179], v[68:71], v[128:131]
    ds_read_b64_tr_b16 v[110:111], v10 offset:43008
    v_mfma_f32_16x16x32_bf16 v[132:135], v[180:183], v[68:71], v[132:135]
    ds_read_b64_tr_b16 v[112:113], v11 offset:36864
    ds_read_b64_tr_b16 v[114:115], v11 offset:43008
    v_mfma_f32_16x16x32_bf16 v[136:139], v[184:187], v[68:71], v[136:139]
    ds_read_b128 v[88:91], v240 offset:47104
    v_mfma_f32_16x16x32_bf16 v[140:143], v[176:179], v[72:75], v[140:143]
    ds_read_b128 v[92:95], v240 offset:48128
    v_mfma_f32_16x16x32_bf16 v[144:147], v[180:183], v[72:75], v[144:147]
    ds_read_b128 v[96:99], v240 offset:49152
    v_mfma_f32_16x16x32_bf16 v[148:151], v[184:187], v[72:75], v[148:151]
    ds_read_b128 v[100:103], v240 offset:50176
    v_mfma_f32_16x16x32_bf16 v[152:155], v[176:179], v[76:79], v[152:155]
    v_mfma_f32_16x16x32_bf16 v[156:159], v[180:183], v[76:79], v[156:159]
    v_mfma_f32_16x16x32_bf16 v[160:163], v[184:187], v[76:79], v[160:163]
    v_mfma_f32_16x16x32_bf16 v[164:167], v[176:179], v[80:83], v[164:167]
    v_mfma_f32_16x16x32_bf16 v[168:171], v[180:183], v[80:83], v[168:171]
    v_mfma_f32_16x16x32_bf16 v[172:175], v[184:187], v[80:83], v[172:175]
    s_waitcnt vmcnt(8) lgkmcnt(0)
    s_barrier
    v_mfma_f32_16x16x32_bf16 v[116:119], v[104:107], v[84:87], v[116:119]
    s_add_u32 m0, s98, 0
    s_add_u32 s40, s82, s94
    buffer_load_dwordx4 v2, s[16:19], s40 offen lds
    ds_read_b64_tr_b16 v[176:177], v12 offset:0
    ds_read_b64_tr_b16 v[178:179], v12 offset:6144
    v_mfma_f32_16x16x32_bf16 v[120:123], v[108:111], v[84:87], v[120:123]
    ds_read_b128 v[64:67], v240 offset:0
    v_mfma_f32_16x16x32_bf16 v[124:127], v[112:115], v[84:87], v[124:127]
    ds_read_b64_tr_b16 v[180:181], v13 offset:0
    v_mfma_f32_16x16x32_bf16 v[128:131], v[104:107], v[88:91], v[128:131]
    s_add_u32 m0, s98, 1024
    s_nop 0
    buffer_load_dwordx4 v3, s[16:19], s40 offen lds
    ds_read_b64_tr_b16 v[182:183], v13 offset:6144
    v_mfma_f32_16x16x32_bf16 v[132:135], v[108:111], v[88:91], v[132:135]
    ds_read_b64_tr_b16 v[184:185], v14 offset:0
    v_mfma_f32_16x16x32_bf16 v[136:139], v[112:115], v[88:91], v[136:139]
    ds_read_b64_tr_b16 v[186:187], v14 offset:6144
    v_mfma_f32_16x16x32_bf16 v[140:143], v[104:107], v[92:95], v[140:143]
    s_add_u32 m0, s98, 2048
    s_nop 0
    buffer_load_dwordx4 v4, s[16:19], s40 offen lds
    ds_read_b128 v[68:71], v240 offset:1024
    v_mfma_f32_16x16x32_bf16 v[144:147], v[108:111], v[92:95], v[144:147]
    ds_read_b128 v[72:75], v240 offset:2048
    v_mfma_f32_16x16x32_bf16 v[148:151], v[112:115], v[92:95], v[148:151]
    ds_read_b128 v[76:79], v240 offset:3072
    v_mfma_f32_16x16x32_bf16 v[152:155], v[104:107], v[96:99], v[152:155]
    s_add_u32 m0, s98, 3072
    s_nop 0
    buffer_load_dwordx4 v5, s[16:19], s40 offen lds
    ds_read_b128 v[80:83], v240 offset:4096
    v_mfma_f32_16x16x32_bf16 v[156:159], v[108:111], v[96:99], v[156:159]
    v_mfma_f32_16x16x32_bf16 v[160:163], v[112:115], v[96:99], v[160:163]
    v_mfma_f32_16x16x32_bf16 v[164:167], v[104:107], v[100:103], v[164:167]
    s_add_u32 m0, s98, 4096
    s_nop 0
    buffer_load_dwordx4 v7, s[16:19], s40 offen lds
    v_mfma_f32_16x16x32_bf16 v[168:171], v[108:111], v[100:103], v[168:171]
    v_mfma_f32_16x16x32_bf16 v[172:175], v[112:115], v[100:103], v[172:175]
    s_waitcnt lgkmcnt(0)
    v_mfma_f32_16x16x32_bf16 v[116:119], v[176:179], v[64:67], v[116:119]
    ds_read_b64_tr_b16 v[104:105], v12 offset:12288
    ds_read_b64_tr_b16 v[106:107], v12 offset:18432
    v_mfma_f32_16x16x32_bf16 v[120:123], v[180:183], v[64:67], v[120:123]
    ds_read_b128 v[84:87], v240 offset:9216
    v_mfma_f32_16x16x32_bf16 v[124:127], v[184:187], v[64:67], v[124:127]
    ds_read_b64_tr_b16 v[108:109], v13 offset:12288
    v_mfma_f32_16x16x32_bf16 v[128:131], v[176:179], v[68:71], v[128:131]
    ds_read_b64_tr_b16 v[110:111], v13 offset:18432
    v_mfma_f32_16x16x32_bf16 v[132:135], v[180:183], v[68:71], v[132:135]
    ds_read_b64_tr_b16 v[112:113], v14 offset:12288
    ds_read_b64_tr_b16 v[114:115], v14 offset:18432
    v_mfma_f32_16x16x32_bf16 v[136:139], v[184:187], v[68:71], v[136:139]
    ds_read_b128 v[88:91], v240 offset:10240
    v_mfma_f32_16x16x32_bf16 v[140:143], v[176:179], v[72:75], v[140:143]
    ds_read_b128 v[92:95], v240 offset:11264
    v_mfma_f32_16x16x32_bf16 v[144:147], v[180:183], v[72:75], v[144:147]
    ds_read_b128 v[96:99], v240 offset:12288
    v_mfma_f32_16x16x32_bf16 v[148:151], v[184:187], v[72:75], v[148:151]
    ds_read_b128 v[100:103], v240 offset:13312
    v_mfma_f32_16x16x32_bf16 v[152:155], v[176:179], v[76:79], v[152:155]
    v_mfma_f32_16x16x32_bf16 v[156:159], v[180:183], v[76:79], v[156:159]
    v_mfma_f32_16x16x32_bf16 v[160:163], v[184:187], v[76:79], v[160:163]
    v_mfma_f32_16x16x32_bf16 v[164:167], v[176:179], v[80:83], v[164:167]
    v_mfma_f32_16x16x32_bf16 v[168:171], v[180:183], v[80:83], v[168:171]
    v_mfma_f32_16x16x32_bf16 v[172:175], v[184:187], v[80:83], v[172:175]
    s_waitcnt vmcnt(10) lgkmcnt(0)
    s_barrier
    v_mfma_f32_16x16x32_bf16 v[116:119], v[104:107], v[84:87], v[116:119]
    s_add_u32 m0, s98, 24576
    s_add_u32 s40, s83, s94
    buffer_load_dwordx4 v2, s[16:19], s40 offen lds
    ds_read_b64_tr_b16 v[176:177], v9 offset:0
    ds_read_b64_tr_b16 v[178:179], v9 offset:6144
    v_and_b32 v246, 15, v1
    v_lshlrev_b32 v246, 5, v246
    v_mfma_f32_16x16x32_bf16 v[120:123], v[108:111], v[84:87], v[120:123]
    ds_read_b128 v[64:67], v240 offset:18432
    v_add_u32 v246, 155648, v246
    ds_read_b128 v[16:19], v246 offset:0
    v_mfma_f32_16x16x32_bf16 v[124:127], v[112:115], v[84:87], v[124:127]
    ds_read_b64_tr_b16 v[180:181], v10 offset:0
    ds_read_b128 v[20:23], v246 offset:16
    ds_read_b128 v[24:27], v246 offset:512
    v_mfma_f32_16x16x32_bf16 v[128:131], v[104:107], v[88:91], v[128:131]
    s_add_u32 m0, s98, 25600
    s_nop 0
    buffer_load_dwordx4 v3, s[16:19], s40 offen lds
    ds_read_b64_tr_b16 v[182:183], v10 offset:6144
    ds_read_b128 v[28:31], v246 offset:528
    v_mfma_f32_16x16x32_bf16 v[132:135], v[108:111], v[88:91], v[132:135]
    ds_read_b64_tr_b16 v[184:185], v11 offset:0
    ds_read_b128 v[32:35], v246 offset:1024
    ds_read_b128 v[36:39], v246 offset:1040
    v_mfma_f32_16x16x32_bf16 v[136:139], v[112:115], v[88:91], v[136:139]
    ds_read_b64_tr_b16 v[186:187], v11 offset:6144
    ds_read_b128 v[40:43], v246 offset:1536
    ds_read_b128 v[44:47], v246 offset:1552
    v_mfma_f32_16x16x32_bf16 v[140:143], v[104:107], v[92:95], v[140:143]
    s_add_u32 m0, s98, 26624
    s_nop 0
    buffer_load_dwordx4 v4, s[16:19], s40 offen lds
    ds_read_b128 v[68:71], v240 offset:19456
    ds_read_b128 v[48:51], v246 offset:2048
    ds_read_b128 v[52:55], v246 offset:2064
    v_mfma_f32_16x16x32_bf16 v[144:147], v[108:111], v[92:95], v[144:147]
    ds_read_b128 v[72:75], v240 offset:20480
    s_waitcnt lgkmcnt(15)
    v_add_f32 v16, v16, v17
    v_mfma_f32_16x16x32_bf16 v[148:151], v[112:115], v[92:95], v[148:151]
    ds_read_b128 v[76:79], v240 offset:21504
    v_add_f32 v18, v18, v19
    s_waitcnt lgkmcnt(14)
    v_add_f32 v20, v20, v21
    v_mfma_f32_16x16x32_bf16 v[152:155], v[104:107], v[96:99], v[152:155]
    s_add_u32 m0, s98, 27648
    s_nop 0
    buffer_load_dwordx4 v5, s[16:19], s40 offen lds
    ds_read_b128 v[80:83], v240 offset:22528
    v_add_f32 v22, v22, v23
    v_add_f32 v16, v16, v18
    v_mfma_f32_16x16x32_bf16 v[156:159], v[108:111], v[96:99], v[156:159]
    v_add_f32 v20, v20, v22
    v_add_f32 v16, v16, v20
    v_mfma_f32_16x16x32_bf16 v[160:163], v[112:115], v[96:99], v[160:163]
    v_rcp_f32 v212, v16
    v_mfma_f32_16x16x32_bf16 v[164:167], v[104:107], v[100:103], v[164:167]
    s_add_u32 m0, s98, 28672
    s_nop 0
    buffer_load_dwordx4 v7, s[16:19], s40 offen lds
    s_waitcnt lgkmcnt(14)
    v_add_f32 v24, v24, v25
    v_add_f32 v26, v26, v27
    v_mfma_f32_16x16x32_bf16 v[168:171], v[108:111], v[100:103], v[168:171]
    s_waitcnt lgkmcnt(12)
    v_add_f32 v28, v28, v29
    v_add_f32 v30, v30, v31
    v_mfma_f32_16x16x32_bf16 v[172:175], v[112:115], v[100:103], v[172:175]
    v_add_f32 v24, v24, v26
    s_waitcnt lgkmcnt(0)
    v_mfma_f32_16x16x32_bf16 v[116:119], v[176:179], v[64:67], v[116:119]
    ds_read_b64_tr_b16 v[104:105], v9 offset:12288
    ds_read_b64_tr_b16 v[106:107], v9 offset:18432
    v_add_f32 v28, v28, v30
    v_add_f32 v24, v24, v28
    v_mfma_f32_16x16x32_bf16 v[120:123], v[180:183], v[64:67], v[120:123]
    ds_read_b128 v[84:87], v240 offset:27648
    v_rcp_f32 v214, v24
    v_add_f32 v32, v32, v33
    v_mfma_f32_16x16x32_bf16 v[124:127], v[184:187], v[64:67], v[124:127]
    ds_read_b64_tr_b16 v[108:109], v10 offset:12288
    v_add_f32 v34, v34, v35
    v_add_f32 v36, v36, v37
    v_mfma_f32_16x16x32_bf16 v[128:131], v[176:179], v[68:71], v[128:131]
    ds_read_b64_tr_b16 v[110:111], v10 offset:18432
    v_add_f32 v38, v38, v39
    v_add_f32 v32, v32, v34
    v_mfma_f32_16x16x32_bf16 v[132:135], v[180:183], v[68:71], v[132:135]
    ds_read_b64_tr_b16 v[112:113], v11 offset:12288
    ds_read_b64_tr_b16 v[114:115], v11 offset:18432
    v_add_f32 v36, v36, v38
    v_add_f32 v32, v32, v36
    v_mfma_f32_16x16x32_bf16 v[136:139], v[184:187], v[68:71], v[136:139]
    ds_read_b128 v[88:91], v240 offset:28672
    v_rcp_f32 v216, v32
    v_add_f32 v40, v40, v41
    v_mfma_f32_16x16x32_bf16 v[140:143], v[176:179], v[72:75], v[140:143]
    ds_read_b128 v[92:95], v240 offset:29696
    v_add_f32 v42, v42, v43
    v_add_f32 v44, v44, v45
    v_mfma_f32_16x16x32_bf16 v[144:147], v[180:183], v[72:75], v[144:147]
    ds_read_b128 v[96:99], v240 offset:30720
    v_add_f32 v46, v46, v47
    v_add_f32 v40, v40, v42
    v_mfma_f32_16x16x32_bf16 v[148:151], v[184:187], v[72:75], v[148:151]
    ds_read_b128 v[100:103], v240 offset:31744
    v_add_f32 v44, v44, v46
    v_add_f32 v40, v40, v44
    v_mfma_f32_16x16x32_bf16 v[152:155], v[176:179], v[76:79], v[152:155]
    v_rcp_f32 v218, v40
    v_mfma_f32_16x16x32_bf16 v[156:159], v[180:183], v[76:79], v[156:159]
    v_add_f32 v48, v48, v49
    v_add_f32 v50, v50, v51
    v_mfma_f32_16x16x32_bf16 v[160:163], v[184:187], v[76:79], v[160:163]
    v_add_f32 v52, v52, v53
    v_add_f32 v54, v54, v55
    v_mfma_f32_16x16x32_bf16 v[164:167], v[176:179], v[80:83], v[164:167]
    v_add_f32 v48, v48, v50
    v_add_f32 v52, v52, v54
    v_mfma_f32_16x16x32_bf16 v[168:171], v[180:183], v[80:83], v[168:171]
    v_add_f32 v48, v48, v52
    v_rcp_f32 v220, v48
    v_mfma_f32_16x16x32_bf16 v[172:175], v[184:187], v[80:83], v[172:175]
    s_waitcnt lgkmcnt(0)
    s_barrier
    v_mfma_f32_16x16x32_bf16 v[116:119], v[104:107], v[84:87], v[116:119]
    v_mfma_f32_16x16x32_bf16 v[120:123], v[108:111], v[84:87], v[120:123]
    v_mfma_f32_16x16x32_bf16 v[124:127], v[112:115], v[84:87], v[124:127]
    v_mfma_f32_16x16x32_bf16 v[128:131], v[104:107], v[88:91], v[128:131]
    v_mfma_f32_16x16x32_bf16 v[132:135], v[108:111], v[88:91], v[132:135]
    v_mfma_f32_16x16x32_bf16 v[136:139], v[112:115], v[88:91], v[136:139]
    s_nop 2
    v_mul_f32 v116, v116, v212
    v_mul_f32 v117, v117, v212
    v_mul_f32 v118, v118, v212
    v_mul_f32 v119, v119, v212
    v_mul_f32 v120, v120, v212
    v_mul_f32 v121, v121, v212
    v_mul_f32 v122, v122, v212
    v_mul_f32 v123, v123, v212
    v_cvt_pk_bf16_f32 v116, v116, v117
    v_cvt_pk_bf16_f32 v117, v118, v119
    v_cvt_pk_bf16_f32 v118, v120, v121
    v_cvt_pk_bf16_f32 v119, v122, v123
    ds_write_b128 v8, v[116:119] offset:0
    s_mov_b32 s41, 0
    buffer_store_dwordx4 v[116:119], v254, s[32:35], s41 offen sc1
    v_mfma_f32_16x16x32_bf16 v[140:143], v[104:107], v[92:95], v[140:143]
    v_mul_f32 v124, v124, v212
    v_mul_f32 v125, v125, v212
    v_mul_f32 v126, v126, v212
    v_mul_f32 v127, v127, v212
    v_cvt_pk_bf16_f32 v124, v124, v125
    v_cvt_pk_bf16_f32 v125, v126, v127
    ds_write_b64 v255, v[124:125] offset:0
    v_mfma_f32_16x16x32_bf16 v[144:147], v[108:111], v[92:95], v[144:147]
    v_mfma_f32_16x16x32_bf16 v[148:151], v[112:115], v[92:95], v[148:151]
    v_mul_f32 v128, v128, v214
    v_mul_f32 v129, v129, v214
    v_mul_f32 v130, v130, v214
    v_mul_f32 v131, v131, v214
    v_mul_f32 v132, v132, v214
    v_mul_f32 v133, v133, v214
    v_mul_f32 v134, v134, v214
    v_mul_f32 v135, v135, v214
    v_cvt_pk_bf16_f32 v128, v128, v129
    v_cvt_pk_bf16_f32 v129, v130, v131
    v_cvt_pk_bf16_f32 v130, v132, v133
    v_cvt_pk_bf16_f32 v131, v134, v135
    ds_write_b128 v8, v[128:131] offset:1024
    s_mov_b32 s41, 1024
    buffer_store_dwordx4 v[128:131], v254, s[32:35], s41 offen sc1
    v_mfma_f32_16x16x32_bf16 v[152:155], v[104:107], v[96:99], v[152:155]
    v_mul_f32 v136, v136, v214
    v_mul_f32 v137, v137, v214
    v_mul_f32 v138, v138, v214
    v_mul_f32 v139, v139, v214
    v_cvt_pk_bf16_f32 v136, v136, v137
    v_cvt_pk_bf16_f32 v137, v138, v139
    ds_write_b64 v255, v[136:137] offset:1024
    v_mfma_f32_16x16x32_bf16 v[156:159], v[108:111], v[96:99], v[156:159]
    v_mfma_f32_16x16x32_bf16 v[160:163], v[112:115], v[96:99], v[160:163]
    v_mul_f32 v140, v140, v216
    v_mul_f32 v141, v141, v216
    v_mul_f32 v142, v142, v216
    v_mul_f32 v143, v143, v216
    v_mul_f32 v144, v144, v216
    v_mul_f32 v145, v145, v216
    v_mul_f32 v146, v146, v216
    v_mul_f32 v147, v147, v216
    v_cvt_pk_bf16_f32 v140, v140, v141
    v_cvt_pk_bf16_f32 v141, v142, v143
    v_cvt_pk_bf16_f32 v142, v144, v145
    v_cvt_pk_bf16_f32 v143, v146, v147
    ds_write_b128 v8, v[140:143] offset:2048
    s_mov_b32 s41, 2048
    buffer_store_dwordx4 v[140:143], v254, s[32:35], s41 offen sc1
    v_mfma_f32_16x16x32_bf16 v[164:167], v[104:107], v[100:103], v[164:167]
    v_mul_f32 v148, v148, v216
    v_mul_f32 v149, v149, v216
    v_mul_f32 v150, v150, v216
    v_mul_f32 v151, v151, v216
    v_cvt_pk_bf16_f32 v148, v148, v149
    v_cvt_pk_bf16_f32 v149, v150, v151
    ds_write_b64 v255, v[148:149] offset:2048
    v_mfma_f32_16x16x32_bf16 v[168:171], v[108:111], v[100:103], v[168:171]
    v_mfma_f32_16x16x32_bf16 v[172:175], v[112:115], v[100:103], v[172:175]
    v_mul_f32 v152, v152, v218
    v_mul_f32 v153, v153, v218
    v_mul_f32 v154, v154, v218
    v_mul_f32 v155, v155, v218
    v_mul_f32 v156, v156, v218
    v_mul_f32 v157, v157, v218
    v_mul_f32 v158, v158, v218
    v_mul_f32 v159, v159, v218
    v_cvt_pk_bf16_f32 v152, v152, v153
    v_cvt_pk_bf16_f32 v153, v154, v155
    v_cvt_pk_bf16_f32 v154, v156, v157
    v_cvt_pk_bf16_f32 v155, v158, v159
    ds_write_b128 v8, v[152:155] offset:3072
    s_mov_b32 s41, 3072
    buffer_store_dwordx4 v[152:155], v254, s[32:35], s41 offen sc1
    v_pk_mul_f32 v[160:161], v[160:161], v[218:219] op_sel_hi:[1,0]
    v_pk_mul_f32 v[162:163], v[162:163], v[218:219] op_sel_hi:[1,0]
    v_cvt_pk_bf16_f32 v160, v160, v161
    v_cvt_pk_bf16_f32 v161, v162, v163
    ds_write_b64 v255, v[160:161] offset:3072
    v_pk_mul_f32 v[164:165], v[164:165], v[220:221] op_sel_hi:[1,0]
    v_pk_mul_f32 v[166:167], v[166:167], v[220:221] op_sel_hi:[1,0]
    v_pk_mul_f32 v[168:169], v[168:169], v[220:221] op_sel_hi:[1,0]
    v_pk_mul_f32 v[170:171], v[170:171], v[220:221] op_sel_hi:[1,0]
    v_cvt_pk_bf16_f32 v164, v164, v165
    v_cvt_pk_bf16_f32 v165, v166, v167
    v_cvt_pk_bf16_f32 v166, v168, v169
    v_cvt_pk_bf16_f32 v167, v170, v171
    ds_write_b128 v8, v[164:167] offset:4096
    s_mov_b32 s41, 4096
    buffer_store_dwordx4 v[164:167], v254, s[32:35], s41 offen sc1
    v_pk_mul_f32 v[172:173], v[172:173], v[220:221] op_sel_hi:[1,0]
    v_pk_mul_f32 v[174:175], v[174:175], v[220:221] op_sel_hi:[1,0]
    v_cvt_pk_bf16_f32 v172, v172, v173
    v_cvt_pk_bf16_f32 v173, v174, v175
    ds_write_b64 v255, v[172:173] offset:4096
    s_waitcnt vmcnt(15) lgkmcnt(0)
    s_barrier
    s_bitcmp1_b32 s36, 1
    s_cbranch_scc1 L_tail1
    v_lshlrev_b32 v56, 4, v0
    v_add_u32 v57, 0, v56
    ds_read_b128 v[176:179], v57 offset:40960
    ds_read_b128 v[180:183], v57 offset:49152
    ds_read_b128 v[184:187], v57 offset:57344
    s_mov_b32 s41, 36864
    s_waitcnt lgkmcnt(2)
    buffer_store_dwordx4 v[176:179], v56, s[32:35], s41 offen sc1
    s_mov_b32 s41, 45056
    s_waitcnt lgkmcnt(1)
    buffer_store_dwordx4 v[180:183], v56, s[32:35], s41 offen sc1
    s_mov_b32 s41, 53248
    s_waitcnt lgkmcnt(0)
    buffer_store_dwordx4 v[184:187], v56, s[32:35], s41 offen sc1
    ds_read_b64_tr_b16 v[76:77], v248 offset:49152
    ds_read_b64_tr_b16 v[78:79], v248 offset:54272
    ds_read_b128 v[16:19], v251 offset:0
    ds_read_b64_tr_b16 v[80:81], v249 offset:49152
    ds_read_b64_tr_b16 v[82:83], v249 offset:54272
    ds_read_b64_tr_b16 v[84:85], v250 offset:49152
    ds_read_b64_tr_b16 v[86:87], v250 offset:54272
    ds_read_b128 v[20:23], v251 offset:1024
    ds_read_b128 v[24:27], v251 offset:2048
    ds_read_b128 v[28:31], v251 offset:3072
    ds_read_b128 v[32:35], v251 offset:4096
    v_lshlrev_b32 v57, 4, v1
    s_and_b32 s42, s36, 1
    s_add_u32 s43, s42, 0
    s_mul_i32 s43, s43, 9
    s_add_u32 s43, s43, s99
    s_lshl_b32 s43, s43, 10
    v_add_u32 v58, s43, v57
    s_mul_i32 s42, s42, 5120
    s_add_u32 s42, s42, 36864
    v_add_u32 v59, s42, v57
    s_waitcnt lgkmcnt(8)
    v_mfma_f32_16x16x32_bf16 v[116:119], v[76:79], v[16:19], 0
    ds_read_b64_tr_b16 v[88:89], v248 offset:59392
    ds_read_b64_tr_b16 v[90:91], v248 offset:64512
    s_waitcnt lgkmcnt(8)
    v_mfma_f32_16x16x32_bf16 v[120:123], v[80:83], v[16:19], 0
    ds_read_b128 v[36:39], v251 offset:9216
    s_waitcnt lgkmcnt(7)
    v_mfma_f32_16x16x32_bf16 v[124:127], v[84:87], v[16:19], 0
    ds_read_b64_tr_b16 v[92:93], v249 offset:59392
    s_waitcnt lgkmcnt(7)
    v_mfma_f32_16x16x32_bf16 v[128:131], v[76:79], v[20:23], 0
    ds_read_b64_tr_b16 v[94:95], v249 offset:64512
    v_mfma_f32_16x16x32_bf16 v[132:135], v[80:83], v[20:23], 0
    ds_read_b64_tr_b16 v[96:97], v250 offset:59392
    ds_read_b64_tr_b16 v[98:99], v250 offset:64512
    v_mfma_f32_16x16x32_bf16 v[136:139], v[84:87], v[20:23], 0
    ds_read_b128 v[40:43], v251 offset:10240
    s_waitcnt lgkmcnt(10)
    v_mfma_f32_16x16x32_bf16 v[140:143], v[76:79], v[24:27], 0
    ds_read_b128 v[44:47], v251 offset:11264
    v_mfma_f32_16x16x32_bf16 v[144:147], v[80:83], v[24:27], 0
    ds_read_b128 v[48:51], v251 offset:12288
    v_mfma_f32_16x16x32_bf16 v[148:151], v[84:87], v[24:27], 0
    ds_read_b128 v[52:55], v251 offset:13312
    s_waitcnt lgkmcnt(12)
    v_mfma_f32_16x16x32_bf16 v[152:155], v[76:79], v[28:31], 0
    v_mfma_f32_16x16x32_bf16 v[156:159], v[80:83], v[28:31], 0
    v_mfma_f32_16x16x32_bf16 v[160:163], v[84:87], v[28:31], 0
    s_waitcnt lgkmcnt(11)
    v_mfma_f32_16x16x32_bf16 v[164:167], v[76:79], v[32:35], 0
    v_mfma_f32_16x16x32_bf16 v[168:171], v[80:83], v[32:35], 0
    v_mfma_f32_16x16x32_bf16 v[172:175], v[84:87], v[32:35], 0
    s_waitcnt vmcnt(3) lgkmcnt(0)
    s_barrier
    v_mfma_f32_16x16x32_bf16 v[116:119], v[88:91], v[36:39], v[116:119]
    s_add_u32 m0, s98, 49152
    s_add_u32 s40, s81, s95
    buffer_load_dwordx4 v2, s[16:19], s40 offen lds
    ds_read_b64_tr_b16 v[76:77], v248 offset:0
    ds_read_b64_tr_b16 v[78:79], v248 offset:5120
    v_mfma_f32_16x16x32_bf16 v[120:123], v[92:95], v[36:39], v[120:123]
    ds_read_b128 v[16:19], v251 offset:20480
    v_mfma_f32_16x16x32_bf16 v[124:127], v[96:99], v[36:39], v[124:127]
    ds_read_b64_tr_b16 v[80:81], v249 offset:0
    v_mfma_f32_16x16x32_bf16 v[128:131], v[88:91], v[40:43], v[128:131]
    ds_read_b64_tr_b16 v[82:83], v249 offset:5120
    v_mfma_f32_16x16x32_bf16 v[132:135], v[92:95], v[40:43], v[132:135]
    ds_read_b64_tr_b16 v[84:85], v250 offset:0
    ds_read_b64_tr_b16 v[86:87], v250 offset:5120
    v_mfma_f32_16x16x32_bf16 v[136:139], v[96:99], v[40:43], v[136:139]
    s_add_u32 m0, s98, 50176
    s_nop 0
    buffer_load_dwordx4 v3, s[16:19], s40 offen lds
    ds_read_b128 v[20:23], v251 offset:21504
    v_mfma_f32_16x16x32_bf16 v[140:143], v[88:91], v[44:47], v[140:143]
    ds_read_b128 v[24:27], v251 offset:22528
    v_mfma_f32_16x16x32_bf16 v[144:147], v[92:95], v[44:47], v[144:147]
    ds_read_b128 v[28:31], v251 offset:23552
    v_mfma_f32_16x16x32_bf16 v[148:151], v[96:99], v[44:47], v[148:151]
    ds_read_b128 v[32:35], v251 offset:24576
    v_mfma_f32_16x16x32_bf16 v[152:155], v[88:91], v[48:51], v[152:155]
    s_add_u32 m0, s98, 51200
    s_nop 0
    buffer_load_dwordx4 v4, s[16:19], s40 offen lds
    v_mfma_f32_16x16x32_bf16 v[156:159], v[92:95], v[48:51], v[156:159]
    v_mfma_f32_16x16x32_bf16 v[160:163], v[96:99], v[48:51], v[160:163]
    v_mfma_f32_16x16x32_bf16 v[164:167], v[88:91], v[52:55], v[164:167]
    v_mfma_f32_16x16x32_bf16 v[168:171], v[92:95], v[52:55], v[168:171]
    v_mfma_f32_16x16x32_bf16 v[172:175], v[96:99], v[52:55], v[172:175]
    s_waitcnt lgkmcnt(0)
    v_mfma_f32_16x16x32_bf16 v[116:119], v[76:79], v[16:19], v[116:119]
    ds_read_b64_tr_b16 v[88:89], v248 offset:10240
    ds_read_b64_tr_b16 v[90:91], v248 offset:15360
    s_add_u32 m0, s98, 52224
    s_nop 0
    buffer_load_dwordx4 v5, s[16:19], s40 offen lds
    v_mfma_f32_16x16x32_bf16 v[120:123], v[80:83], v[16:19], v[120:123]
    ds_read_b128 v[36:39], v251 offset:29696
    v_mfma_f32_16x16x32_bf16 v[124:127], v[84:87], v[16:19], v[124:127]
    ds_read_b64_tr_b16 v[92:93], v249 offset:10240
    v_mfma_f32_16x16x32_bf16 v[128:131], v[76:79], v[20:23], v[128:131]
    ds_read_b64_tr_b16 v[94:95], v249 offset:15360
    v_mfma_f32_16x16x32_bf16 v[132:135], v[80:83], v[20:23], v[132:135]
    ds_read_b64_tr_b16 v[96:97], v250 offset:10240
    ds_read_b64_tr_b16 v[98:99], v250 offset:15360
    v_mfma_f32_16x16x32_bf16 v[136:139], v[84:87], v[20:23], v[136:139]
    ds_read_b128 v[40:43], v251 offset:30720
    v_mfma_f32_16x16x32_bf16 v[140:143], v[76:79], v[24:27], v[140:143]
    ds_read_b128 v[44:47], v251 offset:31744
    v_mfma_f32_16x16x32_bf16 v[144:147], v[80:83], v[24:27], v[144:147]
    ds_read_b128 v[48:51], v251 offset:32768
    s_add_u32 m0, s98, 53248
    s_nop 0
    buffer_load_dwordx4 v7, s[16:19], s40 offen lds
    v_mfma_f32_16x16x32_bf16 v[148:151], v[84:87], v[24:27], v[148:151]
    ds_read_b128 v[52:55], v251 offset:33792
    v_mfma_f32_16x16x32_bf16 v[152:155], v[76:79], v[28:31], v[152:155]
    v_mfma_f32_16x16x32_bf16 v[156:159], v[80:83], v[28:31], v[156:159]
    v_mfma_f32_16x16x32_bf16 v[160:163], v[84:87], v[28:31], v[160:163]
    v_mfma_f32_16x16x32_bf16 v[164:167], v[76:79], v[32:35], v[164:167]
    v_mfma_f32_16x16x32_bf16 v[168:171], v[80:83], v[32:35], v[168:171]
    v_mfma_f32_16x16x32_bf16 v[172:175], v[84:87], v[32:35], v[172:175]
    s_waitcnt vmcnt(5)
    s_waitcnt lgkmcnt(0)
    s_barrier
    v_mfma_f32_16x16x32_bf16 v[116:119], v[88:91], v[36:39], v[116:119]
    s_add_u32 m0, s98, 0
    s_add_u32 s40, s81, s96
    buffer_load_dwordx4 v2, s[16:19], s40 offen lds
    ds_read_b64_tr_b16 v[76:77], v248 offset:24576
    ds_read_b64_tr_b16 v[78:79], v248 offset:29696
    v_mfma_f32_16x16x32_bf16 v[120:123], v[92:95], v[36:39], v[120:123]
    ds_read_b128 v[16:19], v251 offset:40960
    v_mfma_f32_16x16x32_bf16 v[124:127], v[96:99], v[36:39], v[124:127]
    ds_read_b64_tr_b16 v[80:81], v249 offset:24576
    v_mfma_f32_16x16x32_bf16 v[128:131], v[88:91], v[40:43], v[128:131]
    ds_read_b64_tr_b16 v[82:83], v249 offset:29696
    v_mfma_f32_16x16x32_bf16 v[132:135], v[92:95], v[40:43], v[132:135]
    ds_read_b64_tr_b16 v[84:85], v250 offset:24576
    ds_read_b64_tr_b16 v[86:87], v250 offset:29696
    v_mfma_f32_16x16x32_bf16 v[136:139], v[96:99], v[40:43], v[136:139]
    s_add_u32 m0, s98, 1024
    s_nop 0
    buffer_load_dwordx4 v3, s[16:19], s40 offen lds
    ds_read_b128 v[20:23], v251 offset:41984
    v_mfma_f32_16x16x32_bf16 v[140:143], v[88:91], v[44:47], v[140:143]
    ds_read_b128 v[24:27], v251 offset:43008
    v_mfma_f32_16x16x32_bf16 v[144:147], v[92:95], v[44:47], v[144:147]
    ds_read_b128 v[28:31], v251 offset:44032
    v_mfma_f32_16x16x32_bf16 v[148:151], v[96:99], v[44:47], v[148:151]
    ds_read_b128 v[32:35], v251 offset:45056
    v_mfma_f32_16x16x32_bf16 v[152:155], v[88:91], v[48:51], v[152:155]
    s_add_u32 m0, s98, 2048
    s_nop 0
    buffer_load_dwordx4 v4, s[16:19], s40 offen lds
    v_mfma_f32_16x16x32_bf16 v[156:159], v[92:95], v[48:51], v[156:159]
    v_mfma_f32_16x16x32_bf16 v[160:163], v[96:99], v[48:51], v[160:163]
    v_mfma_f32_16x16x32_bf16 v[164:167], v[88:91], v[52:55], v[164:167]
    v_mfma_f32_16x16x32_bf16 v[168:171], v[92:95], v[52:55], v[168:171]
    v_mfma_f32_16x16x32_bf16 v[172:175], v[96:99], v[52:55], v[172:175]
    s_waitcnt lgkmcnt(0)
    v_mfma_f32_16x16x32_bf16 v[116:119], v[76:79], v[16:19], v[116:119]
    ds_read_b64_tr_b16 v[88:89], v248 offset:34816
    ds_read_b64_tr_b16 v[90:91], v248 offset:39936
    s_add_u32 m0, s98, 3072
    s_nop 0
    buffer_load_dwordx4 v5, s[16:19], s40 offen lds
    v_mfma_f32_16x16x32_bf16 v[120:123], v[80:83], v[16:19], v[120:123]
    ds_read_b128 v[36:39], v251 offset:50176
    v_mfma_f32_16x16x32_bf16 v[124:127], v[84:87], v[16:19], v[124:127]
    ds_read_b64_tr_b16 v[92:93], v249 offset:34816
    v_mfma_f32_16x16x32_bf16 v[128:131], v[76:79], v[20:23], v[128:131]
    ds_read_b64_tr_b16 v[94:95], v249 offset:39936
    v_mfma_f32_16x16x32_bf16 v[132:135], v[80:83], v[20:23], v[132:135]
    ds_read_b64_tr_b16 v[96:97], v250 offset:34816
    ds_read_b64_tr_b16 v[98:99], v250 offset:39936
    v_mfma_f32_16x16x32_bf16 v[136:139], v[84:87], v[20:23], v[136:139]
    ds_read_b128 v[40:43], v251 offset:51200
    v_mfma_f32_16x16x32_bf16 v[140:143], v[76:79], v[24:27], v[140:143]
    ds_read_b128 v[44:47], v251 offset:52224
    v_mfma_f32_16x16x32_bf16 v[144:147], v[80:83], v[24:27], v[144:147]
    ds_read_b128 v[48:51], v251 offset:53248
    s_add_u32 m0, s98, 4096
    s_nop 0
    buffer_load_dwordx4 v7, s[16:19], s40 offen lds
    v_mfma_f32_16x16x32_bf16 v[148:151], v[84:87], v[24:27], v[148:151]
    ds_read_b128 v[52:55], v251 offset:54272
    v_mfma_f32_16x16x32_bf16 v[152:155], v[76:79], v[28:31], v[152:155]
    v_mfma_f32_16x16x32_bf16 v[156:159], v[80:83], v[28:31], v[156:159]
    v_mfma_f32_16x16x32_bf16 v[160:163], v[84:87], v[28:31], v[160:163]
    v_mfma_f32_16x16x32_bf16 v[164:167], v[76:79], v[32:35], v[164:167]
    v_mfma_f32_16x16x32_bf16 v[168:171], v[80:83], v[32:35], v[168:171]
    v_mfma_f32_16x16x32_bf16 v[172:175], v[84:87], v[32:35], v[172:175]
    s_waitcnt vmcnt(5) lgkmcnt(0)
    s_barrier
    v_mfma_f32_16x16x32_bf16 v[116:119], v[88:91], v[36:39], v[116:119]
    s_add_u32 m0, s98, 24576
    s_add_u32 s40, s81, s97
    buffer_load_dwordx4 v2, s[16:19], s40 offen lds
    ds_read_b64_tr_b16 v[76:77], v248 offset:49152
    ds_read_b64_tr_b16 v[78:79], v248 offset:54272
    v_mfma_f32_16x16x32_bf16 v[120:123], v[92:95], v[36:39], v[120:123]
    ds_read_b128 v[16:19], v251 offset:0
    v_mfma_f32_16x16x32_bf16 v[124:127], v[96:99], v[36:39], v[124:127]
    ds_read_b64_tr_b16 v[80:81], v249 offset:49152
    v_mfma_f32_16x16x32_bf16 v[128:131], v[88:91], v[40:43], v[128:131]
    ds_read_b64_tr_b16 v[82:83], v249 offset:54272
    v_mfma_f32_16x16x32_bf16 v[132:135], v[92:95], v[40:43], v[132:135]
    ds_read_b64_tr_b16 v[84:85], v250 offset:49152
    ds_read_b64_tr_b16 v[86:87], v250 offset:54272
    v_mfma_f32_16x16x32_bf16 v[136:139], v[96:99], v[40:43], v[136:139]
    s_add_u32 m0, s98, 25600
    s_nop 0
    buffer_load_dwordx4 v3, s[16:19], s40 offen lds
    ds_read_b128 v[20:23], v251 offset:1024
    v_mfma_f32_16x16x32_bf16 v[140:143], v[88:91], v[44:47], v[140:143]
    ds_read_b128 v[24:27], v251 offset:2048
    v_mfma_f32_16x16x32_bf16 v[144:147], v[92:95], v[44:47], v[144:147]
    ds_read_b128 v[28:31], v251 offset:3072
    v_mfma_f32_16x16x32_bf16 v[148:151], v[96:99], v[44:47], v[148:151]
    ds_read_b128 v[32:35], v251 offset:4096
    v_mfma_f32_16x16x32_bf16 v[152:155], v[88:91], v[48:51], v[152:155]
    s_add_u32 m0, s98, 26624
    s_nop 0
    buffer_load_dwordx4 v4, s[16:19], s40 offen lds
    v_mfma_f32_16x16x32_bf16 v[156:159], v[92:95], v[48:51], v[156:159]
    v_mfma_f32_16x16x32_bf16 v[160:163], v[96:99], v[48:51], v[160:163]
    v_mfma_f32_16x16x32_bf16 v[164:167], v[88:91], v[52:55], v[164:167]
    v_mfma_f32_16x16x32_bf16 v[168:171], v[92:95], v[52:55], v[168:171]
    v_mfma_f32_16x16x32_bf16 v[172:175], v[96:99], v[52:55], v[172:175]
    s_waitcnt lgkmcnt(0)
    v_mfma_f32_16x16x32_bf16 v[116:119], v[76:79], v[16:19], v[116:119]
    ds_read_b64_tr_b16 v[88:89], v248 offset:59392
    ds_read_b64_tr_b16 v[90:91], v248 offset:64512
    s_add_u32 m0, s98, 27648
    s_nop 0
    buffer_load_dwordx4 v5, s[16:19], s40 offen lds
    v_mfma_f32_16x16x32_bf16 v[120:123], v[80:83], v[16:19], v[120:123]
    ds_read_b128 v[36:39], v251 offset:9216
    v_mfma_f32_16x16x32_bf16 v[124:127], v[84:87], v[16:19], v[124:127]
    ds_read_b64_tr_b16 v[92:93], v249 offset:59392
    v_mfma_f32_16x16x32_bf16 v[128:131], v[76:79], v[20:23], v[128:131]
    ds_read_b64_tr_b16 v[94:95], v249 offset:64512
    v_mfma_f32_16x16x32_bf16 v[132:135], v[80:83], v[20:23], v[132:135]
    ds_read_b64_tr_b16 v[96:97], v250 offset:59392
    ds_read_b64_tr_b16 v[98:99], v250 offset:64512
    v_mfma_f32_16x16x32_bf16 v[136:139], v[84:87], v[20:23], v[136:139]
    ds_read_b128 v[40:43], v251 offset:10240
    v_mfma_f32_16x16x32_bf16 v[140:143], v[76:79], v[24:27], v[140:143]
    ds_read_b128 v[44:47], v251 offset:11264
    v_mfma_f32_16x16x32_bf16 v[144:147], v[80:83], v[24:27], v[144:147]
    ds_read_b128 v[48:51], v251 offset:12288
    s_add_u32 m0, s98, 28672
    s_nop 0
    buffer_load_dwordx4 v7, s[16:19], s40 offen lds
    v_mfma_f32_16x16x32_bf16 v[148:151], v[84:87], v[24:27], v[148:151]
    ds_read_b128 v[52:55], v251 offset:13312
    v_mfma_f32_16x16x32_bf16 v[152:155], v[76:79], v[28:31], v[152:155]
    v_mfma_f32_16x16x32_bf16 v[156:159], v[80:83], v[28:31], v[156:159]
    v_mfma_f32_16x16x32_bf16 v[160:163], v[84:87], v[28:31], v[160:163]
    v_mfma_f32_16x16x32_bf16 v[164:167], v[76:79], v[32:35], v[164:167]
    v_mfma_f32_16x16x32_bf16 v[168:171], v[80:83], v[32:35], v[168:171]
    v_mfma_f32_16x16x32_bf16 v[172:175], v[84:87], v[32:35], v[172:175]
    s_waitcnt vmcnt(5) lgkmcnt(0)
    s_barrier
    v_mfma_f32_16x16x32_bf16 v[116:119], v[88:91], v[36:39], v[116:119]
    s_add_u32 m0, s98, 49152
    s_add_u32 s40, s82, s95
    buffer_load_dwordx4 v2, s[16:19], s40 offen lds
    ds_read_b64_tr_b16 v[76:77], v248 offset:0
    ds_read_b64_tr_b16 v[78:79], v248 offset:5120
    v_mfma_f32_16x16x32_bf16 v[120:123], v[92:95], v[36:39], v[120:123]
    ds_read_b128 v[16:19], v251 offset:20480
    v_mfma_f32_16x16x32_bf16 v[124:127], v[96:99], v[36:39], v[124:127]
    ds_read_b64_tr_b16 v[80:81], v249 offset:0
    v_mfma_f32_16x16x32_bf16 v[128:131], v[88:91], v[40:43], v[128:131]
    ds_read_b64_tr_b16 v[82:83], v249 offset:5120
    v_mfma_f32_16x16x32_bf16 v[132:135], v[92:95], v[40:43], v[132:135]
    ds_read_b64_tr_b16 v[84:85], v250 offset:0
    ds_read_b64_tr_b16 v[86:87], v250 offset:5120
    v_mfma_f32_16x16x32_bf16 v[136:139], v[96:99], v[40:43], v[136:139]
    s_add_u32 m0, s98, 50176
    s_nop 0
    buffer_load_dwordx4 v3, s[16:19], s40 offen lds
    ds_read_b128 v[20:23], v251 offset:21504
    v_mfma_f32_16x16x32_bf16 v[140:143], v[88:91], v[44:47], v[140:143]
    ds_read_b128 v[24:27], v251 offset:22528
    v_mfma_f32_16x16x32_bf16 v[144:147], v[92:95], v[44:47], v[144:147]
    ds_read_b128 v[28:31], v251 offset:23552
    v_mfma_f32_16x16x32_bf16 v[148:151], v[96:99], v[44:47], v[148:151]
    ds_read_b128 v[32:35], v251 offset:24576
    v_mfma_f32_16x16x32_bf16 v[152:155], v[88:91], v[48:51], v[152:155]
    s_add_u32 m0, s98, 51200
    s_nop 0
    buffer_load_dwordx4 v4, s[16:19], s40 offen lds
    v_mfma_f32_16x16x32_bf16 v[156:159], v[92:95], v[48:51], v[156:159]
    v_mfma_f32_16x16x32_bf16 v[160:163], v[96:99], v[48:51], v[160:163]
    v_mfma_f32_16x16x32_bf16 v[164:167], v[88:91], v[52:55], v[164:167]
    v_mfma_f32_16x16x32_bf16 v[168:171], v[92:95], v[52:55], v[168:171]
    v_mfma_f32_16x16x32_bf16 v[172:175], v[96:99], v[52:55], v[172:175]
    s_waitcnt lgkmcnt(0)
    v_mfma_f32_16x16x32_bf16 v[116:119], v[76:79], v[16:19], v[116:119]
    ds_read_b64_tr_b16 v[88:89], v248 offset:10240
    ds_read_b64_tr_b16 v[90:91], v248 offset:15360
    s_add_u32 m0, s98, 52224
    s_nop 0
    buffer_load_dwordx4 v5, s[16:19], s40 offen lds
    v_mfma_f32_16x16x32_bf16 v[120:123], v[80:83], v[16:19], v[120:123]
    ds_read_b128 v[36:39], v251 offset:29696
    v_mfma_f32_16x16x32_bf16 v[124:127], v[84:87], v[16:19], v[124:127]
    ds_read_b64_tr_b16 v[92:93], v249 offset:10240
    v_mfma_f32_16x16x32_bf16 v[128:131], v[76:79], v[20:23], v[128:131]
    ds_read_b64_tr_b16 v[94:95], v249 offset:15360
    v_mfma_f32_16x16x32_bf16 v[132:135], v[80:83], v[20:23], v[132:135]
    ds_read_b64_tr_b16 v[96:97], v250 offset:10240
    ds_read_b64_tr_b16 v[98:99], v250 offset:15360
    v_mfma_f32_16x16x32_bf16 v[136:139], v[84:87], v[20:23], v[136:139]
    ds_read_b128 v[40:43], v251 offset:30720
    v_mfma_f32_16x16x32_bf16 v[140:143], v[76:79], v[24:27], v[140:143]
    ds_read_b128 v[44:47], v251 offset:31744
    v_mfma_f32_16x16x32_bf16 v[144:147], v[80:83], v[24:27], v[144:147]
    ds_read_b128 v[48:51], v251 offset:32768
    s_add_u32 m0, s98, 53248
    s_nop 0
    buffer_load_dwordx4 v7, s[16:19], s40 offen lds
    v_mfma_f32_16x16x32_bf16 v[148:151], v[84:87], v[24:27], v[148:151]
    ds_read_b128 v[52:55], v251 offset:33792
    v_mfma_f32_16x16x32_bf16 v[152:155], v[76:79], v[28:31], v[152:155]
    v_mfma_f32_16x16x32_bf16 v[156:159], v[80:83], v[28:31], v[156:159]
    v_mfma_f32_16x16x32_bf16 v[160:163], v[84:87], v[28:31], v[160:163]
    v_mfma_f32_16x16x32_bf16 v[164:167], v[76:79], v[32:35], v[164:167]
    v_mfma_f32_16x16x32_bf16 v[168:171], v[80:83], v[32:35], v[168:171]
    v_mfma_f32_16x16x32_bf16 v[172:175], v[84:87], v[32:35], v[172:175]
    s_waitcnt vmcnt(5) lgkmcnt(0)
    s_barrier
    v_mfma_f32_16x16x32_bf16 v[116:119], v[88:91], v[36:39], v[116:119]
    s_add_u32 m0, s98, 0
    s_add_u32 s40, s82, s96
    buffer_load_dwordx4 v2, s[16:19], s40 offen lds
    ds_read_b64_tr_b16 v[76:77], v248 offset:24576
    ds_read_b64_tr_b16 v[78:79], v248 offset:29696
    v_mfma_f32_16x16x32_bf16 v[120:123], v[92:95], v[36:39], v[120:123]
    ds_read_b128 v[16:19], v251 offset:40960
    v_mfma_f32_16x16x32_bf16 v[124:127], v[96:99], v[36:39], v[124:127]
    ds_read_b64_tr_b16 v[80:81], v249 offset:24576
    v_mfma_f32_16x16x32_bf16 v[128:131], v[88:91], v[40:43], v[128:131]
    ds_read_b64_tr_b16 v[82:83], v249 offset:29696
    v_mfma_f32_16x16x32_bf16 v[132:135], v[92:95], v[40:43], v[132:135]
    ds_read_b64_tr_b16 v[84:85], v250 offset:24576
    ds_read_b64_tr_b16 v[86:87], v250 offset:29696
    v_mfma_f32_16x16x32_bf16 v[136:139], v[96:99], v[40:43], v[136:139]
    s_add_u32 m0, s98, 1024
    s_nop 0
    buffer_load_dwordx4 v3, s[16:19], s40 offen lds
    ds_read_b128 v[20:23], v251 offset:41984
    v_mfma_f32_16x16x32_bf16 v[140:143], v[88:91], v[44:47], v[140:143]
    ds_read_b128 v[24:27], v251 offset:43008
    v_mfma_f32_16x16x32_bf16 v[144:147], v[92:95], v[44:47], v[144:147]
    ds_read_b128 v[28:31], v251 offset:44032
    v_mfma_f32_16x16x32_bf16 v[148:151], v[96:99], v[44:47], v[148:151]
    ds_read_b128 v[32:35], v251 offset:45056
    v_mfma_f32_16x16x32_bf16 v[152:155], v[88:91], v[48:51], v[152:155]
    s_add_u32 m0, s98, 2048
    s_nop 0
    buffer_load_dwordx4 v4, s[16:19], s40 offen lds
    v_mfma_f32_16x16x32_bf16 v[156:159], v[92:95], v[48:51], v[156:159]
    v_mfma_f32_16x16x32_bf16 v[160:163], v[96:99], v[48:51], v[160:163]
    v_mfma_f32_16x16x32_bf16 v[164:167], v[88:91], v[52:55], v[164:167]
    v_mfma_f32_16x16x32_bf16 v[168:171], v[92:95], v[52:55], v[168:171]
    v_mfma_f32_16x16x32_bf16 v[172:175], v[96:99], v[52:55], v[172:175]
    s_waitcnt lgkmcnt(0)
    v_mfma_f32_16x16x32_bf16 v[116:119], v[76:79], v[16:19], v[116:119]
    ds_read_b64_tr_b16 v[88:89], v248 offset:34816
    ds_read_b64_tr_b16 v[90:91], v248 offset:39936
    s_add_u32 m0, s98, 3072
    s_nop 0
    buffer_load_dwordx4 v5, s[16:19], s40 offen lds
    v_mfma_f32_16x16x32_bf16 v[120:123], v[80:83], v[16:19], v[120:123]
    ds_read_b128 v[36:39], v251 offset:50176
    v_mfma_f32_16x16x32_bf16 v[124:127], v[84:87], v[16:19], v[124:127]
    ds_read_b64_tr_b16 v[92:93], v249 offset:34816
    v_mfma_f32_16x16x32_bf16 v[128:131], v[76:79], v[20:23], v[128:131]
    ds_read_b64_tr_b16 v[94:95], v249 offset:39936
    v_mfma_f32_16x16x32_bf16 v[132:135], v[80:83], v[20:23], v[132:135]
    ds_read_b64_tr_b16 v[96:97], v250 offset:34816
    ds_read_b64_tr_b16 v[98:99], v250 offset:39936
    v_mfma_f32_16x16x32_bf16 v[136:139], v[84:87], v[20:23], v[136:139]
    ds_read_b128 v[40:43], v251 offset:51200
    v_mfma_f32_16x16x32_bf16 v[140:143], v[76:79], v[24:27], v[140:143]
    ds_read_b128 v[44:47], v251 offset:52224
    v_mfma_f32_16x16x32_bf16 v[144:147], v[80:83], v[24:27], v[144:147]
    ds_read_b128 v[48:51], v251 offset:53248
    s_add_u32 m0, s98, 4096
    s_nop 0
    buffer_load_dwordx4 v7, s[16:19], s40 offen lds
    v_mfma_f32_16x16x32_bf16 v[148:151], v[84:87], v[24:27], v[148:151]
    ds_read_b128 v[52:55], v251 offset:54272
    v_mfma_f32_16x16x32_bf16 v[152:155], v[76:79], v[28:31], v[152:155]
    v_mfma_f32_16x16x32_bf16 v[156:159], v[80:83], v[28:31], v[156:159]
    v_mfma_f32_16x16x32_bf16 v[160:163], v[84:87], v[28:31], v[160:163]
    v_mfma_f32_16x16x32_bf16 v[164:167], v[76:79], v[32:35], v[164:167]
    v_mfma_f32_16x16x32_bf16 v[168:171], v[80:83], v[32:35], v[168:171]
    v_mfma_f32_16x16x32_bf16 v[172:175], v[84:87], v[32:35], v[172:175]
    s_waitcnt vmcnt(5) lgkmcnt(0)
    s_barrier
    v_mfma_f32_16x16x32_bf16 v[116:119], v[88:91], v[36:39], v[116:119]
    s_add_u32 m0, s98, 24576
    s_add_u32 s40, s82, s97
    buffer_load_dwordx4 v2, s[16:19], s40 offen lds
    ds_read_b64_tr_b16 v[76:77], v248 offset:49152
    ds_read_b64_tr_b16 v[78:79], v248 offset:54272
    v_mfma_f32_16x16x32_bf16 v[120:123], v[92:95], v[36:39], v[120:123]
    ds_read_b128 v[16:19], v251 offset:0
    v_mfma_f32_16x16x32_bf16 v[124:127], v[96:99], v[36:39], v[124:127]
    ds_read_b64_tr_b16 v[80:81], v249 offset:49152
    v_mfma_f32_16x16x32_bf16 v[128:131], v[88:91], v[40:43], v[128:131]
    ds_read_b64_tr_b16 v[82:83], v249 offset:54272
    v_mfma_f32_16x16x32_bf16 v[132:135], v[92:95], v[40:43], v[132:135]
    ds_read_b64_tr_b16 v[84:85], v250 offset:49152
    ds_read_b64_tr_b16 v[86:87], v250 offset:54272
    v_mfma_f32_16x16x32_bf16 v[136:139], v[96:99], v[40:43], v[136:139]
    s_add_u32 m0, s98, 25600
    s_nop 0
    buffer_load_dwordx4 v3, s[16:19], s40 offen lds
    ds_read_b128 v[20:23], v251 offset:1024
    v_mfma_f32_16x16x32_bf16 v[140:143], v[88:91], v[44:47], v[140:143]
    ds_read_b128 v[24:27], v251 offset:2048
    v_mfma_f32_16x16x32_bf16 v[144:147], v[92:95], v[44:47], v[144:147]
    ds_read_b128 v[28:31], v251 offset:3072
    v_mfma_f32_16x16x32_bf16 v[148:151], v[96:99], v[44:47], v[148:151]
    ds_read_b128 v[32:35], v251 offset:4096
    v_mfma_f32_16x16x32_bf16 v[152:155], v[88:91], v[48:51], v[152:155]
    s_add_u32 m0, s98, 26624
    s_nop 0
    buffer_load_dwordx4 v4, s[16:19], s40 offen lds
    v_mfma_f32_16x16x32_bf16 v[156:159], v[92:95], v[48:51], v[156:159]
    v_mfma_f32_16x16x32_bf16 v[160:163], v[96:99], v[48:51], v[160:163]
    v_mfma_f32_16x16x32_bf16 v[164:167], v[88:91], v[52:55], v[164:167]
    v_mfma_f32_16x16x32_bf16 v[168:171], v[92:95], v[52:55], v[168:171]
    v_mfma_f32_16x16x32_bf16 v[172:175], v[96:99], v[52:55], v[172:175]
    s_waitcnt lgkmcnt(0)
    v_mfma_f32_16x16x32_bf16 v[116:119], v[76:79], v[16:19], v[116:119]
    ds_read_b64_tr_b16 v[88:89], v248 offset:59392
    ds_read_b64_tr_b16 v[90:91], v248 offset:64512
    s_add_u32 m0, s98, 27648
    s_nop 0
    buffer_load_dwordx4 v5, s[16:19], s40 offen lds
    v_mfma_f32_16x16x32_bf16 v[120:123], v[80:83], v[16:19], v[120:123]
    ds_read_b128 v[36:39], v251 offset:9216
    v_mfma_f32_16x16x32_bf16 v[124:127], v[84:87], v[16:19], v[124:127]
    ds_read_b64_tr_b16 v[92:93], v249 offset:59392
    v_mfma_f32_16x16x32_bf16 v[128:131], v[76:79], v[20:23], v[128:131]
    ds_read_b64_tr_b16 v[94:95], v249 offset:64512
    v_mfma_f32_16x16x32_bf16 v[132:135], v[80:83], v[20:23], v[132:135]
    ds_read_b64_tr_b16 v[96:97], v250 offset:59392
    ds_read_b64_tr_b16 v[98:99], v250 offset:64512
    v_mfma_f32_16x16x32_bf16 v[136:139], v[84:87], v[20:23], v[136:139]
    ds_read_b128 v[40:43], v251 offset:10240
    v_mfma_f32_16x16x32_bf16 v[140:143], v[76:79], v[24:27], v[140:143]
    ds_read_b128 v[44:47], v251 offset:11264
    v_mfma_f32_16x16x32_bf16 v[144:147], v[80:83], v[24:27], v[144:147]
    ds_read_b128 v[48:51], v251 offset:12288
    s_add_u32 m0, s98, 28672
    s_nop 0
    buffer_load_dwordx4 v7, s[16:19], s40 offen lds
    v_mfma_f32_16x16x32_bf16 v[148:151], v[84:87], v[24:27], v[148:151]
    ds_read_b128 v[52:55], v251 offset:13312
    v_mfma_f32_16x16x32_bf16 v[152:155], v[76:79], v[28:31], v[152:155]
    v_mfma_f32_16x16x32_bf16 v[156:159], v[80:83], v[28:31], v[156:159]
    v_mfma_f32_16x16x32_bf16 v[160:163], v[84:87], v[28:31], v[160:163]
    v_mfma_f32_16x16x32_bf16 v[164:167], v[76:79], v[32:35], v[164:167]
    v_mfma_f32_16x16x32_bf16 v[168:171], v[80:83], v[32:35], v[168:171]
    v_mfma_f32_16x16x32_bf16 v[172:175], v[84:87], v[32:35], v[172:175]
    s_waitcnt vmcnt(5) lgkmcnt(0)
    s_barrier
    v_mfma_f32_16x16x32_bf16 v[116:119], v[88:91], v[36:39], v[116:119]
    s_add_u32 m0, s98, 49152
    s_add_u32 s40, s83, s95
    buffer_load_dwordx4 v2, s[16:19], s40 offen lds
    ds_read_b64_tr_b16 v[76:77], v248 offset:0
    ds_read_b64_tr_b16 v[78:79], v248 offset:5120
    v_mfma_f32_16x16x32_bf16 v[120:123], v[92:95], v[36:39], v[120:123]
    ds_read_b128 v[16:19], v251 offset:20480
    v_mfma_f32_16x16x32_bf16 v[124:127], v[96:99], v[36:39], v[124:127]
    ds_read_b64_tr_b16 v[80:81], v249 offset:0
    v_mfma_f32_16x16x32_bf16 v[128:131], v[88:91], v[40:43], v[128:131]
    ds_read_b64_tr_b16 v[82:83], v249 offset:5120
    v_mfma_f32_16x16x32_bf16 v[132:135], v[92:95], v[40:43], v[132:135]
    ds_read_b64_tr_b16 v[84:85], v250 offset:0
    ds_read_b64_tr_b16 v[86:87], v250 offset:5120
    v_mfma_f32_16x16x32_bf16 v[136:139], v[96:99], v[40:43], v[136:139]
    s_add_u32 m0, s98, 50176
    s_nop 0
    buffer_load_dwordx4 v3, s[16:19], s40 offen lds
    ds_read_b128 v[20:23], v251 offset:21504
    v_mfma_f32_16x16x32_bf16 v[140:143], v[88:91], v[44:47], v[140:143]
    ds_read_b128 v[24:27], v251 offset:22528
    v_mfma_f32_16x16x32_bf16 v[144:147], v[92:95], v[44:47], v[144:147]
    ds_read_b128 v[28:31], v251 offset:23552
    v_mfma_f32_16x16x32_bf16 v[148:151], v[96:99], v[44:47], v[148:151]
    ds_read_b128 v[32:35], v251 offset:24576
    v_mfma_f32_16x16x32_bf16 v[152:155], v[88:91], v[48:51], v[152:155]
    s_add_u32 m0, s98, 51200
    s_nop 0
    buffer_load_dwordx4 v4, s[16:19], s40 offen lds
    v_mfma_f32_16x16x32_bf16 v[156:159], v[92:95], v[48:51], v[156:159]
    v_mfma_f32_16x16x32_bf16 v[160:163], v[96:99], v[48:51], v[160:163]
    v_mfma_f32_16x16x32_bf16 v[164:167], v[88:91], v[52:55], v[164:167]
    v_mfma_f32_16x16x32_bf16 v[168:171], v[92:95], v[52:55], v[168:171]
    v_mfma_f32_16x16x32_bf16 v[172:175], v[96:99], v[52:55], v[172:175]
    s_waitcnt lgkmcnt(0)
    v_mfma_f32_16x16x32_bf16 v[116:119], v[76:79], v[16:19], v[116:119]
    ds_read_b64_tr_b16 v[88:89], v248 offset:10240
    ds_read_b64_tr_b16 v[90:91], v248 offset:15360
    s_add_u32 m0, s98, 52224
    s_nop 0
    buffer_load_dwordx4 v5, s[16:19], s40 offen lds
    v_mfma_f32_16x16x32_bf16 v[120:123], v[80:83], v[16:19], v[120:123]
    ds_read_b128 v[36:39], v251 offset:29696
    v_mfma_f32_16x16x32_bf16 v[124:127], v[84:87], v[16:19], v[124:127]
    ds_read_b64_tr_b16 v[92:93], v249 offset:10240
    v_mfma_f32_16x16x32_bf16 v[128:131], v[76:79], v[20:23], v[128:131]
    ds_read_b64_tr_b16 v[94:95], v249 offset:15360
    v_mfma_f32_16x16x32_bf16 v[132:135], v[80:83], v[20:23], v[132:135]
    ds_read_b64_tr_b16 v[96:97], v250 offset:10240
    ds_read_b64_tr_b16 v[98:99], v250 offset:15360
    v_mfma_f32_16x16x32_bf16 v[136:139], v[84:87], v[20:23], v[136:139]
    ds_read_b128 v[40:43], v251 offset:30720
    v_mfma_f32_16x16x32_bf16 v[140:143], v[76:79], v[24:27], v[140:143]
    ds_read_b128 v[44:47], v251 offset:31744
    v_mfma_f32_16x16x32_bf16 v[144:147], v[80:83], v[24:27], v[144:147]
    ds_read_b128 v[48:51], v251 offset:32768
    s_add_u32 m0, s98, 53248
    s_nop 0
    buffer_load_dwordx4 v7, s[16:19], s40 offen lds
    v_mfma_f32_16x16x32_bf16 v[148:151], v[84:87], v[24:27], v[148:151]
    ds_read_b128 v[52:55], v251 offset:33792
    v_mfma_f32_16x16x32_bf16 v[152:155], v[76:79], v[28:31], v[152:155]
    v_mfma_f32_16x16x32_bf16 v[156:159], v[80:83], v[28:31], v[156:159]
    v_mfma_f32_16x16x32_bf16 v[160:163], v[84:87], v[28:31], v[160:163]
    v_mfma_f32_16x16x32_bf16 v[164:167], v[76:79], v[32:35], v[164:167]
    v_mfma_f32_16x16x32_bf16 v[168:171], v[80:83], v[32:35], v[168:171]
    v_mfma_f32_16x16x32_bf16 v[172:175], v[84:87], v[32:35], v[172:175]
    s_waitcnt vmcnt(5) lgkmcnt(0)
    s_barrier
    v_mfma_f32_16x16x32_bf16 v[116:119], v[88:91], v[36:39], v[116:119]
    s_add_u32 m0, s98, 0
    s_add_u32 s40, s83, s96
    buffer_load_dwordx4 v2, s[16:19], s40 offen lds
    ds_read_b64_tr_b16 v[76:77], v248 offset:24576
    ds_read_b64_tr_b16 v[78:79], v248 offset:29696
    v_mfma_f32_16x16x32_bf16 v[120:123], v[92:95], v[36:39], v[120:123]
    ds_read_b128 v[16:19], v251 offset:40960
    v_mfma_f32_16x16x32_bf16 v[124:127], v[96:99], v[36:39], v[124:127]
    ds_read_b64_tr_b16 v[80:81], v249 offset:24576
    v_mfma_f32_16x16x32_bf16 v[128:131], v[88:91], v[40:43], v[128:131]
    ds_read_b64_tr_b16 v[82:83], v249 offset:29696
    v_mfma_f32_16x16x32_bf16 v[132:135], v[92:95], v[40:43], v[132:135]
    ds_read_b64_tr_b16 v[84:85], v250 offset:24576
    ds_read_b64_tr_b16 v[86:87], v250 offset:29696
    v_mfma_f32_16x16x32_bf16 v[136:139], v[96:99], v[40:43], v[136:139]
    s_add_u32 m0, s98, 1024
    s_nop 0
    buffer_load_dwordx4 v3, s[16:19], s40 offen lds
    ds_read_b128 v[20:23], v251 offset:41984
    v_mfma_f32_16x16x32_bf16 v[140:143], v[88:91], v[44:47], v[140:143]
    ds_read_b128 v[24:27], v251 offset:43008
    v_mfma_f32_16x16x32_bf16 v[144:147], v[92:95], v[44:47], v[144:147]
    ds_read_b128 v[28:31], v251 offset:44032
    v_mfma_f32_16x16x32_bf16 v[148:151], v[96:99], v[44:47], v[148:151]
    ds_read_b128 v[32:35], v251 offset:45056
    v_mfma_f32_16x16x32_bf16 v[152:155], v[88:91], v[48:51], v[152:155]
    s_add_u32 m0, s98, 2048
    s_nop 0
    buffer_load_dwordx4 v4, s[16:19], s40 offen lds
    v_mfma_f32_16x16x32_bf16 v[156:159], v[92:95], v[48:51], v[156:159]
    v_mfma_f32_16x16x32_bf16 v[160:163], v[96:99], v[48:51], v[160:163]
    v_mfma_f32_16x16x32_bf16 v[164:167], v[88:91], v[52:55], v[164:167]
    v_mfma_f32_16x16x32_bf16 v[168:171], v[92:95], v[52:55], v[168:171]
    v_mfma_f32_16x16x32_bf16 v[172:175], v[96:99], v[52:55], v[172:175]
    s_waitcnt lgkmcnt(0)
    v_mfma_f32_16x16x32_bf16 v[116:119], v[76:79], v[16:19], v[116:119]
    ds_read_b64_tr_b16 v[88:89], v248 offset:34816
    ds_read_b64_tr_b16 v[90:91], v248 offset:39936
    s_add_u32 m0, s98, 3072
    s_nop 0
    buffer_load_dwordx4 v5, s[16:19], s40 offen lds
    v_mfma_f32_16x16x32_bf16 v[120:123], v[80:83], v[16:19], v[120:123]
    ds_read_b128 v[36:39], v251 offset:50176
    v_mfma_f32_16x16x32_bf16 v[124:127], v[84:87], v[16:19], v[124:127]
    ds_read_b64_tr_b16 v[92:93], v249 offset:34816
    v_mfma_f32_16x16x32_bf16 v[128:131], v[76:79], v[20:23], v[128:131]
    ds_read_b64_tr_b16 v[94:95], v249 offset:39936
    v_mfma_f32_16x16x32_bf16 v[132:135], v[80:83], v[20:23], v[132:135]
    ds_read_b64_tr_b16 v[96:97], v250 offset:34816
    ds_read_b64_tr_b16 v[98:99], v250 offset:39936
    v_mfma_f32_16x16x32_bf16 v[136:139], v[84:87], v[20:23], v[136:139]
    ds_read_b128 v[40:43], v251 offset:51200
    v_mfma_f32_16x16x32_bf16 v[140:143], v[76:79], v[24:27], v[140:143]
    ds_read_b128 v[44:47], v251 offset:52224
    v_mfma_f32_16x16x32_bf16 v[144:147], v[80:83], v[24:27], v[144:147]
    ds_read_b128 v[48:51], v251 offset:53248
    s_add_u32 m0, s98, 4096
    s_nop 0
    buffer_load_dwordx4 v7, s[16:19], s40 offen lds
    v_mfma_f32_16x16x32_bf16 v[148:151], v[84:87], v[24:27], v[148:151]
    ds_read_b128 v[52:55], v251 offset:54272
    v_mfma_f32_16x16x32_bf16 v[152:155], v[76:79], v[28:31], v[152:155]
    v_mfma_f32_16x16x32_bf16 v[156:159], v[80:83], v[28:31], v[156:159]
    v_mfma_f32_16x16x32_bf16 v[160:163], v[84:87], v[28:31], v[160:163]
    v_mfma_f32_16x16x32_bf16 v[164:167], v[76:79], v[32:35], v[164:167]
    v_mfma_f32_16x16x32_bf16 v[168:171], v[80:83], v[32:35], v[168:171]
    v_mfma_f32_16x16x32_bf16 v[172:175], v[84:87], v[32:35], v[172:175]
    s_waitcnt vmcnt(5) lgkmcnt(0)
    s_barrier
    v_mfma_f32_16x16x32_bf16 v[116:119], v[88:91], v[36:39], v[116:119]
    s_add_u32 m0, s98, 24576
    s_add_u32 s40, s83, s97
    buffer_load_dwordx4 v2, s[16:19], s40 offen lds
    ds_read_b64_tr_b16 v[76:77], v248 offset:49152
    ds_read_b64_tr_b16 v[78:79], v248 offset:54272
    v_mfma_f32_16x16x32_bf16 v[120:123], v[92:95], v[36:39], v[120:123]
    ds_read_b128 v[16:19], v251 offset:0
    v_mfma_f32_16x16x32_bf16 v[124:127], v[96:99], v[36:39], v[124:127]
    ds_read_b64_tr_b16 v[80:81], v249 offset:49152
    v_mfma_f32_16x16x32_bf16 v[128:131], v[88:91], v[40:43], v[128:131]
    ds_read_b64_tr_b16 v[82:83], v249 offset:54272
    v_mfma_f32_16x16x32_bf16 v[132:135], v[92:95], v[40:43], v[132:135]
    ds_read_b64_tr_b16 v[84:85], v250 offset:49152
    ds_read_b64_tr_b16 v[86:87], v250 offset:54272
    v_mfma_f32_16x16x32_bf16 v[136:139], v[96:99], v[40:43], v[136:139]
    s_add_u32 m0, s98, 25600
    s_nop 0
    buffer_load_dwordx4 v3, s[16:19], s40 offen lds
    ds_read_b128 v[20:23], v251 offset:1024
    v_mfma_f32_16x16x32_bf16 v[140:143], v[88:91], v[44:47], v[140:143]
    ds_read_b128 v[24:27], v251 offset:2048
    v_mfma_f32_16x16x32_bf16 v[144:147], v[92:95], v[44:47], v[144:147]
    ds_read_b128 v[28:31], v251 offset:3072
    v_mfma_f32_16x16x32_bf16 v[148:151], v[96:99], v[44:47], v[148:151]
    ds_read_b128 v[32:35], v251 offset:4096
    v_mfma_f32_16x16x32_bf16 v[152:155], v[88:91], v[48:51], v[152:155]
    s_add_u32 m0, s98, 26624
    s_nop 0
    buffer_load_dwordx4 v4, s[16:19], s40 offen lds
    v_mfma_f32_16x16x32_bf16 v[156:159], v[92:95], v[48:51], v[156:159]
    v_mfma_f32_16x16x32_bf16 v[160:163], v[96:99], v[48:51], v[160:163]
    v_mfma_f32_16x16x32_bf16 v[164:167], v[88:91], v[52:55], v[164:167]
    v_mfma_f32_16x16x32_bf16 v[168:171], v[92:95], v[52:55], v[168:171]
    v_mfma_f32_16x16x32_bf16 v[172:175], v[96:99], v[52:55], v[172:175]
    s_waitcnt lgkmcnt(0)
    v_mfma_f32_16x16x32_bf16 v[116:119], v[76:79], v[16:19], v[116:119]
    ds_read_b64_tr_b16 v[88:89], v248 offset:59392
    ds_read_b64_tr_b16 v[90:91], v248 offset:64512
    s_add_u32 m0, s98, 27648
    s_nop 0
    buffer_load_dwordx4 v5, s[16:19], s40 offen lds
    v_mfma_f32_16x16x32_bf16 v[120:123], v[80:83], v[16:19], v[120:123]
    ds_read_b128 v[36:39], v251 offset:9216
    v_mfma_f32_16x16x32_bf16 v[124:127], v[84:87], v[16:19], v[124:127]
    ds_read_b64_tr_b16 v[92:93], v249 offset:59392
    v_mfma_f32_16x16x32_bf16 v[128:131], v[76:79], v[20:23], v[128:131]
    ds_read_b64_tr_b16 v[94:95], v249 offset:64512
    v_mfma_f32_16x16x32_bf16 v[132:135], v[80:83], v[20:23], v[132:135]
    ds_read_b64_tr_b16 v[96:97], v250 offset:59392
    ds_read_b64_tr_b16 v[98:99], v250 offset:64512
    v_mfma_f32_16x16x32_bf16 v[136:139], v[84:87], v[20:23], v[136:139]
    ds_read_b128 v[40:43], v251 offset:10240
    v_mfma_f32_16x16x32_bf16 v[140:143], v[76:79], v[24:27], v[140:143]
    ds_read_b128 v[44:47], v251 offset:11264
    v_mfma_f32_16x16x32_bf16 v[144:147], v[80:83], v[24:27], v[144:147]
    ds_read_b128 v[48:51], v251 offset:12288
    s_add_u32 m0, s98, 28672
    s_nop 0
    buffer_load_dwordx4 v7, s[16:19], s40 offen lds
    v_mfma_f32_16x16x32_bf16 v[148:151], v[84:87], v[24:27], v[148:151]
    ds_read_b128 v[52:55], v251 offset:13312
    v_mfma_f32_16x16x32_bf16 v[152:155], v[76:79], v[28:31], v[152:155]
    v_mfma_f32_16x16x32_bf16 v[156:159], v[80:83], v[28:31], v[156:159]
    v_mfma_f32_16x16x32_bf16 v[160:163], v[84:87], v[28:31], v[160:163]
    v_mfma_f32_16x16x32_bf16 v[164:167], v[76:79], v[32:35], v[164:167]
    v_mfma_f32_16x16x32_bf16 v[168:171], v[80:83], v[32:35], v[168:171]
    v_mfma_f32_16x16x32_bf16 v[172:175], v[84:87], v[32:35], v[172:175]
    s_waitcnt vmcnt(5) lgkmcnt(0)
    s_barrier
    v_mfma_f32_16x16x32_bf16 v[116:119], v[88:91], v[36:39], v[116:119]
    ds_read_b64_tr_b16 v[76:77], v248 offset:0
    ds_read_b64_tr_b16 v[78:79], v248 offset:5120
    v_mfma_f32_16x16x32_bf16 v[120:123], v[92:95], v[36:39], v[120:123]
    ds_read_b128 v[16:19], v251 offset:20480
    v_mfma_f32_16x16x32_bf16 v[124:127], v[96:99], v[36:39], v[124:127]
    ds_read_b64_tr_b16 v[80:81], v249 offset:0
    v_mfma_f32_16x16x32_bf16 v[128:131], v[88:91], v[40:43], v[128:131]
    ds_read_b64_tr_b16 v[82:83], v249 offset:5120
    v_mfma_f32_16x16x32_bf16 v[132:135], v[92:95], v[40:43], v[132:135]
    ds_read_b64_tr_b16 v[84:85], v250 offset:0
    ds_read_b64_tr_b16 v[86:87], v250 offset:5120
    v_mfma_f32_16x16x32_bf16 v[136:139], v[96:99], v[40:43], v[136:139]
    ds_read_b128 v[20:23], v251 offset:21504
    v_mfma_f32_16x16x32_bf16 v[140:143], v[88:91], v[44:47], v[140:143]
    ds_read_b128 v[24:27], v251 offset:22528
    v_mfma_f32_16x16x32_bf16 v[144:147], v[92:95], v[44:47], v[144:147]
    ds_read_b128 v[28:31], v251 offset:23552
    v_mfma_f32_16x16x32_bf16 v[148:151], v[96:99], v[44:47], v[148:151]
    ds_read_b128 v[32:35], v251 offset:24576
    v_mfma_f32_16x16x32_bf16 v[152:155], v[88:91], v[48:51], v[152:155]
    v_mfma_f32_16x16x32_bf16 v[156:159], v[92:95], v[48:51], v[156:159]
    v_mfma_f32_16x16x32_bf16 v[160:163], v[96:99], v[48:51], v[160:163]
    v_mfma_f32_16x16x32_bf16 v[164:167], v[88:91], v[52:55], v[164:167]
    v_mfma_f32_16x16x32_bf16 v[168:171], v[92:95], v[52:55], v[168:171]
    v_mfma_f32_16x16x32_bf16 v[172:175], v[96:99], v[52:55], v[172:175]
    s_waitcnt lgkmcnt(0)
    v_mfma_f32_16x16x32_bf16 v[116:119], v[76:79], v[16:19], v[116:119]
    ds_read_b64_tr_b16 v[88:89], v248 offset:10240
    ds_read_b64_tr_b16 v[90:91], v248 offset:15360
    v_mfma_f32_16x16x32_bf16 v[120:123], v[80:83], v[16:19], v[120:123]
    ds_read_b128 v[36:39], v251 offset:29696
    v_mfma_f32_16x16x32_bf16 v[124:127], v[84:87], v[16:19], v[124:127]
    ds_read_b64_tr_b16 v[92:93], v249 offset:10240
    v_mfma_f32_16x16x32_bf16 v[128:131], v[76:79], v[20:23], v[128:131]
    ds_read_b64_tr_b16 v[94:95], v249 offset:15360
    v_mfma_f32_16x16x32_bf16 v[132:135], v[80:83], v[20:23], v[132:135]
    ds_read_b64_tr_b16 v[96:97], v250 offset:10240
    ds_read_b64_tr_b16 v[98:99], v250 offset:15360
    v_mfma_f32_16x16x32_bf16 v[136:139], v[84:87], v[20:23], v[136:139]
    ds_read_b128 v[40:43], v251 offset:30720
    v_mfma_f32_16x16x32_bf16 v[140:143], v[76:79], v[24:27], v[140:143]
    ds_read_b128 v[44:47], v251 offset:31744
    v_mfma_f32_16x16x32_bf16 v[144:147], v[80:83], v[24:27], v[144:147]
    ds_read_b128 v[48:51], v251 offset:32768
    v_mfma_f32_16x16x32_bf16 v[148:151], v[84:87], v[24:27], v[148:151]
    ds_read_b128 v[52:55], v251 offset:33792
    v_mfma_f32_16x16x32_bf16 v[152:155], v[76:79], v[28:31], v[152:155]
    v_mfma_f32_16x16x32_bf16 v[156:159], v[80:83], v[28:31], v[156:159]
    v_mfma_f32_16x16x32_bf16 v[160:163], v[84:87], v[28:31], v[160:163]
    v_mfma_f32_16x16x32_bf16 v[164:167], v[76:79], v[32:35], v[164:167]
    v_mfma_f32_16x16x32_bf16 v[168:171], v[80:83], v[32:35], v[168:171]
    v_mfma_f32_16x16x32_bf16 v[172:175], v[84:87], v[32:35], v[172:175]
    s_waitcnt vmcnt(0) lgkmcnt(0)
    s_barrier
    v_mfma_f32_16x16x32_bf16 v[116:119], v[88:91], v[36:39], v[116:119]
    ds_read_b64_tr_b16 v[76:77], v248 offset:24576
    ds_read_b64_tr_b16 v[78:79], v248 offset:29696
    v_mfma_f32_16x16x32_bf16 v[120:123], v[92:95], v[36:39], v[120:123]
    ds_read_b128 v[16:19], v251 offset:40960
    v_mfma_f32_16x16x32_bf16 v[124:127], v[96:99], v[36:39], v[124:127]
    ds_read_b64_tr_b16 v[80:81], v249 offset:24576
    v_mfma_f32_16x16x32_bf16 v[128:131], v[88:91], v[40:43], v[128:131]
    ds_read_b64_tr_b16 v[82:83], v249 offset:29696
    v_mfma_f32_16x16x32_bf16 v[132:135], v[92:95], v[40:43], v[132:135]
    ds_read_b64_tr_b16 v[84:85], v250 offset:24576
    ds_read_b64_tr_b16 v[86:87], v250 offset:29696
    v_mfma_f32_16x16x32_bf16 v[136:139], v[96:99], v[40:43], v[136:139]
    ds_read_b128 v[20:23], v251 offset:41984
    v_mfma_f32_16x16x32_bf16 v[140:143], v[88:91], v[44:47], v[140:143]
    ds_read_b128 v[24:27], v251 offset:43008
    v_mfma_f32_16x16x32_bf16 v[144:147], v[92:95], v[44:47], v[144:147]
    ds_read_b128 v[28:31], v251 offset:44032
    v_mfma_f32_16x16x32_bf16 v[148:151], v[96:99], v[44:47], v[148:151]
    ds_read_b128 v[32:35], v251 offset:45056
    v_mfma_f32_16x16x32_bf16 v[152:155], v[88:91], v[48:51], v[152:155]
    v_mfma_f32_16x16x32_bf16 v[156:159], v[92:95], v[48:51], v[156:159]
    v_mfma_f32_16x16x32_bf16 v[160:163], v[96:99], v[48:51], v[160:163]
    v_mfma_f32_16x16x32_bf16 v[164:167], v[88:91], v[52:55], v[164:167]
    v_mfma_f32_16x16x32_bf16 v[168:171], v[92:95], v[52:55], v[168:171]
    v_mfma_f32_16x16x32_bf16 v[172:175], v[96:99], v[52:55], v[172:175]
    s_waitcnt lgkmcnt(0)
    v_mfma_f32_16x16x32_bf16 v[116:119], v[76:79], v[16:19], v[116:119]
    ds_read_b64_tr_b16 v[88:89], v248 offset:34816
    ds_read_b64_tr_b16 v[90:91], v248 offset:39936
    v_mfma_f32_16x16x32_bf16 v[120:123], v[80:83], v[16:19], v[120:123]
    ds_read_b128 v[36:39], v251 offset:50176
    v_mfma_f32_16x16x32_bf16 v[124:127], v[84:87], v[16:19], v[124:127]
    ds_read_b64_tr_b16 v[92:93], v249 offset:34816
    v_mfma_f32_16x16x32_bf16 v[128:131], v[76:79], v[20:23], v[128:131]
    ds_read_b64_tr_b16 v[94:95], v249 offset:39936
    v_mfma_f32_16x16x32_bf16 v[132:135], v[80:83], v[20:23], v[132:135]
    ds_read_b64_tr_b16 v[96:97], v250 offset:34816
    ds_read_b64_tr_b16 v[98:99], v250 offset:39936
    v_mfma_f32_16x16x32_bf16 v[136:139], v[84:87], v[20:23], v[136:139]
    ds_read_b128 v[40:43], v251 offset:51200
    v_mfma_f32_16x16x32_bf16 v[140:143], v[76:79], v[24:27], v[140:143]
    ds_read_b128 v[44:47], v251 offset:52224
    v_mfma_f32_16x16x32_bf16 v[144:147], v[80:83], v[24:27], v[144:147]
    ds_read_b128 v[48:51], v251 offset:53248
    v_mfma_f32_16x16x32_bf16 v[148:151], v[84:87], v[24:27], v[148:151]
    ds_read_b128 v[52:55], v251 offset:54272
    v_mfma_f32_16x16x32_bf16 v[152:155], v[76:79], v[28:31], v[152:155]
    v_mfma_f32_16x16x32_bf16 v[156:159], v[80:83], v[28:31], v[156:159]
    v_mfma_f32_16x16x32_bf16 v[160:163], v[84:87], v[28:31], v[160:163]
    v_mfma_f32_16x16x32_bf16 v[164:167], v[76:79], v[32:35], v[164:167]
    v_mfma_f32_16x16x32_bf16 v[168:171], v[80:83], v[32:35], v[168:171]
    v_mfma_f32_16x16x32_bf16 v[172:175], v[84:87], v[32:35], v[172:175]
    s_waitcnt lgkmcnt(8)
    v_mfma_f32_16x16x32_bf16 v[116:119], v[88:91], v[36:39], v[116:119]
    s_waitcnt lgkmcnt(6)
    v_mfma_f32_16x16x32_bf16 v[120:123], v[92:95], v[36:39], v[120:123]
    s_waitcnt lgkmcnt(4)
    v_mfma_f32_16x16x32_bf16 v[124:127], v[96:99], v[36:39], v[124:127]
    s_waitcnt lgkmcnt(3)
    v_mfma_f32_16x16x32_bf16 v[128:131], v[88:91], v[40:43], v[128:131]
    v_mfma_f32_16x16x32_bf16 v[132:135], v[92:95], v[40:43], v[132:135]
    v_mfma_f32_16x16x32_bf16 v[136:139], v[96:99], v[40:43], v[136:139]
    v_cvt_pk_bf16_f32 v116, v116, v117
    v_cvt_pk_bf16_f32 v117, v118, v119
    v_cvt_pk_bf16_f32 v118, v120, v121
    v_cvt_pk_bf16_f32 v119, v122, v123
    s_mov_b32 s41, 0
    buffer_store_dwordx4 v[116:119], v58, s[20:23], s41 offen sc1
    s_waitcnt lgkmcnt(2)
    v_mfma_f32_16x16x32_bf16 v[140:143], v[88:91], v[44:47], v[140:143]
    v_mfma_f32_16x16x32_bf16 v[144:147], v[92:95], v[44:47], v[144:147]
    v_mfma_f32_16x16x32_bf16 v[148:151], v[96:99], v[44:47], v[148:151]
    v_cvt_pk_bf16_f32 v128, v128, v129
    v_cvt_pk_bf16_f32 v129, v130, v131
    v_cvt_pk_bf16_f32 v130, v132, v133
    v_cvt_pk_bf16_f32 v131, v134, v135
    s_mov_b32 s41, 1024
    buffer_store_dwordx4 v[128:131], v58, s[20:23], s41 offen sc1
    s_waitcnt lgkmcnt(1)
    v_mfma_f32_16x16x32_bf16 v[152:155], v[88:91], v[48:51], v[152:155]
    v_cvt_pk_bf16_f32 v124, v124, v125
    v_cvt_pk_bf16_f32 v125, v126, v127
    v_cvt_pk_bf16_f32 v126, v136, v137
    v_cvt_pk_bf16_f32 v127, v138, v139
    s_mov_b32 s41, 0
    buffer_store_dwordx4 v[124:127], v59, s[20:23], s41 offen sc1
    v_mfma_f32_16x16x32_bf16 v[156:159], v[92:95], v[48:51], v[156:159]
    v_mfma_f32_16x16x32_bf16 v[160:163], v[96:99], v[48:51], v[160:163]
    v_cvt_pk_bf16_f32 v140, v140, v141
    v_cvt_pk_bf16_f32 v141, v142, v143
    v_cvt_pk_bf16_f32 v142, v144, v145
    v_cvt_pk_bf16_f32 v143, v146, v147
    s_mov_b32 s41, 2048
    buffer_store_dwordx4 v[140:143], v58, s[20:23], s41 offen sc1
    s_waitcnt lgkmcnt(0)
    v_mfma_f32_16x16x32_bf16 v[164:167], v[88:91], v[52:55], v[164:167]
    v_mfma_f32_16x16x32_bf16 v[168:171], v[92:95], v[52:55], v[168:171]
    v_mfma_f32_16x16x32_bf16 v[172:175], v[96:99], v[52:55], v[172:175]
    v_cvt_pk_bf16_f32 v152, v152, v153
    v_cvt_pk_bf16_f32 v153, v154, v155
    v_cvt_pk_bf16_f32 v154, v156, v157
    v_cvt_pk_bf16_f32 v155, v158, v159
    s_mov_b32 s41, 3072
    buffer_store_dwordx4 v[152:155], v58, s[20:23], s41 offen sc1
    v_cvt_pk_bf16_f32 v148, v148, v149
    v_cvt_pk_bf16_f32 v149, v150, v151
    v_cvt_pk_bf16_f32 v150, v160, v161
    v_cvt_pk_bf16_f32 v151, v162, v163
    s_mov_b32 s41, 1024
    buffer_store_dwordx4 v[148:151], v59, s[20:23], s41 offen sc1
    v_cvt_pk_bf16_f32 v164, v164, v165
    v_cvt_pk_bf16_f32 v165, v166, v167
    v_cvt_pk_bf16_f32 v166, v168, v169
    v_cvt_pk_bf16_f32 v167, v170, v171
    s_mov_b32 s41, 4096
    buffer_store_dwordx4 v[164:167], v58, s[20:23], s41 offen sc1
    v_cvt_pk_bf16_f32 v172, v172, v173
    v_cvt_pk_bf16_f32 v173, v174, v175
    s_mov_b32 s41, 2048
    buffer_store_dwordx4 v[172:175], v59, s[20:23], s41 offen sc1
    s_lshl_b32 s56, s36, 3
    s_add_u32 s56, s56, s53
    s_lshl_b32 s41, s56, 10
    v_add_u32 v58, s41, v57
    s_mul_i32 s41, s56, 57
    s_lshr_b32 s41, s41, 9
    s_mul_i32 s42, s41, 9
    s_sub_u32 s42, s56, s42
    s_lshl_b32 s41, s41, 2
    s_lshr_b32 s41, 0x8630, s41
    s_and_b32 s41, s41, 15
    s_mov_b32 s59, 32
    s_cmp_lt_u32 s56, 36
    s_cbranch_scc1 L_dec0
    s_cmp_ge_u32 s56, 41
    s_cselect_b32 s41, 5, 2
    s_cselect_b32 s42, 41, 36
    s_sub_u32 s42, s56, s42
    s_cmp_eq_u32 s42, 2
    s_mov_b32 s59, 20480
    s_cselect_b32 s59, 0x40000000, s59
    s_lshl_b32 s42, s42, 2
    s_lshr_b32 s42, 0x75420, s42
    s_and_b32 s42, s42, 15
L_dec0:
    s_lshl_b32 s42, s42, 4
    s_mul_i32 s43, s52, 144
    s_add_u32 s42, s42, s43
    s_mul_i32 s42, s42, 1280
    s_lshl_b32 s41, s41, 5
    s_add_u32 s42, s42, s41
    s_mul_i32 s41, s47, 320
    s_add_u32 s42, s42, s41
    v_and_b32 v59, 15, v1
    v_mul_u32_u24 v59, 1280, v59
    v_lshrrev_b32 v56, 4, v1
    v_lshl_add_u32 v59, v56, 3, v59
    v_add_u32 v59, s42, v59
    s_waitcnt vmcnt(0)
    s_barrier
    v_and_b32 v62, 7, v1
    v_lshlrev_b32 v62, 2, v62
    s_mov_b32 s101, 0x20000
    s_waitcnt vmcnt(0)
L_p2_0:
    global_load_dword v63, v62, s[92:93] offset:0 sc1
    s_sub_u32 s101, s101, 1
    s_cbranch_scc1 L_p2_0_done
    s_waitcnt vmcnt(0)
    v_cmp_ne_u32 vcc, s88, v63
    s_nop 4
    s_cbranch_vccz L_p2_0_done
    s_sleep 1
    s_branch L_p2_0
L_p2_0_done:
    s_waitcnt vmcnt(0)
    s_mov_b32 s41, 0
    buffer_load_dwordx4 v[76:79], v58, s[24:27], s41 offen sc1
    s_mov_b32 s41, 47104
    buffer_load_dwordx4 v[80:83], v58, s[24:27], s41 offen sc1
    s_mov_b32 s41, 94208
    buffer_load_dwordx4 v[84:87], v58, s[24:27], s41 offen sc1
    s_mov_b32 s41, 141312
    buffer_load_dwordx4 v[88:91], v58, s[24:27], s41 offen sc1
    s_mov_b32 s41, 188416
    buffer_load_dwordx4 v[92:95], v58, s[24:27], s41 offen sc1
    s_mov_b32 s41, 235520
    buffer_load_dwordx4 v[96:99], v58, s[24:27], s41 offen sc1
    s_mov_b32 s41, 282624
    buffer_load_dwordx4 v[100:103], v58, s[24:27], s41 offen sc1
    s_mov_b32 s41, 329728
    buffer_load_dwordx4 v[104:107], v58, s[24:27], s41 offen sc1
    s_or_b32 s41, s46, s36
    s_cmp_eq_u32 s41, 0
    s_cbranch_scc0 L_nw
    s_lshl_b32 s41, s52, 8
    s_add_u32 s41, s41, 29360128
    v_mov_b32 v60, s41
    v_mov_b32 v61, s88
    s_mov_b64 exec, 1
    global_store_dword v60, v61, s[12:13]
    s_mov_b64 exec, -1
L_nw:
    s_waitcnt vmcnt(7)
    v_lshlrev_b32 v108, 16, v76
    v_and_b32 v109, 0xffff0000, v76
    v_lshlrev_b32 v110, 16, v77
    v_and_b32 v111, 0xffff0000, v77
    v_lshlrev_b32 v112, 16, v78
    v_and_b32 v113, 0xffff0000, v78
    v_lshlrev_b32 v114, 16, v79
    v_and_b32 v115, 0xffff0000, v79
    s_waitcnt vmcnt(6)
    v_lshlrev_b32 v116, 16, v80
    v_and_b32 v117, 0xffff0000, v80
    v_pk_add_f32 v[108:109], v[108:109], v[116:117]
    v_lshlrev_b32 v118, 16, v81
    v_and_b32 v119, 0xffff0000, v81
    v_pk_add_f32 v[110:111], v[110:111], v[118:119]
    v_lshlrev_b32 v116, 16, v82
    v_and_b32 v117, 0xffff0000, v82
    v_pk_add_f32 v[112:113], v[112:113], v[116:117]
    v_lshlrev_b32 v118, 16, v83
    v_and_b32 v119, 0xffff0000, v83
    v_pk_add_f32 v[114:115], v[114:115], v[118:119]
    s_waitcnt vmcnt(5)
    v_lshlrev_b32 v116, 16, v84
    v_and_b32 v117, 0xffff0000, v84
    v_pk_add_f32 v[108:109], v[108:109], v[116:117]
    v_lshlrev_b32 v118, 16, v85
    v_and_b32 v119, 0xffff0000, v85
    v_pk_add_f32 v[110:111], v[110:111], v[118:119]
    v_lshlrev_b32 v116, 16, v86
    v_and_b32 v117, 0xffff0000, v86
    v_pk_add_f32 v[112:113], v[112:113], v[116:117]
    v_lshlrev_b32 v118, 16, v87
    v_and_b32 v119, 0xffff0000, v87
    v_pk_add_f32 v[114:115], v[114:115], v[118:119]
    s_waitcnt vmcnt(4)
    v_lshlrev_b32 v116, 16, v88
    v_and_b32 v117, 0xffff0000, v88
    v_pk_add_f32 v[108:109], v[108:109], v[116:117]
    v_lshlrev_b32 v118, 16, v89
    v_and_b32 v119, 0xffff0000, v89
    v_pk_add_f32 v[110:111], v[110:111], v[118:119]
    v_lshlrev_b32 v116, 16, v90
    v_and_b32 v117, 0xffff0000, v90
    v_pk_add_f32 v[112:113], v[112:113], v[116:117]
    v_lshlrev_b32 v118, 16, v91
    v_and_b32 v119, 0xffff0000, v91
    v_pk_add_f32 v[114:115], v[114:115], v[118:119]
    s_waitcnt vmcnt(3)
    v_lshlrev_b32 v116, 16, v92
    v_and_b32 v117, 0xffff0000, v92
    v_pk_add_f32 v[108:109], v[108:109], v[116:117]
    v_lshlrev_b32 v118, 16, v93
    v_and_b32 v119, 0xffff0000, v93
    v_pk_add_f32 v[110:111], v[110:111], v[118:119]
    v_lshlrev_b32 v116, 16, v94
    v_and_b32 v117, 0xffff0000, v94
    v_pk_add_f32 v[112:113], v[112:113], v[116:117]
    v_lshlrev_b32 v118, 16, v95
    v_and_b32 v119, 0xffff0000, v95
    v_pk_add_f32 v[114:115], v[114:115], v[118:119]
    s_waitcnt vmcnt(2)
    v_lshlrev_b32 v116, 16, v96
    v_and_b32 v117, 0xffff0000, v96
    v_pk_add_f32 v[108:109], v[108:109], v[116:117]
    v_lshlrev_b32 v118, 16, v97
    v_and_b32 v119, 0xffff0000, v97
    v_pk_add_f32 v[110:111], v[110:111], v[118:119]
    v_lshlrev_b32 v116, 16, v98
    v_and_b32 v117, 0xffff0000, v98
    v_pk_add_f32 v[112:113], v[112:113], v[116:117]
    v_lshlrev_b32 v118, 16, v99
    v_and_b32 v119, 0xffff0000, v99
    v_pk_add_f32 v[114:115], v[114:115], v[118:119]
    s_waitcnt vmcnt(1)
    v_lshlrev_b32 v116, 16, v100
    v_and_b32 v117, 0xffff0000, v100
    v_pk_add_f32 v[108:109], v[108:109], v[116:117]
    v_lshlrev_b32 v118, 16, v101
    v_and_b32 v119, 0xffff0000, v101
    v_pk_add_f32 v[110:111], v[110:111], v[118:119]
    v_lshlrev_b32 v116, 16, v102
    v_and_b32 v117, 0xffff0000, v102
    v_pk_add_f32 v[112:113], v[112:113], v[116:117]
    v_lshlrev_b32 v118, 16, v103
    v_and_b32 v119, 0xffff0000, v103
    v_pk_add_f32 v[114:115], v[114:115], v[118:119]
    s_waitcnt vmcnt(0)
    v_lshlrev_b32 v116, 16, v104
    v_and_b32 v117, 0xffff0000, v104
    v_pk_add_f32 v[108:109], v[108:109], v[116:117]
    v_lshlrev_b32 v118, 16, v105
    v_and_b32 v119, 0xffff0000, v105
    v_pk_add_f32 v[110:111], v[110:111], v[118:119]
    v_lshlrev_b32 v116, 16, v106
    v_and_b32 v117, 0xffff0000, v106
    v_pk_add_f32 v[112:113], v[112:113], v[116:117]
    v_lshlrev_b32 v118, 16, v107
    v_and_b32 v119, 0xffff0000, v107
    v_pk_add_f32 v[114:115], v[114:115], v[118:119]
    v_cvt_pk_bf16_f32 v108, v108, v109
    v_cvt_pk_bf16_f32 v109, v110, v111
    v_cvt_pk_bf16_f32 v110, v112, v113
    v_cvt_pk_bf16_f32 v111, v114, v115
    buffer_store_dwordx2 v[108:109], v59, s[84:87], 0 offen
    buffer_store_dwordx2 v[110:111], v59, s[84:87], s59 offen
    s_endpgm
L_tail1:
    v_lshlrev_b32 v56, 4, v0
    v_add_u32 v57, 0, v56
    ds_read_b128 v[176:179], v57 offset:40960
    ds_read_b128 v[180:183], v57 offset:49152
    s_mov_b32 s41, 36864
    s_waitcnt lgkmcnt(1)
    buffer_store_dwordx4 v[176:179], v56, s[32:35], s41 offen sc1
    s_mov_b32 s41, 45056
    s_waitcnt lgkmcnt(0)
    buffer_store_dwordx4 v[180:183], v56, s[32:35], s41 offen sc1
    ds_read_b64_tr_b16 v[76:77], v248 offset:49152
    ds_read_b64_tr_b16 v[78:79], v248 offset:54272
    ds_read_b128 v[16:19], v251 offset:0
    ds_read_b64_tr_b16 v[80:81], v249 offset:49152
    ds_read_b64_tr_b16 v[82:83], v249 offset:54272
    ds_read_b64_tr_b16 v[84:85], v250 offset:49152
    ds_read_b64_tr_b16 v[86:87], v250 offset:54272
    ds_read_b128 v[20:23], v251 offset:1024
    ds_read_b128 v[24:27], v251 offset:2048
    ds_read_b128 v[28:31], v251 offset:3072
    v_lshlrev_b32 v57, 4, v1
    s_and_b32 s42, s36, 1
    s_add_u32 s43, s42, 0
    s_mul_i32 s43, s43, 9
    s_add_u32 s43, s43, s99
    s_lshl_b32 s43, s43, 10
    v_add_u32 v58, s43, v57
    s_mul_i32 s42, s42, 5120
    s_add_u32 s42, s42, 39936
    v_add_u32 v59, s42, v57
    s_waitcnt lgkmcnt(7)
    v_mfma_f32_16x16x32_bf16 v[116:119], v[76:79], v[16:19], 0
    ds_read_b64_tr_b16 v[88:89], v248 offset:59392
    ds_read_b64_tr_b16 v[90:91], v248 offset:64512
    s_waitcnt lgkmcnt(7)
    v_mfma_f32_16x16x32_bf16 v[120:123], v[80:83], v[16:19], 0
    ds_read_b128 v[36:39], v251 offset:9216
    s_waitcnt lgkmcnt(6)
    v_mfma_f32_16x16x32_bf16 v[124:127], v[84:87], v[16:19], 0
    ds_read_b64_tr_b16 v[92:93], v249 offset:59392
    ds_read_b64_tr_b16 v[94:95], v249 offset:64512
    s_waitcnt lgkmcnt(7)
    v_mfma_f32_16x16x32_bf16 v[128:131], v[76:79], v[20:23], 0
    ds_read_b64_tr_b16 v[96:97], v250 offset:59392
    v_mfma_f32_16x16x32_bf16 v[132:135], v[80:83], v[20:23], 0
    ds_read_b64_tr_b16 v[98:99], v250 offset:64512
    v_mfma_f32_16x16x32_bf16 v[136:139], v[84:87], v[20:23], 0
    ds_read_b128 v[40:43], v251 offset:10240
    ds_read_b128 v[44:47], v251 offset:11264
    s_waitcnt lgkmcnt(10)
    v_mfma_f32_16x16x32_bf16 v[140:143], v[76:79], v[24:27], 0
    ds_read_b128 v[48:51], v251 offset:12288
    v_mfma_f32_16x16x32_bf16 v[144:147], v[80:83], v[24:27], 0
    v_mfma_f32_16x16x32_bf16 v[148:151], v[84:87], v[24:27], 0
    s_waitcnt lgkmcnt(10)
    v_mfma_f32_16x16x32_bf16 v[152:155], v[76:79], v[28:31], 0
    v_mfma_f32_16x16x32_bf16 v[156:159], v[80:83], v[28:31], 0
    v_mfma_f32_16x16x32_bf16 v[160:163], v[84:87], v[28:31], 0
    s_waitcnt vmcnt(2) lgkmcnt(0)
    s_barrier
    v_mfma_f32_16x16x32_bf16 v[116:119], v[88:91], v[36:39], v[116:119]
    s_add_u32 m0, s98, 49152
    s_add_u32 s40, s81, s95
    buffer_load_dwordx4 v2, s[16:19], s40 offen lds
    ds_read_b64_tr_b16 v[76:77], v248 offset:0
    ds_read_b64_tr_b16 v[78:79], v248 offset:5120
    v_mfma_f32_16x16x32_bf16 v[120:123], v[92:95], v[36:39], v[120:123]
    ds_read_b128 v[16:19], v251 offset:20480
    v_mfma_f32_16x16x32_bf16 v[124:127], v[96:99], v[36:39], v[124:127]
    ds_read_b64_tr_b16 v[80:81], v249 offset:0
    ds_read_b64_tr_b16 v[82:83], v249 offset:5120
    v_mfma_f32_16x16x32_bf16 v[128:131], v[88:91], v[40:43], v[128:131]
    ds_read_b64_tr_b16 v[84:85], v250 offset:0
    v_mfma_f32_16x16x32_bf16 v[132:135], v[92:95], v[40:43], v[132:135]
    s_add_u32 m0, s98, 50176
    s_nop 0
    buffer_load_dwordx4 v3, s[16:19], s40 offen lds
    ds_read_b64_tr_b16 v[86:87], v250 offset:5120
    v_mfma_f32_16x16x32_bf16 v[136:139], v[96:99], v[40:43], v[136:139]
    ds_read_b128 v[20:23], v251 offset:21504
    ds_read_b128 v[24:27], v251 offset:22528
    v_mfma_f32_16x16x32_bf16 v[140:143], v[88:91], v[44:47], v[140:143]
    ds_read_b128 v[28:31], v251 offset:23552
    v_mfma_f32_16x16x32_bf16 v[144:147], v[92:95], v[44:47], v[144:147]
    s_add_u32 m0, s98, 51200
    s_nop 0
    buffer_load_dwordx4 v4, s[16:19], s40 offen lds
    v_mfma_f32_16x16x32_bf16 v[148:151], v[96:99], v[44:47], v[148:151]
    v_mfma_f32_16x16x32_bf16 v[152:155], v[88:91], v[48:51], v[152:155]
    v_mfma_f32_16x16x32_bf16 v[156:159], v[92:95], v[48:51], v[156:159]
    v_mfma_f32_16x16x32_bf16 v[160:163], v[96:99], v[48:51], v[160:163]
    s_waitcnt lgkmcnt(0)
    v_mfma_f32_16x16x32_bf16 v[116:119], v[76:79], v[16:19], v[116:119]
    ds_read_b64_tr_b16 v[88:89], v248 offset:10240
    ds_read_b64_tr_b16 v[90:91], v248 offset:15360
    s_add_u32 m0, s98, 52224
    s_nop 0
    buffer_load_dwordx4 v5, s[16:19], s40 offen lds
    v_mfma_f32_16x16x32_bf16 v[120:123], v[80:83], v[16:19], v[120:123]
    ds_read_b128 v[36:39], v251 offset:29696
    v_mfma_f32_16x16x32_bf16 v[124:127], v[84:87], v[16:19], v[124:127]
    ds_read_b64_tr_b16 v[92:93], v249 offset:10240
    ds_read_b64_tr_b16 v[94:95], v249 offset:15360
    v_mfma_f32_16x16x32_bf16 v[128:131], v[76:79], v[20:23], v[128:131]
    ds_read_b64_tr_b16 v[96:97], v250 offset:10240
    v_mfma_f32_16x16x32_bf16 v[132:135], v[80:83], v[20:23], v[132:135]
    ds_read_b64_tr_b16 v[98:99], v250 offset:15360
    v_mfma_f32_16x16x32_bf16 v[136:139], v[84:87], v[20:23], v[136:139]
    ds_read_b128 v[40:43], v251 offset:30720
    ds_read_b128 v[44:47], v251 offset:31744
    v_mfma_f32_16x16x32_bf16 v[140:143], v[76:79], v[24:27], v[140:143]
    ds_read_b128 v[48:51], v251 offset:32768
    s_add_u32 m0, s98, 53248
    s_nop 0
    buffer_load_dwordx4 v7, s[16:19], s40 offen lds
    v_mfma_f32_16x16x32_bf16 v[144:147], v[80:83], v[24:27], v[144:147]
    v_mfma_f32_16x16x32_bf16 v[148:151], v[84:87], v[24:27], v[148:151]
    v_mfma_f32_16x16x32_bf16 v[152:155], v[76:79], v[28:31], v[152:155]
    v_mfma_f32_16x16x32_bf16 v[156:159], v[80:83], v[28:31], v[156:159]
    v_mfma_f32_16x16x32_bf16 v[160:163], v[84:87], v[28:31], v[160:163]
    s_waitcnt vmcnt(5)
    s_waitcnt lgkmcnt(0)
    s_barrier
    v_mfma_f32_16x16x32_bf16 v[116:119], v[88:91], v[36:39], v[116:119]
    s_add_u32 m0, s98, 0
    s_add_u32 s40, s81, s96
    buffer_load_dwordx4 v2, s[16:19], s40 offen lds
    ds_read_b64_tr_b16 v[76:77], v248 offset:24576
    ds_read_b64_tr_b16 v[78:79], v248 offset:29696
    v_mfma_f32_16x16x32_bf16 v[120:123], v[92:95], v[36:39], v[120:123]
    ds_read_b128 v[16:19], v251 offset:40960
    v_mfma_f32_16x16x32_bf16 v[124:127], v[96:99], v[36:39], v[124:127]
    ds_read_b64_tr_b16 v[80:81], v249 offset:24576
    ds_read_b64_tr_b16 v[82:83], v249 offset:29696
    v_mfma_f32_16x16x32_bf16 v[128:131], v[88:91], v[40:43], v[128:131]
    ds_read_b64_tr_b16 v[84:85], v250 offset:24576
    v_mfma_f32_16x16x32_bf16 v[132:135], v[92:95], v[40:43], v[132:135]
    s_add_u32 m0, s98, 1024
    s_nop 0
    buffer_load_dwordx4 v3, s[16:19], s40 offen lds
    ds_read_b64_tr_b16 v[86:87], v250 offset:29696
    v_mfma_f32_16x16x32_bf16 v[136:139], v[96:99], v[40:43], v[136:139]
    ds_read_b128 v[20:23], v251 offset:41984
    ds_read_b128 v[24:27], v251 offset:43008
    v_mfma_f32_16x16x32_bf16 v[140:143], v[88:91], v[44:47], v[140:143]
    ds_read_b128 v[28:31], v251 offset:44032
    v_mfma_f32_16x16x32_bf16 v[144:147], v[92:95], v[44:47], v[144:147]
    s_add_u32 m0, s98, 2048
    s_nop 0
    buffer_load_dwordx4 v4, s[16:19], s40 offen lds
    v_mfma_f32_16x16x32_bf16 v[148:151], v[96:99], v[44:47], v[148:151]
    v_mfma_f32_16x16x32_bf16 v[152:155], v[88:91], v[48:51], v[152:155]
    v_mfma_f32_16x16x32_bf16 v[156:159], v[92:95], v[48:51], v[156:159]
    v_mfma_f32_16x16x32_bf16 v[160:163], v[96:99], v[48:51], v[160:163]
    s_waitcnt lgkmcnt(0)
    v_mfma_f32_16x16x32_bf16 v[116:119], v[76:79], v[16:19], v[116:119]
    ds_read_b64_tr_b16 v[88:89], v248 offset:34816
    ds_read_b64_tr_b16 v[90:91], v248 offset:39936
    s_add_u32 m0, s98, 3072
    s_nop 0
    buffer_load_dwordx4 v5, s[16:19], s40 offen lds
    v_mfma_f32_16x16x32_bf16 v[120:123], v[80:83], v[16:19], v[120:123]
    ds_read_b128 v[36:39], v251 offset:50176
    v_mfma_f32_16x16x32_bf16 v[124:127], v[84:87], v[16:19], v[124:127]
    ds_read_b64_tr_b16 v[92:93], v249 offset:34816
    ds_read_b64_tr_b16 v[94:95], v249 offset:39936
    v_mfma_f32_16x16x32_bf16 v[128:131], v[76:79], v[20:23], v[128:131]
    ds_read_b64_tr_b16 v[96:97], v250 offset:34816
    v_mfma_f32_16x16x32_bf16 v[132:135], v[80:83], v[20:23], v[132:135]
    ds_read_b64_tr_b16 v[98:99], v250 offset:39936
    v_mfma_f32_16x16x32_bf16 v[136:139], v[84:87], v[20:23], v[136:139]
    ds_read_b128 v[40:43], v251 offset:51200
    ds_read_b128 v[44:47], v251 offset:52224
    v_mfma_f32_16x16x32_bf16 v[140:143], v[76:79], v[24:27], v[140:143]
    ds_read_b128 v[48:51], v251 offset:53248
    s_add_u32 m0, s98, 4096
    s_nop 0
    buffer_load_dwordx4 v7, s[16:19], s40 offen lds
    v_mfma_f32_16x16x32_bf16 v[144:147], v[80:83], v[24:27], v[144:147]
    v_mfma_f32_16x16x32_bf16 v[148:151], v[84:87], v[24:27], v[148:151]
    v_mfma_f32_16x16x32_bf16 v[152:155], v[76:79], v[28:31], v[152:155]
    v_mfma_f32_16x16x32_bf16 v[156:159], v[80:83], v[28:31], v[156:159]
    v_mfma_f32_16x16x32_bf16 v[160:163], v[84:87], v[28:31], v[160:163]
    s_waitcnt vmcnt(5) lgkmcnt(0)
    s_barrier
    v_mfma_f32_16x16x32_bf16 v[116:119], v[88:91], v[36:39], v[116:119]
    s_add_u32 m0, s98, 24576
    s_add_u32 s40, s81, s97
    buffer_load_dwordx4 v2, s[16:19], s40 offen lds
    ds_read_b64_tr_b16 v[76:77], v248 offset:49152
    ds_read_b64_tr_b16 v[78:79], v248 offset:54272
    v_mfma_f32_16x16x32_bf16 v[120:123], v[92:95], v[36:39], v[120:123]
    ds_read_b128 v[16:19], v251 offset:0
    v_mfma_f32_16x16x32_bf16 v[124:127], v[96:99], v[36:39], v[124:127]
    ds_read_b64_tr_b16 v[80:81], v249 offset:49152
    ds_read_b64_tr_b16 v[82:83], v249 offset:54272
    v_mfma_f32_16x16x32_bf16 v[128:131], v[88:91], v[40:43], v[128:131]
    ds_read_b64_tr_b16 v[84:85], v250 offset:49152
    v_mfma_f32_16x16x32_bf16 v[132:135], v[92:95], v[40:43], v[132:135]
    s_add_u32 m0, s98, 25600
    s_nop 0
    buffer_load_dwordx4 v3, s[16:19], s40 offen lds
    ds_read_b64_tr_b16 v[86:87], v250 offset:54272
    v_mfma_f32_16x16x32_bf16 v[136:139], v[96:99], v[40:43], v[136:139]
    ds_read_b128 v[20:23], v251 offset:1024
    ds_read_b128 v[24:27], v251 offset:2048
    v_mfma_f32_16x16x32_bf16 v[140:143], v[88:91], v[44:47], v[140:143]
    ds_read_b128 v[28:31], v251 offset:3072
    v_mfma_f32_16x16x32_bf16 v[144:147], v[92:95], v[44:47], v[144:147]
    s_add_u32 m0, s98, 26624
    s_nop 0
    buffer_load_dwordx4 v4, s[16:19], s40 offen lds
    v_mfma_f32_16x16x32_bf16 v[148:151], v[96:99], v[44:47], v[148:151]
    v_mfma_f32_16x16x32_bf16 v[152:155], v[88:91], v[48:51], v[152:155]
    v_mfma_f32_16x16x32_bf16 v[156:159], v[92:95], v[48:51], v[156:159]
    v_mfma_f32_16x16x32_bf16 v[160:163], v[96:99], v[48:51], v[160:163]
    s_waitcnt lgkmcnt(0)
    v_mfma_f32_16x16x32_bf16 v[116:119], v[76:79], v[16:19], v[116:119]
    ds_read_b64_tr_b16 v[88:89], v248 offset:59392
    ds_read_b64_tr_b16 v[90:91], v248 offset:64512
    s_add_u32 m0, s98, 27648
    s_nop 0
    buffer_load_dwordx4 v5, s[16:19], s40 offen lds
    v_mfma_f32_16x16x32_bf16 v[120:123], v[80:83], v[16:19], v[120:123]
    ds_read_b128 v[36:39], v251 offset:9216
    v_mfma_f32_16x16x32_bf16 v[124:127], v[84:87], v[16:19], v[124:127]
    ds_read_b64_tr_b16 v[92:93], v249 offset:59392
    ds_read_b64_tr_b16 v[94:95], v249 offset:64512
    v_mfma_f32_16x16x32_bf16 v[128:131], v[76:79], v[20:23], v[128:131]
    ds_read_b64_tr_b16 v[96:97], v250 offset:59392
    v_mfma_f32_16x16x32_bf16 v[132:135], v[80:83], v[20:23], v[132:135]
    ds_read_b64_tr_b16 v[98:99], v250 offset:64512
    v_mfma_f32_16x16x32_bf16 v[136:139], v[84:87], v[20:23], v[136:139]
    ds_read_b128 v[40:43], v251 offset:10240
    ds_read_b128 v[44:47], v251 offset:11264
    v_mfma_f32_16x16x32_bf16 v[140:143], v[76:79], v[24:27], v[140:143]
    ds_read_b128 v[48:51], v251 offset:12288
    s_add_u32 m0, s98, 28672
    s_nop 0
    buffer_load_dwordx4 v7, s[16:19], s40 offen lds
    v_mfma_f32_16x16x32_bf16 v[144:147], v[80:83], v[24:27], v[144:147]
    v_mfma_f32_16x16x32_bf16 v[148:151], v[84:87], v[24:27], v[148:151]
    v_mfma_f32_16x16x32_bf16 v[152:155], v[76:79], v[28:31], v[152:155]
    v_mfma_f32_16x16x32_bf16 v[156:159], v[80:83], v[28:31], v[156:159]
    v_mfma_f32_16x16x32_bf16 v[160:163], v[84:87], v[28:31], v[160:163]
    s_waitcnt vmcnt(5) lgkmcnt(0)
    s_barrier
    v_mfma_f32_16x16x32_bf16 v[116:119], v[88:91], v[36:39], v[116:119]
    s_add_u32 m0, s98, 49152
    s_add_u32 s40, s82, s95
    buffer_load_dwordx4 v2, s[16:19], s40 offen lds
    ds_read_b64_tr_b16 v[76:77], v248 offset:0
    ds_read_b64_tr_b16 v[78:79], v248 offset:5120
    v_mfma_f32_16x16x32_bf16 v[120:123], v[92:95], v[36:39], v[120:123]
    ds_read_b128 v[16:19], v251 offset:20480
    v_mfma_f32_16x16x32_bf16 v[124:127], v[96:99], v[36:39], v[124:127]
    ds_read_b64_tr_b16 v[80:81], v249 offset:0
    ds_read_b64_tr_b16 v[82:83], v249 offset:5120
    v_mfma_f32_16x16x32_bf16 v[128:131], v[88:91], v[40:43], v[128:131]
    ds_read_b64_tr_b16 v[84:85], v250 offset:0
    v_mfma_f32_16x16x32_bf16 v[132:135], v[92:95], v[40:43], v[132:135]
    s_add_u32 m0, s98, 50176
    s_nop 0
    buffer_load_dwordx4 v3, s[16:19], s40 offen lds
    ds_read_b64_tr_b16 v[86:87], v250 offset:5120
    v_mfma_f32_16x16x32_bf16 v[136:139], v[96:99], v[40:43], v[136:139]
    ds_read_b128 v[20:23], v251 offset:21504
    ds_read_b128 v[24:27], v251 offset:22528
    v_mfma_f32_16x16x32_bf16 v[140:143], v[88:91], v[44:47], v[140:143]
    ds_read_b128 v[28:31], v251 offset:23552
    v_mfma_f32_16x16x32_bf16 v[144:147], v[92:95], v[44:47], v[144:147]
    s_add_u32 m0, s98, 51200
    s_nop 0
    buffer_load_dwordx4 v4, s[16:19], s40 offen lds
    v_mfma_f32_16x16x32_bf16 v[148:151], v[96:99], v[44:47], v[148:151]
    v_mfma_f32_16x16x32_bf16 v[152:155], v[88:91], v[48:51], v[152:155]
    v_mfma_f32_16x16x32_bf16 v[156:159], v[92:95], v[48:51], v[156:159]
    v_mfma_f32_16x16x32_bf16 v[160:163], v[96:99], v[48:51], v[160:163]
    s_waitcnt lgkmcnt(0)
    v_mfma_f32_16x16x32_bf16 v[116:119], v[76:79], v[16:19], v[116:119]
    ds_read_b64_tr_b16 v[88:89], v248 offset:10240
    ds_read_b64_tr_b16 v[90:91], v248 offset:15360
    s_add_u32 m0, s98, 52224
    s_nop 0
    buffer_load_dwordx4 v5, s[16:19], s40 offen lds
    v_mfma_f32_16x16x32_bf16 v[120:123], v[80:83], v[16:19], v[120:123]
    ds_read_b128 v[36:39], v251 offset:29696
    v_mfma_f32_16x16x32_bf16 v[124:127], v[84:87], v[16:19], v[124:127]
    ds_read_b64_tr_b16 v[92:93], v249 offset:10240
    ds_read_b64_tr_b16 v[94:95], v249 offset:15360
    v_mfma_f32_16x16x32_bf16 v[128:131], v[76:79], v[20:23], v[128:131]
    ds_read_b64_tr_b16 v[96:97], v250 offset:10240
    v_mfma_f32_16x16x32_bf16 v[132:135], v[80:83], v[20:23], v[132:135]
    ds_read_b64_tr_b16 v[98:99], v250 offset:15360
    v_mfma_f32_16x16x32_bf16 v[136:139], v[84:87], v[20:23], v[136:139]
    ds_read_b128 v[40:43], v251 offset:30720
    ds_read_b128 v[44:47], v251 offset:31744
    v_mfma_f32_16x16x32_bf16 v[140:143], v[76:79], v[24:27], v[140:143]
    ds_read_b128 v[48:51], v251 offset:32768
    s_add_u32 m0, s98, 53248
    s_nop 0
    buffer_load_dwordx4 v7, s[16:19], s40 offen lds
    v_mfma_f32_16x16x32_bf16 v[144:147], v[80:83], v[24:27], v[144:147]
    v_mfma_f32_16x16x32_bf16 v[148:151], v[84:87], v[24:27], v[148:151]
    v_mfma_f32_16x16x32_bf16 v[152:155], v[76:79], v[28:31], v[152:155]
    v_mfma_f32_16x16x32_bf16 v[156:159], v[80:83], v[28:31], v[156:159]
    v_mfma_f32_16x16x32_bf16 v[160:163], v[84:87], v[28:31], v[160:163]
    s_waitcnt vmcnt(5) lgkmcnt(0)
    s_barrier
    v_mfma_f32_16x16x32_bf16 v[116:119], v[88:91], v[36:39], v[116:119]
    s_add_u32 m0, s98, 0
    s_add_u32 s40, s82, s96
    buffer_load_dwordx4 v2, s[16:19], s40 offen lds
    ds_read_b64_tr_b16 v[76:77], v248 offset:24576
    ds_read_b64_tr_b16 v[78:79], v248 offset:29696
    v_mfma_f32_16x16x32_bf16 v[120:123], v[92:95], v[36:39], v[120:123]
    ds_read_b128 v[16:19], v251 offset:40960
    v_mfma_f32_16x16x32_bf16 v[124:127], v[96:99], v[36:39], v[124:127]
    ds_read_b64_tr_b16 v[80:81], v249 offset:24576
    ds_read_b64_tr_b16 v[82:83], v249 offset:29696
    v_mfma_f32_16x16x32_bf16 v[128:131], v[88:91], v[40:43], v[128:131]
    ds_read_b64_tr_b16 v[84:85], v250 offset:24576
    v_mfma_f32_16x16x32_bf16 v[132:135], v[92:95], v[40:43], v[132:135]
    s_add_u32 m0, s98, 1024
    s_nop 0
    buffer_load_dwordx4 v3, s[16:19], s40 offen lds
    ds_read_b64_tr_b16 v[86:87], v250 offset:29696
    v_mfma_f32_16x16x32_bf16 v[136:139], v[96:99], v[40:43], v[136:139]
    ds_read_b128 v[20:23], v251 offset:41984
    ds_read_b128 v[24:27], v251 offset:43008
    v_mfma_f32_16x16x32_bf16 v[140:143], v[88:91], v[44:47], v[140:143]
    ds_read_b128 v[28:31], v251 offset:44032
    v_mfma_f32_16x16x32_bf16 v[144:147], v[92:95], v[44:47], v[144:147]
    s_add_u32 m0, s98, 2048
    s_nop 0
    buffer_load_dwordx4 v4, s[16:19], s40 offen lds
    v_mfma_f32_16x16x32_bf16 v[148:151], v[96:99], v[44:47], v[148:151]
    v_mfma_f32_16x16x32_bf16 v[152:155], v[88:91], v[48:51], v[152:155]
    v_mfma_f32_16x16x32_bf16 v[156:159], v[92:95], v[48:51], v[156:159]
    v_mfma_f32_16x16x32_bf16 v[160:163], v[96:99], v[48:51], v[160:163]
    s_waitcnt lgkmcnt(0)
    v_mfma_f32_16x16x32_bf16 v[116:119], v[76:79], v[16:19], v[116:119]
    ds_read_b64_tr_b16 v[88:89], v248 offset:34816
    ds_read_b64_tr_b16 v[90:91], v248 offset:39936
    s_add_u32 m0, s98, 3072
    s_nop 0
    buffer_load_dwordx4 v5, s[16:19], s40 offen lds
    v_mfma_f32_16x16x32_bf16 v[120:123], v[80:83], v[16:19], v[120:123]
    ds_read_b128 v[36:39], v251 offset:50176
    v_mfma_f32_16x16x32_bf16 v[124:127], v[84:87], v[16:19], v[124:127]
    ds_read_b64_tr_b16 v[92:93], v249 offset:34816
    ds_read_b64_tr_b16 v[94:95], v249 offset:39936
    v_mfma_f32_16x16x32_bf16 v[128:131], v[76:79], v[20:23], v[128:131]
    ds_read_b64_tr_b16 v[96:97], v250 offset:34816
    v_mfma_f32_16x16x32_bf16 v[132:135], v[80:83], v[20:23], v[132:135]
    ds_read_b64_tr_b16 v[98:99], v250 offset:39936
    v_mfma_f32_16x16x32_bf16 v[136:139], v[84:87], v[20:23], v[136:139]
    ds_read_b128 v[40:43], v251 offset:51200
    ds_read_b128 v[44:47], v251 offset:52224
    v_mfma_f32_16x16x32_bf16 v[140:143], v[76:79], v[24:27], v[140:143]
    ds_read_b128 v[48:51], v251 offset:53248
    s_add_u32 m0, s98, 4096
    s_nop 0
    buffer_load_dwordx4 v7, s[16:19], s40 offen lds
    v_mfma_f32_16x16x32_bf16 v[144:147], v[80:83], v[24:27], v[144:147]
    v_mfma_f32_16x16x32_bf16 v[148:151], v[84:87], v[24:27], v[148:151]
    v_mfma_f32_16x16x32_bf16 v[152:155], v[76:79], v[28:31], v[152:155]
    v_mfma_f32_16x16x32_bf16 v[156:159], v[80:83], v[28:31], v[156:159]
    v_mfma_f32_16x16x32_bf16 v[160:163], v[84:87], v[28:31], v[160:163]
    s_waitcnt vmcnt(5) lgkmcnt(0)
    s_barrier
    v_mfma_f32_16x16x32_bf16 v[116:119], v[88:91], v[36:39], v[116:119]
    s_add_u32 m0, s98, 24576
    s_add_u32 s40, s82, s97
    buffer_load_dwordx4 v2, s[16:19], s40 offen lds
    ds_read_b64_tr_b16 v[76:77], v248 offset:49152
    ds_read_b64_tr_b16 v[78:79], v248 offset:54272
    v_mfma_f32_16x16x32_bf16 v[120:123], v[92:95], v[36:39], v[120:123]
    ds_read_b128 v[16:19], v251 offset:0
    v_mfma_f32_16x16x32_bf16 v[124:127], v[96:99], v[36:39], v[124:127]
    ds_read_b64_tr_b16 v[80:81], v249 offset:49152
    ds_read_b64_tr_b16 v[82:83], v249 offset:54272
    v_mfma_f32_16x16x32_bf16 v[128:131], v[88:91], v[40:43], v[128:131]
    ds_read_b64_tr_b16 v[84:85], v250 offset:49152
    v_mfma_f32_16x16x32_bf16 v[132:135], v[92:95], v[40:43], v[132:135]
    s_add_u32 m0, s98, 25600
    s_nop 0
    buffer_load_dwordx4 v3, s[16:19], s40 offen lds
    ds_read_b64_tr_b16 v[86:87], v250 offset:54272
    v_mfma_f32_16x16x32_bf16 v[136:139], v[96:99], v[40:43], v[136:139]
    ds_read_b128 v[20:23], v251 offset:1024
    ds_read_b128 v[24:27], v251 offset:2048
    v_mfma_f32_16x16x32_bf16 v[140:143], v[88:91], v[44:47], v[140:143]
    ds_read_b128 v[28:31], v251 offset:3072
    v_mfma_f32_16x16x32_bf16 v[144:147], v[92:95], v[44:47], v[144:147]
    s_add_u32 m0, s98, 26624
    s_nop 0
    buffer_load_dwordx4 v4, s[16:19], s40 offen lds
    v_mfma_f32_16x16x32_bf16 v[148:151], v[96:99], v[44:47], v[148:151]
    v_mfma_f32_16x16x32_bf16 v[152:155], v[88:91], v[48:51], v[152:155]
    v_mfma_f32_16x16x32_bf16 v[156:159], v[92:95], v[48:51], v[156:159]
    v_mfma_f32_16x16x32_bf16 v[160:163], v[96:99], v[48:51], v[160:163]
    s_waitcnt lgkmcnt(0)
    v_mfma_f32_16x16x32_bf16 v[116:119], v[76:79], v[16:19], v[116:119]
    ds_read_b64_tr_b16 v[88:89], v248 offset:59392
    ds_read_b64_tr_b16 v[90:91], v248 offset:64512
    s_add_u32 m0, s98, 27648
    s_nop 0
    buffer_load_dwordx4 v5, s[16:19], s40 offen lds
    v_mfma_f32_16x16x32_bf16 v[120:123], v[80:83], v[16:19], v[120:123]
    ds_read_b128 v[36:39], v251 offset:9216
    v_mfma_f32_16x16x32_bf16 v[124:127], v[84:87], v[16:19], v[124:127]
    ds_read_b64_tr_b16 v[92:93], v249 offset:59392
    ds_read_b64_tr_b16 v[94:95], v249 offset:64512
    v_mfma_f32_16x16x32_bf16 v[128:131], v[76:79], v[20:23], v[128:131]
    ds_read_b64_tr_b16 v[96:97], v250 offset:59392
    v_mfma_f32_16x16x32_bf16 v[132:135], v[80:83], v[20:23], v[132:135]
    ds_read_b64_tr_b16 v[98:99], v250 offset:64512
    v_mfma_f32_16x16x32_bf16 v[136:139], v[84:87], v[20:23], v[136:139]
    ds_read_b128 v[40:43], v251 offset:10240
    ds_read_b128 v[44:47], v251 offset:11264
    v_mfma_f32_16x16x32_bf16 v[140:143], v[76:79], v[24:27], v[140:143]
    ds_read_b128 v[48:51], v251 offset:12288
    s_add_u32 m0, s98, 28672
    s_nop 0
    buffer_load_dwordx4 v7, s[16:19], s40 offen lds
    v_mfma_f32_16x16x32_bf16 v[144:147], v[80:83], v[24:27], v[144:147]
    v_mfma_f32_16x16x32_bf16 v[148:151], v[84:87], v[24:27], v[148:151]
    v_mfma_f32_16x16x32_bf16 v[152:155], v[76:79], v[28:31], v[152:155]
    v_mfma_f32_16x16x32_bf16 v[156:159], v[80:83], v[28:31], v[156:159]
    v_mfma_f32_16x16x32_bf16 v[160:163], v[84:87], v[28:31], v[160:163]
    s_waitcnt vmcnt(5) lgkmcnt(0)
    s_barrier
    v_mfma_f32_16x16x32_bf16 v[116:119], v[88:91], v[36:39], v[116:119]
    s_add_u32 m0, s98, 49152
    s_add_u32 s40, s83, s95
    buffer_load_dwordx4 v2, s[16:19], s40 offen lds
    ds_read_b64_tr_b16 v[76:77], v248 offset:0
    ds_read_b64_tr_b16 v[78:79], v248 offset:5120
    v_mfma_f32_16x16x32_bf16 v[120:123], v[92:95], v[36:39], v[120:123]
    ds_read_b128 v[16:19], v251 offset:20480
    v_mfma_f32_16x16x32_bf16 v[124:127], v[96:99], v[36:39], v[124:127]
    ds_read_b64_tr_b16 v[80:81], v249 offset:0
    ds_read_b64_tr_b16 v[82:83], v249 offset:5120
    v_mfma_f32_16x16x32_bf16 v[128:131], v[88:91], v[40:43], v[128:131]
    ds_read_b64_tr_b16 v[84:85], v250 offset:0
    v_mfma_f32_16x16x32_bf16 v[132:135], v[92:95], v[40:43], v[132:135]
    s_add_u32 m0, s98, 50176
    s_nop 0
    buffer_load_dwordx4 v3, s[16:19], s40 offen lds
    ds_read_b64_tr_b16 v[86:87], v250 offset:5120
    v_mfma_f32_16x16x32_bf16 v[136:139], v[96:99], v[40:43], v[136:139]
    ds_read_b128 v[20:23], v251 offset:21504
    ds_read_b128 v[24:27], v251 offset:22528
    v_mfma_f32_16x16x32_bf16 v[140:143], v[88:91], v[44:47], v[140:143]
    ds_read_b128 v[28:31], v251 offset:23552
    v_mfma_f32_16x16x32_bf16 v[144:147], v[92:95], v[44:47], v[144:147]
    s_add_u32 m0, s98, 51200
    s_nop 0
    buffer_load_dwordx4 v4, s[16:19], s40 offen lds
    v_mfma_f32_16x16x32_bf16 v[148:151], v[96:99], v[44:47], v[148:151]
    v_mfma_f32_16x16x32_bf16 v[152:155], v[88:91], v[48:51], v[152:155]
    v_mfma_f32_16x16x32_bf16 v[156:159], v[92:95], v[48:51], v[156:159]
    v_mfma_f32_16x16x32_bf16 v[160:163], v[96:99], v[48:51], v[160:163]
    s_waitcnt lgkmcnt(0)
    v_mfma_f32_16x16x32_bf16 v[116:119], v[76:79], v[16:19], v[116:119]
    ds_read_b64_tr_b16 v[88:89], v248 offset:10240
    ds_read_b64_tr_b16 v[90:91], v248 offset:15360
    s_add_u32 m0, s98, 52224
    s_nop 0
    buffer_load_dwordx4 v5, s[16:19], s40 offen lds
    v_mfma_f32_16x16x32_bf16 v[120:123], v[80:83], v[16:19], v[120:123]
    ds_read_b128 v[36:39], v251 offset:29696
    v_mfma_f32_16x16x32_bf16 v[124:127], v[84:87], v[16:19], v[124:127]
    ds_read_b64_tr_b16 v[92:93], v249 offset:10240
    ds_read_b64_tr_b16 v[94:95], v249 offset:15360
    v_mfma_f32_16x16x32_bf16 v[128:131], v[76:79], v[20:23], v[128:131]
    ds_read_b64_tr_b16 v[96:97], v250 offset:10240
    v_mfma_f32_16x16x32_bf16 v[132:135], v[80:83], v[20:23], v[132:135]
    ds_read_b64_tr_b16 v[98:99], v250 offset:15360
    v_mfma_f32_16x16x32_bf16 v[136:139], v[84:87], v[20:23], v[136:139]
    ds_read_b128 v[40:43], v251 offset:30720
    ds_read_b128 v[44:47], v251 offset:31744
    v_mfma_f32_16x16x32_bf16 v[140:143], v[76:79], v[24:27], v[140:143]
    ds_read_b128 v[48:51], v251 offset:32768
    s_add_u32 m0, s98, 53248
    s_nop 0
    buffer_load_dwordx4 v7, s[16:19], s40 offen lds
    v_mfma_f32_16x16x32_bf16 v[144:147], v[80:83], v[24:27], v[144:147]
    v_mfma_f32_16x16x32_bf16 v[148:151], v[84:87], v[24:27], v[148:151]
    v_mfma_f32_16x16x32_bf16 v[152:155], v[76:79], v[28:31], v[152:155]
    v_mfma_f32_16x16x32_bf16 v[156:159], v[80:83], v[28:31], v[156:159]
    v_mfma_f32_16x16x32_bf16 v[160:163], v[84:87], v[28:31], v[160:163]
    s_waitcnt vmcnt(5) lgkmcnt(0)
    s_barrier
    v_mfma_f32_16x16x32_bf16 v[116:119], v[88:91], v[36:39], v[116:119]
    s_add_u32 m0, s98, 0
    s_add_u32 s40, s83, s96
    buffer_load_dwordx4 v2, s[16:19], s40 offen lds
    ds_read_b64_tr_b16 v[76:77], v248 offset:24576
    ds_read_b64_tr_b16 v[78:79], v248 offset:29696
    v_mfma_f32_16x16x32_bf16 v[120:123], v[92:95], v[36:39], v[120:123]
    ds_read_b128 v[16:19], v251 offset:40960
    v_mfma_f32_16x16x32_bf16 v[124:127], v[96:99], v[36:39], v[124:127]
    ds_read_b64_tr_b16 v[80:81], v249 offset:24576
    ds_read_b64_tr_b16 v[82:83], v249 offset:29696
    v_mfma_f32_16x16x32_bf16 v[128:131], v[88:91], v[40:43], v[128:131]
    ds_read_b64_tr_b16 v[84:85], v250 offset:24576
    v_mfma_f32_16x16x32_bf16 v[132:135], v[92:95], v[40:43], v[132:135]
    s_add_u32 m0, s98, 1024
    s_nop 0
    buffer_load_dwordx4 v3, s[16:19], s40 offen lds
    ds_read_b64_tr_b16 v[86:87], v250 offset:29696
    v_mfma_f32_16x16x32_bf16 v[136:139], v[96:99], v[40:43], v[136:139]
    ds_read_b128 v[20:23], v251 offset:41984
    ds_read_b128 v[24:27], v251 offset:43008
    v_mfma_f32_16x16x32_bf16 v[140:143], v[88:91], v[44:47], v[140:143]
    ds_read_b128 v[28:31], v251 offset:44032
    v_mfma_f32_16x16x32_bf16 v[144:147], v[92:95], v[44:47], v[144:147]
    s_add_u32 m0, s98, 2048
    s_nop 0
    buffer_load_dwordx4 v4, s[16:19], s40 offen lds
    v_mfma_f32_16x16x32_bf16 v[148:151], v[96:99], v[44:47], v[148:151]
    v_mfma_f32_16x16x32_bf16 v[152:155], v[88:91], v[48:51], v[152:155]
    v_mfma_f32_16x16x32_bf16 v[156:159], v[92:95], v[48:51], v[156:159]
    v_mfma_f32_16x16x32_bf16 v[160:163], v[96:99], v[48:51], v[160:163]
    s_waitcnt lgkmcnt(0)
    v_mfma_f32_16x16x32_bf16 v[116:119], v[76:79], v[16:19], v[116:119]
    ds_read_b64_tr_b16 v[88:89], v248 offset:34816
    ds_read_b64_tr_b16 v[90:91], v248 offset:39936
    s_add_u32 m0, s98, 3072
    s_nop 0
    buffer_load_dwordx4 v5, s[16:19], s40 offen lds
    v_mfma_f32_16x16x32_bf16 v[120:123], v[80:83], v[16:19], v[120:123]
    ds_read_b128 v[36:39], v251 offset:50176
    v_mfma_f32_16x16x32_bf16 v[124:127], v[84:87], v[16:19], v[124:127]
    ds_read_b64_tr_b16 v[92:93], v249 offset:34816
    ds_read_b64_tr_b16 v[94:95], v249 offset:39936
    v_mfma_f32_16x16x32_bf16 v[128:131], v[76:79], v[20:23], v[128:131]
    ds_read_b64_tr_b16 v[96:97], v250 offset:34816
    v_mfma_f32_16x16x32_bf16 v[132:135], v[80:83], v[20:23], v[132:135]
    ds_read_b64_tr_b16 v[98:99], v250 offset:39936
    v_mfma_f32_16x16x32_bf16 v[136:139], v[84:87], v[20:23], v[136:139]
    ds_read_b128 v[40:43], v251 offset:51200
    ds_read_b128 v[44:47], v251 offset:52224
    v_mfma_f32_16x16x32_bf16 v[140:143], v[76:79], v[24:27], v[140:143]
    ds_read_b128 v[48:51], v251 offset:53248
    s_add_u32 m0, s98, 4096
    s_nop 0
    buffer_load_dwordx4 v7, s[16:19], s40 offen lds
    v_mfma_f32_16x16x32_bf16 v[144:147], v[80:83], v[24:27], v[144:147]
    v_mfma_f32_16x16x32_bf16 v[148:151], v[84:87], v[24:27], v[148:151]
    v_mfma_f32_16x16x32_bf16 v[152:155], v[76:79], v[28:31], v[152:155]
    v_mfma_f32_16x16x32_bf16 v[156:159], v[80:83], v[28:31], v[156:159]
    v_mfma_f32_16x16x32_bf16 v[160:163], v[84:87], v[28:31], v[160:163]
    s_waitcnt vmcnt(5) lgkmcnt(0)
    s_barrier
    v_mfma_f32_16x16x32_bf16 v[116:119], v[88:91], v[36:39], v[116:119]
    s_add_u32 m0, s98, 24576
    s_add_u32 s40, s83, s97
    buffer_load_dwordx4 v2, s[16:19], s40 offen lds
    ds_read_b64_tr_b16 v[76:77], v248 offset:49152
    ds_read_b64_tr_b16 v[78:79], v248 offset:54272
    v_mfma_f32_16x16x32_bf16 v[120:123], v[92:95], v[36:39], v[120:123]
    ds_read_b128 v[16:19], v251 offset:0
    v_mfma_f32_16x16x32_bf16 v[124:127], v[96:99], v[36:39], v[124:127]
    ds_read_b64_tr_b16 v[80:81], v249 offset:49152
    ds_read_b64_tr_b16 v[82:83], v249 offset:54272
    v_mfma_f32_16x16x32_bf16 v[128:131], v[88:91], v[40:43], v[128:131]
    ds_read_b64_tr_b16 v[84:85], v250 offset:49152
    v_mfma_f32_16x16x32_bf16 v[132:135], v[92:95], v[40:43], v[132:135]
    s_add_u32 m0, s98, 25600
    s_nop 0
    buffer_load_dwordx4 v3, s[16:19], s40 offen lds
    ds_read_b64_tr_b16 v[86:87], v250 offset:54272
    v_mfma_f32_16x16x32_bf16 v[136:139], v[96:99], v[40:43], v[136:139]
    ds_read_b128 v[20:23], v251 offset:1024
    ds_read_b128 v[24:27], v251 offset:2048
    v_mfma_f32_16x16x32_bf16 v[140:143], v[88:91], v[44:47], v[140:143]
    ds_read_b128 v[28:31], v251 offset:3072
    v_mfma_f32_16x16x32_bf16 v[144:147], v[92:95], v[44:47], v[144:147]
    s_add_u32 m0, s98, 26624
    s_nop 0
    buffer_load_dwordx4 v4, s[16:19], s40 offen lds
    v_mfma_f32_16x16x32_bf16 v[148:151], v[96:99], v[44:47], v[148:151]
    v_mfma_f32_16x16x32_bf16 v[152:155], v[88:91], v[48:51], v[152:155]
    v_mfma_f32_16x16x32_bf16 v[156:159], v[92:95], v[48:51], v[156:159]
    v_mfma_f32_16x16x32_bf16 v[160:163], v[96:99], v[48:51], v[160:163]
    s_waitcnt lgkmcnt(0)
    v_mfma_f32_16x16x32_bf16 v[116:119], v[76:79], v[16:19], v[116:119]
    ds_read_b64_tr_b16 v[88:89], v248 offset:59392
    ds_read_b64_tr_b16 v[90:91], v248 offset:64512
    s_add_u32 m0, s98, 27648
    s_nop 0
    buffer_load_dwordx4 v5, s[16:19], s40 offen lds
    v_mfma_f32_16x16x32_bf16 v[120:123], v[80:83], v[16:19], v[120:123]
    ds_read_b128 v[36:39], v251 offset:9216
    v_mfma_f32_16x16x32_bf16 v[124:127], v[84:87], v[16:19], v[124:127]
    ds_read_b64_tr_b16 v[92:93], v249 offset:59392
    ds_read_b64_tr_b16 v[94:95], v249 offset:64512
    v_mfma_f32_16x16x32_bf16 v[128:131], v[76:79], v[20:23], v[128:131]
    ds_read_b64_tr_b16 v[96:97], v250 offset:59392
    v_mfma_f32_16x16x32_bf16 v[132:135], v[80:83], v[20:23], v[132:135]
    ds_read_b64_tr_b16 v[98:99], v250 offset:64512
    v_mfma_f32_16x16x32_bf16 v[136:139], v[84:87], v[20:23], v[136:139]
    ds_read_b128 v[40:43], v251 offset:10240
    ds_read_b128 v[44:47], v251 offset:11264
    v_mfma_f32_16x16x32_bf16 v[140:143], v[76:79], v[24:27], v[140:143]
    ds_read_b128 v[48:51], v251 offset:12288
    s_add_u32 m0, s98, 28672
    s_nop 0
    buffer_load_dwordx4 v7, s[16:19], s40 offen lds
    v_mfma_f32_16x16x32_bf16 v[144:147], v[80:83], v[24:27], v[144:147]
    v_mfma_f32_16x16x32_bf16 v[148:151], v[84:87], v[24:27], v[148:151]
    v_mfma_f32_16x16x32_bf16 v[152:155], v[76:79], v[28:31], v[152:155]
    v_mfma_f32_16x16x32_bf16 v[156:159], v[80:83], v[28:31], v[156:159]
    v_mfma_f32_16x16x32_bf16 v[160:163], v[84:87], v[28:31], v[160:163]
    s_waitcnt vmcnt(5) lgkmcnt(0)
    s_barrier
    v_mfma_f32_16x16x32_bf16 v[116:119], v[88:91], v[36:39], v[116:119]
    ds_read_b64_tr_b16 v[76:77], v248 offset:0
    ds_read_b64_tr_b16 v[78:79], v248 offset:5120
    v_mfma_f32_16x16x32_bf16 v[120:123], v[92:95], v[36:39], v[120:123]
    ds_read_b128 v[16:19], v251 offset:20480
    v_mfma_f32_16x16x32_bf16 v[124:127], v[96:99], v[36:39], v[124:127]
    ds_read_b64_tr_b16 v[80:81], v249 offset:0
    ds_read_b64_tr_b16 v[82:83], v249 offset:5120
    v_mfma_f32_16x16x32_bf16 v[128:131], v[88:91], v[40:43], v[128:131]
    ds_read_b64_tr_b16 v[84:85], v250 offset:0
    v_mfma_f32_16x16x32_bf16 v[132:135], v[92:95], v[40:43], v[132:135]
    ds_read_b64_tr_b16 v[86:87], v250 offset:5120
    v_mfma_f32_16x16x32_bf16 v[136:139], v[96:99], v[40:43], v[136:139]
    ds_read_b128 v[20:23], v251 offset:21504
    ds_read_b128 v[24:27], v251 offset:22528
    v_mfma_f32_16x16x32_bf16 v[140:143], v[88:91], v[44:47], v[140:143]
    ds_read_b128 v[28:31], v251 offset:23552
    v_mfma_f32_16x16x32_bf16 v[144:147], v[92:95], v[44:47], v[144:147]
    v_mfma_f32_16x16x32_bf16 v[148:151], v[96:99], v[44:47], v[148:151]
    v_mfma_f32_16x16x32_bf16 v[152:155], v[88:91], v[48:51], v[152:155]
    v_mfma_f32_16x16x32_bf16 v[156:159], v[92:95], v[48:51], v[156:159]
    v_mfma_f32_16x16x32_bf16 v[160:163], v[96:99], v[48:51], v[160:163]
    s_waitcnt lgkmcnt(0)
    v_mfma_f32_16x16x32_bf16 v[116:119], v[76:79], v[16:19], v[116:119]
    ds_read_b64_tr_b16 v[88:89], v248 offset:10240
    ds_read_b64_tr_b16 v[90:91], v248 offset:15360
    v_mfma_f32_16x16x32_bf16 v[120:123], v[80:83], v[16:19], v[120:123]
    ds_read_b128 v[36:39], v251 offset:29696
    v_mfma_f32_16x16x32_bf16 v[124:127], v[84:87], v[16:19], v[124:127]
    ds_read_b64_tr_b16 v[92:93], v249 offset:10240
    ds_read_b64_tr_b16 v[94:95], v249 offset:15360
    v_mfma_f32_16x16x32_bf16 v[128:131], v[76:79], v[20:23], v[128:131]
    ds_read_b64_tr_b16 v[96:97], v250 offset:10240
    v_mfma_f32_16x16x32_bf16 v[132:135], v[80:83], v[20:23], v[132:135]
    ds_read_b64_tr_b16 v[98:99], v250 offset:15360
    v_mfma_f32_16x16x32_bf16 v[136:139], v[84:87], v[20:23], v[136:139]
    ds_read_b128 v[40:43], v251 offset:30720
    ds_read_b128 v[44:47], v251 offset:31744
    v_mfma_f32_16x16x32_bf16 v[140:143], v[76:79], v[24:27], v[140:143]
    ds_read_b128 v[48:51], v251 offset:32768
    v_mfma_f32_16x16x32_bf16 v[144:147], v[80:83], v[24:27], v[144:147]
    v_mfma_f32_16x16x32_bf16 v[148:151], v[84:87], v[24:27], v[148:151]
    v_mfma_f32_16x16x32_bf16 v[152:155], v[76:79], v[28:31], v[152:155]
    v_mfma_f32_16x16x32_bf16 v[156:159], v[80:83], v[28:31], v[156:159]
    v_mfma_f32_16x16x32_bf16 v[160:163], v[84:87], v[28:31], v[160:163]
    s_waitcnt vmcnt(0) lgkmcnt(0)
    s_barrier
    v_mfma_f32_16x16x32_bf16 v[116:119], v[88:91], v[36:39], v[116:119]
    ds_read_b64_tr_b16 v[76:77], v248 offset:24576
    ds_read_b64_tr_b16 v[78:79], v248 offset:29696
    v_mfma_f32_16x16x32_bf16 v[120:123], v[92:95], v[36:39], v[120:123]
    ds_read_b128 v[16:19], v251 offset:40960
    v_mfma_f32_16x16x32_bf16 v[124:127], v[96:99], v[36:39], v[124:127]
    ds_read_b64_tr_b16 v[80:81], v249 offset:24576
    ds_read_b64_tr_b16 v[82:83], v249 offset:29696
    v_mfma_f32_16x16x32_bf16 v[128:131], v[88:91], v[40:43], v[128:131]
    ds_read_b64_tr_b16 v[84:85], v250 offset:24576
    v_mfma_f32_16x16x32_bf16 v[132:135], v[92:95], v[40:43], v[132:135]
    ds_read_b64_tr_b16 v[86:87], v250 offset:29696
    v_mfma_f32_16x16x32_bf16 v[136:139], v[96:99], v[40:43], v[136:139]
    ds_read_b128 v[20:23], v251 offset:41984
    ds_read_b128 v[24:27], v251 offset:43008
    v_mfma_f32_16x16x32_bf16 v[140:143], v[88:91], v[44:47], v[140:143]
    ds_read_b128 v[28:31], v251 offset:44032
    v_mfma_f32_16x16x32_bf16 v[144:147], v[92:95], v[44:47], v[144:147]
    v_mfma_f32_16x16x32_bf16 v[148:151], v[96:99], v[44:47], v[148:151]
    v_mfma_f32_16x16x32_bf16 v[152:155], v[88:91], v[48:51], v[152:155]
    v_mfma_f32_16x16x32_bf16 v[156:159], v[92:95], v[48:51], v[156:159]
    v_mfma_f32_16x16x32_bf16 v[160:163], v[96:99], v[48:51], v[160:163]
    s_waitcnt lgkmcnt(0)
    v_mfma_f32_16x16x32_bf16 v[116:119], v[76:79], v[16:19], v[116:119]
    ds_read_b64_tr_b16 v[88:89], v248 offset:34816
    ds_read_b64_tr_b16 v[90:91], v248 offset:39936
    v_mfma_f32_16x16x32_bf16 v[120:123], v[80:83], v[16:19], v[120:123]
    ds_read_b128 v[36:39], v251 offset:50176
    v_mfma_f32_16x16x32_bf16 v[124:127], v[84:87], v[16:19], v[124:127]
    ds_read_b64_tr_b16 v[92:93], v249 offset:34816
    ds_read_b64_tr_b16 v[94:95], v249 offset:39936
    v_mfma_f32_16x16x32_bf16 v[128:131], v[76:79], v[20:23], v[128:131]
    ds_read_b64_tr_b16 v[96:97], v250 offset:34816
    v_mfma_f32_16x16x32_bf16 v[132:135], v[80:83], v[20:23], v[132:135]
    ds_read_b64_tr_b16 v[98:99], v250 offset:39936
    v_mfma_f32_16x16x32_bf16 v[136:139], v[84:87], v[20:23], v[136:139]
    ds_read_b128 v[40:43], v251 offset:51200
    ds_read_b128 v[44:47], v251 offset:52224
    v_mfma_f32_16x16x32_bf16 v[140:143], v[76:79], v[24:27], v[140:143]
    ds_read_b128 v[48:51], v251 offset:53248
    v_mfma_f32_16x16x32_bf16 v[144:147], v[80:83], v[24:27], v[144:147]
    v_mfma_f32_16x16x32_bf16 v[148:151], v[84:87], v[24:27], v[148:151]
    v_mfma_f32_16x16x32_bf16 v[152:155], v[76:79], v[28:31], v[152:155]
    v_mfma_f32_16x16x32_bf16 v[156:159], v[80:83], v[28:31], v[156:159]
    v_mfma_f32_16x16x32_bf16 v[160:163], v[84:87], v[28:31], v[160:163]
    s_waitcnt lgkmcnt(7)
    v_mfma_f32_16x16x32_bf16 v[116:119], v[88:91], v[36:39], v[116:119]
    s_waitcnt lgkmcnt(5)
    v_mfma_f32_16x16x32_bf16 v[120:123], v[92:95], v[36:39], v[120:123]
    s_waitcnt lgkmcnt(3)
    v_mfma_f32_16x16x32_bf16 v[124:127], v[96:99], v[36:39], v[124:127]
    s_waitcnt lgkmcnt(2)
    v_mfma_f32_16x16x32_bf16 v[128:131], v[88:91], v[40:43], v[128:131]
    v_mfma_f32_16x16x32_bf16 v[132:135], v[92:95], v[40:43], v[132:135]
    v_mfma_f32_16x16x32_bf16 v[136:139], v[96:99], v[40:43], v[136:139]
    v_cvt_pk_bf16_f32 v116, v116, v117
    v_cvt_pk_bf16_f32 v117, v118, v119
    v_cvt_pk_bf16_f32 v118, v120, v121
    v_cvt_pk_bf16_f32 v119, v122, v123
    s_mov_b32 s41, 0
    buffer_store_dwordx4 v[116:119], v58, s[20:23], s41 offen sc1
    s_waitcnt lgkmcnt(1)
    v_mfma_f32_16x16x32_bf16 v[140:143], v[88:91], v[44:47], v[140:143]
    v_mfma_f32_16x16x32_bf16 v[144:147], v[92:95], v[44:47], v[144:147]
    v_mfma_f32_16x16x32_bf16 v[148:151], v[96:99], v[44:47], v[148:151]
    v_cvt_pk_bf16_f32 v128, v128, v129
    v_cvt_pk_bf16_f32 v129, v130, v131
    v_cvt_pk_bf16_f32 v130, v132, v133
    v_cvt_pk_bf16_f32 v131, v134, v135
    s_mov_b32 s41, 1024
    buffer_store_dwordx4 v[128:131], v58, s[20:23], s41 offen sc1
    s_waitcnt lgkmcnt(0)
    v_mfma_f32_16x16x32_bf16 v[152:155], v[88:91], v[48:51], v[152:155]
    v_cvt_pk_bf16_f32 v124, v124, v125
    v_cvt_pk_bf16_f32 v125, v126, v127
    v_cvt_pk_bf16_f32 v126, v136, v137
    v_cvt_pk_bf16_f32 v127, v138, v139
    s_mov_b32 s41, 0
    buffer_store_dwordx4 v[124:127], v59, s[20:23], s41 offen sc1
    v_mfma_f32_16x16x32_bf16 v[156:159], v[92:95], v[48:51], v[156:159]
    v_mfma_f32_16x16x32_bf16 v[160:163], v[96:99], v[48:51], v[160:163]
    v_cvt_pk_bf16_f32 v140, v140, v141
    v_cvt_pk_bf16_f32 v141, v142, v143
    v_cvt_pk_bf16_f32 v142, v144, v145
    v_cvt_pk_bf16_f32 v143, v146, v147
    s_mov_b32 s41, 2048
    buffer_store_dwordx4 v[140:143], v58, s[20:23], s41 offen sc1
    v_cvt_pk_bf16_f32 v152, v152, v153
    v_cvt_pk_bf16_f32 v153, v154, v155
    v_cvt_pk_bf16_f32 v154, v156, v157
    v_cvt_pk_bf16_f32 v155, v158, v159
    s_mov_b32 s41, 3072
    buffer_store_dwordx4 v[152:155], v58, s[20:23], s41 offen sc1
    v_cvt_pk_bf16_f32 v148, v148, v149
    v_cvt_pk_bf16_f32 v149, v150, v151
    v_cvt_pk_bf16_f32 v150, v160, v161
    v_cvt_pk_bf16_f32 v151, v162, v163
    s_mov_b32 s41, 1024
    buffer_store_dwordx4 v[148:151], v59, s[20:23], s41 offen sc1
    s_lshl_b32 s56, s36, 3
    s_add_u32 s56, s56, s53
    s_lshl_b32 s41, s56, 10
    v_add_u32 v58, s41, v57
    s_mul_i32 s41, s56, 57
    s_lshr_b32 s41, s41, 9
    s_mul_i32 s42, s41, 9
    s_sub_u32 s42, s56, s42
    s_lshl_b32 s41, s41, 2
    s_lshr_b32 s41, 0x8630, s41
    s_and_b32 s41, s41, 15
    s_mov_b32 s59, 32
    s_cmp_lt_u32 s56, 36
    s_cbranch_scc1 L_dec1
    s_cmp_ge_u32 s56, 41
    s_cselect_b32 s41, 5, 2
    s_cselect_b32 s42, 41, 36
    s_sub_u32 s42, s56, s42
    s_cmp_eq_u32 s42, 2
    s_mov_b32 s59, 20480
    s_cselect_b32 s59, 0x40000000, s59
    s_lshl_b32 s42, s42, 2
    s_lshr_b32 s42, 0x75420, s42
    s_and_b32 s42, s42, 15
L_dec1:
    s_lshl_b32 s42, s42, 4
    s_mul_i32 s43, s52, 144
    s_add_u32 s42, s42, s43
    s_mul_i32 s42, s42, 1280
    s_lshl_b32 s41, s41, 5
    s_add_u32 s42, s42, s41
    s_mul_i32 s41, s47, 320
    s_add_u32 s42, s42, s41
    v_and_b32 v59, 15, v1
    v_mul_u32_u24 v59, 1280, v59
    v_lshrrev_b32 v56, 4, v1
    v_lshl_add_u32 v59, v56, 3, v59
    v_add_u32 v59, s42, v59
    s_waitcnt vmcnt(0)
    s_barrier
    v_and_b32 v62, 7, v1
    v_lshlrev_b32 v62, 2, v62
    s_mov_b32 s101, 0x20000
    s_waitcnt vmcnt(0)
L_p2_1:
    global_load_dword v63, v62, s[92:93] offset:0 sc1
    s_sub_u32 s101, s101, 1
    s_cbranch_scc1 L_p2_1_done
    s_waitcnt vmcnt(0)
    v_cmp_ne_u32 vcc, s88, v63
    s_nop 4
    s_cbranch_vccz L_p2_1_done
    s_sleep 1
    s_branch L_p2_1
L_p2_1_done:
    s_waitcnt vmcnt(0)
    s_mov_b32 s41, 0
    buffer_load_dwordx4 v[76:79], v58, s[24:27], s41 offen sc1
    s_mov_b32 s41, 47104
    buffer_load_dwordx4 v[80:83], v58, s[24:27], s41 offen sc1
    s_mov_b32 s41, 94208
    buffer_load_dwordx4 v[84:87], v58, s[24:27], s41 offen sc1
    s_mov_b32 s41, 141312
    buffer_load_dwordx4 v[88:91], v58, s[24:27], s41 offen sc1
    s_mov_b32 s41, 188416
    buffer_load_dwordx4 v[92:95], v58, s[24:27], s41 offen sc1
    s_mov_b32 s41, 235520
    buffer_load_dwordx4 v[96:99], v58, s[24:27], s41 offen sc1
    s_mov_b32 s41, 282624
    buffer_load_dwordx4 v[100:103], v58, s[24:27], s41 offen sc1
    s_mov_b32 s41, 329728
    buffer_load_dwordx4 v[104:107], v58, s[24:27], s41 offen sc1
    s_waitcnt vmcnt(7)
    v_lshlrev_b32 v108, 16, v76
    v_and_b32 v109, 0xffff0000, v76
    v_lshlrev_b32 v110, 16, v77
    v_and_b32 v111, 0xffff0000, v77
    v_lshlrev_b32 v112, 16, v78
    v_and_b32 v113, 0xffff0000, v78
    v_lshlrev_b32 v114, 16, v79
    v_and_b32 v115, 0xffff0000, v79
    s_waitcnt vmcnt(6)
    v_lshlrev_b32 v116, 16, v80
    v_and_b32 v117, 0xffff0000, v80
    v_pk_add_f32 v[108:109], v[108:109], v[116:117]
    v_lshlrev_b32 v118, 16, v81
    v_and_b32 v119, 0xffff0000, v81
    v_pk_add_f32 v[110:111], v[110:111], v[118:119]
    v_lshlrev_b32 v116, 16, v82
    v_and_b32 v117, 0xffff0000, v82
    v_pk_add_f32 v[112:113], v[112:113], v[116:117]
    v_lshlrev_b32 v118, 16, v83
    v_and_b32 v119, 0xffff0000, v83
    v_pk_add_f32 v[114:115], v[114:115], v[118:119]
    s_waitcnt vmcnt(5)
    v_lshlrev_b32 v116, 16, v84
    v_and_b32 v117, 0xffff0000, v84
    v_pk_add_f32 v[108:109], v[108:109], v[116:117]
    v_lshlrev_b32 v118, 16, v85
    v_and_b32 v119, 0xffff0000, v85
    v_pk_add_f32 v[110:111], v[110:111], v[118:119]
    v_lshlrev_b32 v116, 16, v86
    v_and_b32 v117, 0xffff0000, v86
    v_pk_add_f32 v[112:113], v[112:113], v[116:117]
    v_lshlrev_b32 v118, 16, v87
    v_and_b32 v119, 0xffff0000, v87
    v_pk_add_f32 v[114:115], v[114:115], v[118:119]
    s_waitcnt vmcnt(4)
    v_lshlrev_b32 v116, 16, v88
    v_and_b32 v117, 0xffff0000, v88
    v_pk_add_f32 v[108:109], v[108:109], v[116:117]
    v_lshlrev_b32 v118, 16, v89
    v_and_b32 v119, 0xffff0000, v89
    v_pk_add_f32 v[110:111], v[110:111], v[118:119]
    v_lshlrev_b32 v116, 16, v90
    v_and_b32 v117, 0xffff0000, v90
    v_pk_add_f32 v[112:113], v[112:113], v[116:117]
    v_lshlrev_b32 v118, 16, v91
    v_and_b32 v119, 0xffff0000, v91
    v_pk_add_f32 v[114:115], v[114:115], v[118:119]
    s_waitcnt vmcnt(3)
    v_lshlrev_b32 v116, 16, v92
    v_and_b32 v117, 0xffff0000, v92
    v_pk_add_f32 v[108:109], v[108:109], v[116:117]
    v_lshlrev_b32 v118, 16, v93
    v_and_b32 v119, 0xffff0000, v93
    v_pk_add_f32 v[110:111], v[110:111], v[118:119]
    v_lshlrev_b32 v116, 16, v94
    v_and_b32 v117, 0xffff0000, v94
    v_pk_add_f32 v[112:113], v[112:113], v[116:117]
    v_lshlrev_b32 v118, 16, v95
    v_and_b32 v119, 0xffff0000, v95
    v_pk_add_f32 v[114:115], v[114:115], v[118:119]
    s_waitcnt vmcnt(2)
    v_lshlrev_b32 v116, 16, v96
    v_and_b32 v117, 0xffff0000, v96
    v_pk_add_f32 v[108:109], v[108:109], v[116:117]
    v_lshlrev_b32 v118, 16, v97
    v_and_b32 v119, 0xffff0000, v97
    v_pk_add_f32 v[110:111], v[110:111], v[118:119]
    v_lshlrev_b32 v116, 16, v98
    v_and_b32 v117, 0xffff0000, v98
    v_pk_add_f32 v[112:113], v[112:113], v[116:117]
    v_lshlrev_b32 v118, 16, v99
    v_and_b32 v119, 0xffff0000, v99
    v_pk_add_f32 v[114:115], v[114:115], v[118:119]
    s_waitcnt vmcnt(1)
    v_lshlrev_b32 v116, 16, v100
    v_and_b32 v117, 0xffff0000, v100
    v_pk_add_f32 v[108:109], v[108:109], v[116:117]
    v_lshlrev_b32 v118, 16, v101
    v_and_b32 v119, 0xffff0000, v101
    v_pk_add_f32 v[110:111], v[110:111], v[118:119]
    v_lshlrev_b32 v116, 16, v102
    v_and_b32 v117, 0xffff0000, v102
    v_pk_add_f32 v[112:113], v[112:113], v[116:117]
    v_lshlrev_b32 v118, 16, v103
    v_and_b32 v119, 0xffff0000, v103
    v_pk_add_f32 v[114:115], v[114:115], v[118:119]
    s_waitcnt vmcnt(0)
    v_lshlrev_b32 v116, 16, v104
    v_and_b32 v117, 0xffff0000, v104
    v_pk_add_f32 v[108:109], v[108:109], v[116:117]
    v_lshlrev_b32 v118, 16, v105
    v_and_b32 v119, 0xffff0000, v105
    v_pk_add_f32 v[110:111], v[110:111], v[118:119]
    v_lshlrev_b32 v116, 16, v106
    v_and_b32 v117, 0xffff0000, v106
    v_pk_add_f32 v[112:113], v[112:113], v[116:117]
    v_lshlrev_b32 v118, 16, v107
    v_and_b32 v119, 0xffff0000, v107
    v_pk_add_f32 v[114:115], v[114:115], v[118:119]
    v_cvt_pk_bf16_f32 v108, v108, v109
    v_cvt_pk_bf16_f32 v109, v110, v111
    v_cvt_pk_bf16_f32 v110, v112, v113
    v_cvt_pk_bf16_f32 v111, v114, v115
    buffer_store_dwordx2 v[108:109], v59, s[84:87], 0 offen
    buffer_store_dwordx2 v[110:111], v59, s[84:87], s59 offen
    s_endpgm
L_qp11:
    s_add_u32 m0, s57, 0
    s_mov_b32 s40, 0
    buffer_load_dwordx4 v4, s[24:27], s40 offen offset:0 nt lds
    s_add_u32 m0, s57, 1024
    s_mov_b32 s40, 0
    buffer_load_dwordx4 v5, s[24:27], s40 offen offset:0 nt lds
    s_add_u32 m0, s57, 6144
    s_mov_b32 s40, 6144
    buffer_load_dwordx4 v4, s[24:27], s40 offen offset:0 nt lds
    s_add_u32 m0, s57, 7168
    s_mov_b32 s40, 6144
    buffer_load_dwordx4 v5, s[24:27], s40 offen offset:0 nt lds
    s_add_u32 m0, s57, 1920
    s_mov_b32 s40, 0
    buffer_load_dwordx4 v4, s[24:27], s40 offen offset:128 nt lds
    s_add_u32 m0, s57, 2944
    s_mov_b32 s40, 0
    buffer_load_dwordx4 v5, s[24:27], s40 offen offset:128 nt lds
    s_add_u32 m0, s57, 8064
    s_mov_b32 s40, 6144
    buffer_load_dwordx4 v4, s[24:27], s40 offen offset:128 nt lds
    s_add_u32 m0, s57, 9088
    s_mov_b32 s40, 6144
    buffer_load_dwordx4 v5, s[24:27], s40 offen offset:128 nt lds
    s_add_u32 m0, s57, 3840
    s_mov_b32 s40, 0
    buffer_load_dwordx4 v4, s[24:27], s40 offen offset:256 nt lds
    s_add_u32 m0, s57, 4864
    s_mov_b32 s40, 0
    buffer_load_dwordx4 v5, s[24:27], s40 offen offset:256 nt lds
    s_add_u32 m0, s57, 9984
    s_mov_b32 s40, 6144
    buffer_load_dwordx4 v4, s[24:27], s40 offen offset:256 nt lds
    s_add_u32 m0, s57, 11008
    s_mov_b32 s40, 6144
    buffer_load_dwordx4 v5, s[24:27], s40 offen offset:256 nt lds
    s_add_u32 s32, s12, s35
    s_addc_u32 s33, s13, 0
    s_mov_b32 s34, 55296
    s_mov_b32 s35, 0x20000
    s_mov_b32 s44, 1037384597
    v_lshlrev_b32 v247, 2, v0
    v_add_u32 v247, 153600, v247
    v_mov_b32 v248, 0xff800000
    ds_write_b32 v247, v248
    v_and_b32 v243, 15, v1
    v_lshlrev_b32 v243, 2, v243
    v_add_u32 v243, 153600, v243
    v_add_u32 v7, 10240, v7
    v_xor_b32 v8, 64, v7
    s_lshl_b32 s41, s49, 2
    s_lshr_b32 s41, 42560, s41
    s_and_b32 s41, s41, 15
    s_lshr_b32 s42, s41, 2
    s_lshl_b32 s42, s42, 10
    s_add_u32 s42, s42, 55296
    s_and_b32 s41, s41, 3
    v_lshrrev_b32 v244, 4, v1
    v_bfe_u32 v245, v1, 2, 2
    v_and_b32 v246, 1, v244
    v_lshlrev_b32 v246, 1, v246
    v_lshrrev_b32 v247, 1, v245
    v_add_u32 v247, v247, v246
    v_xor_b32 v247, s41, v247
    v_lshlrev_b32 v247, 5, v247
    v_lshlrev_b32 v9, 7, v245
    v_add_u32 v9, v9, v247
    v_mul_u32_u24 v247, 3072, v244
    v_add_u32 v9, v9, v247
    v_and_b32 v247, 3, v1
    v_lshlrev_b32 v247, 3, v247
    v_add_u32 v9, v9, v247
    v_add_u32 v9, s42, v9
    s_lshl_b32 s41, s49, 2
    s_lshr_b32 s41, 46929, s41
    s_and_b32 s41, s41, 15
    s_lshr_b32 s42, s41, 2
    s_lshl_b32 s42, s42, 10
    s_add_u32 s42, s42, 55296
    s_and_b32 s41, s41, 3
    v_lshrrev_b32 v244, 4, v1
    v_bfe_u32 v245, v1, 2, 2
    v_and_b32 v246, 1, v244
    v_lshlrev_b32 v246, 1, v246
    v_lshrrev_b32 v247, 1, v245
    v_add_u32 v247, v247, v246
    v_xor_b32 v247, s41, v247
    v_lshlrev_b32 v247, 5, v247
    v_lshlrev_b32 v10, 7, v245
    v_add_u32 v10, v10, v247
    v_mul_u32_u24 v247, 3072, v244
    v_add_u32 v10, v10, v247
    v_and_b32 v247, 3, v1
    v_lshlrev_b32 v247, 3, v247
    v_add_u32 v10, v10, v247
    v_add_u32 v10, s42, v10
    s_lshl_b32 s41, s49, 2
    s_lshr_b32 s41, 38962, s41
    s_and_b32 s41, s41, 15
    s_lshr_b32 s42, s41, 2
    s_lshl_b32 s42, s42, 10
    s_add_u32 s42, s42, 55296
    s_and_b32 s41, s41, 3
    v_lshrrev_b32 v244, 4, v1
    v_bfe_u32 v245, v1, 2, 2
    v_and_b32 v246, 1, v244
    v_lshlrev_b32 v246, 1, v246
    v_lshrrev_b32 v247, 1, v245
    v_add_u32 v247, v247, v246
    v_xor_b32 v247, s41, v247
    v_lshlrev_b32 v247, 5, v247
    v_lshlrev_b32 v11, 7, v245
    v_add_u32 v11, v11, v247
    v_mul_u32_u24 v247, 3072, v244
    v_add_u32 v11, v11, v247
    v_and_b32 v247, 3, v1
    v_lshlrev_b32 v247, 3, v247
    v_add_u32 v11, v11, v247
    v_add_u32 v11, s42, v11
    s_lshl_b32 s41, s49, 2
    s_lshr_b32 s41, 42560, s41
    s_and_b32 s41, s41, 15
    s_lshr_b32 s42, s41, 1
    s_mul_i32 s42, s42, 9216
    s_and_b32 s41, s41, 1
    s_lshl_b32 s41, s41, 3
    s_add_u32 s41, s41, s42
    s_add_u32 s41, s41, 5120
    v_lshl_add_u32 v12, v1, 4, s41
    s_lshl_b32 s41, s49, 2
    s_lshr_b32 s41, 38962, s41
    s_and_b32 s41, s41, 15
    s_lshr_b32 s42, s41, 1
    s_mul_i32 s42, s42, 9216
    s_and_b32 s41, s41, 1
    s_lshl_b32 s41, s41, 3
    s_add_u32 s41, s41, s42
    s_add_u32 s41, s41, 5120
    v_lshl_add_u32 v14, v1, 4, s41
    v_lshlrev_b32 v240, 4, v1
    s_lshl_b32 s41, s36, 2
    s_lshr_b32 s42, 0x10543210, s41
    s_and_b32 s42, s42, 15
    s_mul_i32 s42, s42, 9216
    v_add_u32 v242, s42, v240
    v_add_u32 v240, 5120, v240
    s_waitcnt lgkmcnt(0)
    v_xor_b32 v246, 32, v250
    v_xor_b32 v247, 32, v251
    s_waitcnt vmcnt(10)
    ds_read_b64 v[16:17], v250 offset:0
    ds_read_b64 v[18:19], v246 offset:0
    ds_read_b64 v[20:21], v251 offset:0
    ds_read_b64 v[22:23], v247 offset:0
    s_waitcnt vmcnt(8)
    ds_read_b64 v[40:41], v250 offset:6144
    ds_read_b64 v[42:43], v246 offset:6144
    ds_read_b64 v[44:45], v251 offset:6144
    ds_read_b64 v[46:47], v247 offset:6144
    s_waitcnt vmcnt(6)
    ds_read_b64 v[24:25], v250 offset:2048
    ds_read_b64 v[26:27], v246 offset:2048
    ds_read_b64 v[28:29], v251 offset:2048
    ds_read_b64 v[30:31], v247 offset:2048
    s_waitcnt vmcnt(4)
    ds_read_b64 v[48:49], v250 offset:8192
    ds_read_b64 v[50:51], v246 offset:8192
    ds_read_b64 v[52:53], v251 offset:8192
    ds_read_b64 v[54:55], v247 offset:8192
    s_waitcnt vmcnt(2)
    ds_read_b64 v[32:33], v250 offset:4096
    ds_read_b64 v[34:35], v246 offset:4096
    ds_read_b64 v[36:37], v251 offset:4096
    ds_read_b64 v[38:39], v247 offset:4096
    s_waitcnt vmcnt(0)
    ds_read_b64 v[56:57], v250 offset:10240
    ds_read_b64 v[58:59], v246 offset:10240
    ds_read_b64 v[60:61], v251 offset:10240
    ds_read_b64 v[62:63], v247 offset:10240
    s_waitcnt lgkmcnt(0)
    s_barrier
    s_cmp_lt_u32 s36, 6
    s_cbranch_scc0 L_x11
    s_add_u32 m0, s38, 12288
    s_mov_b32 s40, 122880
    buffer_load_dwordx4 v2, s[16:19], s40 offen lds
L_x11:
    s_add_u32 m0, s37, 55296
    s_mov_b32 s3, 0
    buffer_load_dwordx4 v3, s[20:23], s3 offen offset:0 lds
    s_add_u32 m0, s37, 56192
    s_nop 0
    buffer_load_dwordx4 v3, s[20:23], s3 offen offset:128 lds
    s_add_u32 m0, s37, 57088
    s_nop 0
    buffer_load_dwordx4 v3, s[20:23], s3 offen offset:256 lds
    s_add_u32 m0, s38, 0
    s_mov_b32 s40, 0
    buffer_load_dwordx4 v2, s[16:19], s40 offen lds
    s_add_u32 m0, s38, 8192
    s_mov_b32 s40, 81920
    buffer_load_dwordx4 v2, s[16:19], s40 offen lds
    s_barrier
    s_cmp_lt_u32 s36, 6
    s_cbranch_scc0 L_x12
    s_add_u32 m0, s38, 30720
    s_mov_b32 s40, 123008
    buffer_load_dwordx4 v2, s[16:19], s40 offen lds
L_x12:
    s_add_u32 m0, s37, 79872
    s_mov_b32 s3, 786432
    buffer_load_dwordx4 v3, s[20:23], s3 offen offset:0 lds
    s_add_u32 m0, s37, 80768
    s_nop 0
    buffer_load_dwordx4 v3, s[20:23], s3 offen offset:128 lds
    s_add_u32 m0, s37, 81664
    s_nop 0
    buffer_load_dwordx4 v3, s[20:23], s3 offen offset:256 lds
    s_add_u32 m0, s38, 18432
    s_mov_b32 s40, 128
    buffer_load_dwordx4 v2, s[16:19], s40 offen lds
    s_add_u32 m0, s38, 26624
    s_mov_b32 s40, 82048
    buffer_load_dwordx4 v2, s[16:19], s40 offen lds
    s_waitcnt vmcnt(5)
    s_barrier
    s_add_u32 s88, s88, 1
    ds_read_b64_tr_b16 v[176:177], v9 offset:0
    ds_read_b64_tr_b16 v[178:179], v9 offset:512
    ds_read_b128 v[200:203], v7 offset:0
    ds_read_b64_tr_b16 v[180:181], v10 offset:0
    ds_read_b64_tr_b16 v[182:183], v10 offset:512
    ds_read_b64_tr_b16 v[184:185], v11 offset:0
    ds_read_b64_tr_b16 v[186:187], v11 offset:512
    ds_read_b128 v[204:207], v7 offset:2048
    ds_read_b128 v[208:211], v7 offset:4096
    ds_read_b128 v[212:215], v7 offset:6144
    s_waitcnt lgkmcnt(7)
    v_mfma_f32_16x16x32_bf16 v[116:119], v[176:179], v[200:203], 0
    ds_read_b64_tr_b16 v[188:189], v9 offset:12288
    ds_read_b64_tr_b16 v[190:191], v9 offset:12800
    s_cmp_lt_u32 s36, 6
    s_cbranch_scc0 L_x13
    s_add_u32 m0, s38, 49152
    s_mov_b32 s40, 123136
    buffer_load_dwordx4 v2, s[16:19], s40 offen lds
L_x13:
    s_waitcnt lgkmcnt(7)
    v_mfma_f32_16x16x32_bf16 v[120:123], v[180:183], v[200:203], 0
    ds_read_b128 v[220:223], v8 offset:0
    s_waitcnt lgkmcnt(6)
    v_mfma_f32_16x16x32_bf16 v[124:127], v[184:187], v[200:203], 0
    ds_read_b64_tr_b16 v[192:193], v10 offset:12288
    ds_read_b64_tr_b16 v[194:195], v10 offset:12800
    s_add_u32 m0, s37, 104448
    s_mov_b32 s3, 1572864
    buffer_load_dwordx4 v3, s[20:23], s3 offen offset:0 lds
    s_waitcnt lgkmcnt(7)
    v_mfma_f32_16x16x32_bf16 v[128:131], v[176:179], v[204:207], 0
    ds_read_b64_tr_b16 v[196:197], v11 offset:12288
    v_mfma_f32_16x16x32_bf16 v[132:135], v[180:183], v[204:207], 0
    ds_read_b64_tr_b16 v[198:199], v11 offset:12800
    s_add_u32 m0, s37, 105344
    s_nop 0
    buffer_load_dwordx4 v3, s[20:23], s3 offen offset:128 lds
    v_mfma_f32_16x16x32_bf16 v[136:139], v[184:187], v[204:207], 0
    ds_read_b128 v[224:227], v8 offset:2048
    ds_read_b128 v[228:231], v8 offset:4096
    s_waitcnt lgkmcnt(10)
    v_mfma_f32_16x16x32_bf16 v[140:143], v[176:179], v[208:211], 0
    ds_read_b128 v[232:235], v8 offset:6144
    s_add_u32 m0, s37, 106240
    s_nop 0
    buffer_load_dwordx4 v3, s[20:23], s3 offen offset:256 lds
    v_mfma_f32_16x16x32_bf16 v[144:147], v[180:183], v[208:211], 0
    s_add_u32 m0, s38, 36864
    s_mov_b32 s40, 256
    buffer_load_dwordx4 v2, s[16:19], s40 offen lds
    v_mfma_f32_16x16x32_bf16 v[148:151], v[184:187], v[208:211], 0
    s_waitcnt lgkmcnt(10)
    v_mfma_f32_16x16x32_bf16 v[152:155], v[176:179], v[212:215], 0
    s_add_u32 m0, s38, 45056
    s_mov_b32 s40, 82176
    buffer_load_dwordx4 v2, s[16:19], s40 offen lds
    v_mfma_f32_16x16x32_bf16 v[156:159], v[180:183], v[212:215], 0
    v_mfma_f32_16x16x32_bf16 v[160:163], v[184:187], v[212:215], 0
    s_waitcnt vmcnt(5) lgkmcnt(0)
    s_barrier
    v_mfma_f32_16x16x32_bf16 v[116:119], v[188:191], v[220:223], v[116:119]
    ds_read_b64_tr_b16 v[176:177], v9 offset:24576
    ds_read_b64_tr_b16 v[178:179], v9 offset:25088
    v_mfma_f32_16x16x32_bf16 v[120:123], v[192:195], v[220:223], v[120:123]
    s_cmp_lt_u32 s36, 6
    s_cbranch_scc0 L_x14
    s_add_u32 m0, s38, 12288
    s_mov_b32 s40, 123264
    buffer_load_dwordx4 v2, s[16:19], s40 offen lds
L_x14:
    ds_read_b128 v[200:203], v7 offset:18432
    v_mfma_f32_16x16x32_bf16 v[124:127], v[196:199], v[220:223], v[124:127]
    ds_read_b64_tr_b16 v[180:181], v10 offset:24576
    ds_read_b64_tr_b16 v[182:183], v10 offset:25088
    v_mfma_f32_16x16x32_bf16 v[128:131], v[188:191], v[224:227], v[128:131]
    ds_read_b64_tr_b16 v[184:185], v11 offset:24576
    v_mfma_f32_16x16x32_bf16 v[132:135], v[192:195], v[224:227], v[132:135]
    s_add_u32 m0, s37, 55296
    s_mov_b32 s3, 2359296
    buffer_load_dwordx4 v3, s[20:23], s3 offen offset:0 lds
    ds_read_b64_tr_b16 v[186:187], v11 offset:25088
    v_mfma_f32_16x16x32_bf16 v[136:139], v[196:199], v[224:227], v[136:139]
    ds_read_b128 v[204:207], v7 offset:20480
    ds_read_b128 v[208:211], v7 offset:22528
    v_mfma_f32_16x16x32_bf16 v[140:143], v[188:191], v[228:231], v[140:143]
    ds_read_b128 v[212:215], v7 offset:24576
    v_mfma_f32_16x16x32_bf16 v[144:147], v[192:195], v[228:231], v[144:147]
    v_mfma_f32_16x16x32_bf16 v[148:151], v[196:199], v[228:231], v[148:151]
    s_add_u32 m0, s37, 56192
    s_nop 0
    buffer_load_dwordx4 v3, s[20:23], s3 offen offset:128 lds
    v_mfma_f32_16x16x32_bf16 v[152:155], v[188:191], v[232:235], v[152:155]
    v_mfma_f32_16x16x32_bf16 v[156:159], v[192:195], v[232:235], v[156:159]
    v_mfma_f32_16x16x32_bf16 v[160:163], v[196:199], v[232:235], v[160:163]
    s_waitcnt lgkmcnt(0)
    v_mfma_f32_16x16x32_bf16 v[116:119], v[176:179], v[200:203], v[116:119]
    ds_read_b64_tr_b16 v[188:189], v9 offset:36864
    ds_read_b64_tr_b16 v[190:191], v9 offset:37376
    s_add_u32 m0, s37, 57088
    s_nop 0
    buffer_load_dwordx4 v3, s[20:23], s3 offen offset:256 lds
    v_mfma_f32_16x16x32_bf16 v[120:123], v[180:183], v[200:203], v[120:123]
    ds_read_b128 v[220:223], v8 offset:18432
    v_mfma_f32_16x16x32_bf16 v[124:127], v[184:187], v[200:203], v[124:127]
    ds_read_b64_tr_b16 v[192:193], v10 offset:36864
    ds_read_b64_tr_b16 v[194:195], v10 offset:37376
    v_mfma_f32_16x16x32_bf16 v[128:131], v[176:179], v[204:207], v[128:131]
    ds_read_b64_tr_b16 v[196:197], v11 offset:36864
    v_mfma_f32_16x16x32_bf16 v[132:135], v[180:183], v[204:207], v[132:135]
    ds_read_b64_tr_b16 v[198:199], v11 offset:37376
    s_add_u32 m0, s38, 0
    s_mov_b32 s40, 384
    buffer_load_dwordx4 v2, s[16:19], s40 offen lds
    v_mfma_f32_16x16x32_bf16 v[136:139], v[184:187], v[204:207], v[136:139]
    ds_read_b128 v[224:227], v8 offset:20480
    ds_read_b128 v[228:231], v8 offset:22528
    v_mfma_f32_16x16x32_bf16 v[140:143], v[176:179], v[208:211], v[140:143]
    ds_read_b128 v[232:235], v8 offset:24576
    v_mfma_f32_16x16x32_bf16 v[144:147], v[180:183], v[208:211], v[144:147]
    s_add_u32 m0, s38, 8192
    s_mov_b32 s40, 82304
    buffer_load_dwordx4 v2, s[16:19], s40 offen lds
    v_mfma_f32_16x16x32_bf16 v[148:151], v[184:187], v[208:211], v[148:151]
    v_mfma_f32_16x16x32_bf16 v[152:155], v[176:179], v[212:215], v[152:155]
    v_mfma_f32_16x16x32_bf16 v[156:159], v[180:183], v[212:215], v[156:159]
    v_mfma_f32_16x16x32_bf16 v[160:163], v[184:187], v[212:215], v[160:163]
    s_waitcnt vmcnt(5) lgkmcnt(0)
    s_barrier
    v_mfma_f32_16x16x32_bf16 v[116:119], v[188:191], v[220:223], v[116:119]
    ds_read_b64_tr_b16 v[176:177], v9 offset:49152
    ds_read_b64_tr_b16 v[178:179], v9 offset:49664
    v_mfma_f32_16x16x32_bf16 v[120:123], v[192:195], v[220:223], v[120:123]
    s_cmp_lt_u32 s36, 6
    s_cbranch_scc0 L_x15
    s_add_u32 m0, s38, 30720
    s_mov_b32 s40, 123392
    buffer_load_dwordx4 v2, s[16:19], s40 offen lds
L_x15:
    ds_read_b128 v[200:203], v7 offset:36864
    v_mfma_f32_16x16x32_bf16 v[124:127], v[196:199], v[220:223], v[124:127]
    ds_read_b64_tr_b16 v[180:181], v10 offset:49152
    ds_read_b64_tr_b16 v[182:183], v10 offset:49664
    v_mfma_f32_16x16x32_bf16 v[128:131], v[188:191], v[224:227], v[128:131]
    ds_read_b64_tr_b16 v[184:185], v11 offset:49152
    v_mfma_f32_16x16x32_bf16 v[132:135], v[192:195], v[224:227], v[132:135]
    s_add_u32 m0, s37, 79872
    s_mov_b32 s3, 3145728
    buffer_load_dwordx4 v3, s[20:23], s3 offen offset:0 lds
    ds_read_b64_tr_b16 v[186:187], v11 offset:49664
    v_mfma_f32_16x16x32_bf16 v[136:139], v[196:199], v[224:227], v[136:139]
    ds_read_b128 v[204:207], v7 offset:38912
    ds_read_b128 v[208:211], v7 offset:40960
    v_mfma_f32_16x16x32_bf16 v[140:143], v[188:191], v[228:231], v[140:143]
    ds_read_b128 v[212:215], v7 offset:43008
    v_mfma_f32_16x16x32_bf16 v[144:147], v[192:195], v[228:231], v[144:147]
    v_mfma_f32_16x16x32_bf16 v[148:151], v[196:199], v[228:231], v[148:151]
    s_add_u32 m0, s37, 80768
    s_nop 0
    buffer_load_dwordx4 v3, s[20:23], s3 offen offset:128 lds
    v_mfma_f32_16x16x32_bf16 v[152:155], v[188:191], v[232:235], v[152:155]
    v_mfma_f32_16x16x32_bf16 v[156:159], v[192:195], v[232:235], v[156:159]
    v_mfma_f32_16x16x32_bf16 v[160:163], v[196:199], v[232:235], v[160:163]
    s_waitcnt lgkmcnt(0)
    v_mfma_f32_16x16x32_bf16 v[116:119], v[176:179], v[200:203], v[116:119]
    ds_read_b64_tr_b16 v[188:189], v9 offset:61440
    ds_read_b64_tr_b16 v[190:191], v9 offset:61952
    s_add_u32 m0, s37, 81664
    s_nop 0
    buffer_load_dwordx4 v3, s[20:23], s3 offen offset:256 lds
    v_mfma_f32_16x16x32_bf16 v[120:123], v[180:183], v[200:203], v[120:123]
    ds_read_b128 v[220:223], v8 offset:36864
    v_mfma_f32_16x16x32_bf16 v[124:127], v[184:187], v[200:203], v[124:127]
    ds_read_b64_tr_b16 v[192:193], v10 offset:61440
    ds_read_b64_tr_b16 v[194:195], v10 offset:61952
    v_mfma_f32_16x16x32_bf16 v[128:131], v[176:179], v[204:207], v[128:131]
    ds_read_b64_tr_b16 v[196:197], v11 offset:61440
    v_mfma_f32_16x16x32_bf16 v[132:135], v[180:183], v[204:207], v[132:135]
    ds_read_b64_tr_b16 v[198:199], v11 offset:61952
    s_add_u32 m0, s38, 18432
    s_mov_b32 s40, 512
    buffer_load_dwordx4 v2, s[16:19], s40 offen lds
    v_mfma_f32_16x16x32_bf16 v[136:139], v[184:187], v[204:207], v[136:139]
    ds_read_b128 v[224:227], v8 offset:38912
    ds_read_b128 v[228:231], v8 offset:40960
    v_mfma_f32_16x16x32_bf16 v[140:143], v[176:179], v[208:211], v[140:143]
    ds_read_b128 v[232:235], v8 offset:43008
    v_mfma_f32_16x16x32_bf16 v[144:147], v[180:183], v[208:211], v[144:147]
    s_add_u32 m0, s38, 26624
    s_mov_b32 s40, 82432
    buffer_load_dwordx4 v2, s[16:19], s40 offen lds
    v_mfma_f32_16x16x32_bf16 v[148:151], v[184:187], v[208:211], v[148:151]
    v_mfma_f32_16x16x32_bf16 v[152:155], v[176:179], v[212:215], v[152:155]
    v_mfma_f32_16x16x32_bf16 v[156:159], v[180:183], v[212:215], v[156:159]
    v_mfma_f32_16x16x32_bf16 v[160:163], v[184:187], v[212:215], v[160:163]
    s_waitcnt vmcnt(5) lgkmcnt(0)
    s_barrier
    v_mfma_f32_16x16x32_bf16 v[116:119], v[188:191], v[220:223], v[116:119]
    ds_read_b64_tr_b16 v[176:177], v9 offset:0
    ds_read_b64_tr_b16 v[178:179], v9 offset:512
    v_mfma_f32_16x16x32_bf16 v[120:123], v[192:195], v[220:223], v[120:123]
    s_cmp_lt_u32 s36, 6
    s_cbranch_scc0 L_x16
    s_add_u32 m0, s38, 49152
    s_mov_b32 s40, 123520
    buffer_load_dwordx4 v2, s[16:19], s40 offen lds
L_x16:
    ds_read_b128 v[200:203], v7 offset:0
    v_mfma_f32_16x16x32_bf16 v[124:127], v[196:199], v[220:223], v[124:127]
    ds_read_b64_tr_b16 v[180:181], v10 offset:0
    ds_read_b64_tr_b16 v[182:183], v10 offset:512
    v_mfma_f32_16x16x32_bf16 v[128:131], v[188:191], v[224:227], v[128:131]
    ds_read_b64_tr_b16 v[184:185], v11 offset:0
    v_mfma_f32_16x16x32_bf16 v[132:135], v[192:195], v[224:227], v[132:135]
    s_add_u32 m0, s37, 104448
    s_mov_b32 s3, 3932160
    buffer_load_dwordx4 v3, s[20:23], s3 offen offset:0 lds
    ds_read_b64_tr_b16 v[186:187], v11 offset:512
    v_mfma_f32_16x16x32_bf16 v[136:139], v[196:199], v[224:227], v[136:139]
    ds_read_b128 v[204:207], v7 offset:2048
    ds_read_b128 v[208:211], v7 offset:4096
    v_mfma_f32_16x16x32_bf16 v[140:143], v[188:191], v[228:231], v[140:143]
    ds_read_b128 v[212:215], v7 offset:6144
    v_mfma_f32_16x16x32_bf16 v[144:147], v[192:195], v[228:231], v[144:147]
    v_mfma_f32_16x16x32_bf16 v[148:151], v[196:199], v[228:231], v[148:151]
    s_add_u32 m0, s37, 105344
    s_nop 0
    buffer_load_dwordx4 v3, s[20:23], s3 offen offset:128 lds
    v_mfma_f32_16x16x32_bf16 v[152:155], v[188:191], v[232:235], v[152:155]
    v_mfma_f32_16x16x32_bf16 v[156:159], v[192:195], v[232:235], v[156:159]
    v_mfma_f32_16x16x32_bf16 v[160:163], v[196:199], v[232:235], v[160:163]
    s_waitcnt lgkmcnt(0)
    v_mfma_f32_16x16x32_bf16 v[116:119], v[176:179], v[200:203], v[116:119]
    ds_read_b64_tr_b16 v[188:189], v9 offset:12288
    ds_read_b64_tr_b16 v[190:191], v9 offset:12800
    s_add_u32 m0, s37, 106240
    s_nop 0
    buffer_load_dwordx4 v3, s[20:23], s3 offen offset:256 lds
    v_mfma_f32_16x16x32_bf16 v[120:123], v[180:183], v[200:203], v[120:123]
    ds_read_b128 v[220:223], v8 offset:0
    v_mfma_f32_16x16x32_bf16 v[124:127], v[184:187], v[200:203], v[124:127]
    ds_read_b64_tr_b16 v[192:193], v10 offset:12288
    ds_read_b64_tr_b16 v[194:195], v10 offset:12800
    v_mfma_f32_16x16x32_bf16 v[128:131], v[176:179], v[204:207], v[128:131]
    ds_read_b64_tr_b16 v[196:197], v11 offset:12288
    v_mfma_f32_16x16x32_bf16 v[132:135], v[180:183], v[204:207], v[132:135]
    ds_read_b64_tr_b16 v[198:199], v11 offset:12800
    s_add_u32 m0, s38, 36864
    s_mov_b32 s40, 640
    buffer_load_dwordx4 v2, s[16:19], s40 offen lds
    v_mfma_f32_16x16x32_bf16 v[136:139], v[184:187], v[204:207], v[136:139]
    ds_read_b128 v[224:227], v8 offset:2048
    ds_read_b128 v[228:231], v8 offset:4096
    v_mfma_f32_16x16x32_bf16 v[140:143], v[176:179], v[208:211], v[140:143]
    ds_read_b128 v[232:235], v8 offset:6144
    v_mfma_f32_16x16x32_bf16 v[144:147], v[180:183], v[208:211], v[144:147]
    s_add_u32 m0, s38, 45056
    s_mov_b32 s40, 82560
    buffer_load_dwordx4 v2, s[16:19], s40 offen lds
    v_mfma_f32_16x16x32_bf16 v[148:151], v[184:187], v[208:211], v[148:151]
    v_mfma_f32_16x16x32_bf16 v[152:155], v[176:179], v[212:215], v[152:155]
    v_mfma_f32_16x16x32_bf16 v[156:159], v[180:183], v[212:215], v[156:159]
    v_mfma_f32_16x16x32_bf16 v[160:163], v[184:187], v[212:215], v[160:163]
    s_waitcnt vmcnt(5) lgkmcnt(0)
    s_barrier
    v_mfma_f32_16x16x32_bf16 v[116:119], v[188:191], v[220:223], v[116:119]
    ds_read_b64_tr_b16 v[176:177], v9 offset:24576
    ds_read_b64_tr_b16 v[178:179], v9 offset:25088
    v_mfma_f32_16x16x32_bf16 v[120:123], v[192:195], v[220:223], v[120:123]
    s_cmp_lt_u32 s36, 6
    s_cbranch_scc0 L_x17
    s_add_u32 m0, s38, 12288
    s_mov_b32 s40, 123648
    buffer_load_dwordx4 v2, s[16:19], s40 offen lds
L_x17:
    ds_read_b128 v[200:203], v7 offset:18432
    v_mfma_f32_16x16x32_bf16 v[124:127], v[196:199], v[220:223], v[124:127]
    ds_read_b64_tr_b16 v[180:181], v10 offset:24576
    ds_read_b64_tr_b16 v[182:183], v10 offset:25088
    v_mfma_f32_16x16x32_bf16 v[128:131], v[188:191], v[224:227], v[128:131]
    ds_read_b64_tr_b16 v[184:185], v11 offset:24576
    v_mfma_f32_16x16x32_bf16 v[132:135], v[192:195], v[224:227], v[132:135]
    s_add_u32 m0, s37, 55296
    s_mov_b32 s3, 4718592
    buffer_load_dwordx4 v3, s[20:23], s3 offen offset:0 lds
    ds_read_b64_tr_b16 v[186:187], v11 offset:25088
    v_mfma_f32_16x16x32_bf16 v[136:139], v[196:199], v[224:227], v[136:139]
    ds_read_b128 v[204:207], v7 offset:20480
    ds_read_b128 v[208:211], v7 offset:22528
    v_mfma_f32_16x16x32_bf16 v[140:143], v[188:191], v[228:231], v[140:143]
    ds_read_b128 v[212:215], v7 offset:24576
    v_mfma_f32_16x16x32_bf16 v[144:147], v[192:195], v[228:231], v[144:147]
    v_mfma_f32_16x16x32_bf16 v[148:151], v[196:199], v[228:231], v[148:151]
    s_add_u32 m0, s37, 56192
    s_nop 0
    buffer_load_dwordx4 v3, s[20:23], s3 offen offset:128 lds
    v_mfma_f32_16x16x32_bf16 v[152:155], v[188:191], v[232:235], v[152:155]
    v_mfma_f32_16x16x32_bf16 v[156:159], v[192:195], v[232:235], v[156:159]
    v_mfma_f32_16x16x32_bf16 v[160:163], v[196:199], v[232:235], v[160:163]
    s_waitcnt lgkmcnt(0)
    v_mfma_f32_16x16x32_bf16 v[116:119], v[176:179], v[200:203], v[116:119]
    ds_read_b64_tr_b16 v[188:189], v9 offset:36864
    ds_read_b64_tr_b16 v[190:191], v9 offset:37376
    s_add_u32 m0, s37, 57088
    s_nop 0
    buffer_load_dwordx4 v3, s[20:23], s3 offen offset:256 lds
    v_mfma_f32_16x16x32_bf16 v[120:123], v[180:183], v[200:203], v[120:123]
    ds_read_b128 v[220:223], v8 offset:18432
    v_mfma_f32_16x16x32_bf16 v[124:127], v[184:187], v[200:203], v[124:127]
    ds_read_b64_tr_b16 v[192:193], v10 offset:36864
    ds_read_b64_tr_b16 v[194:195], v10 offset:37376
    v_mfma_f32_16x16x32_bf16 v[128:131], v[176:179], v[204:207], v[128:131]
    ds_read_b64_tr_b16 v[196:197], v11 offset:36864
    v_mfma_f32_16x16x32_bf16 v[132:135], v[180:183], v[204:207], v[132:135]
    ds_read_b64_tr_b16 v[198:199], v11 offset:37376
    s_add_u32 m0, s38, 0
    s_mov_b32 s40, 768
    buffer_load_dwordx4 v2, s[16:19], s40 offen lds
    v_mfma_f32_16x16x32_bf16 v[136:139], v[184:187], v[204:207], v[136:139]
    ds_read_b128 v[224:227], v8 offset:20480
    ds_read_b128 v[228:231], v8 offset:22528
    v_mfma_f32_16x16x32_bf16 v[140:143], v[176:179], v[208:211], v[140:143]
    ds_read_b128 v[232:235], v8 offset:24576
    v_mfma_f32_16x16x32_bf16 v[144:147], v[180:183], v[208:211], v[144:147]
    s_add_u32 m0, s38, 8192
    s_mov_b32 s40, 82688
    buffer_load_dwordx4 v2, s[16:19], s40 offen lds
    v_mfma_f32_16x16x32_bf16 v[148:151], v[184:187], v[208:211], v[148:151]
    v_mfma_f32_16x16x32_bf16 v[152:155], v[176:179], v[212:215], v[152:155]
    v_mfma_f32_16x16x32_bf16 v[156:159], v[180:183], v[212:215], v[156:159]
    v_mfma_f32_16x16x32_bf16 v[160:163], v[184:187], v[212:215], v[160:163]
    s_waitcnt vmcnt(5) lgkmcnt(0)
    s_barrier
    v_mfma_f32_16x16x32_bf16 v[116:119], v[188:191], v[220:223], v[116:119]
    ds_read_b64_tr_b16 v[176:177], v9 offset:49152
    ds_read_b64_tr_b16 v[178:179], v9 offset:49664
    v_mfma_f32_16x16x32_bf16 v[120:123], v[192:195], v[220:223], v[120:123]
    s_cmp_lt_u32 s36, 6
    s_cbranch_scc0 L_x18
    s_add_u32 m0, s38, 30720
    s_mov_b32 s40, 123776
    buffer_load_dwordx4 v2, s[16:19], s40 offen lds
L_x18:
    ds_read_b128 v[200:203], v7 offset:36864
    v_mfma_f32_16x16x32_bf16 v[124:127], v[196:199], v[220:223], v[124:127]
    ds_read_b64_tr_b16 v[180:181], v10 offset:49152
    ds_read_b64_tr_b16 v[182:183], v10 offset:49664
    v_mfma_f32_16x16x32_bf16 v[128:131], v[188:191], v[224:227], v[128:131]
    ds_read_b64_tr_b16 v[184:185], v11 offset:49152
    v_mfma_f32_16x16x32_bf16 v[132:135], v[192:195], v[224:227], v[132:135]
    s_add_u32 m0, s37, 79872
    s_mov_b32 s3, 5505024
    buffer_load_dwordx4 v3, s[20:23], s3 offen offset:0 lds
    ds_read_b64_tr_b16 v[186:187], v11 offset:49664
    v_mfma_f32_16x16x32_bf16 v[136:139], v[196:199], v[224:227], v[136:139]
    ds_read_b128 v[204:207], v7 offset:38912
    ds_read_b128 v[208:211], v7 offset:40960
    v_mfma_f32_16x16x32_bf16 v[140:143], v[188:191], v[228:231], v[140:143]
    ds_read_b128 v[212:215], v7 offset:43008
    v_mfma_f32_16x16x32_bf16 v[144:147], v[192:195], v[228:231], v[144:147]
    v_mfma_f32_16x16x32_bf16 v[148:151], v[196:199], v[228:231], v[148:151]
    s_add_u32 m0, s37, 80768
    s_nop 0
    buffer_load_dwordx4 v3, s[20:23], s3 offen offset:128 lds
    v_mfma_f32_16x16x32_bf16 v[152:155], v[188:191], v[232:235], v[152:155]
    v_mfma_f32_16x16x32_bf16 v[156:159], v[192:195], v[232:235], v[156:159]
    v_mfma_f32_16x16x32_bf16 v[160:163], v[196:199], v[232:235], v[160:163]
    s_waitcnt lgkmcnt(0)
    v_mfma_f32_16x16x32_bf16 v[116:119], v[176:179], v[200:203], v[116:119]
    ds_read_b64_tr_b16 v[188:189], v9 offset:61440
    ds_read_b64_tr_b16 v[190:191], v9 offset:61952
    s_add_u32 m0, s37, 81664
    s_nop 0
    buffer_load_dwordx4 v3, s[20:23], s3 offen offset:256 lds
    v_mfma_f32_16x16x32_bf16 v[120:123], v[180:183], v[200:203], v[120:123]
    ds_read_b128 v[220:223], v8 offset:36864
    v_mfma_f32_16x16x32_bf16 v[124:127], v[184:187], v[200:203], v[124:127]
    ds_read_b64_tr_b16 v[192:193], v10 offset:61440
    ds_read_b64_tr_b16 v[194:195], v10 offset:61952
    v_mfma_f32_16x16x32_bf16 v[128:131], v[176:179], v[204:207], v[128:131]
    ds_read_b64_tr_b16 v[196:197], v11 offset:61440
    v_mfma_f32_16x16x32_bf16 v[132:135], v[180:183], v[204:207], v[132:135]
    ds_read_b64_tr_b16 v[198:199], v11 offset:61952
    s_add_u32 m0, s38, 18432
    s_mov_b32 s40, 896
    buffer_load_dwordx4 v2, s[16:19], s40 offen lds
    v_mfma_f32_16x16x32_bf16 v[136:139], v[184:187], v[204:207], v[136:139]
    ds_read_b128 v[224:227], v8 offset:38912
    ds_read_b128 v[228:231], v8 offset:40960
    v_mfma_f32_16x16x32_bf16 v[140:143], v[176:179], v[208:211], v[140:143]
    ds_read_b128 v[232:235], v8 offset:43008
    v_mfma_f32_16x16x32_bf16 v[144:147], v[180:183], v[208:211], v[144:147]
    s_add_u32 m0, s38, 26624
    s_mov_b32 s40, 82816
    buffer_load_dwordx4 v2, s[16:19], s40 offen lds
    v_mfma_f32_16x16x32_bf16 v[148:151], v[184:187], v[208:211], v[148:151]
    v_mfma_f32_16x16x32_bf16 v[152:155], v[176:179], v[212:215], v[152:155]
    v_mfma_f32_16x16x32_bf16 v[156:159], v[180:183], v[212:215], v[156:159]
    v_mfma_f32_16x16x32_bf16 v[160:163], v[184:187], v[212:215], v[160:163]
    s_waitcnt vmcnt(5) lgkmcnt(0)
    s_barrier
    v_mfma_f32_16x16x32_bf16 v[116:119], v[188:191], v[220:223], v[116:119]
    ds_read_b64_tr_b16 v[176:177], v9 offset:0
    ds_read_b64_tr_b16 v[178:179], v9 offset:512
    v_mfma_f32_16x16x32_bf16 v[120:123], v[192:195], v[220:223], v[120:123]
    s_cmp_lt_u32 s36, 6
    s_cbranch_scc0 L_x19
    s_add_u32 m0, s38, 49152
    s_mov_b32 s40, 123904
    buffer_load_dwordx4 v2, s[16:19], s40 offen lds
L_x19:
    ds_read_b128 v[200:203], v7 offset:0
    v_mfma_f32_16x16x32_bf16 v[124:127], v[196:199], v[220:223], v[124:127]
    ds_read_b64_tr_b16 v[180:181], v10 offset:0
    ds_read_b64_tr_b16 v[182:183], v10 offset:512
    v_mfma_f32_16x16x32_bf16 v[128:131], v[188:191], v[224:227], v[128:131]
    ds_read_b64_tr_b16 v[184:185], v11 offset:0
    v_mfma_f32_16x16x32_bf16 v[132:135], v[192:195], v[224:227], v[132:135]
    s_add_u32 m0, s37, 104448
    s_mov_b32 s3, 6291456
    buffer_load_dwordx4 v3, s[20:23], s3 offen offset:0 lds
    ds_read_b64_tr_b16 v[186:187], v11 offset:512
    v_mfma_f32_16x16x32_bf16 v[136:139], v[196:199], v[224:227], v[136:139]
    ds_read_b128 v[204:207], v7 offset:2048
    ds_read_b128 v[208:211], v7 offset:4096
    v_mfma_f32_16x16x32_bf16 v[140:143], v[188:191], v[228:231], v[140:143]
    ds_read_b128 v[212:215], v7 offset:6144
    v_mfma_f32_16x16x32_bf16 v[144:147], v[192:195], v[228:231], v[144:147]
    v_mfma_f32_16x16x32_bf16 v[148:151], v[196:199], v[228:231], v[148:151]
    s_add_u32 m0, s37, 105344
    s_nop 0
    buffer_load_dwordx4 v3, s[20:23], s3 offen offset:128 lds
    v_mfma_f32_16x16x32_bf16 v[152:155], v[188:191], v[232:235], v[152:155]
    v_mfma_f32_16x16x32_bf16 v[156:159], v[192:195], v[232:235], v[156:159]
    v_mfma_f32_16x16x32_bf16 v[160:163], v[196:199], v[232:235], v[160:163]
    s_waitcnt lgkmcnt(0)
    v_mfma_f32_16x16x32_bf16 v[116:119], v[176:179], v[200:203], v[116:119]
    ds_read_b64_tr_b16 v[188:189], v9 offset:12288
    ds_read_b64_tr_b16 v[190:191], v9 offset:12800
    s_add_u32 m0, s37, 106240
    s_nop 0
    buffer_load_dwordx4 v3, s[20:23], s3 offen offset:256 lds
    v_mfma_f32_16x16x32_bf16 v[120:123], v[180:183], v[200:203], v[120:123]
    ds_read_b128 v[220:223], v8 offset:0
    v_mfma_f32_16x16x32_bf16 v[124:127], v[184:187], v[200:203], v[124:127]
    ds_read_b64_tr_b16 v[192:193], v10 offset:12288
    ds_read_b64_tr_b16 v[194:195], v10 offset:12800
    v_mfma_f32_16x16x32_bf16 v[128:131], v[176:179], v[204:207], v[128:131]
    ds_read_b64_tr_b16 v[196:197], v11 offset:12288
    v_mfma_f32_16x16x32_bf16 v[132:135], v[180:183], v[204:207], v[132:135]
    ds_read_b64_tr_b16 v[198:199], v11 offset:12800
    s_add_u32 m0, s38, 36864
    s_mov_b32 s40, 1024
    buffer_load_dwordx4 v2, s[16:19], s40 offen lds
    v_mfma_f32_16x16x32_bf16 v[136:139], v[184:187], v[204:207], v[136:139]
    ds_read_b128 v[224:227], v8 offset:2048
    ds_read_b128 v[228:231], v8 offset:4096
    v_mfma_f32_16x16x32_bf16 v[140:143], v[176:179], v[208:211], v[140:143]
    ds_read_b128 v[232:235], v8 offset:6144
    v_mfma_f32_16x16x32_bf16 v[144:147], v[180:183], v[208:211], v[144:147]
    s_add_u32 m0, s38, 45056
    s_mov_b32 s40, 82944
    buffer_load_dwordx4 v2, s[16:19], s40 offen lds
    v_mfma_f32_16x16x32_bf16 v[148:151], v[184:187], v[208:211], v[148:151]
    v_mfma_f32_16x16x32_bf16 v[152:155], v[176:179], v[212:215], v[152:155]
    v_mfma_f32_16x16x32_bf16 v[156:159], v[180:183], v[212:215], v[156:159]
    v_mfma_f32_16x16x32_bf16 v[160:163], v[184:187], v[212:215], v[160:163]
    s_waitcnt vmcnt(5) lgkmcnt(0)
    s_barrier
    v_mfma_f32_16x16x32_bf16 v[116:119], v[188:191], v[220:223], v[116:119]
    ds_read_b64_tr_b16 v[176:177], v9 offset:24576
    ds_read_b64_tr_b16 v[178:179], v9 offset:25088
    v_mfma_f32_16x16x32_bf16 v[120:123], v[192:195], v[220:223], v[120:123]
    s_cmp_lt_u32 s36, 6
    s_cbranch_scc0 L_x20
    s_add_u32 m0, s38, 12288
    s_mov_b32 s40, 124032
    buffer_load_dwordx4 v2, s[16:19], s40 offen lds
L_x20:
    ds_read_b128 v[200:203], v7 offset:18432
    v_mfma_f32_16x16x32_bf16 v[124:127], v[196:199], v[220:223], v[124:127]
    ds_read_b64_tr_b16 v[180:181], v10 offset:24576
    ds_read_b64_tr_b16 v[182:183], v10 offset:25088
    v_mfma_f32_16x16x32_bf16 v[128:131], v[188:191], v[224:227], v[128:131]
    ds_read_b64_tr_b16 v[184:185], v11 offset:24576
    v_mfma_f32_16x16x32_bf16 v[132:135], v[192:195], v[224:227], v[132:135]
    s_add_u32 m0, s37, 55296
    s_mov_b32 s3, 7077888
    buffer_load_dwordx4 v3, s[20:23], s3 offen offset:0 lds
    ds_read_b64_tr_b16 v[186:187], v11 offset:25088
    v_mfma_f32_16x16x32_bf16 v[136:139], v[196:199], v[224:227], v[136:139]
    ds_read_b128 v[204:207], v7 offset:20480
    ds_read_b128 v[208:211], v7 offset:22528
    v_mfma_f32_16x16x32_bf16 v[140:143], v[188:191], v[228:231], v[140:143]
    ds_read_b128 v[212:215], v7 offset:24576
    v_mfma_f32_16x16x32_bf16 v[144:147], v[192:195], v[228:231], v[144:147]
    v_mfma_f32_16x16x32_bf16 v[148:151], v[196:199], v[228:231], v[148:151]
    s_add_u32 m0, s37, 56192
    s_nop 0
    buffer_load_dwordx4 v3, s[20:23], s3 offen offset:128 lds
    v_mfma_f32_16x16x32_bf16 v[152:155], v[188:191], v[232:235], v[152:155]
    v_mfma_f32_16x16x32_bf16 v[156:159], v[192:195], v[232:235], v[156:159]
    v_mfma_f32_16x16x32_bf16 v[160:163], v[196:199], v[232:235], v[160:163]
    s_waitcnt lgkmcnt(0)
    v_mfma_f32_16x16x32_bf16 v[116:119], v[176:179], v[200:203], v[116:119]
    ds_read_b64_tr_b16 v[188:189], v9 offset:36864
    ds_read_b64_tr_b16 v[190:191], v9 offset:37376
    s_add_u32 m0, s37, 57088
    s_nop 0
    buffer_load_dwordx4 v3, s[20:23], s3 offen offset:256 lds
    v_mfma_f32_16x16x32_bf16 v[120:123], v[180:183], v[200:203], v[120:123]
    ds_read_b128 v[220:223], v8 offset:18432
    v_mfma_f32_16x16x32_bf16 v[124:127], v[184:187], v[200:203], v[124:127]
    ds_read_b64_tr_b16 v[192:193], v10 offset:36864
    ds_read_b64_tr_b16 v[194:195], v10 offset:37376
    v_mfma_f32_16x16x32_bf16 v[128:131], v[176:179], v[204:207], v[128:131]
    ds_read_b64_tr_b16 v[196:197], v11 offset:36864
    v_mfma_f32_16x16x32_bf16 v[132:135], v[180:183], v[204:207], v[132:135]
    ds_read_b64_tr_b16 v[198:199], v11 offset:37376
    s_add_u32 m0, s38, 0
    s_mov_b32 s40, 1152
    buffer_load_dwordx4 v2, s[16:19], s40 offen lds
    v_mfma_f32_16x16x32_bf16 v[136:139], v[184:187], v[204:207], v[136:139]
    ds_read_b128 v[224:227], v8 offset:20480
    ds_read_b128 v[228:231], v8 offset:22528
    v_mfma_f32_16x16x32_bf16 v[140:143], v[176:179], v[208:211], v[140:143]
    ds_read_b128 v[232:235], v8 offset:24576
    v_mfma_f32_16x16x32_bf16 v[144:147], v[180:183], v[208:211], v[144:147]
    s_add_u32 m0, s38, 8192
    s_mov_b32 s40, 83072
    buffer_load_dwordx4 v2, s[16:19], s40 offen lds
    v_mfma_f32_16x16x32_bf16 v[148:151], v[184:187], v[208:211], v[148:151]
    v_mfma_f32_16x16x32_bf16 v[152:155], v[176:179], v[212:215], v[152:155]
    v_mfma_f32_16x16x32_bf16 v[156:159], v[180:183], v[212:215], v[156:159]
    v_mfma_f32_16x16x32_bf16 v[160:163], v[184:187], v[212:215], v[160:163]
    s_waitcnt vmcnt(5) lgkmcnt(0)
    s_barrier
    v_mfma_f32_16x16x32_bf16 v[116:119], v[188:191], v[220:223], v[116:119]
    ds_read_b64_tr_b16 v[176:177], v9 offset:49152
    ds_read_b64_tr_b16 v[178:179], v9 offset:49664
    s_lshl_b32 s41, s49, 2
    s_lshr_b32 s41, 42560, s41
    s_and_b32 s41, s41, 15
    s_lshr_b32 s42, s41, 2
    s_lshl_b32 s42, s42, 10
    s_add_u32 s42, s42, 55296
    s_and_b32 s41, s41, 3
    v_mfma_f32_16x16x32_bf16 v[120:123], v[192:195], v[220:223], v[120:123]
    ds_read_b128 v[200:203], v7 offset:36864
    v_lshrrev_b32 v244, 4, v1
    v_bfe_u32 v245, v1, 2, 2
    v_and_b32 v246, 1, v244
    v_lshlrev_b32 v246, 1, v246
    v_lshrrev_b32 v247, 1, v245
    v_add_u32 v247, v247, v246
    v_mfma_f32_16x16x32_bf16 v[124:127], v[196:199], v[220:223], v[124:127]
    ds_read_b64_tr_b16 v[180:181], v10 offset:49152
    ds_read_b64_tr_b16 v[182:183], v10 offset:49664
    v_xor_b32 v247, s41, v247
    v_lshlrev_b32 v247, 5, v247
    v_lshlrev_b32 v248, 7, v245
    v_add_u32 v248, v248, v247
    v_lshlrev_b32 v246, 8, v246
    v_add_u32 v248, v248, v246
    v_lshrrev_b32 v247, 1, v244
    v_mfma_f32_16x16x32_bf16 v[128:131], v[188:191], v[224:227], v[128:131]
    ds_read_b64_tr_b16 v[184:185], v11 offset:49152
    v_mul_u32_u24 v247, 3072, v247
    v_add_u32 v248, v248, v247
    v_and_b32 v247, 3, v1
    v_lshlrev_b32 v247, 3, v247
    v_add_u32 v248, v248, v247
    v_add_u32 v248, s42, v248
    v_mfma_f32_16x16x32_bf16 v[132:135], v[192:195], v[224:227], v[132:135]
    ds_read_b64_tr_b16 v[186:187], v11 offset:49664
    s_lshl_b32 s41, s49, 2
    s_lshr_b32 s41, 46929, s41
    s_and_b32 s41, s41, 15
    s_lshr_b32 s42, s41, 2
    s_lshl_b32 s42, s42, 10
    s_add_u32 s42, s42, 55296
    s_and_b32 s41, s41, 3
    v_mfma_f32_16x16x32_bf16 v[136:139], v[196:199], v[224:227], v[136:139]
    ds_read_b128 v[204:207], v7 offset:38912
    ds_read_b128 v[208:211], v7 offset:40960
    v_lshrrev_b32 v244, 4, v1
    v_bfe_u32 v245, v1, 2, 2
    v_and_b32 v246, 1, v244
    v_lshlrev_b32 v246, 1, v246
    v_lshrrev_b32 v247, 1, v245
    v_add_u32 v247, v247, v246
    v_mfma_f32_16x16x32_bf16 v[140:143], v[188:191], v[228:231], v[140:143]
    ds_read_b128 v[212:215], v7 offset:43008
    v_xor_b32 v247, s41, v247
    v_lshlrev_b32 v247, 5, v247
    v_lshlrev_b32 v249, 7, v245
    v_add_u32 v249, v249, v247
    v_lshlrev_b32 v246, 8, v246
    v_add_u32 v249, v249, v246
    v_lshrrev_b32 v247, 1, v244
    v_mfma_f32_16x16x32_bf16 v[144:147], v[192:195], v[228:231], v[144:147]
    v_mul_u32_u24 v247, 3072, v247
    v_add_u32 v249, v249, v247
    v_and_b32 v247, 3, v1
    v_lshlrev_b32 v247, 3, v247
    v_add_u32 v249, v249, v247
    v_add_u32 v249, s42, v249
    v_mfma_f32_16x16x32_bf16 v[148:151], v[196:199], v[228:231], v[148:151]
    s_lshl_b32 s41, s49, 2
    s_lshr_b32 s41, 38962, s41
    s_and_b32 s41, s41, 15
    s_lshr_b32 s42, s41, 2
    s_lshl_b32 s42, s42, 10
    s_add_u32 s42, s42, 55296
    s_and_b32 s41, s41, 3
    v_mfma_f32_16x16x32_bf16 v[152:155], v[188:191], v[232:235], v[152:155]
    v_lshrrev_b32 v244, 4, v1
    v_bfe_u32 v245, v1, 2, 2
    v_and_b32 v246, 1, v244
    v_lshlrev_b32 v246, 1, v246
    v_lshrrev_b32 v247, 1, v245
    v_add_u32 v247, v247, v246
    v_mfma_f32_16x16x32_bf16 v[156:159], v[192:195], v[232:235], v[156:159]
    v_xor_b32 v247, s41, v247
    v_lshlrev_b32 v247, 5, v247
    v_lshlrev_b32 v253, 7, v245
    v_add_u32 v253, v253, v247
    v_lshlrev_b32 v246, 8, v246
    v_add_u32 v253, v253, v246
    v_lshrrev_b32 v247, 1, v244
    v_mfma_f32_16x16x32_bf16 v[160:163], v[196:199], v[232:235], v[160:163]
    v_mul_u32_u24 v247, 3072, v247
    v_add_u32 v253, v253, v247
    v_and_b32 v247, 3, v1
    v_lshlrev_b32 v247, 3, v247
    v_add_u32 v253, v253, v247
    v_add_u32 v253, s42, v253
    s_waitcnt lgkmcnt(0)
    v_mfma_f32_16x16x32_bf16 v[116:119], v[176:179], v[200:203], v[116:119]
    ds_read_b64_tr_b16 v[188:189], v9 offset:61440
    ds_read_b64_tr_b16 v[190:191], v9 offset:61952
    v_mfma_f32_16x16x32_bf16 v[120:123], v[180:183], v[200:203], v[120:123]
    ds_read_b128 v[220:223], v8 offset:36864
    v_mfma_f32_16x16x32_bf16 v[124:127], v[184:187], v[200:203], v[124:127]
    ds_read_b64_tr_b16 v[192:193], v10 offset:61440
    ds_read_b64_tr_b16 v[194:195], v10 offset:61952
    v_mfma_f32_16x16x32_bf16 v[128:131], v[176:179], v[204:207], v[128:131]
    ds_read_b64_tr_b16 v[196:197], v11 offset:61440
    v_mfma_f32_16x16x32_bf16 v[132:135], v[180:183], v[204:207], v[132:135]
    ds_read_b64_tr_b16 v[198:199], v11 offset:61952
    v_mfma_f32_16x16x32_bf16 v[136:139], v[184:187], v[204:207], v[136:139]
    ds_read_b128 v[224:227], v8 offset:38912
    ds_read_b128 v[228:231], v8 offset:40960
    v_mfma_f32_16x16x32_bf16 v[140:143], v[176:179], v[208:211], v[140:143]
    ds_read_b128 v[232:235], v8 offset:43008
    v_mfma_f32_16x16x32_bf16 v[144:147], v[180:183], v[208:211], v[144:147]
    v_mfma_f32_16x16x32_bf16 v[148:151], v[184:187], v[208:211], v[148:151]
    v_mfma_f32_16x16x32_bf16 v[152:155], v[176:179], v[212:215], v[152:155]
    v_mfma_f32_16x16x32_bf16 v[156:159], v[180:183], v[212:215], v[156:159]
    v_mfma_f32_16x16x32_bf16 v[160:163], v[184:187], v[212:215], v[160:163]
    s_waitcnt vmcnt(0) lgkmcnt(0)
    s_barrier
    v_mfma_f32_16x16x32_bf16 v[116:119], v[188:191], v[220:223], v[116:119]
    ds_read_b64_tr_b16 v[176:177], v9 offset:0
    ds_read_b64_tr_b16 v[178:179], v9 offset:512
    v_mfma_f32_16x16x32_bf16 v[120:123], v[192:195], v[220:223], v[120:123]
    ds_read_b128 v[200:203], v7 offset:0
    v_mfma_f32_16x16x32_bf16 v[124:127], v[196:199], v[220:223], v[124:127]
    ds_read_b64_tr_b16 v[180:181], v10 offset:0
    ds_read_b64_tr_b16 v[182:183], v10 offset:512
    v_mfma_f32_16x16x32_bf16 v[128:131], v[188:191], v[224:227], v[128:131]
    ds_read_b64_tr_b16 v[184:185], v11 offset:0
    v_mfma_f32_16x16x32_bf16 v[132:135], v[192:195], v[224:227], v[132:135]
    ds_read_b64_tr_b16 v[186:187], v11 offset:512
    v_mfma_f32_16x16x32_bf16 v[136:139], v[196:199], v[224:227], v[136:139]
    ds_read_b128 v[204:207], v7 offset:2048
    ds_read_b128 v[208:211], v7 offset:4096
    v_mfma_f32_16x16x32_bf16 v[140:143], v[188:191], v[228:231], v[140:143]
    ds_read_b128 v[212:215], v7 offset:6144
    v_mfma_f32_16x16x32_bf16 v[144:147], v[192:195], v[228:231], v[144:147]
    v_mfma_f32_16x16x32_bf16 v[148:151], v[196:199], v[228:231], v[148:151]
    v_mfma_f32_16x16x32_bf16 v[152:155], v[188:191], v[232:235], v[152:155]
    v_mfma_f32_16x16x32_bf16 v[156:159], v[192:195], v[232:235], v[156:159]
    v_mfma_f32_16x16x32_bf16 v[160:163], v[196:199], v[232:235], v[160:163]
    s_waitcnt lgkmcnt(0)
    v_mfma_f32_16x16x32_bf16 v[116:119], v[176:179], v[200:203], v[116:119]
    ds_read_b64_tr_b16 v[188:189], v9 offset:12288
    ds_read_b64_tr_b16 v[190:191], v9 offset:12800
    v_mfma_f32_16x16x32_bf16 v[120:123], v[180:183], v[200:203], v[120:123]
    ds_read_b128 v[220:223], v8 offset:0
    v_mfma_f32_16x16x32_bf16 v[124:127], v[184:187], v[200:203], v[124:127]
    ds_read_b64_tr_b16 v[192:193], v10 offset:12288
    ds_read_b64_tr_b16 v[194:195], v10 offset:12800
    v_mfma_f32_16x16x32_bf16 v[128:131], v[176:179], v[204:207], v[128:131]
    ds_read_b64_tr_b16 v[196:197], v11 offset:12288
    v_mfma_f32_16x16x32_bf16 v[132:135], v[180:183], v[204:207], v[132:135]
    ds_read_b64_tr_b16 v[198:199], v11 offset:12800
    v_mfma_f32_16x16x32_bf16 v[136:139], v[184:187], v[204:207], v[136:139]
    ds_read_b128 v[224:227], v8 offset:2048
    ds_read_b128 v[228:231], v8 offset:4096
    v_mfma_f32_16x16x32_bf16 v[140:143], v[176:179], v[208:211], v[140:143]
    ds_read_b128 v[232:235], v8 offset:6144
    v_mfma_f32_16x16x32_bf16 v[144:147], v[180:183], v[208:211], v[144:147]
    v_mfma_f32_16x16x32_bf16 v[148:151], v[184:187], v[208:211], v[148:151]
    v_mfma_f32_16x16x32_bf16 v[152:155], v[176:179], v[212:215], v[152:155]
    v_mfma_f32_16x16x32_bf16 v[156:159], v[180:183], v[212:215], v[156:159]
    v_mfma_f32_16x16x32_bf16 v[160:163], v[184:187], v[212:215], v[160:163]
    s_waitcnt lgkmcnt(0)
    s_barrier
    v_mfma_f32_16x16x32_bf16 v[116:119], v[188:191], v[220:223], v[116:119]
    v_mfma_f32_16x16x32_bf16 v[120:123], v[192:195], v[220:223], v[120:123]
    v_mfma_f32_16x16x32_bf16 v[124:127], v[196:199], v[220:223], v[124:127]
    v_mfma_f32_16x16x32_bf16 v[128:131], v[188:191], v[224:227], v[128:131]
    v_mfma_f32_16x16x32_bf16 v[132:135], v[192:195], v[224:227], v[132:135]
    s_nop 3
    v_cvt_pk_bf16_f32 v116, v116, v117
    v_cvt_pk_bf16_f32 v117, v118, v119
    v_cvt_pk_bf16_f32 v118, v120, v121
    v_cvt_pk_bf16_f32 v119, v122, v123
    ds_write_b128 v12, v[116:119] offset:0
    v_mfma_f32_16x16x32_bf16 v[136:139], v[196:199], v[224:227], v[136:139]
    v_cvt_pk_bf16_f32 v124, v124, v125
    v_cvt_pk_bf16_f32 v125, v126, v127
    ds_write_b64 v14, v[124:125] offset:0
    v_mfma_f32_16x16x32_bf16 v[140:143], v[188:191], v[228:231], v[140:143]
    v_mfma_f32_16x16x32_bf16 v[144:147], v[192:195], v[228:231], v[144:147]
    v_cvt_pk_bf16_f32 v128, v128, v129
    v_cvt_pk_bf16_f32 v129, v130, v131
    v_cvt_pk_bf16_f32 v130, v132, v133
    v_cvt_pk_bf16_f32 v131, v134, v135
    ds_write_b128 v12, v[128:131] offset:1024
    v_mfma_f32_16x16x32_bf16 v[148:151], v[196:199], v[228:231], v[148:151]
    v_cvt_pk_bf16_f32 v136, v136, v137
    v_cvt_pk_bf16_f32 v137, v138, v139
    ds_write_b64 v14, v[136:137] offset:1024
    v_mfma_f32_16x16x32_bf16 v[152:155], v[188:191], v[232:235], v[152:155]
    v_mfma_f32_16x16x32_bf16 v[156:159], v[192:195], v[232:235], v[156:159]
    v_cvt_pk_bf16_f32 v140, v140, v141
    v_cvt_pk_bf16_f32 v141, v142, v143
    v_cvt_pk_bf16_f32 v142, v144, v145
    v_cvt_pk_bf16_f32 v143, v146, v147
    ds_write_b128 v12, v[140:143] offset:2048
    v_mfma_f32_16x16x32_bf16 v[160:163], v[196:199], v[232:235], v[160:163]
    v_cvt_pk_bf16_f32 v148, v148, v149
    v_cvt_pk_bf16_f32 v149, v150, v151
    ds_write_b64 v14, v[148:149] offset:2048
    v_cvt_pk_bf16_f32 v152, v152, v153
    v_cvt_pk_bf16_f32 v153, v154, v155
    v_cvt_pk_bf16_f32 v154, v156, v157
    v_cvt_pk_bf16_f32 v155, v158, v159
    ds_write_b128 v12, v[152:155] offset:3072
    v_cvt_pk_bf16_f32 v160, v160, v161
    v_cvt_pk_bf16_f32 v161, v162, v163
    ds_write_b64 v14, v[160:161] offset:3072
    v_lshlrev_b32 v7, 4, v1
    v_mov_b32 v9, v248
    v_mov_b32 v10, v249
    v_mov_b32 v11, v253
    s_waitcnt lgkmcnt(0)
    s_barrier
    s_add_u32 m0, s57, 0
    s_mov_b32 s40, 12288
    buffer_load_dwordx4 v4, s[24:27], s40 offen offset:0 nt lds
    s_add_u32 m0, s57, 1024
    s_mov_b32 s40, 12288
    buffer_load_dwordx4 v5, s[24:27], s40 offen offset:0 nt lds
    s_add_u32 m0, s57, 6144
    s_mov_b32 s40, 18432
    buffer_load_dwordx4 v4, s[24:27], s40 offen offset:0 nt lds
    s_add_u32 m0, s57, 7168
    s_mov_b32 s40, 18432
    buffer_load_dwordx4 v5, s[24:27], s40 offen offset:0 nt lds
    s_add_u32 m0, s57, 1920
    s_mov_b32 s40, 12288
    buffer_load_dwordx4 v4, s[24:27], s40 offen offset:128 nt lds
    s_add_u32 m0, s57, 2944
    s_mov_b32 s40, 12288
    buffer_load_dwordx4 v5, s[24:27], s40 offen offset:128 nt lds
    s_add_u32 m0, s57, 8064
    s_mov_b32 s40, 18432
    buffer_load_dwordx4 v4, s[24:27], s40 offen offset:128 nt lds
    s_add_u32 m0, s57, 9088
    s_mov_b32 s40, 18432
    buffer_load_dwordx4 v5, s[24:27], s40 offen offset:128 nt lds
    s_add_u32 m0, s57, 3840
    s_mov_b32 s40, 12288
    buffer_load_dwordx4 v4, s[24:27], s40 offen offset:256 nt lds
    s_add_u32 m0, s57, 4864
    s_mov_b32 s40, 12288
    buffer_load_dwordx4 v5, s[24:27], s40 offen offset:256 nt lds
    s_add_u32 m0, s57, 9984
    s_mov_b32 s40, 18432
    buffer_load_dwordx4 v4, s[24:27], s40 offen offset:256 nt lds
    s_add_u32 m0, s57, 11008
    s_mov_b32 s40, 18432
    buffer_load_dwordx4 v5, s[24:27], s40 offen offset:256 nt lds
    v_add_u32 v12, 49152, v9
    v_add_u32 v13, 49152, v10
    v_add_u32 v14, 49152, v11
    s_lshl_b32 s41, s36, 2
    s_lshr_b32 s42, 0x32105432, s41
    s_and_b32 s42, s42, 15
    s_mul_i32 s42, s42, 9216
    v_lshlrev_b32 v241, 4, v1
    v_add_u32 v241, s42, v241
    ds_read_b128 v[224:227], v7 offset:0
    ds_read_b128 v[228:231], v7 offset:9216
    ds_read_b128 v[232:235], v7 offset:18432
    ds_read_b128 v[236:239], v7 offset:27648
    s_waitcnt lgkmcnt(3)
    v_mfma_f32_16x16x32_bf16 v[116:119], v[16:19], v[224:227], 0
    v_mfma_f32_16x16x32_bf16 v[120:123], v[40:43], v[224:227], 0
    ds_read_b128 v[224:227], v7 offset:36864
    s_waitcnt lgkmcnt(3)
    v_mfma_f32_16x16x32_bf16 v[116:119], v[20:23], v[228:231], v[116:119]
    v_mfma_f32_16x16x32_bf16 v[120:123], v[44:47], v[228:231], v[120:123]
    ds_read_b128 v[228:231], v7 offset:46080
    s_waitcnt lgkmcnt(3)
    v_mfma_f32_16x16x32_bf16 v[116:119], v[24:27], v[232:235], v[116:119]
    v_mfma_f32_16x16x32_bf16 v[120:123], v[48:51], v[232:235], v[120:123]
    ds_read_b128 v[232:235], v7 offset:1024
    s_waitcnt lgkmcnt(3)
    v_mfma_f32_16x16x32_bf16 v[116:119], v[28:31], v[236:239], v[116:119]
    v_mfma_f32_16x16x32_bf16 v[120:123], v[52:55], v[236:239], v[120:123]
    ds_read_b128 v[236:239], v7 offset:10240
    s_waitcnt lgkmcnt(3)
    v_mfma_f32_16x16x32_bf16 v[116:119], v[32:35], v[224:227], v[116:119]
    v_mfma_f32_16x16x32_bf16 v[120:123], v[56:59], v[224:227], v[120:123]
    ds_read_b128 v[224:227], v7 offset:19456
    s_waitcnt lgkmcnt(3)
    v_mfma_f32_16x16x32_bf16 v[116:119], v[36:39], v[228:231], v[116:119]
    v_mfma_f32_16x16x32_bf16 v[120:123], v[60:63], v[228:231], v[120:123]
    ds_read_b128 v[228:231], v7 offset:28672
    s_waitcnt lgkmcnt(3)
    v_mfma_f32_16x16x32_bf16 v[124:127], v[16:19], v[232:235], 0
    v_mfma_f32_16x16x32_bf16 v[128:131], v[40:43], v[232:235], 0
    ds_read_b128 v[232:235], v7 offset:37888
    s_waitcnt lgkmcnt(3)
    v_mfma_f32_16x16x32_bf16 v[124:127], v[20:23], v[236:239], v[124:127]
    v_mfma_f32_16x16x32_bf16 v[128:131], v[44:47], v[236:239], v[128:131]
    ds_read_b128 v[236:239], v7 offset:47104
    s_waitcnt lgkmcnt(3)
    v_mfma_f32_16x16x32_bf16 v[124:127], v[24:27], v[224:227], v[124:127]
    v_mfma_f32_16x16x32_bf16 v[128:131], v[48:51], v[224:227], v[128:131]
    ds_read_b128 v[224:227], v7 offset:2048
    s_waitcnt lgkmcnt(3)
    v_mfma_f32_16x16x32_bf16 v[124:127], v[28:31], v[228:231], v[124:127]
    v_mfma_f32_16x16x32_bf16 v[128:131], v[52:55], v[228:231], v[128:131]
    ds_read_b128 v[228:231], v7 offset:11264
    s_waitcnt lgkmcnt(3)
    v_mfma_f32_16x16x32_bf16 v[124:127], v[32:35], v[232:235], v[124:127]
    v_mfma_f32_16x16x32_bf16 v[128:131], v[56:59], v[232:235], v[128:131]
    ds_read_b128 v[232:235], v7 offset:20480
    s_waitcnt lgkmcnt(3)
    v_mfma_f32_16x16x32_bf16 v[124:127], v[36:39], v[236:239], v[124:127]
    v_mfma_f32_16x16x32_bf16 v[128:131], v[60:63], v[236:239], v[128:131]
    ds_read_b128 v[236:239], v7 offset:29696
    s_waitcnt lgkmcnt(3)
    v_mfma_f32_16x16x32_bf16 v[132:135], v[16:19], v[224:227], 0
    v_mfma_f32_16x16x32_bf16 v[136:139], v[40:43], v[224:227], 0
    ds_read_b128 v[224:227], v7 offset:38912
    s_waitcnt lgkmcnt(3)
    v_mfma_f32_16x16x32_bf16 v[132:135], v[20:23], v[228:231], v[132:135]
    v_mfma_f32_16x16x32_bf16 v[136:139], v[44:47], v[228:231], v[136:139]
    ds_read_b128 v[228:231], v7 offset:48128
    s_waitcnt lgkmcnt(3)
    v_mfma_f32_16x16x32_bf16 v[132:135], v[24:27], v[232:235], v[132:135]
    v_mfma_f32_16x16x32_bf16 v[136:139], v[48:51], v[232:235], v[136:139]
    ds_read_b128 v[232:235], v7 offset:3072
    s_waitcnt lgkmcnt(3)
    v_mfma_f32_16x16x32_bf16 v[132:135], v[28:31], v[236:239], v[132:135]
    v_mfma_f32_16x16x32_bf16 v[136:139], v[52:55], v[236:239], v[136:139]
    ds_read_b128 v[236:239], v7 offset:12288
    s_waitcnt lgkmcnt(3)
    v_mfma_f32_16x16x32_bf16 v[132:135], v[32:35], v[224:227], v[132:135]
    v_mfma_f32_16x16x32_bf16 v[136:139], v[56:59], v[224:227], v[136:139]
    ds_read_b128 v[224:227], v7 offset:21504
    s_waitcnt lgkmcnt(3)
    v_mfma_f32_16x16x32_bf16 v[132:135], v[36:39], v[228:231], v[132:135]
    v_mfma_f32_16x16x32_bf16 v[136:139], v[60:63], v[228:231], v[136:139]
    ds_read_b128 v[228:231], v7 offset:30720
    s_waitcnt lgkmcnt(3)
    v_mfma_f32_16x16x32_bf16 v[140:143], v[16:19], v[232:235], 0
    v_mfma_f32_16x16x32_bf16 v[144:147], v[40:43], v[232:235], 0
    ds_read_b128 v[232:235], v7 offset:39936
    s_waitcnt lgkmcnt(3)
    v_mfma_f32_16x16x32_bf16 v[140:143], v[20:23], v[236:239], v[140:143]
    v_mfma_f32_16x16x32_bf16 v[144:147], v[44:47], v[236:239], v[144:147]
    ds_read_b128 v[236:239], v7 offset:49152
    s_waitcnt lgkmcnt(3)
    v_mfma_f32_16x16x32_bf16 v[140:143], v[24:27], v[224:227], v[140:143]
    v_mfma_f32_16x16x32_bf16 v[144:147], v[48:51], v[224:227], v[144:147]
    ds_read_b128 v[224:227], v7 offset:4096
    s_waitcnt lgkmcnt(3)
    v_mfma_f32_16x16x32_bf16 v[140:143], v[28:31], v[228:231], v[140:143]
    v_mfma_f32_16x16x32_bf16 v[144:147], v[52:55], v[228:231], v[144:147]
    ds_read_b128 v[228:231], v7 offset:13312
    s_waitcnt lgkmcnt(3)
    v_mfma_f32_16x16x32_bf16 v[140:143], v[32:35], v[232:235], v[140:143]
    v_mfma_f32_16x16x32_bf16 v[144:147], v[56:59], v[232:235], v[144:147]
    ds_read_b128 v[232:235], v7 offset:22528
    s_waitcnt lgkmcnt(3)
    v_mfma_f32_16x16x32_bf16 v[140:143], v[36:39], v[236:239], v[140:143]
    v_mfma_f32_16x16x32_bf16 v[144:147], v[60:63], v[236:239], v[144:147]
    ds_read_b128 v[236:239], v7 offset:31744
    s_waitcnt lgkmcnt(3)
    v_mfma_f32_16x16x32_bf16 v[148:151], v[16:19], v[224:227], 0
    v_mfma_f32_16x16x32_bf16 v[152:155], v[40:43], v[224:227], 0
    ds_read_b128 v[224:227], v7 offset:40960
    s_waitcnt lgkmcnt(3)
    v_mfma_f32_16x16x32_bf16 v[148:151], v[20:23], v[228:231], v[148:151]
    v_mfma_f32_16x16x32_bf16 v[152:155], v[44:47], v[228:231], v[152:155]
    ds_read_b128 v[228:231], v7 offset:50176
    s_waitcnt lgkmcnt(3)
    v_mfma_f32_16x16x32_bf16 v[148:151], v[24:27], v[232:235], v[148:151]
    v_mfma_f32_16x16x32_bf16 v[152:155], v[48:51], v[232:235], v[152:155]
    ds_read_b128 v[232:235], v7 offset:5120
    s_waitcnt lgkmcnt(3)
    v_mfma_f32_16x16x32_bf16 v[148:151], v[28:31], v[236:239], v[148:151]
    v_mfma_f32_16x16x32_bf16 v[152:155], v[52:55], v[236:239], v[152:155]
    ds_read_b128 v[236:239], v7 offset:14336
    s_waitcnt lgkmcnt(3)
    v_mfma_f32_16x16x32_bf16 v[148:151], v[32:35], v[224:227], v[148:151]
    v_mfma_f32_16x16x32_bf16 v[152:155], v[56:59], v[224:227], v[152:155]
    ds_read_b128 v[224:227], v7 offset:23552
    s_waitcnt lgkmcnt(3)
    v_mfma_f32_16x16x32_bf16 v[148:151], v[36:39], v[228:231], v[148:151]
    v_mfma_f32_16x16x32_bf16 v[152:155], v[60:63], v[228:231], v[152:155]
    ds_read_b128 v[228:231], v7 offset:32768
    s_waitcnt lgkmcnt(3)
    v_mfma_f32_16x16x32_bf16 v[156:159], v[16:19], v[232:235], 0
    v_mfma_f32_16x16x32_bf16 v[160:163], v[40:43], v[232:235], 0
    ds_read_b128 v[232:235], v7 offset:41984
    s_waitcnt lgkmcnt(3)
    v_mfma_f32_16x16x32_bf16 v[156:159], v[20:23], v[236:239], v[156:159]
    v_mfma_f32_16x16x32_bf16 v[160:163], v[44:47], v[236:239], v[160:163]
    v_xor_b32 v246, 32, v250
    ds_read_b128 v[236:239], v7 offset:51200
    v_xor_b32 v247, 32, v251
    s_waitcnt lgkmcnt(3)
    v_mfma_f32_16x16x32_bf16 v[156:159], v[24:27], v[224:227], v[156:159]
    s_waitcnt vmcnt(10)
    v_mfma_f32_16x16x32_bf16 v[160:163], v[48:51], v[224:227], v[160:163]
    ds_read_b128 v[224:227], v7 offset:6144
    ds_read_b64 v[64:65], v250 offset:0
    s_waitcnt lgkmcnt(4)
    v_mfma_f32_16x16x32_bf16 v[156:159], v[28:31], v[228:231], v[156:159]
    ds_read_b64 v[66:67], v246 offset:0
    v_mfma_f32_16x16x32_bf16 v[160:163], v[52:55], v[228:231], v[160:163]
    ds_read_b64 v[68:69], v251 offset:0
    ds_read_b128 v[228:231], v7 offset:15360
    ds_read_b64 v[70:71], v247 offset:0
    s_waitcnt lgkmcnt(7)
    v_mfma_f32_16x16x32_bf16 v[156:159], v[32:35], v[232:235], v[156:159]
    s_waitcnt vmcnt(8)
    v_mfma_f32_16x16x32_bf16 v[160:163], v[56:59], v[232:235], v[160:163]
    ds_read_b128 v[232:235], v7 offset:24576
    ds_read_b64 v[88:89], v250 offset:6144
    s_waitcnt lgkmcnt(8)
    v_mfma_f32_16x16x32_bf16 v[156:159], v[36:39], v[236:239], v[156:159]
    ds_read_b64 v[90:91], v246 offset:6144
    v_mfma_f32_16x16x32_bf16 v[160:163], v[60:63], v[236:239], v[160:163]
    ds_read_b64 v[92:93], v251 offset:6144
    ds_read_b128 v[236:239], v7 offset:33792
    ds_read_b64 v[94:95], v247 offset:6144
    s_waitcnt lgkmcnt(11)
    v_mfma_f32_16x16x32_bf16 v[164:167], v[16:19], v[224:227], 0
    v_mfma_f32_16x16x32_bf16 v[168:171], v[40:43], v[224:227], 0
    s_waitcnt vmcnt(6)
    ds_read_b128 v[224:227], v7 offset:43008
    ds_read_b64 v[72:73], v250 offset:2048
    s_waitcnt lgkmcnt(9)
    v_mfma_f32_16x16x32_bf16 v[164:167], v[20:23], v[228:231], v[164:167]
    ds_read_b64 v[74:75], v246 offset:2048
    v_mfma_f32_16x16x32_bf16 v[168:171], v[44:47], v[228:231], v[168:171]
    ds_read_b64 v[76:77], v251 offset:2048
    ds_read_b128 v[228:231], v7 offset:52224
    ds_read_b64 v[78:79], v247 offset:2048
    s_waitcnt lgkmcnt(11)
    v_mfma_f32_16x16x32_bf16 v[164:167], v[24:27], v[232:235], v[164:167]
    v_mfma_f32_16x16x32_bf16 v[168:171], v[48:51], v[232:235], v[168:171]
    s_waitcnt vmcnt(4)
    ds_read_b128 v[232:235], v7 offset:7168
    ds_read_b64 v[96:97], v250 offset:8192
    s_waitcnt lgkmcnt(9)
    v_mfma_f32_16x16x32_bf16 v[164:167], v[28:31], v[236:239], v[164:167]
    ds_read_b64 v[98:99], v246 offset:8192
    v_mfma_f32_16x16x32_bf16 v[168:171], v[52:55], v[236:239], v[168:171]
    ds_read_b64 v[100:101], v251 offset:8192
    ds_read_b128 v[236:239], v7 offset:16384
    s_waitcnt lgkmcnt(10)
    v_mfma_f32_16x16x32_bf16 v[164:167], v[32:35], v[224:227], v[164:167]
    ds_read_b64 v[102:103], v247 offset:8192
    v_mfma_f32_16x16x32_bf16 v[168:171], v[56:59], v[224:227], v[168:171]
    s_waitcnt vmcnt(2)
    ds_read_b128 v[224:227], v7 offset:25600
    ds_read_b64 v[80:81], v250 offset:4096
    s_waitcnt lgkmcnt(9)
    v_mfma_f32_16x16x32_bf16 v[164:167], v[36:39], v[228:231], v[164:167]
    ds_read_b64 v[82:83], v246 offset:4096
    v_mfma_f32_16x16x32_bf16 v[168:171], v[60:63], v[228:231], v[168:171]
    ds_read_b64 v[84:85], v251 offset:4096
    ds_read_b128 v[228:231], v7 offset:34816
    s_waitcnt lgkmcnt(10)
    v_mfma_f32_16x16x32_bf16 v[172:175], v[16:19], v[232:235], 0
    ds_read_b64 v[86:87], v247 offset:4096
    v_mfma_f32_16x16x32_bf16 v[176:179], v[40:43], v[232:235], 0
    s_waitcnt vmcnt(0)
    ds_read_b128 v[232:235], v7 offset:44032
    ds_read_b64 v[104:105], v250 offset:10240
    s_waitcnt lgkmcnt(9)
    v_mfma_f32_16x16x32_bf16 v[172:175], v[20:23], v[236:239], v[172:175]
    ds_read_b64 v[106:107], v246 offset:10240
    v_mfma_f32_16x16x32_bf16 v[176:179], v[44:47], v[236:239], v[176:179]
    ds_read_b128 v[236:239], v7 offset:53248
    ds_read_b64 v[108:109], v251 offset:10240
    s_waitcnt lgkmcnt(10)
    v_mfma_f32_16x16x32_bf16 v[172:175], v[24:27], v[224:227], v[172:175]
    ds_read_b64 v[110:111], v247 offset:10240
    v_mfma_f32_16x16x32_bf16 v[176:179], v[48:51], v[224:227], v[176:179]
    s_nop 0
    ds_read_b128 v[224:227], v7 offset:8192
    s_nop 0
    s_waitcnt lgkmcnt(8)
    v_mfma_f32_16x16x32_bf16 v[172:175], v[28:31], v[228:231], v[172:175]
    s_nop 0
    v_mfma_f32_16x16x32_bf16 v[176:179], v[52:55], v[228:231], v[176:179]
    ds_read_b128 v[228:231], v7 offset:17408
    s_nop 0
    s_waitcnt lgkmcnt(7)
    v_mfma_f32_16x16x32_bf16 v[172:175], v[32:35], v[232:235], v[172:175]
    s_nop 0
    v_mfma_f32_16x16x32_bf16 v[176:179], v[56:59], v[232:235], v[176:179]
    s_nop 0
    ds_read_b128 v[232:235], v7 offset:26624
    s_waitcnt lgkmcnt(0)
    s_lshl_b32 s41, s49, 2
    s_add_u32 s41, s41, 154176
    v_mov_b32 v244, s41
    v_mov_b32 v245, 1
    ds_write_b32 v244, v245
    v_mfma_f32_16x16x32_bf16 v[172:175], v[36:39], v[236:239], v[172:175]
    v_mfma_f32_16x16x32_bf16 v[176:179], v[60:63], v[236:239], v[176:179]
    ds_read_b128 v[236:239], v7 offset:35840
    v_mfma_f32_16x16x32_bf16 v[180:183], v[16:19], v[224:227], 0
    v_mfma_f32_16x16x32_bf16 v[184:187], v[40:43], v[224:227], 0
    ds_read_b128 v[224:227], v7 offset:45056
    v_mfma_f32_16x16x32_bf16 v[180:183], v[20:23], v[228:231], v[180:183]
    v_mfma_f32_16x16x32_bf16 v[184:187], v[44:47], v[228:231], v[184:187]
    ds_read_b128 v[228:231], v7 offset:54272
    v_mfma_f32_16x16x32_bf16 v[180:183], v[24:27], v[232:235], v[180:183]
    v_mfma_f32_16x16x32_bf16 v[184:187], v[48:51], v[232:235], v[184:187]
    s_waitcnt lgkmcnt(2)
    v_mfma_f32_16x16x32_bf16 v[180:183], v[28:31], v[236:239], v[180:183]
    v_mfma_f32_16x16x32_bf16 v[184:187], v[52:55], v[236:239], v[184:187]
    s_waitcnt lgkmcnt(1)
    v_mfma_f32_16x16x32_bf16 v[180:183], v[32:35], v[224:227], v[180:183]
    v_mfma_f32_16x16x32_bf16 v[184:187], v[56:59], v[224:227], v[184:187]
    s_waitcnt lgkmcnt(0)
    v_mfma_f32_16x16x32_bf16 v[180:183], v[36:39], v[228:231], v[180:183]
    v_mfma_f32_16x16x32_bf16 v[184:187], v[60:63], v[228:231], v[184:187]
    ds_read_b128 v[224:227], v7 offset:0
    ds_read_b128 v[228:231], v7 offset:9216
    ds_read_b128 v[232:235], v7 offset:18432
    ds_read_b128 v[236:239], v7 offset:27648
    s_waitcnt lgkmcnt(3)
    v_mfma_f32_16x16x32_bf16 v[16:19], v[64:67], v[224:227], 0
    v_mfma_f32_16x16x32_bf16 v[20:23], v[88:91], v[224:227], 0
    ds_read_b128 v[224:227], v7 offset:36864
    v_max3_f32 v212, v116, v117, v118
    s_waitcnt lgkmcnt(3)
    v_mfma_f32_16x16x32_bf16 v[16:19], v[68:71], v[228:231], v[16:19]
    v_mfma_f32_16x16x32_bf16 v[20:23], v[92:95], v[228:231], v[20:23]
    v_max3_f32 v212, v212, v119, v120
    ds_read_b128 v[228:231], v7 offset:46080
    s_waitcnt lgkmcnt(3)
    v_mfma_f32_16x16x32_bf16 v[16:19], v[72:75], v[232:235], v[16:19]
    v_max3_f32 v212, v212, v121, v122
    v_mfma_f32_16x16x32_bf16 v[20:23], v[96:99], v[232:235], v[20:23]
    ds_read_b128 v[232:235], v7 offset:1024
    v_max_f32 v212, v212, v123
    s_waitcnt lgkmcnt(3)
    v_mfma_f32_16x16x32_bf16 v[16:19], v[76:79], v[236:239], v[16:19]
    v_mfma_f32_16x16x32_bf16 v[20:23], v[100:103], v[236:239], v[20:23]
    v_max3_f32 v213, v124, v125, v126
    ds_read_b128 v[236:239], v7 offset:10240
    s_waitcnt lgkmcnt(3)
    v_mfma_f32_16x16x32_bf16 v[16:19], v[80:83], v[224:227], v[16:19]
    v_max3_f32 v213, v213, v127, v128
    v_mfma_f32_16x16x32_bf16 v[20:23], v[104:107], v[224:227], v[20:23]
    ds_read_b128 v[224:227], v7 offset:19456
    v_max3_f32 v213, v213, v129, v130
    s_waitcnt lgkmcnt(3)
    v_mfma_f32_16x16x32_bf16 v[16:19], v[84:87], v[228:231], v[16:19]
    v_mfma_f32_16x16x32_bf16 v[20:23], v[108:111], v[228:231], v[20:23]
    ds_read_b128 v[228:231], v7 offset:28672
    v_max_f32 v213, v213, v131
    s_waitcnt lgkmcnt(3)
    v_mfma_f32_16x16x32_bf16 v[24:27], v[64:67], v[232:235], 0
    v_mfma_f32_16x16x32_bf16 v[28:31], v[88:91], v[232:235], 0
    v_max3_f32 v214, v132, v133, v134
    ds_read_b128 v[232:235], v7 offset:37888
    s_waitcnt lgkmcnt(3)
    v_mfma_f32_16x16x32_bf16 v[24:27], v[68:71], v[236:239], v[24:27]
    v_max3_f32 v214, v214, v135, v136
    v_mfma_f32_16x16x32_bf16 v[28:31], v[92:95], v[236:239], v[28:31]
    ds_read_b128 v[236:239], v7 offset:47104
    v_max3_f32 v214, v214, v137, v138
    s_waitcnt lgkmcnt(3)
    v_mfma_f32_16x16x32_bf16 v[24:27], v[72:75], v[224:227], v[24:27]
    v_mfma_f32_16x16x32_bf16 v[28:31], v[96:99], v[224:227], v[28:31]
    v_max_f32 v214, v214, v139
    ds_read_b128 v[224:227], v7 offset:2048
    s_waitcnt lgkmcnt(3)
    v_mfma_f32_16x16x32_bf16 v[24:27], v[76:79], v[228:231], v[24:27]
    v_max3_f32 v215, v140, v141, v142
    v_mfma_f32_16x16x32_bf16 v[28:31], v[100:103], v[228:231], v[28:31]
    ds_read_b128 v[228:231], v7 offset:11264
    v_max3_f32 v215, v215, v143, v144
    s_waitcnt lgkmcnt(3)
    v_mfma_f32_16x16x32_bf16 v[24:27], v[80:83], v[232:235], v[24:27]
    v_mfma_f32_16x16x32_bf16 v[28:31], v[104:107], v[232:235], v[28:31]
    v_max3_f32 v215, v215, v145, v146
    ds_read_b128 v[232:235], v7 offset:20480
    s_waitcnt lgkmcnt(3)
    v_mfma_f32_16x16x32_bf16 v[24:27], v[84:87], v[236:239], v[24:27]
    v_max_f32 v215, v215, v147
    v_mfma_f32_16x16x32_bf16 v[28:31], v[108:111], v[236:239], v[28:31]
    ds_read_b128 v[236:239], v7 offset:29696
    s_waitcnt lgkmcnt(3)
    v_mfma_f32_16x16x32_bf16 v[32:35], v[64:67], v[224:227], 0
    v_max3_f32 v216, v148, v149, v150
    v_mfma_f32_16x16x32_bf16 v[36:39], v[88:91], v[224:227], 0
    ds_read_b128 v[224:227], v7 offset:38912
    v_max3_f32 v216, v216, v151, v152
    s_waitcnt lgkmcnt(3)
    v_mfma_f32_16x16x32_bf16 v[32:35], v[68:71], v[228:231], v[32:35]
    v_mfma_f32_16x16x32_bf16 v[36:39], v[92:95], v[228:231], v[36:39]
    v_max3_f32 v216, v216, v153, v154
    ds_read_b128 v[228:231], v7 offset:48128
    s_waitcnt lgkmcnt(3)
    v_mfma_f32_16x16x32_bf16 v[32:35], v[72:75], v[232:235], v[32:35]
    v_max_f32 v216, v216, v155
    v_mfma_f32_16x16x32_bf16 v[36:39], v[96:99], v[232:235], v[36:39]
    ds_read_b128 v[232:235], v7 offset:3072
    v_max3_f32 v217, v156, v157, v158
    s_waitcnt lgkmcnt(3)
    v_mfma_f32_16x16x32_bf16 v[32:35], v[76:79], v[236:239], v[32:35]
    v_mfma_f32_16x16x32_bf16 v[36:39], v[100:103], v[236:239], v[36:39]
    v_max3_f32 v217, v217, v159, v160
    ds_read_b128 v[236:239], v7 offset:12288
    s_waitcnt lgkmcnt(3)
    v_mfma_f32_16x16x32_bf16 v[32:35], v[80:83], v[224:227], v[32:35]
    v_max3_f32 v217, v217, v161, v162
    v_mfma_f32_16x16x32_bf16 v[36:39], v[104:107], v[224:227], v[36:39]
    ds_read_b128 v[224:227], v7 offset:21504
    v_max_f32 v217, v217, v163
    s_waitcnt lgkmcnt(3)
    v_mfma_f32_16x16x32_bf16 v[32:35], v[84:87], v[228:231], v[32:35]
    v_mfma_f32_16x16x32_bf16 v[36:39], v[108:111], v[228:231], v[36:39]
    ds_read_b128 v[228:231], v7 offset:30720
    v_max3_f32 v218, v164, v165, v166
    s_waitcnt lgkmcnt(3)
    v_mfma_f32_16x16x32_bf16 v[40:43], v[64:67], v[232:235], 0
    v_mfma_f32_16x16x32_bf16 v[44:47], v[88:91], v[232:235], 0
    v_max3_f32 v218, v218, v167, v168
    ds_read_b128 v[232:235], v7 offset:39936
    s_waitcnt lgkmcnt(3)
    v_mfma_f32_16x16x32_bf16 v[40:43], v[68:71], v[236:239], v[40:43]
    v_max3_f32 v218, v218, v169, v170
    v_mfma_f32_16x16x32_bf16 v[44:47], v[92:95], v[236:239], v[44:47]
    ds_read_b128 v[236:239], v7 offset:49152
    v_max_f32 v218, v218, v171
    s_waitcnt lgkmcnt(3)
    v_mfma_f32_16x16x32_bf16 v[40:43], v[72:75], v[224:227], v[40:43]
    v_mfma_f32_16x16x32_bf16 v[44:47], v[96:99], v[224:227], v[44:47]
    v_max3_f32 v219, v172, v173, v174
    ds_read_b128 v[224:227], v7 offset:4096
    s_waitcnt lgkmcnt(3)
    v_mfma_f32_16x16x32_bf16 v[40:43], v[76:79], v[228:231], v[40:43]
    v_max3_f32 v219, v219, v175, v176
    v_mfma_f32_16x16x32_bf16 v[44:47], v[100:103], v[228:231], v[44:47]
    ds_read_b128 v[228:231], v7 offset:13312
    v_max3_f32 v219, v219, v177, v178
    s_waitcnt lgkmcnt(3)
    v_mfma_f32_16x16x32_bf16 v[40:43], v[80:83], v[232:235], v[40:43]
    v_mfma_f32_16x16x32_bf16 v[44:47], v[104:107], v[232:235], v[44:47]
    v_max_f32 v219, v219, v179
    ds_read_b128 v[232:235], v7 offset:22528
    s_waitcnt lgkmcnt(3)
    v_mfma_f32_16x16x32_bf16 v[40:43], v[84:87], v[236:239], v[40:43]
    v_mfma_f32_16x16x32_bf16 v[44:47], v[108:111], v[236:239], v[44:47]
    v_max3_f32 v220, v180, v181, v182
    ds_read_b128 v[236:239], v7 offset:31744
    s_waitcnt lgkmcnt(3)
    v_mfma_f32_16x16x32_bf16 v[48:51], v[64:67], v[224:227], 0
    v_max3_f32 v220, v220, v183, v184
    v_mfma_f32_16x16x32_bf16 v[52:55], v[88:91], v[224:227], 0
    ds_read_b128 v[224:227], v7 offset:40960
    v_max3_f32 v220, v220, v185, v186
    s_waitcnt lgkmcnt(3)
    v_mfma_f32_16x16x32_bf16 v[48:51], v[68:71], v[228:231], v[48:51]
    v_mfma_f32_16x16x32_bf16 v[52:55], v[92:95], v[228:231], v[52:55]
    v_max_f32 v220, v220, v187
    ds_read_b128 v[228:231], v7 offset:50176
    s_waitcnt lgkmcnt(3)
    v_mfma_f32_16x16x32_bf16 v[48:51], v[72:75], v[232:235], v[48:51]
    v_max3_f32 v212, v212, v16, v17
    v_mfma_f32_16x16x32_bf16 v[52:55], v[96:99], v[232:235], v[52:55]
    ds_read_b128 v[232:235], v7 offset:5120
    v_max3_f32 v212, v212, v18, v19
    s_waitcnt lgkmcnt(3)
    v_mfma_f32_16x16x32_bf16 v[48:51], v[76:79], v[236:239], v[48:51]
    v_mfma_f32_16x16x32_bf16 v[52:55], v[100:103], v[236:239], v[52:55]
    v_max3_f32 v212, v212, v20, v21
    ds_read_b128 v[236:239], v7 offset:14336
    s_waitcnt lgkmcnt(3)
    v_mfma_f32_16x16x32_bf16 v[48:51], v[80:83], v[224:227], v[48:51]
    v_max3_f32 v212, v212, v22, v23
    v_mfma_f32_16x16x32_bf16 v[52:55], v[104:107], v[224:227], v[52:55]
    ds_read_b128 v[224:227], v7 offset:23552
    v_max3_f32 v213, v213, v24, v25
    s_waitcnt lgkmcnt(3)
    v_mfma_f32_16x16x32_bf16 v[48:51], v[84:87], v[228:231], v[48:51]
    v_mfma_f32_16x16x32_bf16 v[52:55], v[108:111], v[228:231], v[52:55]
    v_max3_f32 v213, v213, v26, v27
    ds_read_b128 v[228:231], v7 offset:32768
    s_waitcnt lgkmcnt(3)
    v_mfma_f32_16x16x32_bf16 v[56:59], v[64:67], v[232:235], 0
    v_max3_f32 v213, v213, v28, v29
    v_mfma_f32_16x16x32_bf16 v[60:63], v[88:91], v[232:235], 0
    ds_read_b128 v[232:235], v7 offset:41984
    v_max3_f32 v213, v213, v30, v31
    s_waitcnt lgkmcnt(3)
    v_mfma_f32_16x16x32_bf16 v[56:59], v[68:71], v[236:239], v[56:59]
    v_mfma_f32_16x16x32_bf16 v[60:63], v[92:95], v[236:239], v[60:63]
    v_max3_f32 v214, v214, v32, v33
    ds_read_b128 v[236:239], v7 offset:51200
    s_waitcnt lgkmcnt(3)
    v_mfma_f32_16x16x32_bf16 v[56:59], v[72:75], v[224:227], v[56:59]
    v_max3_f32 v214, v214, v34, v35
    v_mfma_f32_16x16x32_bf16 v[60:63], v[96:99], v[224:227], v[60:63]
    ds_read_b128 v[224:227], v7 offset:6144
    v_max3_f32 v214, v214, v36, v37
    s_waitcnt lgkmcnt(3)
    v_mfma_f32_16x16x32_bf16 v[56:59], v[76:79], v[228:231], v[56:59]
    v_mfma_f32_16x16x32_bf16 v[60:63], v[100:103], v[228:231], v[60:63]
    v_max3_f32 v214, v214, v38, v39
    ds_read_b128 v[228:231], v7 offset:15360
    s_waitcnt lgkmcnt(3)
    v_mfma_f32_16x16x32_bf16 v[56:59], v[80:83], v[232:235], v[56:59]
    v_max3_f32 v215, v215, v40, v41
    v_mfma_f32_16x16x32_bf16 v[60:63], v[104:107], v[232:235], v[60:63]
    ds_read_b128 v[232:235], v7 offset:24576
    v_max3_f32 v215, v215, v42, v43
    s_waitcnt lgkmcnt(3)
    v_mfma_f32_16x16x32_bf16 v[56:59], v[84:87], v[236:239], v[56:59]
    v_mfma_f32_16x16x32_bf16 v[60:63], v[108:111], v[236:239], v[60:63]
    v_max3_f32 v215, v215, v44, v45
    ds_read_b128 v[236:239], v7 offset:33792
    s_waitcnt lgkmcnt(3)
    v_mfma_f32_16x16x32_bf16 v[188:191], v[64:67], v[224:227], 0
    v_max3_f32 v215, v215, v46, v47
    v_mfma_f32_16x16x32_bf16 v[192:195], v[88:91], v[224:227], 0
    ds_read_b128 v[224:227], v7 offset:43008
    v_max3_f32 v216, v216, v48, v49
    s_waitcnt lgkmcnt(3)
    v_mfma_f32_16x16x32_bf16 v[188:191], v[68:71], v[228:231], v[188:191]
    v_mfma_f32_16x16x32_bf16 v[192:195], v[92:95], v[228:231], v[192:195]
    v_max3_f32 v216, v216, v50, v51
    ds_read_b128 v[228:231], v7 offset:52224
    s_waitcnt lgkmcnt(3)
    v_mfma_f32_16x16x32_bf16 v[188:191], v[72:75], v[232:235], v[188:191]
    v_max3_f32 v216, v216, v52, v53
    v_mfma_f32_16x16x32_bf16 v[192:195], v[96:99], v[232:235], v[192:195]
    ds_read_b128 v[232:235], v7 offset:7168
    v_max3_f32 v216, v216, v54, v55
    s_waitcnt lgkmcnt(3)
    v_mfma_f32_16x16x32_bf16 v[188:191], v[76:79], v[236:239], v[188:191]
    v_mfma_f32_16x16x32_bf16 v[192:195], v[100:103], v[236:239], v[192:195]
    v_max3_f32 v217, v217, v56, v57
    ds_read_b128 v[236:239], v7 offset:16384
    s_waitcnt lgkmcnt(3)
    v_mfma_f32_16x16x32_bf16 v[188:191], v[80:83], v[224:227], v[188:191]
    v_max3_f32 v217, v217, v58, v59
    v_mfma_f32_16x16x32_bf16 v[192:195], v[104:107], v[224:227], v[192:195]
    ds_read_b128 v[224:227], v7 offset:25600
    v_max3_f32 v217, v217, v60, v61
    s_waitcnt lgkmcnt(3)
    v_mfma_f32_16x16x32_bf16 v[188:191], v[84:87], v[228:231], v[188:191]
    v_mfma_f32_16x16x32_bf16 v[192:195], v[108:111], v[228:231], v[192:195]
    v_max3_f32 v217, v217, v62, v63
    ds_read_b128 v[228:231], v7 offset:34816
    s_waitcnt lgkmcnt(3)
    v_mfma_f32_16x16x32_bf16 v[196:199], v[64:67], v[232:235], 0
    v_mfma_f32_16x16x32_bf16 v[200:203], v[88:91], v[232:235], 0
    ds_read_b128 v[232:235], v7 offset:44032
    s_waitcnt lgkmcnt(3)
    v_mfma_f32_16x16x32_bf16 v[196:199], v[68:71], v[236:239], v[196:199]
    v_mfma_f32_16x16x32_bf16 v[200:203], v[92:95], v[236:239], v[200:203]
    ds_read_b128 v[236:239], v7 offset:53248
    v_max3_f32 v218, v218, v188, v189
    s_waitcnt lgkmcnt(3)
    v_mfma_f32_16x16x32_bf16 v[196:199], v[72:75], v[224:227], v[196:199]
    v_mfma_f32_16x16x32_bf16 v[200:203], v[96:99], v[224:227], v[200:203]
    v_max3_f32 v218, v218, v190, v191
    ds_read_b128 v[224:227], v7 offset:8192
    s_waitcnt lgkmcnt(3)
    v_mfma_f32_16x16x32_bf16 v[196:199], v[76:79], v[228:231], v[196:199]
    v_max3_f32 v218, v218, v192, v193
    v_mfma_f32_16x16x32_bf16 v[200:203], v[100:103], v[228:231], v[200:203]
    v_max3_f32 v218, v218, v194, v195
    ds_read_b128 v[228:231], v7 offset:17408
    s_waitcnt lgkmcnt(3)
    v_mfma_f32_16x16x32_bf16 v[196:199], v[80:83], v[232:235], v[196:199]
    v_mfma_f32_16x16x32_bf16 v[200:203], v[104:107], v[232:235], v[200:203]
    ds_read_b128 v[232:235], v7 offset:26624
    s_waitcnt lgkmcnt(3)
    v_mfma_f32_16x16x32_bf16 v[196:199], v[84:87], v[236:239], v[196:199]
    v_mfma_f32_16x16x32_bf16 v[200:203], v[108:111], v[236:239], v[200:203]
    ds_read_b128 v[236:239], v7 offset:35840
    s_waitcnt lgkmcnt(3)
    v_mfma_f32_16x16x32_bf16 v[204:207], v[64:67], v[224:227], 0
    v_mfma_f32_16x16x32_bf16 v[208:211], v[88:91], v[224:227], 0
    ds_read_b128 v[224:227], v7 offset:45056
    s_waitcnt lgkmcnt(3)
    v_mfma_f32_16x16x32_bf16 v[204:207], v[68:71], v[228:231], v[204:207]
    v_mfma_f32_16x16x32_bf16 v[208:211], v[92:95], v[228:231], v[208:211]
    ds_read_b128 v[228:231], v7 offset:54272
    v_max3_f32 v219, v219, v196, v197
    s_waitcnt lgkmcnt(3)
    v_mfma_f32_16x16x32_bf16 v[204:207], v[72:75], v[232:235], v[204:207]
    v_max3_f32 v219, v219, v198, v199
    v_mfma_f32_16x16x32_bf16 v[208:211], v[96:99], v[232:235], v[208:211]
    s_waitcnt lgkmcnt(2)
    v_mfma_f32_16x16x32_bf16 v[204:207], v[76:79], v[236:239], v[204:207]
    v_max3_f32 v219, v219, v200, v201
    v_mfma_f32_16x16x32_bf16 v[208:211], v[100:103], v[236:239], v[208:211]
    s_waitcnt lgkmcnt(1)
    v_mfma_f32_16x16x32_bf16 v[204:207], v[80:83], v[224:227], v[204:207]
    v_max3_f32 v219, v219, v202, v203
    v_mfma_f32_16x16x32_bf16 v[208:211], v[104:107], v[224:227], v[208:211]
    s_waitcnt lgkmcnt(0)
    v_mfma_f32_16x16x32_bf16 v[204:207], v[84:87], v[228:231], v[204:207]
    v_mfma_f32_16x16x32_bf16 v[208:211], v[108:111], v[228:231], v[208:211]
    s_nop 6
    v_max3_f32 v220, v220, v204, v205
    v_max3_f32 v220, v220, v206, v207
    v_max3_f32 v220, v220, v208, v209
    v_max3_f32 v220, v220, v210, v211
    ds_max_f32 v243, v212 offset:0
    ds_max_f32 v243, v213 offset:64
    ds_max_f32 v243, v214 offset:128
    ds_max_f32 v243, v215 offset:192
    ds_max_f32 v243, v216 offset:256
    ds_max_f32 v243, v217 offset:320
    ds_max_f32 v243, v218 offset:384
    ds_max_f32 v243, v219 offset:448
    ds_max_f32 v243, v220 offset:512
    s_waitcnt lgkmcnt(0)
    s_barrier
    s_branch L_sm1
L_qp10:
    s_barrier
    s_cmp_lt_u32 s36, 6
    s_cbranch_scc0 L_x21
    s_add_u32 m0, s38, 12288
    s_mov_b32 s40, 122880
    buffer_load_dwordx4 v2, s[16:19], s40 offen lds
L_x21:
    s_add_u32 m0, s37, 55296
    s_mov_b32 s3, 0
    buffer_load_dwordx4 v3, s[20:23], s3 offen offset:0 lds
    s_add_u32 m0, s37, 56192
    s_nop 0
    buffer_load_dwordx4 v3, s[20:23], s3 offen offset:128 lds
    s_add_u32 m0, s37, 57088
    s_nop 0
    buffer_load_dwordx4 v3, s[20:23], s3 offen offset:256 lds
    s_add_u32 m0, s38, 0
    s_mov_b32 s40, 0
    buffer_load_dwordx4 v2, s[16:19], s40 offen lds
    s_add_u32 m0, s38, 8192
    s_mov_b32 s40, 81920
    buffer_load_dwordx4 v2, s[16:19], s40 offen lds
    s_barrier
    s_cmp_lt_u32 s36, 6
    s_cbranch_scc0 L_x22
    s_add_u32 m0, s38, 30720
    s_mov_b32 s40, 123008
    buffer_load_dwordx4 v2, s[16:19], s40 offen lds
L_x22:
    s_add_u32 m0, s37, 79872
    s_mov_b32 s3, 786432
    buffer_load_dwordx4 v3, s[20:23], s3 offen offset:0 lds
    s_add_u32 m0, s37, 80768
    s_nop 0
    buffer_load_dwordx4 v3, s[20:23], s3 offen offset:128 lds
    s_add_u32 m0, s37, 81664
    s_nop 0
    buffer_load_dwordx4 v3, s[20:23], s3 offen offset:256 lds
    s_add_u32 m0, s38, 18432
    s_mov_b32 s40, 128
    buffer_load_dwordx4 v2, s[16:19], s40 offen lds
    s_add_u32 m0, s38, 26624
    s_mov_b32 s40, 82048
    buffer_load_dwordx4 v2, s[16:19], s40 offen lds
    s_add_u32 s32, s12, s35
    s_addc_u32 s33, s13, 0
    s_mov_b32 s34, 55296
    s_mov_b32 s35, 0x20000
    s_mov_b32 s44, 1037384597
    v_lshlrev_b32 v247, 2, v0
    v_add_u32 v247, 153600, v247
    v_mov_b32 v248, 0xff800000
    ds_write_b32 v247, v248
    v_and_b32 v243, 15, v1
    v_lshlrev_b32 v243, 2, v243
    v_add_u32 v243, 153600, v243
    v_add_u32 v7, 10240, v7
    v_xor_b32 v8, 64, v7
    s_lshl_b32 s41, s49, 2
    s_lshr_b32 s41, 42560, s41
    s_and_b32 s41, s41, 15
    s_lshr_b32 s42, s41, 2
    s_lshl_b32 s42, s42, 10
    s_add_u32 s42, s42, 55296
    s_and_b32 s41, s41, 3
    v_lshrrev_b32 v244, 4, v1
    v_bfe_u32 v245, v1, 2, 2
    v_and_b32 v246, 1, v244
    v_lshlrev_b32 v246, 1, v246
    v_lshrrev_b32 v247, 1, v245
    v_add_u32 v247, v247, v246
    v_xor_b32 v247, s41, v247
    v_lshlrev_b32 v247, 5, v247
    v_lshlrev_b32 v9, 7, v245
    v_add_u32 v9, v9, v247
    v_mul_u32_u24 v247, 3072, v244
    v_add_u32 v9, v9, v247
    v_and_b32 v247, 3, v1
    v_lshlrev_b32 v247, 3, v247
    v_add_u32 v9, v9, v247
    v_add_u32 v9, s42, v9
    s_lshl_b32 s41, s49, 2
    s_lshr_b32 s41, 46929, s41
    s_and_b32 s41, s41, 15
    s_lshr_b32 s42, s41, 2
    s_lshl_b32 s42, s42, 10
    s_add_u32 s42, s42, 55296
    s_and_b32 s41, s41, 3
    v_lshrrev_b32 v244, 4, v1
    v_bfe_u32 v245, v1, 2, 2
    v_and_b32 v246, 1, v244
    v_lshlrev_b32 v246, 1, v246
    v_lshrrev_b32 v247, 1, v245
    v_add_u32 v247, v247, v246
    v_xor_b32 v247, s41, v247
    v_lshlrev_b32 v247, 5, v247
    v_lshlrev_b32 v10, 7, v245
    v_add_u32 v10, v10, v247
    v_mul_u32_u24 v247, 3072, v244
    v_add_u32 v10, v10, v247
    v_and_b32 v247, 3, v1
    v_lshlrev_b32 v247, 3, v247
    v_add_u32 v10, v10, v247
    v_add_u32 v10, s42, v10
    s_lshl_b32 s41, s49, 2
    s_lshr_b32 s41, 38962, s41
    s_and_b32 s41, s41, 15
    s_lshr_b32 s42, s41, 2
    s_lshl_b32 s42, s42, 10
    s_add_u32 s42, s42, 55296
    s_and_b32 s41, s41, 3
    v_lshrrev_b32 v244, 4, v1
    v_bfe_u32 v245, v1, 2, 2
    v_and_b32 v246, 1, v244
    v_lshlrev_b32 v246, 1, v246
    v_lshrrev_b32 v247, 1, v245
    v_add_u32 v247, v247, v246
    v_xor_b32 v247, s41, v247
    v_lshlrev_b32 v247, 5, v247
    v_lshlrev_b32 v11, 7, v245
    v_add_u32 v11, v11, v247
    v_mul_u32_u24 v247, 3072, v244
    v_add_u32 v11, v11, v247
    v_and_b32 v247, 3, v1
    v_lshlrev_b32 v247, 3, v247
    v_add_u32 v11, v11, v247
    v_add_u32 v11, s42, v11
    s_lshl_b32 s41, s49, 2
    s_lshr_b32 s41, 42560, s41
    s_and_b32 s41, s41, 15
    s_lshr_b32 s42, s41, 1
    s_mul_i32 s42, s42, 9216
    s_and_b32 s41, s41, 1
    s_lshl_b32 s41, s41, 3
    s_add_u32 s41, s41, s42
    s_add_u32 s41, s41, 5120
    v_lshl_add_u32 v12, v1, 4, s41
    s_lshl_b32 s41, s49, 2
    s_lshr_b32 s41, 38962, s41
    s_and_b32 s41, s41, 15
    s_lshr_b32 s42, s41, 1
    s_mul_i32 s42, s42, 9216
    s_and_b32 s41, s41, 1
    s_lshl_b32 s41, s41, 3
    s_add_u32 s41, s41, s42
    s_add_u32 s41, s41, 5120
    v_lshl_add_u32 v14, v1, 4, s41
    v_lshlrev_b32 v240, 4, v1
    s_lshl_b32 s41, s36, 2
    s_lshr_b32 s42, 0x10543210, s41
    s_and_b32 s42, s42, 15
    s_mul_i32 s42, s42, 9216
    v_add_u32 v242, s42, v240
    v_add_u32 v240, 5120, v240
    s_waitcnt vmcnt(5) lgkmcnt(0)
    s_barrier
    s_add_u32 s88, s88, 1
    ds_read_b64_tr_b16 v[176:177], v9 offset:0
    ds_read_b64_tr_b16 v[178:179], v9 offset:512
    ds_read_b128 v[200:203], v7 offset:0
    ds_read_b64_tr_b16 v[180:181], v10 offset:0
    ds_read_b64_tr_b16 v[182:183], v10 offset:512
    ds_read_b64_tr_b16 v[184:185], v11 offset:0
    ds_read_b64_tr_b16 v[186:187], v11 offset:512
    ds_read_b128 v[204:207], v7 offset:2048
    ds_read_b128 v[208:211], v7 offset:4096
    ds_read_b128 v[212:215], v7 offset:6144
    s_waitcnt lgkmcnt(7)
    v_mfma_f32_16x16x32_bf16 v[116:119], v[176:179], v[200:203], 0
    ds_read_b64_tr_b16 v[188:189], v9 offset:12288
    ds_read_b64_tr_b16 v[190:191], v9 offset:12800
    s_cmp_lt_u32 s36, 6
    s_cbranch_scc0 L_x23
    s_add_u32 m0, s38, 49152
    s_mov_b32 s40, 123136
    buffer_load_dwordx4 v2, s[16:19], s40 offen lds
L_x23:
    s_waitcnt lgkmcnt(7)
    v_mfma_f32_16x16x32_bf16 v[120:123], v[180:183], v[200:203], 0
    ds_read_b128 v[220:223], v8 offset:0
    s_waitcnt lgkmcnt(6)
    v_mfma_f32_16x16x32_bf16 v[124:127], v[184:187], v[200:203], 0
    ds_read_b64_tr_b16 v[192:193], v10 offset:12288
    ds_read_b64_tr_b16 v[194:195], v10 offset:12800
    s_add_u32 m0, s37, 104448
    s_mov_b32 s3, 1572864
    buffer_load_dwordx4 v3, s[20:23], s3 offen offset:0 lds
    s_waitcnt lgkmcnt(7)
    v_mfma_f32_16x16x32_bf16 v[128:131], v[176:179], v[204:207], 0
    ds_read_b64_tr_b16 v[196:197], v11 offset:12288
    v_mfma_f32_16x16x32_bf16 v[132:135], v[180:183], v[204:207], 0
    ds_read_b64_tr_b16 v[198:199], v11 offset:12800
    s_add_u32 m0, s37, 105344
    s_nop 0
    buffer_load_dwordx4 v3, s[20:23], s3 offen offset:128 lds
    v_mfma_f32_16x16x32_bf16 v[136:139], v[184:187], v[204:207], 0
    ds_read_b128 v[224:227], v8 offset:2048
    ds_read_b128 v[228:231], v8 offset:4096
    s_waitcnt lgkmcnt(10)
    v_mfma_f32_16x16x32_bf16 v[140:143], v[176:179], v[208:211], 0
    ds_read_b128 v[232:235], v8 offset:6144
    s_add_u32 m0, s37, 106240
    s_nop 0
    buffer_load_dwordx4 v3, s[20:23], s3 offen offset:256 lds
    v_mfma_f32_16x16x32_bf16 v[144:147], v[180:183], v[208:211], 0
    s_add_u32 m0, s38, 36864
    s_mov_b32 s40, 256
    buffer_load_dwordx4 v2, s[16:19], s40 offen lds
    v_mfma_f32_16x16x32_bf16 v[148:151], v[184:187], v[208:211], 0
    s_waitcnt lgkmcnt(10)
    v_mfma_f32_16x16x32_bf16 v[152:155], v[176:179], v[212:215], 0
    s_add_u32 m0, s38, 45056
    s_mov_b32 s40, 82176
    buffer_load_dwordx4 v2, s[16:19], s40 offen lds
    v_mfma_f32_16x16x32_bf16 v[156:159], v[180:183], v[212:215], 0
    v_mfma_f32_16x16x32_bf16 v[160:163], v[184:187], v[212:215], 0
    s_waitcnt vmcnt(5) lgkmcnt(0)
    s_barrier
    v_mfma_f32_16x16x32_bf16 v[116:119], v[188:191], v[220:223], v[116:119]
    ds_read_b64_tr_b16 v[176:177], v9 offset:24576
    ds_read_b64_tr_b16 v[178:179], v9 offset:25088
    v_mfma_f32_16x16x32_bf16 v[120:123], v[192:195], v[220:223], v[120:123]
    s_cmp_lt_u32 s36, 6
    s_cbranch_scc0 L_x24
    s_add_u32 m0, s38, 12288
    s_mov_b32 s40, 123264
    buffer_load_dwordx4 v2, s[16:19], s40 offen lds
L_x24:
    ds_read_b128 v[200:203], v7 offset:18432
    v_mfma_f32_16x16x32_bf16 v[124:127], v[196:199], v[220:223], v[124:127]
    ds_read_b64_tr_b16 v[180:181], v10 offset:24576
    ds_read_b64_tr_b16 v[182:183], v10 offset:25088
    v_mfma_f32_16x16x32_bf16 v[128:131], v[188:191], v[224:227], v[128:131]
    ds_read_b64_tr_b16 v[184:185], v11 offset:24576
    v_mfma_f32_16x16x32_bf16 v[132:135], v[192:195], v[224:227], v[132:135]
    s_add_u32 m0, s37, 55296
    s_mov_b32 s3, 2359296
    buffer_load_dwordx4 v3, s[20:23], s3 offen offset:0 lds
    ds_read_b64_tr_b16 v[186:187], v11 offset:25088
    v_mfma_f32_16x16x32_bf16 v[136:139], v[196:199], v[224:227], v[136:139]
    ds_read_b128 v[204:207], v7 offset:20480
    ds_read_b128 v[208:211], v7 offset:22528
    v_mfma_f32_16x16x32_bf16 v[140:143], v[188:191], v[228:231], v[140:143]
    ds_read_b128 v[212:215], v7 offset:24576
    v_mfma_f32_16x16x32_bf16 v[144:147], v[192:195], v[228:231], v[144:147]
    v_mfma_f32_16x16x32_bf16 v[148:151], v[196:199], v[228:231], v[148:151]
    s_add_u32 m0, s37, 56192
    s_nop 0
    buffer_load_dwordx4 v3, s[20:23], s3 offen offset:128 lds
    v_mfma_f32_16x16x32_bf16 v[152:155], v[188:191], v[232:235], v[152:155]
    v_mfma_f32_16x16x32_bf16 v[156:159], v[192:195], v[232:235], v[156:159]
    v_mfma_f32_16x16x32_bf16 v[160:163], v[196:199], v[232:235], v[160:163]
    s_waitcnt lgkmcnt(0)
    v_mfma_f32_16x16x32_bf16 v[116:119], v[176:179], v[200:203], v[116:119]
    ds_read_b64_tr_b16 v[188:189], v9 offset:36864
    ds_read_b64_tr_b16 v[190:191], v9 offset:37376
    s_add_u32 m0, s37, 57088
    s_nop 0
    buffer_load_dwordx4 v3, s[20:23], s3 offen offset:256 lds
    v_mfma_f32_16x16x32_bf16 v[120:123], v[180:183], v[200:203], v[120:123]
    ds_read_b128 v[220:223], v8 offset:18432
    v_mfma_f32_16x16x32_bf16 v[124:127], v[184:187], v[200:203], v[124:127]
    ds_read_b64_tr_b16 v[192:193], v10 offset:36864
    ds_read_b64_tr_b16 v[194:195], v10 offset:37376
    v_mfma_f32_16x16x32_bf16 v[128:131], v[176:179], v[204:207], v[128:131]
    ds_read_b64_tr_b16 v[196:197], v11 offset:36864
    v_mfma_f32_16x16x32_bf16 v[132:135], v[180:183], v[204:207], v[132:135]
    ds_read_b64_tr_b16 v[198:199], v11 offset:37376
    s_add_u32 m0, s38, 0
    s_mov_b32 s40, 384
    buffer_load_dwordx4 v2, s[16:19], s40 offen lds
    v_mfma_f32_16x16x32_bf16 v[136:139], v[184:187], v[204:207], v[136:139]
    ds_read_b128 v[224:227], v8 offset:20480
    ds_read_b128 v[228:231], v8 offset:22528
    v_mfma_f32_16x16x32_bf16 v[140:143], v[176:179], v[208:211], v[140:143]
    ds_read_b128 v[232:235], v8 offset:24576
    v_mfma_f32_16x16x32_bf16 v[144:147], v[180:183], v[208:211], v[144:147]
    s_add_u32 m0, s38, 8192
    s_mov_b32 s40, 82304
    buffer_load_dwordx4 v2, s[16:19], s40 offen lds
    v_mfma_f32_16x16x32_bf16 v[148:151], v[184:187], v[208:211], v[148:151]
    v_mfma_f32_16x16x32_bf16 v[152:155], v[176:179], v[212:215], v[152:155]
    v_mfma_f32_16x16x32_bf16 v[156:159], v[180:183], v[212:215], v[156:159]
    v_mfma_f32_16x16x32_bf16 v[160:163], v[184:187], v[212:215], v[160:163]
    s_waitcnt vmcnt(5) lgkmcnt(0)
    s_barrier
    v_mfma_f32_16x16x32_bf16 v[116:119], v[188:191], v[220:223], v[116:119]
    ds_read_b64_tr_b16 v[176:177], v9 offset:49152
    ds_read_b64_tr_b16 v[178:179], v9 offset:49664
    v_mfma_f32_16x16x32_bf16 v[120:123], v[192:195], v[220:223], v[120:123]
    s_cmp_lt_u32 s36, 6
    s_cbranch_scc0 L_x25
    s_add_u32 m0, s38, 30720
    s_mov_b32 s40, 123392
    buffer_load_dwordx4 v2, s[16:19], s40 offen lds
L_x25:
    ds_read_b128 v[200:203], v7 offset:36864
    v_mfma_f32_16x16x32_bf16 v[124:127], v[196:199], v[220:223], v[124:127]
    ds_read_b64_tr_b16 v[180:181], v10 offset:49152
    ds_read_b64_tr_b16 v[182:183], v10 offset:49664
    v_mfma_f32_16x16x32_bf16 v[128:131], v[188:191], v[224:227], v[128:131]
    ds_read_b64_tr_b16 v[184:185], v11 offset:49152
    v_mfma_f32_16x16x32_bf16 v[132:135], v[192:195], v[224:227], v[132:135]
    s_add_u32 m0, s37, 79872
    s_mov_b32 s3, 3145728
    buffer_load_dwordx4 v3, s[20:23], s3 offen offset:0 lds
    ds_read_b64_tr_b16 v[186:187], v11 offset:49664
    v_mfma_f32_16x16x32_bf16 v[136:139], v[196:199], v[224:227], v[136:139]
    ds_read_b128 v[204:207], v7 offset:38912
    ds_read_b128 v[208:211], v7 offset:40960
    v_mfma_f32_16x16x32_bf16 v[140:143], v[188:191], v[228:231], v[140:143]
    ds_read_b128 v[212:215], v7 offset:43008
    v_mfma_f32_16x16x32_bf16 v[144:147], v[192:195], v[228:231], v[144:147]
    v_mfma_f32_16x16x32_bf16 v[148:151], v[196:199], v[228:231], v[148:151]
    s_add_u32 m0, s37, 80768
    s_nop 0
    buffer_load_dwordx4 v3, s[20:23], s3 offen offset:128 lds
    v_mfma_f32_16x16x32_bf16 v[152:155], v[188:191], v[232:235], v[152:155]
    v_mfma_f32_16x16x32_bf16 v[156:159], v[192:195], v[232:235], v[156:159]
    v_mfma_f32_16x16x32_bf16 v[160:163], v[196:199], v[232:235], v[160:163]
    s_waitcnt lgkmcnt(0)
    v_mfma_f32_16x16x32_bf16 v[116:119], v[176:179], v[200:203], v[116:119]
    ds_read_b64_tr_b16 v[188:189], v9 offset:61440
    ds_read_b64_tr_b16 v[190:191], v9 offset:61952
    s_add_u32 m0, s37, 81664
    s_nop 0
    buffer_load_dwordx4 v3, s[20:23], s3 offen offset:256 lds
    v_mfma_f32_16x16x32_bf16 v[120:123], v[180:183], v[200:203], v[120:123]
    ds_read_b128 v[220:223], v8 offset:36864
    v_mfma_f32_16x16x32_bf16 v[124:127], v[184:187], v[200:203], v[124:127]
    ds_read_b64_tr_b16 v[192:193], v10 offset:61440
    ds_read_b64_tr_b16 v[194:195], v10 offset:61952
    v_mfma_f32_16x16x32_bf16 v[128:131], v[176:179], v[204:207], v[128:131]
    ds_read_b64_tr_b16 v[196:197], v11 offset:61440
    v_mfma_f32_16x16x32_bf16 v[132:135], v[180:183], v[204:207], v[132:135]
    ds_read_b64_tr_b16 v[198:199], v11 offset:61952
    s_add_u32 m0, s38, 18432
    s_mov_b32 s40, 512
    buffer_load_dwordx4 v2, s[16:19], s40 offen lds
    v_mfma_f32_16x16x32_bf16 v[136:139], v[184:187], v[204:207], v[136:139]
    ds_read_b128 v[224:227], v8 offset:38912
    ds_read_b128 v[228:231], v8 offset:40960
    v_mfma_f32_16x16x32_bf16 v[140:143], v[176:179], v[208:211], v[140:143]
    ds_read_b128 v[232:235], v8 offset:43008
    v_mfma_f32_16x16x32_bf16 v[144:147], v[180:183], v[208:211], v[144:147]
    s_add_u32 m0, s38, 26624
    s_mov_b32 s40, 82432
    buffer_load_dwordx4 v2, s[16:19], s40 offen lds
    v_mfma_f32_16x16x32_bf16 v[148:151], v[184:187], v[208:211], v[148:151]
    v_mfma_f32_16x16x32_bf16 v[152:155], v[176:179], v[212:215], v[152:155]
    v_mfma_f32_16x16x32_bf16 v[156:159], v[180:183], v[212:215], v[156:159]
    v_mfma_f32_16x16x32_bf16 v[160:163], v[184:187], v[212:215], v[160:163]
    s_waitcnt vmcnt(5) lgkmcnt(0)
    s_barrier
    v_mfma_f32_16x16x32_bf16 v[116:119], v[188:191], v[220:223], v[116:119]
    ds_read_b64_tr_b16 v[176:177], v9 offset:0
    ds_read_b64_tr_b16 v[178:179], v9 offset:512
    v_mfma_f32_16x16x32_bf16 v[120:123], v[192:195], v[220:223], v[120:123]
    s_cmp_lt_u32 s36, 6
    s_cbranch_scc0 L_x26
    s_add_u32 m0, s38, 49152
    s_mov_b32 s40, 123520
    buffer_load_dwordx4 v2, s[16:19], s40 offen lds
L_x26:
    ds_read_b128 v[200:203], v7 offset:0
    v_mfma_f32_16x16x32_bf16 v[124:127], v[196:199], v[220:223], v[124:127]
    ds_read_b64_tr_b16 v[180:181], v10 offset:0
    ds_read_b64_tr_b16 v[182:183], v10 offset:512
    v_mfma_f32_16x16x32_bf16 v[128:131], v[188:191], v[224:227], v[128:131]
    ds_read_b64_tr_b16 v[184:185], v11 offset:0
    v_mfma_f32_16x16x32_bf16 v[132:135], v[192:195], v[224:227], v[132:135]
    s_add_u32 m0, s37, 104448
    s_mov_b32 s3, 3932160
    buffer_load_dwordx4 v3, s[20:23], s3 offen offset:0 lds
    ds_read_b64_tr_b16 v[186:187], v11 offset:512
    v_mfma_f32_16x16x32_bf16 v[136:139], v[196:199], v[224:227], v[136:139]
    ds_read_b128 v[204:207], v7 offset:2048
    ds_read_b128 v[208:211], v7 offset:4096
    v_mfma_f32_16x16x32_bf16 v[140:143], v[188:191], v[228:231], v[140:143]
    ds_read_b128 v[212:215], v7 offset:6144
    v_mfma_f32_16x16x32_bf16 v[144:147], v[192:195], v[228:231], v[144:147]
    v_mfma_f32_16x16x32_bf16 v[148:151], v[196:199], v[228:231], v[148:151]
    s_add_u32 m0, s37, 105344
    s_nop 0
    buffer_load_dwordx4 v3, s[20:23], s3 offen offset:128 lds
    v_mfma_f32_16x16x32_bf16 v[152:155], v[188:191], v[232:235], v[152:155]
    v_mfma_f32_16x16x32_bf16 v[156:159], v[192:195], v[232:235], v[156:159]
    v_mfma_f32_16x16x32_bf16 v[160:163], v[196:199], v[232:235], v[160:163]
    s_waitcnt lgkmcnt(0)
    v_mfma_f32_16x16x32_bf16 v[116:119], v[176:179], v[200:203], v[116:119]
    ds_read_b64_tr_b16 v[188:189], v9 offset:12288
    ds_read_b64_tr_b16 v[190:191], v9 offset:12800
    s_add_u32 m0, s37, 106240
    s_nop 0
    buffer_load_dwordx4 v3, s[20:23], s3 offen offset:256 lds
    v_mfma_f32_16x16x32_bf16 v[120:123], v[180:183], v[200:203], v[120:123]
    ds_read_b128 v[220:223], v8 offset:0
    v_mfma_f32_16x16x32_bf16 v[124:127], v[184:187], v[200:203], v[124:127]
    ds_read_b64_tr_b16 v[192:193], v10 offset:12288
    ds_read_b64_tr_b16 v[194:195], v10 offset:12800
    v_mfma_f32_16x16x32_bf16 v[128:131], v[176:179], v[204:207], v[128:131]
    ds_read_b64_tr_b16 v[196:197], v11 offset:12288
    v_mfma_f32_16x16x32_bf16 v[132:135], v[180:183], v[204:207], v[132:135]
    ds_read_b64_tr_b16 v[198:199], v11 offset:12800
    s_add_u32 m0, s38, 36864
    s_mov_b32 s40, 640
    buffer_load_dwordx4 v2, s[16:19], s40 offen lds
    v_mfma_f32_16x16x32_bf16 v[136:139], v[184:187], v[204:207], v[136:139]
    ds_read_b128 v[224:227], v8 offset:2048
    ds_read_b128 v[228:231], v8 offset:4096
    v_mfma_f32_16x16x32_bf16 v[140:143], v[176:179], v[208:211], v[140:143]
    ds_read_b128 v[232:235], v8 offset:6144
    v_mfma_f32_16x16x32_bf16 v[144:147], v[180:183], v[208:211], v[144:147]
    s_add_u32 m0, s38, 45056
    s_mov_b32 s40, 82560
    buffer_load_dwordx4 v2, s[16:19], s40 offen lds
    v_mfma_f32_16x16x32_bf16 v[148:151], v[184:187], v[208:211], v[148:151]
    v_mfma_f32_16x16x32_bf16 v[152:155], v[176:179], v[212:215], v[152:155]
    v_mfma_f32_16x16x32_bf16 v[156:159], v[180:183], v[212:215], v[156:159]
    v_mfma_f32_16x16x32_bf16 v[160:163], v[184:187], v[212:215], v[160:163]
    s_waitcnt vmcnt(5) lgkmcnt(0)
    s_barrier
    v_mfma_f32_16x16x32_bf16 v[116:119], v[188:191], v[220:223], v[116:119]
    ds_read_b64_tr_b16 v[176:177], v9 offset:24576
    ds_read_b64_tr_b16 v[178:179], v9 offset:25088
    v_mfma_f32_16x16x32_bf16 v[120:123], v[192:195], v[220:223], v[120:123]
    s_cmp_lt_u32 s36, 6
    s_cbranch_scc0 L_x27
    s_add_u32 m0, s38, 12288
    s_mov_b32 s40, 123648
    buffer_load_dwordx4 v2, s[16:19], s40 offen lds
L_x27:
    ds_read_b128 v[200:203], v7 offset:18432
    v_mfma_f32_16x16x32_bf16 v[124:127], v[196:199], v[220:223], v[124:127]
    ds_read_b64_tr_b16 v[180:181], v10 offset:24576
    ds_read_b64_tr_b16 v[182:183], v10 offset:25088
    v_mfma_f32_16x16x32_bf16 v[128:131], v[188:191], v[224:227], v[128:131]
    ds_read_b64_tr_b16 v[184:185], v11 offset:24576
    v_mfma_f32_16x16x32_bf16 v[132:135], v[192:195], v[224:227], v[132:135]
    s_add_u32 m0, s37, 55296
    s_mov_b32 s3, 4718592
    buffer_load_dwordx4 v3, s[20:23], s3 offen offset:0 lds
    ds_read_b64_tr_b16 v[186:187], v11 offset:25088
    v_mfma_f32_16x16x32_bf16 v[136:139], v[196:199], v[224:227], v[136:139]
    ds_read_b128 v[204:207], v7 offset:20480
    ds_read_b128 v[208:211], v7 offset:22528
    v_mfma_f32_16x16x32_bf16 v[140:143], v[188:191], v[228:231], v[140:143]
    ds_read_b128 v[212:215], v7 offset:24576
    v_mfma_f32_16x16x32_bf16 v[144:147], v[192:195], v[228:231], v[144:147]
    v_mfma_f32_16x16x32_bf16 v[148:151], v[196:199], v[228:231], v[148:151]
    s_add_u32 m0, s37, 56192
    s_nop 0
    buffer_load_dwordx4 v3, s[20:23], s3 offen offset:128 lds
    v_mfma_f32_16x16x32_bf16 v[152:155], v[188:191], v[232:235], v[152:155]
    v_mfma_f32_16x16x32_bf16 v[156:159], v[192:195], v[232:235], v[156:159]
    v_mfma_f32_16x16x32_bf16 v[160:163], v[196:199], v[232:235], v[160:163]
    s_waitcnt lgkmcnt(0)
    v_mfma_f32_16x16x32_bf16 v[116:119], v[176:179], v[200:203], v[116:119]
    ds_read_b64_tr_b16 v[188:189], v9 offset:36864
    ds_read_b64_tr_b16 v[190:191], v9 offset:37376
    s_add_u32 m0, s37, 57088
    s_nop 0
    buffer_load_dwordx4 v3, s[20:23], s3 offen offset:256 lds
    v_mfma_f32_16x16x32_bf16 v[120:123], v[180:183], v[200:203], v[120:123]
    ds_read_b128 v[220:223], v8 offset:18432
    v_mfma_f32_16x16x32_bf16 v[124:127], v[184:187], v[200:203], v[124:127]
    ds_read_b64_tr_b16 v[192:193], v10 offset:36864
    ds_read_b64_tr_b16 v[194:195], v10 offset:37376
    v_mfma_f32_16x16x32_bf16 v[128:131], v[176:179], v[204:207], v[128:131]
    ds_read_b64_tr_b16 v[196:197], v11 offset:36864
    v_mfma_f32_16x16x32_bf16 v[132:135], v[180:183], v[204:207], v[132:135]
    ds_read_b64_tr_b16 v[198:199], v11 offset:37376
    s_add_u32 m0, s38, 0
    s_mov_b32 s40, 768
    buffer_load_dwordx4 v2, s[16:19], s40 offen lds
    v_mfma_f32_16x16x32_bf16 v[136:139], v[184:187], v[204:207], v[136:139]
    ds_read_b128 v[224:227], v8 offset:20480
    ds_read_b128 v[228:231], v8 offset:22528
    v_mfma_f32_16x16x32_bf16 v[140:143], v[176:179], v[208:211], v[140:143]
    ds_read_b128 v[232:235], v8 offset:24576
    v_mfma_f32_16x16x32_bf16 v[144:147], v[180:183], v[208:211], v[144:147]
    s_add_u32 m0, s38, 8192
    s_mov_b32 s40, 82688
    buffer_load_dwordx4 v2, s[16:19], s40 offen lds
    v_mfma_f32_16x16x32_bf16 v[148:151], v[184:187], v[208:211], v[148:151]
    v_mfma_f32_16x16x32_bf16 v[152:155], v[176:179], v[212:215], v[152:155]
    v_mfma_f32_16x16x32_bf16 v[156:159], v[180:183], v[212:215], v[156:159]
    v_mfma_f32_16x16x32_bf16 v[160:163], v[184:187], v[212:215], v[160:163]
    s_waitcnt vmcnt(5) lgkmcnt(0)
    s_barrier
    v_mfma_f32_16x16x32_bf16 v[116:119], v[188:191], v[220:223], v[116:119]
    ds_read_b64_tr_b16 v[176:177], v9 offset:49152
    ds_read_b64_tr_b16 v[178:179], v9 offset:49664
    v_mfma_f32_16x16x32_bf16 v[120:123], v[192:195], v[220:223], v[120:123]
    s_cmp_lt_u32 s36, 6
    s_cbranch_scc0 L_x28
    s_add_u32 m0, s38, 30720
    s_mov_b32 s40, 123776
    buffer_load_dwordx4 v2, s[16:19], s40 offen lds
L_x28:
    ds_read_b128 v[200:203], v7 offset:36864
    v_mfma_f32_16x16x32_bf16 v[124:127], v[196:199], v[220:223], v[124:127]
    ds_read_b64_tr_b16 v[180:181], v10 offset:49152
    ds_read_b64_tr_b16 v[182:183], v10 offset:49664
    v_mfma_f32_16x16x32_bf16 v[128:131], v[188:191], v[224:227], v[128:131]
    ds_read_b64_tr_b16 v[184:185], v11 offset:49152
    v_mfma_f32_16x16x32_bf16 v[132:135], v[192:195], v[224:227], v[132:135]
    s_add_u32 m0, s37, 79872
    s_mov_b32 s3, 5505024
    buffer_load_dwordx4 v3, s[20:23], s3 offen offset:0 lds
    ds_read_b64_tr_b16 v[186:187], v11 offset:49664
    v_mfma_f32_16x16x32_bf16 v[136:139], v[196:199], v[224:227], v[136:139]
    ds_read_b128 v[204:207], v7 offset:38912
    ds_read_b128 v[208:211], v7 offset:40960
    v_mfma_f32_16x16x32_bf16 v[140:143], v[188:191], v[228:231], v[140:143]
    ds_read_b128 v[212:215], v7 offset:43008
    v_mfma_f32_16x16x32_bf16 v[144:147], v[192:195], v[228:231], v[144:147]
    v_mfma_f32_16x16x32_bf16 v[148:151], v[196:199], v[228:231], v[148:151]
    s_add_u32 m0, s37, 80768
    s_nop 0
    buffer_load_dwordx4 v3, s[20:23], s3 offen offset:128 lds
    v_mfma_f32_16x16x32_bf16 v[152:155], v[188:191], v[232:235], v[152:155]
    v_mfma_f32_16x16x32_bf16 v[156:159], v[192:195], v[232:235], v[156:159]
    v_mfma_f32_16x16x32_bf16 v[160:163], v[196:199], v[232:235], v[160:163]
    s_waitcnt lgkmcnt(0)
    v_mfma_f32_16x16x32_bf16 v[116:119], v[176:179], v[200:203], v[116:119]
    ds_read_b64_tr_b16 v[188:189], v9 offset:61440
    ds_read_b64_tr_b16 v[190:191], v9 offset:61952
    s_add_u32 m0, s37, 81664
    s_nop 0
    buffer_load_dwordx4 v3, s[20:23], s3 offen offset:256 lds
    v_mfma_f32_16x16x32_bf16 v[120:123], v[180:183], v[200:203], v[120:123]
    ds_read_b128 v[220:223], v8 offset:36864
    v_mfma_f32_16x16x32_bf16 v[124:127], v[184:187], v[200:203], v[124:127]
    ds_read_b64_tr_b16 v[192:193], v10 offset:61440
    ds_read_b64_tr_b16 v[194:195], v10 offset:61952
    v_mfma_f32_16x16x32_bf16 v[128:131], v[176:179], v[204:207], v[128:131]
    ds_read_b64_tr_b16 v[196:197], v11 offset:61440
    v_mfma_f32_16x16x32_bf16 v[132:135], v[180:183], v[204:207], v[132:135]
    ds_read_b64_tr_b16 v[198:199], v11 offset:61952
    s_add_u32 m0, s38, 18432
    s_mov_b32 s40, 896
    buffer_load_dwordx4 v2, s[16:19], s40 offen lds
    v_mfma_f32_16x16x32_bf16 v[136:139], v[184:187], v[204:207], v[136:139]
    ds_read_b128 v[224:227], v8 offset:38912
    ds_read_b128 v[228:231], v8 offset:40960
    v_mfma_f32_16x16x32_bf16 v[140:143], v[176:179], v[208:211], v[140:143]
    ds_read_b128 v[232:235], v8 offset:43008
    v_mfma_f32_16x16x32_bf16 v[144:147], v[180:183], v[208:211], v[144:147]
    s_add_u32 m0, s38, 26624
    s_mov_b32 s40, 82816
    buffer_load_dwordx4 v2, s[16:19], s40 offen lds
    v_mfma_f32_16x16x32_bf16 v[148:151], v[184:187], v[208:211], v[148:151]
    v_mfma_f32_16x16x32_bf16 v[152:155], v[176:179], v[212:215], v[152:155]
    v_mfma_f32_16x16x32_bf16 v[156:159], v[180:183], v[212:215], v[156:159]
    v_mfma_f32_16x16x32_bf16 v[160:163], v[184:187], v[212:215], v[160:163]
    s_waitcnt vmcnt(5) lgkmcnt(0)
    s_barrier
    v_mfma_f32_16x16x32_bf16 v[116:119], v[188:191], v[220:223], v[116:119]
    ds_read_b64_tr_b16 v[176:177], v9 offset:0
    ds_read_b64_tr_b16 v[178:179], v9 offset:512
    v_mfma_f32_16x16x32_bf16 v[120:123], v[192:195], v[220:223], v[120:123]
    s_cmp_lt_u32 s36, 6
    s_cbranch_scc0 L_x29
    s_add_u32 m0, s38, 49152
    s_mov_b32 s40, 123904
    buffer_load_dwordx4 v2, s[16:19], s40 offen lds
L_x29:
    ds_read_b128 v[200:203], v7 offset:0
    v_mfma_f32_16x16x32_bf16 v[124:127], v[196:199], v[220:223], v[124:127]
    ds_read_b64_tr_b16 v[180:181], v10 offset:0
    ds_read_b64_tr_b16 v[182:183], v10 offset:512
    v_mfma_f32_16x16x32_bf16 v[128:131], v[188:191], v[224:227], v[128:131]
    ds_read_b64_tr_b16 v[184:185], v11 offset:0
    v_mfma_f32_16x16x32_bf16 v[132:135], v[192:195], v[224:227], v[132:135]
    s_add_u32 m0, s37, 104448
    s_mov_b32 s3, 6291456
    buffer_load_dwordx4 v3, s[20:23], s3 offen offset:0 lds
    ds_read_b64_tr_b16 v[186:187], v11 offset:512
    v_mfma_f32_16x16x32_bf16 v[136:139], v[196:199], v[224:227], v[136:139]
    ds_read_b128 v[204:207], v7 offset:2048
    ds_read_b128 v[208:211], v7 offset:4096
    v_mfma_f32_16x16x32_bf16 v[140:143], v[188:191], v[228:231], v[140:143]
    ds_read_b128 v[212:215], v7 offset:6144
    v_mfma_f32_16x16x32_bf16 v[144:147], v[192:195], v[228:231], v[144:147]
    v_mfma_f32_16x16x32_bf16 v[148:151], v[196:199], v[228:231], v[148:151]
    s_add_u32 m0, s37, 105344
    s_nop 0
    buffer_load_dwordx4 v3, s[20:23], s3 offen offset:128 lds
    v_mfma_f32_16x16x32_bf16 v[152:155], v[188:191], v[232:235], v[152:155]
    v_mfma_f32_16x16x32_bf16 v[156:159], v[192:195], v[232:235], v[156:159]
    v_mfma_f32_16x16x32_bf16 v[160:163], v[196:199], v[232:235], v[160:163]
    s_waitcnt lgkmcnt(0)
    v_mfma_f32_16x16x32_bf16 v[116:119], v[176:179], v[200:203], v[116:119]
    ds_read_b64_tr_b16 v[188:189], v9 offset:12288
    ds_read_b64_tr_b16 v[190:191], v9 offset:12800
    s_add_u32 m0, s37, 106240
    s_nop 0
    buffer_load_dwordx4 v3, s[20:23], s3 offen offset:256 lds
    v_mfma_f32_16x16x32_bf16 v[120:123], v[180:183], v[200:203], v[120:123]
    ds_read_b128 v[220:223], v8 offset:0
    v_mfma_f32_16x16x32_bf16 v[124:127], v[184:187], v[200:203], v[124:127]
    ds_read_b64_tr_b16 v[192:193], v10 offset:12288
    ds_read_b64_tr_b16 v[194:195], v10 offset:12800
    v_mfma_f32_16x16x32_bf16 v[128:131], v[176:179], v[204:207], v[128:131]
    ds_read_b64_tr_b16 v[196:197], v11 offset:12288
    v_mfma_f32_16x16x32_bf16 v[132:135], v[180:183], v[204:207], v[132:135]
    ds_read_b64_tr_b16 v[198:199], v11 offset:12800
    s_add_u32 m0, s38, 36864
    s_mov_b32 s40, 1024
    buffer_load_dwordx4 v2, s[16:19], s40 offen lds
    v_mfma_f32_16x16x32_bf16 v[136:139], v[184:187], v[204:207], v[136:139]
    ds_read_b128 v[224:227], v8 offset:2048
    ds_read_b128 v[228:231], v8 offset:4096
    v_mfma_f32_16x16x32_bf16 v[140:143], v[176:179], v[208:211], v[140:143]
    ds_read_b128 v[232:235], v8 offset:6144
    v_mfma_f32_16x16x32_bf16 v[144:147], v[180:183], v[208:211], v[144:147]
    s_add_u32 m0, s38, 45056
    s_mov_b32 s40, 82944
    buffer_load_dwordx4 v2, s[16:19], s40 offen lds
    v_mfma_f32_16x16x32_bf16 v[148:151], v[184:187], v[208:211], v[148:151]
    v_mfma_f32_16x16x32_bf16 v[152:155], v[176:179], v[212:215], v[152:155]
    v_mfma_f32_16x16x32_bf16 v[156:159], v[180:183], v[212:215], v[156:159]
    v_mfma_f32_16x16x32_bf16 v[160:163], v[184:187], v[212:215], v[160:163]
    s_waitcnt vmcnt(5) lgkmcnt(0)
    s_barrier
    v_mfma_f32_16x16x32_bf16 v[116:119], v[188:191], v[220:223], v[116:119]
    ds_read_b64_tr_b16 v[176:177], v9 offset:24576
    ds_read_b64_tr_b16 v[178:179], v9 offset:25088
    v_mfma_f32_16x16x32_bf16 v[120:123], v[192:195], v[220:223], v[120:123]
    s_cmp_lt_u32 s36, 6
    s_cbranch_scc0 L_x30
    s_add_u32 m0, s38, 12288
    s_mov_b32 s40, 124032
    buffer_load_dwordx4 v2, s[16:19], s40 offen lds
L_x30:
    ds_read_b128 v[200:203], v7 offset:18432
    v_mfma_f32_16x16x32_bf16 v[124:127], v[196:199], v[220:223], v[124:127]
    ds_read_b64_tr_b16 v[180:181], v10 offset:24576
    ds_read_b64_tr_b16 v[182:183], v10 offset:25088
    v_mfma_f32_16x16x32_bf16 v[128:131], v[188:191], v[224:227], v[128:131]
    ds_read_b64_tr_b16 v[184:185], v11 offset:24576
    v_mfma_f32_16x16x32_bf16 v[132:135], v[192:195], v[224:227], v[132:135]
    s_add_u32 m0, s37, 55296
    s_mov_b32 s3, 7077888
    buffer_load_dwordx4 v3, s[20:23], s3 offen offset:0 lds
    ds_read_b64_tr_b16 v[186:187], v11 offset:25088
    v_mfma_f32_16x16x32_bf16 v[136:139], v[196:199], v[224:227], v[136:139]
    ds_read_b128 v[204:207], v7 offset:20480
    ds_read_b128 v[208:211], v7 offset:22528
    v_mfma_f32_16x16x32_bf16 v[140:143], v[188:191], v[228:231], v[140:143]
    ds_read_b128 v[212:215], v7 offset:24576
    v_mfma_f32_16x16x32_bf16 v[144:147], v[192:195], v[228:231], v[144:147]
    v_mfma_f32_16x16x32_bf16 v[148:151], v[196:199], v[228:231], v[148:151]
    s_add_u32 m0, s37, 56192
    s_nop 0
    buffer_load_dwordx4 v3, s[20:23], s3 offen offset:128 lds
    v_mfma_f32_16x16x32_bf16 v[152:155], v[188:191], v[232:235], v[152:155]
    v_mfma_f32_16x16x32_bf16 v[156:159], v[192:195], v[232:235], v[156:159]
    v_mfma_f32_16x16x32_bf16 v[160:163], v[196:199], v[232:235], v[160:163]
    s_waitcnt lgkmcnt(0)
    v_mfma_f32_16x16x32_bf16 v[116:119], v[176:179], v[200:203], v[116:119]
    ds_read_b64_tr_b16 v[188:189], v9 offset:36864
    ds_read_b64_tr_b16 v[190:191], v9 offset:37376
    s_add_u32 m0, s37, 57088
    s_nop 0
    buffer_load_dwordx4 v3, s[20:23], s3 offen offset:256 lds
    v_mfma_f32_16x16x32_bf16 v[120:123], v[180:183], v[200:203], v[120:123]
    ds_read_b128 v[220:223], v8 offset:18432
    v_mfma_f32_16x16x32_bf16 v[124:127], v[184:187], v[200:203], v[124:127]
    ds_read_b64_tr_b16 v[192:193], v10 offset:36864
    ds_read_b64_tr_b16 v[194:195], v10 offset:37376
    v_mfma_f32_16x16x32_bf16 v[128:131], v[176:179], v[204:207], v[128:131]
    ds_read_b64_tr_b16 v[196:197], v11 offset:36864
    v_mfma_f32_16x16x32_bf16 v[132:135], v[180:183], v[204:207], v[132:135]
    ds_read_b64_tr_b16 v[198:199], v11 offset:37376
    s_add_u32 m0, s38, 0
    s_mov_b32 s40, 1152
    buffer_load_dwordx4 v2, s[16:19], s40 offen lds
    v_mfma_f32_16x16x32_bf16 v[136:139], v[184:187], v[204:207], v[136:139]
    ds_read_b128 v[224:227], v8 offset:20480
    ds_read_b128 v[228:231], v8 offset:22528
    v_mfma_f32_16x16x32_bf16 v[140:143], v[176:179], v[208:211], v[140:143]
    ds_read_b128 v[232:235], v8 offset:24576
    v_mfma_f32_16x16x32_bf16 v[144:147], v[180:183], v[208:211], v[144:147]
    s_add_u32 m0, s38, 8192
    s_mov_b32 s40, 83072
    buffer_load_dwordx4 v2, s[16:19], s40 offen lds
    v_mfma_f32_16x16x32_bf16 v[148:151], v[184:187], v[208:211], v[148:151]
    v_mfma_f32_16x16x32_bf16 v[152:155], v[176:179], v[212:215], v[152:155]
    v_mfma_f32_16x16x32_bf16 v[156:159], v[180:183], v[212:215], v[156:159]
    v_mfma_f32_16x16x32_bf16 v[160:163], v[184:187], v[212:215], v[160:163]
    s_waitcnt vmcnt(5) lgkmcnt(0)
    s_barrier
    v_mfma_f32_16x16x32_bf16 v[116:119], v[188:191], v[220:223], v[116:119]
    ds_read_b64_tr_b16 v[176:177], v9 offset:49152
    ds_read_b64_tr_b16 v[178:179], v9 offset:49664
    s_lshl_b32 s41, s49, 2
    s_lshr_b32 s41, 42560, s41
    s_and_b32 s41, s41, 15
    s_lshr_b32 s42, s41, 2
    s_lshl_b32 s42, s42, 10
    s_add_u32 s42, s42, 55296
    s_and_b32 s41, s41, 3
    v_mfma_f32_16x16x32_bf16 v[120:123], v[192:195], v[220:223], v[120:123]
    ds_read_b128 v[200:203], v7 offset:36864
    v_lshrrev_b32 v244, 4, v1
    v_bfe_u32 v245, v1, 2, 2
    v_and_b32 v246, 1, v244
    v_lshlrev_b32 v246, 1, v246
    v_lshrrev_b32 v247, 1, v245
    v_add_u32 v247, v247, v246
    v_mfma_f32_16x16x32_bf16 v[124:127], v[196:199], v[220:223], v[124:127]
    ds_read_b64_tr_b16 v[180:181], v10 offset:49152
    ds_read_b64_tr_b16 v[182:183], v10 offset:49664
    v_xor_b32 v247, s41, v247
    v_lshlrev_b32 v247, 5, v247
    v_lshlrev_b32 v248, 7, v245
    v_add_u32 v248, v248, v247
    v_lshlrev_b32 v246, 8, v246
    v_add_u32 v248, v248, v246
    v_lshrrev_b32 v247, 1, v244
    v_mfma_f32_16x16x32_bf16 v[128:131], v[188:191], v[224:227], v[128:131]
    ds_read_b64_tr_b16 v[184:185], v11 offset:49152
    v_mul_u32_u24 v247, 3072, v247
    v_add_u32 v248, v248, v247
    v_and_b32 v247, 3, v1
    v_lshlrev_b32 v247, 3, v247
    v_add_u32 v248, v248, v247
    v_add_u32 v248, s42, v248
    v_mfma_f32_16x16x32_bf16 v[132:135], v[192:195], v[224:227], v[132:135]
    ds_read_b64_tr_b16 v[186:187], v11 offset:49664
    s_lshl_b32 s41, s49, 2
    s_lshr_b32 s41, 46929, s41
    s_and_b32 s41, s41, 15
    s_lshr_b32 s42, s41, 2
    s_lshl_b32 s42, s42, 10
    s_add_u32 s42, s42, 55296
    s_and_b32 s41, s41, 3
    v_mfma_f32_16x16x32_bf16 v[136:139], v[196:199], v[224:227], v[136:139]
    ds_read_b128 v[204:207], v7 offset:38912
    ds_read_b128 v[208:211], v7 offset:40960
    v_lshrrev_b32 v244, 4, v1
    v_bfe_u32 v245, v1, 2, 2
    v_and_b32 v246, 1, v244
    v_lshlrev_b32 v246, 1, v246
    v_lshrrev_b32 v247, 1, v245
    v_add_u32 v247, v247, v246
    v_mfma_f32_16x16x32_bf16 v[140:143], v[188:191], v[228:231], v[140:143]
    ds_read_b128 v[212:215], v7 offset:43008
    v_xor_b32 v247, s41, v247
    v_lshlrev_b32 v247, 5, v247
    v_lshlrev_b32 v249, 7, v245
    v_add_u32 v249, v249, v247
    v_lshlrev_b32 v246, 8, v246
    v_add_u32 v249, v249, v246
    v_lshrrev_b32 v247, 1, v244
    v_mfma_f32_16x16x32_bf16 v[144:147], v[192:195], v[228:231], v[144:147]
    v_mul_u32_u24 v247, 3072, v247
    v_add_u32 v249, v249, v247
    v_and_b32 v247, 3, v1
    v_lshlrev_b32 v247, 3, v247
    v_add_u32 v249, v249, v247
    v_add_u32 v249, s42, v249
    v_mfma_f32_16x16x32_bf16 v[148:151], v[196:199], v[228:231], v[148:151]
    s_lshl_b32 s41, s49, 2
    s_lshr_b32 s41, 38962, s41
    s_and_b32 s41, s41, 15
    s_lshr_b32 s42, s41, 2
    s_lshl_b32 s42, s42, 10
    s_add_u32 s42, s42, 55296
    s_and_b32 s41, s41, 3
    v_mfma_f32_16x16x32_bf16 v[152:155], v[188:191], v[232:235], v[152:155]
    v_lshrrev_b32 v244, 4, v1
    v_bfe_u32 v245, v1, 2, 2
    v_and_b32 v246, 1, v244
    v_lshlrev_b32 v246, 1, v246
    v_lshrrev_b32 v247, 1, v245
    v_add_u32 v247, v247, v246
    v_mfma_f32_16x16x32_bf16 v[156:159], v[192:195], v[232:235], v[156:159]
    v_xor_b32 v247, s41, v247
    v_lshlrev_b32 v247, 5, v247
    v_lshlrev_b32 v253, 7, v245
    v_add_u32 v253, v253, v247
    v_lshlrev_b32 v246, 8, v246
    v_add_u32 v253, v253, v246
    v_lshrrev_b32 v247, 1, v244
    v_mfma_f32_16x16x32_bf16 v[160:163], v[196:199], v[232:235], v[160:163]
    v_mul_u32_u24 v247, 3072, v247
    v_add_u32 v253, v253, v247
    v_and_b32 v247, 3, v1
    v_lshlrev_b32 v247, 3, v247
    v_add_u32 v253, v253, v247
    v_add_u32 v253, s42, v253
    s_waitcnt lgkmcnt(0)
    v_mfma_f32_16x16x32_bf16 v[116:119], v[176:179], v[200:203], v[116:119]
    ds_read_b64_tr_b16 v[188:189], v9 offset:61440
    ds_read_b64_tr_b16 v[190:191], v9 offset:61952
    v_mfma_f32_16x16x32_bf16 v[120:123], v[180:183], v[200:203], v[120:123]
    ds_read_b128 v[220:223], v8 offset:36864
    v_mfma_f32_16x16x32_bf16 v[124:127], v[184:187], v[200:203], v[124:127]
    ds_read_b64_tr_b16 v[192:193], v10 offset:61440
    ds_read_b64_tr_b16 v[194:195], v10 offset:61952
    v_mfma_f32_16x16x32_bf16 v[128:131], v[176:179], v[204:207], v[128:131]
    ds_read_b64_tr_b16 v[196:197], v11 offset:61440
    v_mfma_f32_16x16x32_bf16 v[132:135], v[180:183], v[204:207], v[132:135]
    ds_read_b64_tr_b16 v[198:199], v11 offset:61952
    v_mfma_f32_16x16x32_bf16 v[136:139], v[184:187], v[204:207], v[136:139]
    ds_read_b128 v[224:227], v8 offset:38912
    ds_read_b128 v[228:231], v8 offset:40960
    v_mfma_f32_16x16x32_bf16 v[140:143], v[176:179], v[208:211], v[140:143]
    ds_read_b128 v[232:235], v8 offset:43008
    v_mfma_f32_16x16x32_bf16 v[144:147], v[180:183], v[208:211], v[144:147]
    v_mfma_f32_16x16x32_bf16 v[148:151], v[184:187], v[208:211], v[148:151]
    v_mfma_f32_16x16x32_bf16 v[152:155], v[176:179], v[212:215], v[152:155]
    v_mfma_f32_16x16x32_bf16 v[156:159], v[180:183], v[212:215], v[156:159]
    v_mfma_f32_16x16x32_bf16 v[160:163], v[184:187], v[212:215], v[160:163]
    s_waitcnt vmcnt(0) lgkmcnt(0)
    s_barrier
    v_mfma_f32_16x16x32_bf16 v[116:119], v[188:191], v[220:223], v[116:119]
    ds_read_b64_tr_b16 v[176:177], v9 offset:0
    ds_read_b64_tr_b16 v[178:179], v9 offset:512
    v_mfma_f32_16x16x32_bf16 v[120:123], v[192:195], v[220:223], v[120:123]
    ds_read_b128 v[200:203], v7 offset:0
    v_mfma_f32_16x16x32_bf16 v[124:127], v[196:199], v[220:223], v[124:127]
    ds_read_b64_tr_b16 v[180:181], v10 offset:0
    ds_read_b64_tr_b16 v[182:183], v10 offset:512
    v_mfma_f32_16x16x32_bf16 v[128:131], v[188:191], v[224:227], v[128:131]
    ds_read_b64_tr_b16 v[184:185], v11 offset:0
    v_mfma_f32_16x16x32_bf16 v[132:135], v[192:195], v[224:227], v[132:135]
    ds_read_b64_tr_b16 v[186:187], v11 offset:512
    v_mfma_f32_16x16x32_bf16 v[136:139], v[196:199], v[224:227], v[136:139]
    ds_read_b128 v[204:207], v7 offset:2048
    ds_read_b128 v[208:211], v7 offset:4096
    v_mfma_f32_16x16x32_bf16 v[140:143], v[188:191], v[228:231], v[140:143]
    ds_read_b128 v[212:215], v7 offset:6144
    v_mfma_f32_16x16x32_bf16 v[144:147], v[192:195], v[228:231], v[144:147]
    v_mfma_f32_16x16x32_bf16 v[148:151], v[196:199], v[228:231], v[148:151]
    v_mfma_f32_16x16x32_bf16 v[152:155], v[188:191], v[232:235], v[152:155]
    v_mfma_f32_16x16x32_bf16 v[156:159], v[192:195], v[232:235], v[156:159]
    v_mfma_f32_16x16x32_bf16 v[160:163], v[196:199], v[232:235], v[160:163]
    s_waitcnt lgkmcnt(0)
    v_mfma_f32_16x16x32_bf16 v[116:119], v[176:179], v[200:203], v[116:119]
    ds_read_b64_tr_b16 v[188:189], v9 offset:12288
    ds_read_b64_tr_b16 v[190:191], v9 offset:12800
    v_mfma_f32_16x16x32_bf16 v[120:123], v[180:183], v[200:203], v[120:123]
    ds_read_b128 v[220:223], v8 offset:0
    v_mfma_f32_16x16x32_bf16 v[124:127], v[184:187], v[200:203], v[124:127]
    ds_read_b64_tr_b16 v[192:193], v10 offset:12288
    ds_read_b64_tr_b16 v[194:195], v10 offset:12800
    v_mfma_f32_16x16x32_bf16 v[128:131], v[176:179], v[204:207], v[128:131]
    ds_read_b64_tr_b16 v[196:197], v11 offset:12288
    v_mfma_f32_16x16x32_bf16 v[132:135], v[180:183], v[204:207], v[132:135]
    ds_read_b64_tr_b16 v[198:199], v11 offset:12800
    v_mfma_f32_16x16x32_bf16 v[136:139], v[184:187], v[204:207], v[136:139]
    ds_read_b128 v[224:227], v8 offset:2048
    ds_read_b128 v[228:231], v8 offset:4096
    v_mfma_f32_16x16x32_bf16 v[140:143], v[176:179], v[208:211], v[140:143]
    ds_read_b128 v[232:235], v8 offset:6144
    v_mfma_f32_16x16x32_bf16 v[144:147], v[180:183], v[208:211], v[144:147]
    v_mfma_f32_16x16x32_bf16 v[148:151], v[184:187], v[208:211], v[148:151]
    v_mfma_f32_16x16x32_bf16 v[152:155], v[176:179], v[212:215], v[152:155]
    v_mfma_f32_16x16x32_bf16 v[156:159], v[180:183], v[212:215], v[156:159]
    v_mfma_f32_16x16x32_bf16 v[160:163], v[184:187], v[212:215], v[160:163]
    s_waitcnt lgkmcnt(0)
    s_barrier
    v_mfma_f32_16x16x32_bf16 v[116:119], v[188:191], v[220:223], v[116:119]
    s_add_u32 m0, s57, 0
    s_mov_b32 s40, 0
    buffer_load_dwordx4 v4, s[24:27], s40 offen offset:0 nt lds
    v_mfma_f32_16x16x32_bf16 v[120:123], v[192:195], v[220:223], v[120:123]
    s_add_u32 m0, s57, 1024
    s_mov_b32 s40, 0
    buffer_load_dwordx4 v5, s[24:27], s40 offen offset:0 nt lds
    v_mfma_f32_16x16x32_bf16 v[124:127], v[196:199], v[220:223], v[124:127]
    v_mfma_f32_16x16x32_bf16 v[128:131], v[188:191], v[224:227], v[128:131]
    s_add_u32 m0, s57, 6144
    s_mov_b32 s40, 6144
    buffer_load_dwordx4 v4, s[24:27], s40 offen offset:0 nt lds
    v_mfma_f32_16x16x32_bf16 v[132:135], v[192:195], v[224:227], v[132:135]
    v_cvt_pk_bf16_f32 v116, v116, v117
    v_cvt_pk_bf16_f32 v117, v118, v119
    v_cvt_pk_bf16_f32 v118, v120, v121
    v_cvt_pk_bf16_f32 v119, v122, v123
    ds_write_b128 v12, v[116:119] offset:0
    v_mfma_f32_16x16x32_bf16 v[136:139], v[196:199], v[224:227], v[136:139]
    s_add_u32 m0, s57, 7168
    s_mov_b32 s40, 6144
    buffer_load_dwordx4 v5, s[24:27], s40 offen offset:0 nt lds
    v_cvt_pk_bf16_f32 v124, v124, v125
    v_cvt_pk_bf16_f32 v125, v126, v127
    ds_write_b64 v14, v[124:125] offset:0
    v_mfma_f32_16x16x32_bf16 v[140:143], v[188:191], v[228:231], v[140:143]
    v_mfma_f32_16x16x32_bf16 v[144:147], v[192:195], v[228:231], v[144:147]
    s_add_u32 m0, s57, 1920
    s_mov_b32 s40, 0
    buffer_load_dwordx4 v4, s[24:27], s40 offen offset:128 nt lds
    v_cvt_pk_bf16_f32 v128, v128, v129
    v_cvt_pk_bf16_f32 v129, v130, v131
    v_cvt_pk_bf16_f32 v130, v132, v133
    v_cvt_pk_bf16_f32 v131, v134, v135
    ds_write_b128 v12, v[128:131] offset:1024
    v_mfma_f32_16x16x32_bf16 v[148:151], v[196:199], v[228:231], v[148:151]
    v_cvt_pk_bf16_f32 v136, v136, v137
    v_cvt_pk_bf16_f32 v137, v138, v139
    ds_write_b64 v14, v[136:137] offset:1024
    v_mfma_f32_16x16x32_bf16 v[152:155], v[188:191], v[232:235], v[152:155]
    s_add_u32 m0, s57, 2944
    s_mov_b32 s40, 0
    buffer_load_dwordx4 v5, s[24:27], s40 offen offset:128 nt lds
    v_mfma_f32_16x16x32_bf16 v[156:159], v[192:195], v[232:235], v[156:159]
    v_cvt_pk_bf16_f32 v140, v140, v141
    v_cvt_pk_bf16_f32 v141, v142, v143
    v_cvt_pk_bf16_f32 v142, v144, v145
    v_cvt_pk_bf16_f32 v143, v146, v147
    ds_write_b128 v12, v[140:143] offset:2048
    v_mfma_f32_16x16x32_bf16 v[160:163], v[196:199], v[232:235], v[160:163]
    v_cvt_pk_bf16_f32 v148, v148, v149
    v_cvt_pk_bf16_f32 v149, v150, v151
    ds_write_b64 v14, v[148:149] offset:2048
    v_cvt_pk_bf16_f32 v152, v152, v153
    v_cvt_pk_bf16_f32 v153, v154, v155
    v_cvt_pk_bf16_f32 v154, v156, v157
    v_cvt_pk_bf16_f32 v155, v158, v159
    ds_write_b128 v12, v[152:155] offset:3072
    v_cvt_pk_bf16_f32 v160, v160, v161
    v_cvt_pk_bf16_f32 v161, v162, v163
    ds_write_b64 v14, v[160:161] offset:3072
    s_add_u32 m0, s57, 8064
    s_mov_b32 s40, 6144
    buffer_load_dwordx4 v4, s[24:27], s40 offen offset:128 nt lds
    s_add_u32 m0, s57, 9088
    s_mov_b32 s40, 6144
    buffer_load_dwordx4 v5, s[24:27], s40 offen offset:128 nt lds
    s_add_u32 m0, s57, 3840
    s_mov_b32 s40, 0
    buffer_load_dwordx4 v4, s[24:27], s40 offen offset:256 nt lds
    s_add_u32 m0, s57, 4864
    s_mov_b32 s40, 0
    buffer_load_dwordx4 v5, s[24:27], s40 offen offset:256 nt lds
    s_add_u32 m0, s57, 9984
    s_mov_b32 s40, 6144
    buffer_load_dwordx4 v4, s[24:27], s40 offen offset:256 nt lds
    s_add_u32 m0, s57, 11008
    s_mov_b32 s40, 6144
    buffer_load_dwordx4 v5, s[24:27], s40 offen offset:256 nt lds
    v_lshlrev_b32 v7, 4, v1
    v_mov_b32 v9, v248
    v_mov_b32 v10, v249
    v_mov_b32 v11, v253
    s_waitcnt lgkmcnt(0)
    s_barrier
    v_add_u32 v12, 49152, v9
    v_add_u32 v13, 49152, v10
    v_add_u32 v14, 49152, v11
    s_lshl_b32 s41, s36, 2
    s_lshr_b32 s42, 0x32105432, s41
    s_and_b32 s42, s42, 15
    s_mul_i32 s42, s42, 9216
    v_lshlrev_b32 v241, 4, v1
    v_add_u32 v241, s42, v241
    v_xor_b32 v246, 32, v250
    v_xor_b32 v247, 32, v251
    s_waitcnt vmcnt(10)
    ds_read_b64 v[16:17], v250 offset:0
    ds_read_b64 v[18:19], v246 offset:0
    ds_read_b64 v[20:21], v251 offset:0
    ds_read_b64 v[22:23], v247 offset:0
    s_waitcnt vmcnt(8)
    ds_read_b64 v[40:41], v250 offset:6144
    ds_read_b64 v[42:43], v246 offset:6144
    ds_read_b64 v[44:45], v251 offset:6144
    ds_read_b64 v[46:47], v247 offset:6144
    s_waitcnt lgkmcnt(4)
    s_add_u32 m0, s57, 0
    s_mov_b32 s40, 12288
    buffer_load_dwordx4 v4, s[24:27], s40 offen offset:0 nt lds
    s_add_u32 m0, s57, 1024
    s_mov_b32 s40, 12288
    buffer_load_dwordx4 v5, s[24:27], s40 offen offset:0 nt lds
    s_waitcnt vmcnt(8)
    ds_read_b64 v[24:25], v250 offset:2048
    ds_read_b64 v[26:27], v246 offset:2048
    ds_read_b64 v[28:29], v251 offset:2048
    ds_read_b64 v[30:31], v247 offset:2048
    s_waitcnt lgkmcnt(4)
    s_add_u32 m0, s57, 6144
    s_mov_b32 s40, 18432
    buffer_load_dwordx4 v4, s[24:27], s40 offen offset:0 nt lds
    s_add_u32 m0, s57, 7168
    s_mov_b32 s40, 18432
    buffer_load_dwordx4 v5, s[24:27], s40 offen offset:0 nt lds
    s_waitcnt vmcnt(8)
    ds_read_b64 v[48:49], v250 offset:8192
    ds_read_b64 v[50:51], v246 offset:8192
    ds_read_b64 v[52:53], v251 offset:8192
    ds_read_b64 v[54:55], v247 offset:8192
    s_waitcnt lgkmcnt(4)
    s_add_u32 m0, s57, 1920
    s_mov_b32 s40, 12288
    buffer_load_dwordx4 v4, s[24:27], s40 offen offset:128 nt lds
    s_add_u32 m0, s57, 2944
    s_mov_b32 s40, 12288
    buffer_load_dwordx4 v5, s[24:27], s40 offen offset:128 nt lds
    s_waitcnt vmcnt(8)
    ds_read_b64 v[32:33], v250 offset:4096
    ds_read_b64 v[34:35], v246 offset:4096
    ds_read_b64 v[36:37], v251 offset:4096
    ds_read_b64 v[38:39], v247 offset:4096
    s_waitcnt lgkmcnt(4)
    s_add_u32 m0, s57, 8064
    s_mov_b32 s40, 18432
    buffer_load_dwordx4 v4, s[24:27], s40 offen offset:128 nt lds
    s_add_u32 m0, s57, 9088
    s_mov_b32 s40, 18432
    buffer_load_dwordx4 v5, s[24:27], s40 offen offset:128 nt lds
    s_waitcnt vmcnt(8)
    ds_read_b64 v[56:57], v250 offset:10240
    ds_read_b64 v[58:59], v246 offset:10240
    ds_read_b64 v[60:61], v251 offset:10240
    ds_read_b64 v[62:63], v247 offset:10240
    s_waitcnt lgkmcnt(4)
    s_add_u32 m0, s57, 3840
    s_mov_b32 s40, 12288
    buffer_load_dwordx4 v4, s[24:27], s40 offen offset:256 nt lds
    s_add_u32 m0, s57, 4864
    s_mov_b32 s40, 12288
    buffer_load_dwordx4 v5, s[24:27], s40 offen offset:256 nt lds
    s_waitcnt lgkmcnt(0)
    s_add_u32 m0, s57, 9984
    s_mov_b32 s40, 18432
    buffer_load_dwordx4 v4, s[24:27], s40 offen offset:256 nt lds
    s_add_u32 m0, s57, 11008
    s_mov_b32 s40, 18432
    buffer_load_dwordx4 v5, s[24:27], s40 offen offset:256 nt lds
    ds_read_b128 v[224:227], v7 offset:0
    ds_read_b128 v[228:231], v7 offset:9216
    ds_read_b128 v[232:235], v7 offset:18432
    ds_read_b128 v[236:239], v7 offset:27648
    s_waitcnt lgkmcnt(3)
    v_mfma_f32_16x16x32_bf16 v[116:119], v[16:19], v[224:227], 0
    v_mfma_f32_16x16x32_bf16 v[120:123], v[40:43], v[224:227], 0
    ds_read_b128 v[224:227], v7 offset:36864
    s_waitcnt lgkmcnt(3)
    v_mfma_f32_16x16x32_bf16 v[116:119], v[20:23], v[228:231], v[116:119]
    v_mfma_f32_16x16x32_bf16 v[120:123], v[44:47], v[228:231], v[120:123]
    ds_read_b128 v[228:231], v7 offset:46080
    s_waitcnt lgkmcnt(3)
    v_mfma_f32_16x16x32_bf16 v[116:119], v[24:27], v[232:235], v[116:119]
    v_mfma_f32_16x16x32_bf16 v[120:123], v[48:51], v[232:235], v[120:123]
    ds_read_b128 v[232:235], v7 offset:1024
    s_waitcnt lgkmcnt(3)
    v_mfma_f32_16x16x32_bf16 v[116:119], v[28:31], v[236:239], v[116:119]
    v_mfma_f32_16x16x32_bf16 v[120:123], v[52:55], v[236:239], v[120:123]
    ds_read_b128 v[236:239], v7 offset:10240
    s_waitcnt lgkmcnt(3)
    v_mfma_f32_16x16x32_bf16 v[116:119], v[32:35], v[224:227], v[116:119]
    v_mfma_f32_16x16x32_bf16 v[120:123], v[56:59], v[224:227], v[120:123]
    ds_read_b128 v[224:227], v7 offset:19456
    s_waitcnt lgkmcnt(3)
    v_mfma_f32_16x16x32_bf16 v[116:119], v[36:39], v[228:231], v[116:119]
    v_mfma_f32_16x16x32_bf16 v[120:123], v[60:63], v[228:231], v[120:123]
    ds_read_b128 v[228:231], v7 offset:28672
    s_waitcnt lgkmcnt(3)
    v_mfma_f32_16x16x32_bf16 v[124:127], v[16:19], v[232:235], 0
    v_mfma_f32_16x16x32_bf16 v[128:131], v[40:43], v[232:235], 0
    ds_read_b128 v[232:235], v7 offset:37888
    s_waitcnt lgkmcnt(3)
    v_mfma_f32_16x16x32_bf16 v[124:127], v[20:23], v[236:239], v[124:127]
    v_mfma_f32_16x16x32_bf16 v[128:131], v[44:47], v[236:239], v[128:131]
    ds_read_b128 v[236:239], v7 offset:47104
    s_waitcnt lgkmcnt(3)
    v_mfma_f32_16x16x32_bf16 v[124:127], v[24:27], v[224:227], v[124:127]
    v_mfma_f32_16x16x32_bf16 v[128:131], v[48:51], v[224:227], v[128:131]
    ds_read_b128 v[224:227], v7 offset:2048
    s_waitcnt lgkmcnt(3)
    v_mfma_f32_16x16x32_bf16 v[124:127], v[28:31], v[228:231], v[124:127]
    v_mfma_f32_16x16x32_bf16 v[128:131], v[52:55], v[228:231], v[128:131]
    ds_read_b128 v[228:231], v7 offset:11264
    s_waitcnt lgkmcnt(3)
    v_mfma_f32_16x16x32_bf16 v[124:127], v[32:35], v[232:235], v[124:127]
    v_mfma_f32_16x16x32_bf16 v[128:131], v[56:59], v[232:235], v[128:131]
    ds_read_b128 v[232:235], v7 offset:20480
    s_waitcnt lgkmcnt(3)
    v_mfma_f32_16x16x32_bf16 v[124:127], v[36:39], v[236:239], v[124:127]
    v_mfma_f32_16x16x32_bf16 v[128:131], v[60:63], v[236:239], v[128:131]
    ds_read_b128 v[236:239], v7 offset:29696
    s_waitcnt lgkmcnt(3)
    v_mfma_f32_16x16x32_bf16 v[132:135], v[16:19], v[224:227], 0
    v_mfma_f32_16x16x32_bf16 v[136:139], v[40:43], v[224:227], 0
    ds_read_b128 v[224:227], v7 offset:38912
    s_waitcnt lgkmcnt(3)
    v_mfma_f32_16x16x32_bf16 v[132:135], v[20:23], v[228:231], v[132:135]
    v_mfma_f32_16x16x32_bf16 v[136:139], v[44:47], v[228:231], v[136:139]
    ds_read_b128 v[228:231], v7 offset:48128
    s_waitcnt lgkmcnt(3)
    v_mfma_f32_16x16x32_bf16 v[132:135], v[24:27], v[232:235], v[132:135]
    v_mfma_f32_16x16x32_bf16 v[136:139], v[48:51], v[232:235], v[136:139]
    ds_read_b128 v[232:235], v7 offset:3072
    s_waitcnt lgkmcnt(3)
    v_mfma_f32_16x16x32_bf16 v[132:135], v[28:31], v[236:239], v[132:135]
    v_mfma_f32_16x16x32_bf16 v[136:139], v[52:55], v[236:239], v[136:139]
    ds_read_b128 v[236:239], v7 offset:12288
    s_waitcnt lgkmcnt(3)
    v_mfma_f32_16x16x32_bf16 v[132:135], v[32:35], v[224:227], v[132:135]
    v_mfma_f32_16x16x32_bf16 v[136:139], v[56:59], v[224:227], v[136:139]
    ds_read_b128 v[224:227], v7 offset:21504
    s_waitcnt lgkmcnt(3)
    v_mfma_f32_16x16x32_bf16 v[132:135], v[36:39], v[228:231], v[132:135]
    v_mfma_f32_16x16x32_bf16 v[136:139], v[60:63], v[228:231], v[136:139]
    ds_read_b128 v[228:231], v7 offset:30720
    s_waitcnt lgkmcnt(3)
    v_mfma_f32_16x16x32_bf16 v[140:143], v[16:19], v[232:235], 0
    v_mfma_f32_16x16x32_bf16 v[144:147], v[40:43], v[232:235], 0
    ds_read_b128 v[232:235], v7 offset:39936
    s_waitcnt lgkmcnt(3)
    v_mfma_f32_16x16x32_bf16 v[140:143], v[20:23], v[236:239], v[140:143]
    v_mfma_f32_16x16x32_bf16 v[144:147], v[44:47], v[236:239], v[144:147]
    ds_read_b128 v[236:239], v7 offset:49152
    s_waitcnt lgkmcnt(3)
    v_mfma_f32_16x16x32_bf16 v[140:143], v[24:27], v[224:227], v[140:143]
    v_mfma_f32_16x16x32_bf16 v[144:147], v[48:51], v[224:227], v[144:147]
    ds_read_b128 v[224:227], v7 offset:4096
    s_waitcnt lgkmcnt(3)
    v_mfma_f32_16x16x32_bf16 v[140:143], v[28:31], v[228:231], v[140:143]
    v_mfma_f32_16x16x32_bf16 v[144:147], v[52:55], v[228:231], v[144:147]
    ds_read_b128 v[228:231], v7 offset:13312
    s_waitcnt lgkmcnt(3)
    v_mfma_f32_16x16x32_bf16 v[140:143], v[32:35], v[232:235], v[140:143]
    v_mfma_f32_16x16x32_bf16 v[144:147], v[56:59], v[232:235], v[144:147]
    ds_read_b128 v[232:235], v7 offset:22528
    s_waitcnt lgkmcnt(3)
    v_mfma_f32_16x16x32_bf16 v[140:143], v[36:39], v[236:239], v[140:143]
    v_mfma_f32_16x16x32_bf16 v[144:147], v[60:63], v[236:239], v[144:147]
    ds_read_b128 v[236:239], v7 offset:31744
    s_waitcnt lgkmcnt(3)
    v_mfma_f32_16x16x32_bf16 v[148:151], v[16:19], v[224:227], 0
    v_mfma_f32_16x16x32_bf16 v[152:155], v[40:43], v[224:227], 0
    ds_read_b128 v[224:227], v7 offset:40960
    s_waitcnt lgkmcnt(3)
    v_mfma_f32_16x16x32_bf16 v[148:151], v[20:23], v[228:231], v[148:151]
    v_mfma_f32_16x16x32_bf16 v[152:155], v[44:47], v[228:231], v[152:155]
    ds_read_b128 v[228:231], v7 offset:50176
    s_waitcnt lgkmcnt(3)
    v_mfma_f32_16x16x32_bf16 v[148:151], v[24:27], v[232:235], v[148:151]
    v_mfma_f32_16x16x32_bf16 v[152:155], v[48:51], v[232:235], v[152:155]
    ds_read_b128 v[232:235], v7 offset:5120
    s_waitcnt lgkmcnt(3)
    v_mfma_f32_16x16x32_bf16 v[148:151], v[28:31], v[236:239], v[148:151]
    v_mfma_f32_16x16x32_bf16 v[152:155], v[52:55], v[236:239], v[152:155]
    ds_read_b128 v[236:239], v7 offset:14336
    s_waitcnt lgkmcnt(3)
    v_mfma_f32_16x16x32_bf16 v[148:151], v[32:35], v[224:227], v[148:151]
    v_mfma_f32_16x16x32_bf16 v[152:155], v[56:59], v[224:227], v[152:155]
    ds_read_b128 v[224:227], v7 offset:23552
    s_waitcnt lgkmcnt(3)
    v_mfma_f32_16x16x32_bf16 v[148:151], v[36:39], v[228:231], v[148:151]
    v_mfma_f32_16x16x32_bf16 v[152:155], v[60:63], v[228:231], v[152:155]
    ds_read_b128 v[228:231], v7 offset:32768
    s_waitcnt lgkmcnt(3)
    v_mfma_f32_16x16x32_bf16 v[156:159], v[16:19], v[232:235], 0
    v_mfma_f32_16x16x32_bf16 v[160:163], v[40:43], v[232:235], 0
    ds_read_b128 v[232:235], v7 offset:41984
    s_waitcnt lgkmcnt(3)
    v_mfma_f32_16x16x32_bf16 v[156:159], v[20:23], v[236:239], v[156:159]
    v_mfma_f32_16x16x32_bf16 v[160:163], v[44:47], v[236:239], v[160:163]
    ds_read_b128 v[236:239], v7 offset:51200
    s_waitcnt lgkmcnt(3)
    v_mfma_f32_16x16x32_bf16 v[156:159], v[24:27], v[224:227], v[156:159]
    v_mfma_f32_16x16x32_bf16 v[160:163], v[48:51], v[224:227], v[160:163]
    ds_read_b128 v[224:227], v7 offset:6144
    s_waitcnt lgkmcnt(3)
    v_mfma_f32_16x16x32_bf16 v[156:159], v[28:31], v[228:231], v[156:159]
    v_mfma_f32_16x16x32_bf16 v[160:163], v[52:55], v[228:231], v[160:163]
    ds_read_b128 v[228:231], v7 offset:15360
    s_waitcnt lgkmcnt(3)
    v_mfma_f32_16x16x32_bf16 v[156:159], v[32:35], v[232:235], v[156:159]
    v_mfma_f32_16x16x32_bf16 v[160:163], v[56:59], v[232:235], v[160:163]
    ds_read_b128 v[232:235], v7 offset:24576
    s_waitcnt lgkmcnt(3)
    v_mfma_f32_16x16x32_bf16 v[156:159], v[36:39], v[236:239], v[156:159]
    v_mfma_f32_16x16x32_bf16 v[160:163], v[60:63], v[236:239], v[160:163]
    ds_read_b128 v[236:239], v7 offset:33792
    s_waitcnt lgkmcnt(3)
    v_mfma_f32_16x16x32_bf16 v[164:167], v[16:19], v[224:227], 0
    v_mfma_f32_16x16x32_bf16 v[168:171], v[40:43], v[224:227], 0
    ds_read_b128 v[224:227], v7 offset:43008
    s_waitcnt lgkmcnt(3)
    v_mfma_f32_16x16x32_bf16 v[164:167], v[20:23], v[228:231], v[164:167]
    v_mfma_f32_16x16x32_bf16 v[168:171], v[44:47], v[228:231], v[168:171]
    ds_read_b128 v[228:231], v7 offset:52224
    s_waitcnt lgkmcnt(3)
    v_mfma_f32_16x16x32_bf16 v[164:167], v[24:27], v[232:235], v[164:167]
    v_mfma_f32_16x16x32_bf16 v[168:171], v[48:51], v[232:235], v[168:171]
    ds_read_b128 v[232:235], v7 offset:7168
    s_waitcnt lgkmcnt(3)
    v_mfma_f32_16x16x32_bf16 v[164:167], v[28:31], v[236:239], v[164:167]
    v_mfma_f32_16x16x32_bf16 v[168:171], v[52:55], v[236:239], v[168:171]
    ds_read_b128 v[236:239], v7 offset:16384
    s_waitcnt lgkmcnt(3)
    v_mfma_f32_16x16x32_bf16 v[164:167], v[32:35], v[224:227], v[164:167]
    v_mfma_f32_16x16x32_bf16 v[168:171], v[56:59], v[224:227], v[168:171]
    ds_read_b128 v[224:227], v7 offset:25600
    s_waitcnt lgkmcnt(3)
    v_mfma_f32_16x16x32_bf16 v[164:167], v[36:39], v[228:231], v[164:167]
    v_mfma_f32_16x16x32_bf16 v[168:171], v[60:63], v[228:231], v[168:171]
    ds_read_b128 v[228:231], v7 offset:34816
    s_waitcnt lgkmcnt(3)
    v_mfma_f32_16x16x32_bf16 v[172:175], v[16:19], v[232:235], 0
    v_mfma_f32_16x16x32_bf16 v[176:179], v[40:43], v[232:235], 0
    ds_read_b128 v[232:235], v7 offset:44032
    s_waitcnt lgkmcnt(3)
    v_mfma_f32_16x16x32_bf16 v[172:175], v[20:23], v[236:239], v[172:175]
    v_mfma_f32_16x16x32_bf16 v[176:179], v[44:47], v[236:239], v[176:179]
    ds_read_b128 v[236:239], v7 offset:53248
    s_waitcnt lgkmcnt(3)
    v_mfma_f32_16x16x32_bf16 v[172:175], v[24:27], v[224:227], v[172:175]
    v_mfma_f32_16x16x32_bf16 v[176:179], v[48:51], v[224:227], v[176:179]
    ds_read_b128 v[224:227], v7 offset:8192
    s_waitcnt lgkmcnt(3)
    v_mfma_f32_16x16x32_bf16 v[172:175], v[28:31], v[228:231], v[172:175]
    v_mfma_f32_16x16x32_bf16 v[176:179], v[52:55], v[228:231], v[176:179]
    ds_read_b128 v[228:231], v7 offset:17408
    s_waitcnt lgkmcnt(3)
    v_mfma_f32_16x16x32_bf16 v[172:175], v[32:35], v[232:235], v[172:175]
    v_mfma_f32_16x16x32_bf16 v[176:179], v[56:59], v[232:235], v[176:179]
    ds_read_b128 v[232:235], v7 offset:26624
    s_waitcnt lgkmcnt(3)
    v_mfma_f32_16x16x32_bf16 v[172:175], v[36:39], v[236:239], v[172:175]
    v_mfma_f32_16x16x32_bf16 v[176:179], v[60:63], v[236:239], v[176:179]
    ds_read_b128 v[236:239], v7 offset:35840
    s_waitcnt lgkmcnt(3)
    v_mfma_f32_16x16x32_bf16 v[180:183], v[16:19], v[224:227], 0
    v_mfma_f32_16x16x32_bf16 v[184:187], v[40:43], v[224:227], 0
    ds_read_b128 v[224:227], v7 offset:45056
    s_waitcnt lgkmcnt(3)
    v_mfma_f32_16x16x32_bf16 v[180:183], v[20:23], v[228:231], v[180:183]
    v_mfma_f32_16x16x32_bf16 v[184:187], v[44:47], v[228:231], v[184:187]
    ds_read_b128 v[228:231], v7 offset:54272
    s_waitcnt lgkmcnt(3)
    v_mfma_f32_16x16x32_bf16 v[180:183], v[24:27], v[232:235], v[180:183]
    v_mfma_f32_16x16x32_bf16 v[184:187], v[48:51], v[232:235], v[184:187]
    s_waitcnt lgkmcnt(2)
    v_mfma_f32_16x16x32_bf16 v[180:183], v[28:31], v[236:239], v[180:183]
    v_mfma_f32_16x16x32_bf16 v[184:187], v[52:55], v[236:239], v[184:187]
    s_waitcnt lgkmcnt(1)
    v_mfma_f32_16x16x32_bf16 v[180:183], v[32:35], v[224:227], v[180:183]
    v_mfma_f32_16x16x32_bf16 v[184:187], v[56:59], v[224:227], v[184:187]
    s_waitcnt lgkmcnt(0)
    v_mfma_f32_16x16x32_bf16 v[180:183], v[36:39], v[228:231], v[180:183]
    v_mfma_f32_16x16x32_bf16 v[184:187], v[60:63], v[228:231], v[184:187]
    v_xor_b32 v246, 32, v250
    v_xor_b32 v247, 32, v251
    s_waitcnt vmcnt(10)
    ds_read_b64 v[64:65], v250 offset:0
    ds_read_b64 v[66:67], v246 offset:0
    ds_read_b64 v[68:69], v251 offset:0
    ds_read_b64 v[70:71], v247 offset:0
    s_waitcnt vmcnt(8)
    ds_read_b64 v[88:89], v250 offset:6144
    ds_read_b64 v[90:91], v246 offset:6144
    ds_read_b64 v[92:93], v251 offset:6144
    ds_read_b64 v[94:95], v247 offset:6144
    s_waitcnt vmcnt(6)
    ds_read_b64 v[72:73], v250 offset:2048
    ds_read_b64 v[74:75], v246 offset:2048
    ds_read_b64 v[76:77], v251 offset:2048
    ds_read_b64 v[78:79], v247 offset:2048
    s_waitcnt vmcnt(4)
    ds_read_b64 v[96:97], v250 offset:8192
    ds_read_b64 v[98:99], v246 offset:8192
    ds_read_b64 v[100:101], v251 offset:8192
    ds_read_b64 v[102:103], v247 offset:8192
    s_waitcnt vmcnt(2)
    ds_read_b64 v[80:81], v250 offset:4096
    ds_read_b64 v[82:83], v246 offset:4096
    ds_read_b64 v[84:85], v251 offset:4096
    ds_read_b64 v[86:87], v247 offset:4096
    s_waitcnt vmcnt(0)
    ds_read_b64 v[104:105], v250 offset:10240
    ds_read_b64 v[106:107], v246 offset:10240
    ds_read_b64 v[108:109], v251 offset:10240
    ds_read_b64 v[110:111], v247 offset:10240
    s_waitcnt lgkmcnt(0)
    s_lshl_b32 s41, s49, 2
    s_add_u32 s41, s41, 154176
    v_mov_b32 v244, s41
    v_mov_b32 v245, 1
    ds_write_b32 v244, v245
    ds_read_b128 v[224:227], v7 offset:0
    ds_read_b128 v[228:231], v7 offset:9216
    ds_read_b128 v[232:235], v7 offset:18432
    ds_read_b128 v[236:239], v7 offset:27648
    s_waitcnt lgkmcnt(3)
    v_mfma_f32_16x16x32_bf16 v[16:19], v[64:67], v[224:227], 0
    v_mfma_f32_16x16x32_bf16 v[20:23], v[88:91], v[224:227], 0
    ds_read_b128 v[224:227], v7 offset:36864
    v_max3_f32 v212, v116, v117, v118
    s_waitcnt lgkmcnt(3)
    v_mfma_f32_16x16x32_bf16 v[16:19], v[68:71], v[228:231], v[16:19]
    v_mfma_f32_16x16x32_bf16 v[20:23], v[92:95], v[228:231], v[20:23]
    v_max3_f32 v212, v212, v119, v120
    ds_read_b128 v[228:231], v7 offset:46080
    s_waitcnt lgkmcnt(3)
    v_mfma_f32_16x16x32_bf16 v[16:19], v[72:75], v[232:235], v[16:19]
    v_max3_f32 v212, v212, v121, v122
    v_mfma_f32_16x16x32_bf16 v[20:23], v[96:99], v[232:235], v[20:23]
    ds_read_b128 v[232:235], v7 offset:1024
    v_max_f32 v212, v212, v123
    s_waitcnt lgkmcnt(3)
    v_mfma_f32_16x16x32_bf16 v[16:19], v[76:79], v[236:239], v[16:19]
    v_mfma_f32_16x16x32_bf16 v[20:23], v[100:103], v[236:239], v[20:23]
    v_max3_f32 v213, v124, v125, v126
    ds_read_b128 v[236:239], v7 offset:10240
    s_waitcnt lgkmcnt(3)
    v_mfma_f32_16x16x32_bf16 v[16:19], v[80:83], v[224:227], v[16:19]
    v_max3_f32 v213, v213, v127, v128
    v_mfma_f32_16x16x32_bf16 v[20:23], v[104:107], v[224:227], v[20:23]
    ds_read_b128 v[224:227], v7 offset:19456
    v_max3_f32 v213, v213, v129, v130
    s_waitcnt lgkmcnt(3)
    v_mfma_f32_16x16x32_bf16 v[16:19], v[84:87], v[228:231], v[16:19]
    v_mfma_f32_16x16x32_bf16 v[20:23], v[108:111], v[228:231], v[20:23]
    ds_read_b128 v[228:231], v7 offset:28672
    v_max_f32 v213, v213, v131
    s_waitcnt lgkmcnt(3)
    v_mfma_f32_16x16x32_bf16 v[24:27], v[64:67], v[232:235], 0
    v_mfma_f32_16x16x32_bf16 v[28:31], v[88:91], v[232:235], 0
    v_max3_f32 v214, v132, v133, v134
    ds_read_b128 v[232:235], v7 offset:37888
    s_waitcnt lgkmcnt(3)
    v_mfma_f32_16x16x32_bf16 v[24:27], v[68:71], v[236:239], v[24:27]
    v_max3_f32 v214, v214, v135, v136
    v_mfma_f32_16x16x32_bf16 v[28:31], v[92:95], v[236:239], v[28:31]
    ds_read_b128 v[236:239], v7 offset:47104
    v_max3_f32 v214, v214, v137, v138
    s_waitcnt lgkmcnt(3)
    v_mfma_f32_16x16x32_bf16 v[24:27], v[72:75], v[224:227], v[24:27]
    v_mfma_f32_16x16x32_bf16 v[28:31], v[96:99], v[224:227], v[28:31]
    v_max_f32 v214, v214, v139
    ds_read_b128 v[224:227], v7 offset:2048
    s_waitcnt lgkmcnt(3)
    v_mfma_f32_16x16x32_bf16 v[24:27], v[76:79], v[228:231], v[24:27]
    v_max3_f32 v215, v140, v141, v142
    v_mfma_f32_16x16x32_bf16 v[28:31], v[100:103], v[228:231], v[28:31]
    ds_read_b128 v[228:231], v7 offset:11264
    v_max3_f32 v215, v215, v143, v144
    s_waitcnt lgkmcnt(3)
    v_mfma_f32_16x16x32_bf16 v[24:27], v[80:83], v[232:235], v[24:27]
    v_mfma_f32_16x16x32_bf16 v[28:31], v[104:107], v[232:235], v[28:31]
    v_max3_f32 v215, v215, v145, v146
    ds_read_b128 v[232:235], v7 offset:20480
    s_waitcnt lgkmcnt(3)
    v_mfma_f32_16x16x32_bf16 v[24:27], v[84:87], v[236:239], v[24:27]
    v_max_f32 v215, v215, v147
    v_mfma_f32_16x16x32_bf16 v[28:31], v[108:111], v[236:239], v[28:31]
    ds_read_b128 v[236:239], v7 offset:29696
    s_waitcnt lgkmcnt(3)
    v_mfma_f32_16x16x32_bf16 v[32:35], v[64:67], v[224:227], 0
    v_max3_f32 v216, v148, v149, v150
    v_mfma_f32_16x16x32_bf16 v[36:39], v[88:91], v[224:227], 0
    ds_read_b128 v[224:227], v7 offset:38912
    v_max3_f32 v216, v216, v151, v152
    s_waitcnt lgkmcnt(3)
    v_mfma_f32_16x16x32_bf16 v[32:35], v[68:71], v[228:231], v[32:35]
    v_mfma_f32_16x16x32_bf16 v[36:39], v[92:95], v[228:231], v[36:39]
    v_max3_f32 v216, v216, v153, v154
    ds_read_b128 v[228:231], v7 offset:48128
    s_waitcnt lgkmcnt(3)
    v_mfma_f32_16x16x32_bf16 v[32:35], v[72:75], v[232:235], v[32:35]
    v_max_f32 v216, v216, v155
    v_mfma_f32_16x16x32_bf16 v[36:39], v[96:99], v[232:235], v[36:39]
    ds_read_b128 v[232:235], v7 offset:3072
    v_max3_f32 v217, v156, v157, v158
    s_waitcnt lgkmcnt(3)
    v_mfma_f32_16x16x32_bf16 v[32:35], v[76:79], v[236:239], v[32:35]
    v_mfma_f32_16x16x32_bf16 v[36:39], v[100:103], v[236:239], v[36:39]
    v_max3_f32 v217, v217, v159, v160
    ds_read_b128 v[236:239], v7 offset:12288
    s_waitcnt lgkmcnt(3)
    v_mfma_f32_16x16x32_bf16 v[32:35], v[80:83], v[224:227], v[32:35]
    v_max3_f32 v217, v217, v161, v162
    v_mfma_f32_16x16x32_bf16 v[36:39], v[104:107], v[224:227], v[36:39]
    ds_read_b128 v[224:227], v7 offset:21504
    v_max_f32 v217, v217, v163
    s_waitcnt lgkmcnt(3)
    v_mfma_f32_16x16x32_bf16 v[32:35], v[84:87], v[228:231], v[32:35]
    v_mfma_f32_16x16x32_bf16 v[36:39], v[108:111], v[228:231], v[36:39]
    ds_read_b128 v[228:231], v7 offset:30720
    v_max3_f32 v218, v164, v165, v166
    s_waitcnt lgkmcnt(3)
    v_mfma_f32_16x16x32_bf16 v[40:43], v[64:67], v[232:235], 0
    v_mfma_f32_16x16x32_bf16 v[44:47], v[88:91], v[232:235], 0
    v_max3_f32 v218, v218, v167, v168
    ds_read_b128 v[232:235], v7 offset:39936
    s_waitcnt lgkmcnt(3)
    v_mfma_f32_16x16x32_bf16 v[40:43], v[68:71], v[236:239], v[40:43]
    v_max3_f32 v218, v218, v169, v170
    v_mfma_f32_16x16x32_bf16 v[44:47], v[92:95], v[236:239], v[44:47]
    ds_read_b128 v[236:239], v7 offset:49152
    v_max_f32 v218, v218, v171
    s_waitcnt lgkmcnt(3)
    v_mfma_f32_16x16x32_bf16 v[40:43], v[72:75], v[224:227], v[40:43]
    v_mfma_f32_16x16x32_bf16 v[44:47], v[96:99], v[224:227], v[44:47]
    v_max3_f32 v219, v172, v173, v174
    ds_read_b128 v[224:227], v7 offset:4096
    s_waitcnt lgkmcnt(3)
    v_mfma_f32_16x16x32_bf16 v[40:43], v[76:79], v[228:231], v[40:43]
    v_max3_f32 v219, v219, v175, v176
    v_mfma_f32_16x16x32_bf16 v[44:47], v[100:103], v[228:231], v[44:47]
    ds_read_b128 v[228:231], v7 offset:13312
    v_max3_f32 v219, v219, v177, v178
    s_waitcnt lgkmcnt(3)
    v_mfma_f32_16x16x32_bf16 v[40:43], v[80:83], v[232:235], v[40:43]
    v_mfma_f32_16x16x32_bf16 v[44:47], v[104:107], v[232:235], v[44:47]
    v_max_f32 v219, v219, v179
    ds_read_b128 v[232:235], v7 offset:22528
    s_waitcnt lgkmcnt(3)
    v_mfma_f32_16x16x32_bf16 v[40:43], v[84:87], v[236:239], v[40:43]
    v_mfma_f32_16x16x32_bf16 v[44:47], v[108:111], v[236:239], v[44:47]
    v_max3_f32 v220, v180, v181, v182
    ds_read_b128 v[236:239], v7 offset:31744
    s_waitcnt lgkmcnt(3)
    v_mfma_f32_16x16x32_bf16 v[48:51], v[64:67], v[224:227], 0
    v_max3_f32 v220, v220, v183, v184
    v_mfma_f32_16x16x32_bf16 v[52:55], v[88:91], v[224:227], 0
    ds_read_b128 v[224:227], v7 offset:40960
    v_max3_f32 v220, v220, v185, v186
    s_waitcnt lgkmcnt(3)
    v_mfma_f32_16x16x32_bf16 v[48:51], v[68:71], v[228:231], v[48:51]
    v_mfma_f32_16x16x32_bf16 v[52:55], v[92:95], v[228:231], v[52:55]
    v_max_f32 v220, v220, v187
    ds_read_b128 v[228:231], v7 offset:50176
    s_waitcnt lgkmcnt(3)
    v_mfma_f32_16x16x32_bf16 v[48:51], v[72:75], v[232:235], v[48:51]
    v_max3_f32 v212, v212, v16, v17
    v_mfma_f32_16x16x32_bf16 v[52:55], v[96:99], v[232:235], v[52:55]
    ds_read_b128 v[232:235], v7 offset:5120
    v_max3_f32 v212, v212, v18, v19
    s_waitcnt lgkmcnt(3)
    v_mfma_f32_16x16x32_bf16 v[48:51], v[76:79], v[236:239], v[48:51]
    v_mfma_f32_16x16x32_bf16 v[52:55], v[100:103], v[236:239], v[52:55]
    v_max3_f32 v212, v212, v20, v21
    ds_read_b128 v[236:239], v7 offset:14336
    s_waitcnt lgkmcnt(3)
    v_mfma_f32_16x16x32_bf16 v[48:51], v[80:83], v[224:227], v[48:51]
    v_max3_f32 v212, v212, v22, v23
    v_mfma_f32_16x16x32_bf16 v[52:55], v[104:107], v[224:227], v[52:55]
    ds_read_b128 v[224:227], v7 offset:23552
    v_max3_f32 v213, v213, v24, v25
    s_waitcnt lgkmcnt(3)
    v_mfma_f32_16x16x32_bf16 v[48:51], v[84:87], v[228:231], v[48:51]
    v_mfma_f32_16x16x32_bf16 v[52:55], v[108:111], v[228:231], v[52:55]
    v_max3_f32 v213, v213, v26, v27
    ds_read_b128 v[228:231], v7 offset:32768
    s_waitcnt lgkmcnt(3)
    v_mfma_f32_16x16x32_bf16 v[56:59], v[64:67], v[232:235], 0
    v_max3_f32 v213, v213, v28, v29
    v_mfma_f32_16x16x32_bf16 v[60:63], v[88:91], v[232:235], 0
    ds_read_b128 v[232:235], v7 offset:41984
    v_max3_f32 v213, v213, v30, v31
    s_waitcnt lgkmcnt(3)
    v_mfma_f32_16x16x32_bf16 v[56:59], v[68:71], v[236:239], v[56:59]
    v_mfma_f32_16x16x32_bf16 v[60:63], v[92:95], v[236:239], v[60:63]
    v_max3_f32 v214, v214, v32, v33
    ds_read_b128 v[236:239], v7 offset:51200
    s_waitcnt lgkmcnt(3)
    v_mfma_f32_16x16x32_bf16 v[56:59], v[72:75], v[224:227], v[56:59]
    v_max3_f32 v214, v214, v34, v35
    v_mfma_f32_16x16x32_bf16 v[60:63], v[96:99], v[224:227], v[60:63]
    ds_read_b128 v[224:227], v7 offset:6144
    v_max3_f32 v214, v214, v36, v37
    s_waitcnt lgkmcnt(3)
    v_mfma_f32_16x16x32_bf16 v[56:59], v[76:79], v[228:231], v[56:59]
    v_mfma_f32_16x16x32_bf16 v[60:63], v[100:103], v[228:231], v[60:63]
    v_max3_f32 v214, v214, v38, v39
    ds_read_b128 v[228:231], v7 offset:15360
    s_waitcnt lgkmcnt(3)
    v_mfma_f32_16x16x32_bf16 v[56:59], v[80:83], v[232:235], v[56:59]
    v_max3_f32 v215, v215, v40, v41
    v_mfma_f32_16x16x32_bf16 v[60:63], v[104:107], v[232:235], v[60:63]
    ds_read_b128 v[232:235], v7 offset:24576
    v_max3_f32 v215, v215, v42, v43
    s_waitcnt lgkmcnt(3)
    v_mfma_f32_16x16x32_bf16 v[56:59], v[84:87], v[236:239], v[56:59]
    v_mfma_f32_16x16x32_bf16 v[60:63], v[108:111], v[236:239], v[60:63]
    v_max3_f32 v215, v215, v44, v45
    ds_read_b128 v[236:239], v7 offset:33792
    s_waitcnt lgkmcnt(3)
    v_mfma_f32_16x16x32_bf16 v[188:191], v[64:67], v[224:227], 0
    v_max3_f32 v215, v215, v46, v47
    v_mfma_f32_16x16x32_bf16 v[192:195], v[88:91], v[224:227], 0
    ds_read_b128 v[224:227], v7 offset:43008
    v_max3_f32 v216, v216, v48, v49
    s_waitcnt lgkmcnt(3)
    v_mfma_f32_16x16x32_bf16 v[188:191], v[68:71], v[228:231], v[188:191]
    v_mfma_f32_16x16x32_bf16 v[192:195], v[92:95], v[228:231], v[192:195]
    v_max3_f32 v216, v216, v50, v51
    ds_read_b128 v[228:231], v7 offset:52224
    s_waitcnt lgkmcnt(3)
    v_mfma_f32_16x16x32_bf16 v[188:191], v[72:75], v[232:235], v[188:191]
    v_max3_f32 v216, v216, v52, v53
    v_mfma_f32_16x16x32_bf16 v[192:195], v[96:99], v[232:235], v[192:195]
    ds_read_b128 v[232:235], v7 offset:7168
    v_max3_f32 v216, v216, v54, v55
    s_waitcnt lgkmcnt(3)
    v_mfma_f32_16x16x32_bf16 v[188:191], v[76:79], v[236:239], v[188:191]
    v_mfma_f32_16x16x32_bf16 v[192:195], v[100:103], v[236:239], v[192:195]
    v_max3_f32 v217, v217, v56, v57
    ds_read_b128 v[236:239], v7 offset:16384
    s_waitcnt lgkmcnt(3)
    v_mfma_f32_16x16x32_bf16 v[188:191], v[80:83], v[224:227], v[188:191]
    v_max3_f32 v217, v217, v58, v59
    v_mfma_f32_16x16x32_bf16 v[192:195], v[104:107], v[224:227], v[192:195]
    ds_read_b128 v[224:227], v7 offset:25600
    v_max3_f32 v217, v217, v60, v61
    s_waitcnt lgkmcnt(3)
    v_mfma_f32_16x16x32_bf16 v[188:191], v[84:87], v[228:231], v[188:191]
    v_mfma_f32_16x16x32_bf16 v[192:195], v[108:111], v[228:231], v[192:195]
    v_max3_f32 v217, v217, v62, v63
    ds_read_b128 v[228:231], v7 offset:34816
    s_waitcnt lgkmcnt(3)
    v_mfma_f32_16x16x32_bf16 v[196:199], v[64:67], v[232:235], 0
    v_mfma_f32_16x16x32_bf16 v[200:203], v[88:91], v[232:235], 0
    ds_read_b128 v[232:235], v7 offset:44032
    s_waitcnt lgkmcnt(3)
    v_mfma_f32_16x16x32_bf16 v[196:199], v[68:71], v[236:239], v[196:199]
    v_mfma_f32_16x16x32_bf16 v[200:203], v[92:95], v[236:239], v[200:203]
    ds_read_b128 v[236:239], v7 offset:53248
    v_max3_f32 v218, v218, v188, v189
    s_waitcnt lgkmcnt(3)
    v_mfma_f32_16x16x32_bf16 v[196:199], v[72:75], v[224:227], v[196:199]
    v_mfma_f32_16x16x32_bf16 v[200:203], v[96:99], v[224:227], v[200:203]
    v_max3_f32 v218, v218, v190, v191
    ds_read_b128 v[224:227], v7 offset:8192
    s_waitcnt lgkmcnt(3)
    v_mfma_f32_16x16x32_bf16 v[196:199], v[76:79], v[228:231], v[196:199]
    v_max3_f32 v218, v218, v192, v193
    v_mfma_f32_16x16x32_bf16 v[200:203], v[100:103], v[228:231], v[200:203]
    v_max3_f32 v218, v218, v194, v195
    ds_read_b128 v[228:231], v7 offset:17408
    s_waitcnt lgkmcnt(3)
    v_mfma_f32_16x16x32_bf16 v[196:199], v[80:83], v[232:235], v[196:199]
    v_mfma_f32_16x16x32_bf16 v[200:203], v[104:107], v[232:235], v[200:203]
    ds_read_b128 v[232:235], v7 offset:26624
    s_waitcnt lgkmcnt(3)
    v_mfma_f32_16x16x32_bf16 v[196:199], v[84:87], v[236:239], v[196:199]
    v_mfma_f32_16x16x32_bf16 v[200:203], v[108:111], v[236:239], v[200:203]
    ds_read_b128 v[236:239], v7 offset:35840
    s_waitcnt lgkmcnt(3)
    v_mfma_f32_16x16x32_bf16 v[204:207], v[64:67], v[224:227], 0
    v_mfma_f32_16x16x32_bf16 v[208:211], v[88:91], v[224:227], 0
    ds_read_b128 v[224:227], v7 offset:45056
    s_waitcnt lgkmcnt(3)
    v_mfma_f32_16x16x32_bf16 v[204:207], v[68:71], v[228:231], v[204:207]
    v_mfma_f32_16x16x32_bf16 v[208:211], v[92:95], v[228:231], v[208:211]
    ds_read_b128 v[228:231], v7 offset:54272
    v_max3_f32 v219, v219, v196, v197
    s_waitcnt lgkmcnt(3)
    v_mfma_f32_16x16x32_bf16 v[204:207], v[72:75], v[232:235], v[204:207]
    v_max3_f32 v219, v219, v198, v199
    v_mfma_f32_16x16x32_bf16 v[208:211], v[96:99], v[232:235], v[208:211]
    s_waitcnt lgkmcnt(2)
    v_mfma_f32_16x16x32_bf16 v[204:207], v[76:79], v[236:239], v[204:207]
    v_max3_f32 v219, v219, v200, v201
    v_mfma_f32_16x16x32_bf16 v[208:211], v[100:103], v[236:239], v[208:211]
    s_waitcnt lgkmcnt(1)
    v_mfma_f32_16x16x32_bf16 v[204:207], v[80:83], v[224:227], v[204:207]
    v_max3_f32 v219, v219, v202, v203
    v_mfma_f32_16x16x32_bf16 v[208:211], v[104:107], v[224:227], v[208:211]
    s_waitcnt lgkmcnt(0)
    v_mfma_f32_16x16x32_bf16 v[204:207], v[84:87], v[228:231], v[204:207]
    v_mfma_f32_16x16x32_bf16 v[208:211], v[108:111], v[228:231], v[208:211]
    s_nop 6
    v_max3_f32 v220, v220, v204, v205
    v_max3_f32 v220, v220, v206, v207
    v_max3_f32 v220, v220, v208, v209
    v_max3_f32 v220, v220, v210, v211
    ds_max_f32 v243, v212 offset:0
    ds_max_f32 v243, v213 offset:64
    ds_max_f32 v243, v214 offset:128
    ds_max_f32 v243, v215 offset:192
    ds_max_f32 v243, v216 offset:256
    ds_max_f32 v243, v217 offset:320
    ds_max_f32 v243, v218 offset:384
    ds_max_f32 v243, v219 offset:448
    ds_max_f32 v243, v220 offset:512
    s_waitcnt lgkmcnt(0)
    s_barrier
L_sm1:
    ds_read_b32 v212, v243 offset:0
    ds_read_b32 v213, v243 offset:64
    ds_read_b32 v214, v243 offset:128
    ds_read_b32 v215, v243 offset:192
    ds_read_b32 v216, v243 offset:256
    ds_read_b32 v217, v243 offset:320
    ds_read_b32 v218, v243 offset:384
    ds_read_b32 v219, v243 offset:448
    ds_read_b32 v220, v243 offset:512
    s_waitcnt lgkmcnt(8)
    v_mul_f32 v212, s44, v212
    s_waitcnt lgkmcnt(7)
    v_mul_f32 v213, s44, v213
    s_waitcnt lgkmcnt(6)
    v_mul_f32 v214, s44, v214
    s_waitcnt lgkmcnt(5)
    v_mul_f32 v215, s44, v215
    s_waitcnt lgkmcnt(4)
    v_mul_f32 v216, s44, v216
    s_waitcnt lgkmcnt(3)
    v_mul_f32 v217, s44, v217
    s_waitcnt lgkmcnt(2)
    v_mul_f32 v218, s44, v218
    s_waitcnt lgkmcnt(1)
    v_mul_f32 v219, s44, v219
    s_waitcnt lgkmcnt(0)
    v_mul_f32 v220, s44, v220
    s_andn2_b32 s42, s48, 4
    s_mul_i32 s42, s42, 30720
    s_mul_i32 s41, s53, 983040
    s_add_u32 s41, s41, s42
    v_lshl_add_u32 v64, v0, 4, s41
    v_pk_fma_f32 v[116:117], v[116:117], s[44:45], v[212:213] op_sel:[0,0,0] op_sel_hi:[1,0,0] neg_lo:[0,0,1] neg_hi:[0,0,1]
    v_pk_fma_f32 v[118:119], v[118:119], s[44:45], v[212:213] op_sel:[0,0,0] op_sel_hi:[1,0,0] neg_lo:[0,0,1] neg_hi:[0,0,1]
    v_pk_fma_f32 v[120:121], v[120:121], s[44:45], v[212:213] op_sel:[0,0,0] op_sel_hi:[1,0,0] neg_lo:[0,0,1] neg_hi:[0,0,1]
    v_pk_fma_f32 v[122:123], v[122:123], s[44:45], v[212:213] op_sel:[0,0,0] op_sel_hi:[1,0,0] neg_lo:[0,0,1] neg_hi:[0,0,1]
    v_exp_f32 v116, v116
    v_exp_f32 v117, v117
    v_exp_f32 v118, v118
    v_exp_f32 v119, v119
    v_exp_f32 v120, v120
    v_exp_f32 v121, v121
    v_exp_f32 v122, v122
    v_exp_f32 v123, v123
    v_pk_add_f32 v[244:245], v[116:117], v[118:119]
    v_pk_add_f32 v[246:247], v[120:121], v[122:123]
    v_cvt_pk_bf16_f32 v116, v116, v117
    v_cvt_pk_bf16_f32 v117, v118, v119
    v_cvt_pk_bf16_f32 v118, v120, v121
    v_cvt_pk_bf16_f32 v119, v122, v123
    v_pk_add_f32 v[222:223], v[244:245], v[246:247]
    v_pk_fma_f32 v[124:125], v[124:125], s[44:45], v[212:213] op_sel:[0,0,1] op_sel_hi:[1,0,1] neg_lo:[0,0,1] neg_hi:[0,0,1]
    v_pk_fma_f32 v[126:127], v[126:127], s[44:45], v[212:213] op_sel:[0,0,1] op_sel_hi:[1,0,1] neg_lo:[0,0,1] neg_hi:[0,0,1]
    v_pk_fma_f32 v[128:129], v[128:129], s[44:45], v[212:213] op_sel:[0,0,1] op_sel_hi:[1,0,1] neg_lo:[0,0,1] neg_hi:[0,0,1]
    v_pk_fma_f32 v[130:131], v[130:131], s[44:45], v[212:213] op_sel:[0,0,1] op_sel_hi:[1,0,1] neg_lo:[0,0,1] neg_hi:[0,0,1]
    v_exp_f32 v124, v124
    v_exp_f32 v125, v125
    v_exp_f32 v126, v126
    v_exp_f32 v127, v127
    v_exp_f32 v128, v128
    v_exp_f32 v129, v129
    v_exp_f32 v130, v130
    v_exp_f32 v131, v131
    v_pk_add_f32 v[244:245], v[124:125], v[126:127]
    v_pk_add_f32 v[246:247], v[128:129], v[130:131]
    v_cvt_pk_bf16_f32 v124, v124, v125
    v_cvt_pk_bf16_f32 v125, v126, v127
    v_cvt_pk_bf16_f32 v126, v128, v129
    s_cmp_eq_u32 s39, 0
    s_cbranch_scc0 L_ws31
    s_mov_b32 m0, 154240
    v_min_u32 v65, 7864304, v64
    global_load_lds_dwordx4 v65, s[14:15]
    v_add_u32 v64, 8192, v64
L_ws31:
    v_cvt_pk_bf16_f32 v127, v130, v131
    v_pk_add_f32 v[224:225], v[244:245], v[246:247]
    v_pk_fma_f32 v[132:133], v[132:133], s[44:45], v[214:215] op_sel:[0,0,0] op_sel_hi:[1,0,0] neg_lo:[0,0,1] neg_hi:[0,0,1]
    v_pk_fma_f32 v[134:135], v[134:135], s[44:45], v[214:215] op_sel:[0,0,0] op_sel_hi:[1,0,0] neg_lo:[0,0,1] neg_hi:[0,0,1]
    v_pk_fma_f32 v[136:137], v[136:137], s[44:45], v[214:215] op_sel:[0,0,0] op_sel_hi:[1,0,0] neg_lo:[0,0,1] neg_hi:[0,0,1]
    v_pk_fma_f32 v[138:139], v[138:139], s[44:45], v[214:215] op_sel:[0,0,0] op_sel_hi:[1,0,0] neg_lo:[0,0,1] neg_hi:[0,0,1]
    v_exp_f32 v132, v132
    v_exp_f32 v133, v133
    v_exp_f32 v134, v134
    v_exp_f32 v135, v135
    v_exp_f32 v136, v136
    v_exp_f32 v137, v137
    v_exp_f32 v138, v138
    v_exp_f32 v139, v139
    v_pk_add_f32 v[244:245], v[132:133], v[134:135]
    v_pk_add_f32 v[246:247], v[136:137], v[138:139]
    v_cvt_pk_bf16_f32 v132, v132, v133
    v_cvt_pk_bf16_f32 v133, v134, v135
    v_cvt_pk_bf16_f32 v134, v136, v137
    v_cvt_pk_bf16_f32 v135, v138, v139
    v_pk_add_f32 v[226:227], v[244:245], v[246:247]
    v_pk_fma_f32 v[140:141], v[140:141], s[44:45], v[214:215] op_sel:[0,0,1] op_sel_hi:[1,0,1] neg_lo:[0,0,1] neg_hi:[0,0,1]
    v_pk_fma_f32 v[142:143], v[142:143], s[44:45], v[214:215] op_sel:[0,0,1] op_sel_hi:[1,0,1] neg_lo:[0,0,1] neg_hi:[0,0,1]
    v_pk_fma_f32 v[144:145], v[144:145], s[44:45], v[214:215] op_sel:[0,0,1] op_sel_hi:[1,0,1] neg_lo:[0,0,1] neg_hi:[0,0,1]
    v_pk_fma_f32 v[146:147], v[146:147], s[44:45], v[214:215] op_sel:[0,0,1] op_sel_hi:[1,0,1] neg_lo:[0,0,1] neg_hi:[0,0,1]
    v_exp_f32 v140, v140
    v_exp_f32 v141, v141
    v_exp_f32 v142, v142
    v_exp_f32 v143, v143
    v_exp_f32 v144, v144
    v_exp_f32 v145, v145
    v_exp_f32 v146, v146
    v_exp_f32 v147, v147
    v_pk_add_f32 v[244:245], v[140:141], v[142:143]
    v_pk_add_f32 v[246:247], v[144:145], v[146:147]
    v_cvt_pk_bf16_f32 v140, v140, v141
    v_cvt_pk_bf16_f32 v141, v142, v143
    s_cmp_eq_u32 s39, 0
    s_cbranch_scc0 L_ws32
    s_mov_b32 m0, 154240
    v_min_u32 v65, 7864304, v64
    global_load_lds_dwordx4 v65, s[14:15]
    v_add_u32 v64, 8192, v64
L_ws32:
    v_cvt_pk_bf16_f32 v142, v144, v145
    v_cvt_pk_bf16_f32 v143, v146, v147
    v_pk_add_f32 v[228:229], v[244:245], v[246:247]
    v_pk_fma_f32 v[148:149], v[148:149], s[44:45], v[216:217] op_sel:[0,0,0] op_sel_hi:[1,0,0] neg_lo:[0,0,1] neg_hi:[0,0,1]
    v_pk_fma_f32 v[150:151], v[150:151], s[44:45], v[216:217] op_sel:[0,0,0] op_sel_hi:[1,0,0] neg_lo:[0,0,1] neg_hi:[0,0,1]
    v_pk_fma_f32 v[152:153], v[152:153], s[44:45], v[216:217] op_sel:[0,0,0] op_sel_hi:[1,0,0] neg_lo:[0,0,1] neg_hi:[0,0,1]
    v_pk_fma_f32 v[154:155], v[154:155], s[44:45], v[216:217] op_sel:[0,0,0] op_sel_hi:[1,0,0] neg_lo:[0,0,1] neg_hi:[0,0,1]
    v_exp_f32 v148, v148
    v_exp_f32 v149, v149
    v_exp_f32 v150, v150
    v_exp_f32 v151, v151
    v_exp_f32 v152, v152
    v_exp_f32 v153, v153
    v_exp_f32 v154, v154
    v_exp_f32 v155, v155
    v_pk_add_f32 v[244:245], v[148:149], v[150:151]
    v_pk_add_f32 v[246:247], v[152:153], v[154:155]
    v_cvt_pk_bf16_f32 v148, v148, v149
    v_cvt_pk_bf16_f32 v149, v150, v151
    v_cvt_pk_bf16_f32 v150, v152, v153
    v_cvt_pk_bf16_f32 v151, v154, v155
    v_pk_add_f32 v[230:231], v[244:245], v[246:247]
    v_pk_fma_f32 v[156:157], v[156:157], s[44:45], v[216:217] op_sel:[0,0,1] op_sel_hi:[1,0,1] neg_lo:[0,0,1] neg_hi:[0,0,1]
    v_pk_fma_f32 v[158:159], v[158:159], s[44:45], v[216:217] op_sel:[0,0,1] op_sel_hi:[1,0,1] neg_lo:[0,0,1] neg_hi:[0,0,1]
    v_pk_fma_f32 v[160:161], v[160:161], s[44:45], v[216:217] op_sel:[0,0,1] op_sel_hi:[1,0,1] neg_lo:[0,0,1] neg_hi:[0,0,1]
    v_pk_fma_f32 v[162:163], v[162:163], s[44:45], v[216:217] op_sel:[0,0,1] op_sel_hi:[1,0,1] neg_lo:[0,0,1] neg_hi:[0,0,1]
    v_exp_f32 v156, v156
    v_exp_f32 v157, v157
    v_exp_f32 v158, v158
    v_exp_f32 v159, v159
    v_exp_f32 v160, v160
    v_exp_f32 v161, v161
    v_exp_f32 v162, v162
    v_exp_f32 v163, v163
    v_pk_add_f32 v[244:245], v[156:157], v[158:159]
    v_pk_add_f32 v[246:247], v[160:161], v[162:163]
    v_cvt_pk_bf16_f32 v156, v156, v157
    s_cmp_eq_u32 s39, 0
    s_cbranch_scc0 L_ws33
    s_mov_b32 m0, 154240
    v_min_u32 v65, 7864304, v64
    global_load_lds_dwordx4 v65, s[14:15]
    v_add_u32 v64, 8192, v64
L_ws33:
    v_cvt_pk_bf16_f32 v157, v158, v159
    v_cvt_pk_bf16_f32 v158, v160, v161
    v_cvt_pk_bf16_f32 v159, v162, v163
    v_pk_add_f32 v[232:233], v[244:245], v[246:247]
    v_pk_fma_f32 v[164:165], v[164:165], s[44:45], v[218:219] op_sel:[0,0,0] op_sel_hi:[1,0,0] neg_lo:[0,0,1] neg_hi:[0,0,1]
    v_pk_fma_f32 v[166:167], v[166:167], s[44:45], v[218:219] op_sel:[0,0,0] op_sel_hi:[1,0,0] neg_lo:[0,0,1] neg_hi:[0,0,1]
    v_pk_fma_f32 v[168:169], v[168:169], s[44:45], v[218:219] op_sel:[0,0,0] op_sel_hi:[1,0,0] neg_lo:[0,0,1] neg_hi:[0,0,1]
    v_pk_fma_f32 v[170:171], v[170:171], s[44:45], v[218:219] op_sel:[0,0,0] op_sel_hi:[1,0,0] neg_lo:[0,0,1] neg_hi:[0,0,1]
    v_exp_f32 v164, v164
    v_exp_f32 v165, v165
    v_exp_f32 v166, v166
    v_exp_f32 v167, v167
    v_exp_f32 v168, v168
    v_exp_f32 v169, v169
    v_exp_f32 v170, v170
    v_exp_f32 v171, v171
    v_pk_add_f32 v[244:245], v[164:165], v[166:167]
    v_pk_add_f32 v[246:247], v[168:169], v[170:171]
    v_cvt_pk_bf16_f32 v164, v164, v165
    v_cvt_pk_bf16_f32 v165, v166, v167
    v_cvt_pk_bf16_f32 v166, v168, v169
    v_cvt_pk_bf16_f32 v167, v170, v171
    v_pk_add_f32 v[234:235], v[244:245], v[246:247]
    v_pk_fma_f32 v[172:173], v[172:173], s[44:45], v[218:219] op_sel:[0,0,1] op_sel_hi:[1,0,1] neg_lo:[0,0,1] neg_hi:[0,0,1]
    v_pk_fma_f32 v[174:175], v[174:175], s[44:45], v[218:219] op_sel:[0,0,1] op_sel_hi:[1,0,1] neg_lo:[0,0,1] neg_hi:[0,0,1]
    v_pk_fma_f32 v[176:177], v[176:177], s[44:45], v[218:219] op_sel:[0,0,1] op_sel_hi:[1,0,1] neg_lo:[0,0,1] neg_hi:[0,0,1]
    v_pk_fma_f32 v[178:179], v[178:179], s[44:45], v[218:219] op_sel:[0,0,1] op_sel_hi:[1,0,1] neg_lo:[0,0,1] neg_hi:[0,0,1]
    v_exp_f32 v172, v172
    v_exp_f32 v173, v173
    v_exp_f32 v174, v174
    v_exp_f32 v175, v175
    v_exp_f32 v176, v176
    v_exp_f32 v177, v177
    v_exp_f32 v178, v178
    v_exp_f32 v179, v179
    v_pk_add_f32 v[244:245], v[172:173], v[174:175]
    v_pk_add_f32 v[246:247], v[176:177], v[178:179]
    s_cmp_eq_u32 s39, 0
    s_cbranch_scc0 L_ws34
    s_mov_b32 m0, 154240
    v_min_u32 v65, 7864304, v64
    global_load_lds_dwordx4 v65, s[14:15]
    v_add_u32 v64, 98304, v64
L_ws34:
    v_cvt_pk_bf16_f32 v172, v172, v173
    v_cvt_pk_bf16_f32 v173, v174, v175
    v_cvt_pk_bf16_f32 v174, v176, v177
    v_cvt_pk_bf16_f32 v175, v178, v179
    v_pk_add_f32 v[236:237], v[244:245], v[246:247]
    v_pk_fma_f32 v[180:181], v[180:181], s[44:45], v[220:221] op_sel:[0,0,0] op_sel_hi:[1,0,0] neg_lo:[0,0,1] neg_hi:[0,0,1]
    v_pk_fma_f32 v[182:183], v[182:183], s[44:45], v[220:221] op_sel:[0,0,0] op_sel_hi:[1,0,0] neg_lo:[0,0,1] neg_hi:[0,0,1]
    v_pk_fma_f32 v[184:185], v[184:185], s[44:45], v[220:221] op_sel:[0,0,0] op_sel_hi:[1,0,0] neg_lo:[0,0,1] neg_hi:[0,0,1]
    v_pk_fma_f32 v[186:187], v[186:187], s[44:45], v[220:221] op_sel:[0,0,0] op_sel_hi:[1,0,0] neg_lo:[0,0,1] neg_hi:[0,0,1]
    v_exp_f32 v180, v180
    v_exp_f32 v181, v181
    v_exp_f32 v182, v182
    v_exp_f32 v183, v183
    v_exp_f32 v184, v184
    v_exp_f32 v185, v185
    v_exp_f32 v186, v186
    v_exp_f32 v187, v187
    v_pk_add_f32 v[244:245], v[180:181], v[182:183]
    v_pk_add_f32 v[246:247], v[184:185], v[186:187]
    v_cvt_pk_bf16_f32 v180, v180, v181
    v_cvt_pk_bf16_f32 v181, v182, v183
    v_cvt_pk_bf16_f32 v182, v184, v185
    v_cvt_pk_bf16_f32 v183, v186, v187
    v_pk_add_f32 v[238:239], v[244:245], v[246:247]
    v_pk_fma_f32 v[16:17], v[16:17], s[44:45], v[212:213] op_sel:[0,0,0] op_sel_hi:[1,0,0] neg_lo:[0,0,1] neg_hi:[0,0,1]
    v_pk_fma_f32 v[18:19], v[18:19], s[44:45], v[212:213] op_sel:[0,0,0] op_sel_hi:[1,0,0] neg_lo:[0,0,1] neg_hi:[0,0,1]
    v_pk_fma_f32 v[20:21], v[20:21], s[44:45], v[212:213] op_sel:[0,0,0] op_sel_hi:[1,0,0] neg_lo:[0,0,1] neg_hi:[0,0,1]
    v_pk_fma_f32 v[22:23], v[22:23], s[44:45], v[212:213] op_sel:[0,0,0] op_sel_hi:[1,0,0] neg_lo:[0,0,1] neg_hi:[0,0,1]
    v_exp_f32 v16, v16
    v_exp_f32 v17, v17
    v_exp_f32 v18, v18
    v_exp_f32 v19, v19
    v_exp_f32 v20, v20
    v_exp_f32 v21, v21
    v_exp_f32 v22, v22
    v_exp_f32 v23, v23
    v_pk_add_f32 v[244:245], v[16:17], v[18:19]
    v_pk_add_f32 v[246:247], v[20:21], v[22:23]
    s_cmp_eq_u32 s39, 0
    s_cbranch_scc0 L_ws35
    s_mov_b32 m0, 154240
    v_min_u32 v65, 7864304, v64
    global_load_lds_dwordx4 v65, s[14:15]
    v_add_u32 v64, 8192, v64
L_ws35:
    v_cvt_pk_bf16_f32 v16, v16, v17
    v_cvt_pk_bf16_f32 v17, v18, v19
    v_cvt_pk_bf16_f32 v18, v20, v21
    v_cvt_pk_bf16_f32 v19, v22, v23
    v_pk_add_f32 v[244:245], v[244:245], v[246:247]
    v_pk_add_f32 v[222:223], v[222:223], v[244:245]
    v_pk_fma_f32 v[24:25], v[24:25], s[44:45], v[212:213] op_sel:[0,0,1] op_sel_hi:[1,0,1] neg_lo:[0,0,1] neg_hi:[0,0,1]
    v_pk_fma_f32 v[26:27], v[26:27], s[44:45], v[212:213] op_sel:[0,0,1] op_sel_hi:[1,0,1] neg_lo:[0,0,1] neg_hi:[0,0,1]
    v_pk_fma_f32 v[28:29], v[28:29], s[44:45], v[212:213] op_sel:[0,0,1] op_sel_hi:[1,0,1] neg_lo:[0,0,1] neg_hi:[0,0,1]
    v_pk_fma_f32 v[30:31], v[30:31], s[44:45], v[212:213] op_sel:[0,0,1] op_sel_hi:[1,0,1] neg_lo:[0,0,1] neg_hi:[0,0,1]
    v_exp_f32 v24, v24
    v_exp_f32 v25, v25
    v_exp_f32 v26, v26
    v_exp_f32 v27, v27
    v_exp_f32 v28, v28
    v_exp_f32 v29, v29
    v_exp_f32 v30, v30
    v_exp_f32 v31, v31
    v_pk_add_f32 v[244:245], v[24:25], v[26:27]
    v_pk_add_f32 v[246:247], v[28:29], v[30:31]
    v_cvt_pk_bf16_f32 v24, v24, v25
    v_cvt_pk_bf16_f32 v25, v26, v27
    v_cvt_pk_bf16_f32 v26, v28, v29
    v_cvt_pk_bf16_f32 v27, v30, v31
    v_pk_add_f32 v[244:245], v[244:245], v[246:247]
    v_pk_add_f32 v[224:225], v[224:225], v[244:245]
    v_pk_fma_f32 v[32:33], v[32:33], s[44:45], v[214:215] op_sel:[0,0,0] op_sel_hi:[1,0,0] neg_lo:[0,0,1] neg_hi:[0,0,1]
    v_pk_fma_f32 v[34:35], v[34:35], s[44:45], v[214:215] op_sel:[0,0,0] op_sel_hi:[1,0,0] neg_lo:[0,0,1] neg_hi:[0,0,1]
    v_pk_fma_f32 v[36:37], v[36:37], s[44:45], v[214:215] op_sel:[0,0,0] op_sel_hi:[1,0,0] neg_lo:[0,0,1] neg_hi:[0,0,1]
    v_pk_fma_f32 v[38:39], v[38:39], s[44:45], v[214:215] op_sel:[0,0,0] op_sel_hi:[1,0,0] neg_lo:[0,0,1] neg_hi:[0,0,1]
    v_exp_f32 v32, v32
    v_exp_f32 v33, v33
    v_exp_f32 v34, v34
    v_exp_f32 v35, v35
    v_exp_f32 v36, v36
    v_exp_f32 v37, v37
    v_exp_f32 v38, v38
    s_cmp_eq_u32 s39, 0
    s_cbranch_scc0 L_ws36
    s_mov_b32 m0, 154240
    v_min_u32 v65, 7864304, v64
    global_load_lds_dwordx4 v65, s[14:15]
    v_add_u32 v64, 8192, v64
L_ws36:
    v_exp_f32 v39, v39
    v_pk_add_f32 v[244:245], v[32:33], v[34:35]
    v_pk_add_f32 v[246:247], v[36:37], v[38:39]
    v_cvt_pk_bf16_f32 v32, v32, v33
    v_cvt_pk_bf16_f32 v33, v34, v35
    v_cvt_pk_bf16_f32 v34, v36, v37
    v_cvt_pk_bf16_f32 v35, v38, v39
    v_pk_add_f32 v[244:245], v[244:245], v[246:247]
    v_pk_add_f32 v[226:227], v[226:227], v[244:245]
    v_pk_fma_f32 v[40:41], v[40:41], s[44:45], v[214:215] op_sel:[0,0,1] op_sel_hi:[1,0,1] neg_lo:[0,0,1] neg_hi:[0,0,1]
    v_pk_fma_f32 v[42:43], v[42:43], s[44:45], v[214:215] op_sel:[0,0,1] op_sel_hi:[1,0,1] neg_lo:[0,0,1] neg_hi:[0,0,1]
    v_pk_fma_f32 v[44:45], v[44:45], s[44:45], v[214:215] op_sel:[0,0,1] op_sel_hi:[1,0,1] neg_lo:[0,0,1] neg_hi:[0,0,1]
    v_pk_fma_f32 v[46:47], v[46:47], s[44:45], v[214:215] op_sel:[0,0,1] op_sel_hi:[1,0,1] neg_lo:[0,0,1] neg_hi:[0,0,1]
    v_exp_f32 v40, v40
    v_exp_f32 v41, v41
    v_exp_f32 v42, v42
    v_exp_f32 v43, v43
    v_exp_f32 v44, v44
    v_exp_f32 v45, v45
    v_exp_f32 v46, v46
    v_exp_f32 v47, v47
    v_pk_add_f32 v[244:245], v[40:41], v[42:43]
    v_pk_add_f32 v[246:247], v[44:45], v[46:47]
    v_cvt_pk_bf16_f32 v40, v40, v41
    v_cvt_pk_bf16_f32 v41, v42, v43
    v_cvt_pk_bf16_f32 v42, v44, v45
    v_cvt_pk_bf16_f32 v43, v46, v47
    v_pk_add_f32 v[244:245], v[244:245], v[246:247]
    v_pk_add_f32 v[228:229], v[228:229], v[244:245]
    v_pk_fma_f32 v[48:49], v[48:49], s[44:45], v[216:217] op_sel:[0,0,0] op_sel_hi:[1,0,0] neg_lo:[0,0,1] neg_hi:[0,0,1]
    v_pk_fma_f32 v[50:51], v[50:51], s[44:45], v[216:217] op_sel:[0,0,0] op_sel_hi:[1,0,0] neg_lo:[0,0,1] neg_hi:[0,0,1]
    v_pk_fma_f32 v[52:53], v[52:53], s[44:45], v[216:217] op_sel:[0,0,0] op_sel_hi:[1,0,0] neg_lo:[0,0,1] neg_hi:[0,0,1]
    v_pk_fma_f32 v[54:55], v[54:55], s[44:45], v[216:217] op_sel:[0,0,0] op_sel_hi:[1,0,0] neg_lo:[0,0,1] neg_hi:[0,0,1]
    v_exp_f32 v48, v48
    v_exp_f32 v49, v49
    v_exp_f32 v50, v50
    v_exp_f32 v51, v51
    s_cmp_eq_u32 s39, 0
    s_cbranch_scc0 L_ws37
    s_mov_b32 m0, 154240
    v_min_u32 v65, 7864304, v64
    global_load_lds_dwordx4 v65, s[14:15]
    v_add_u32 v64, 8192, v64
L_ws37:
    v_exp_f32 v52, v52
    v_exp_f32 v53, v53
    v_exp_f32 v54, v54
    v_exp_f32 v55, v55
    v_pk_add_f32 v[244:245], v[48:49], v[50:51]
    v_pk_add_f32 v[246:247], v[52:53], v[54:55]
    v_cvt_pk_bf16_f32 v48, v48, v49
    v_cvt_pk_bf16_f32 v49, v50, v51
    v_cvt_pk_bf16_f32 v50, v52, v53
    v_cvt_pk_bf16_f32 v51, v54, v55
    v_pk_add_f32 v[244:245], v[244:245], v[246:247]
    v_pk_add_f32 v[230:231], v[230:231], v[244:245]
    v_pk_fma_f32 v[56:57], v[56:57], s[44:45], v[216:217] op_sel:[0,0,1] op_sel_hi:[1,0,1] neg_lo:[0,0,1] neg_hi:[0,0,1]
    v_pk_fma_f32 v[58:59], v[58:59], s[44:45], v[216:217] op_sel:[0,0,1] op_sel_hi:[1,0,1] neg_lo:[0,0,1] neg_hi:[0,0,1]
    v_pk_fma_f32 v[60:61], v[60:61], s[44:45], v[216:217] op_sel:[0,0,1] op_sel_hi:[1,0,1] neg_lo:[0,0,1] neg_hi:[0,0,1]
    v_pk_fma_f32 v[62:63], v[62:63], s[44:45], v[216:217] op_sel:[0,0,1] op_sel_hi:[1,0,1] neg_lo:[0,0,1] neg_hi:[0,0,1]
    v_exp_f32 v56, v56
    v_exp_f32 v57, v57
    v_exp_f32 v58, v58
    v_exp_f32 v59, v59
    v_exp_f32 v60, v60
    v_exp_f32 v61, v61
    v_exp_f32 v62, v62
    v_exp_f32 v63, v63
    v_pk_add_f32 v[244:245], v[56:57], v[58:59]
    v_pk_add_f32 v[246:247], v[60:61], v[62:63]
    v_cvt_pk_bf16_f32 v56, v56, v57
    v_cvt_pk_bf16_f32 v57, v58, v59
    v_cvt_pk_bf16_f32 v58, v60, v61
    v_cvt_pk_bf16_f32 v59, v62, v63
    v_pk_add_f32 v[244:245], v[244:245], v[246:247]
    v_pk_add_f32 v[232:233], v[232:233], v[244:245]
    v_pk_fma_f32 v[188:189], v[188:189], s[44:45], v[218:219] op_sel:[0,0,0] op_sel_hi:[1,0,0] neg_lo:[0,0,1] neg_hi:[0,0,1]
    v_pk_fma_f32 v[190:191], v[190:191], s[44:45], v[218:219] op_sel:[0,0,0] op_sel_hi:[1,0,0] neg_lo:[0,0,1] neg_hi:[0,0,1]
    v_pk_fma_f32 v[192:193], v[192:193], s[44:45], v[218:219] op_sel:[0,0,0] op_sel_hi:[1,0,0] neg_lo:[0,0,1] neg_hi:[0,0,1]
    v_pk_fma_f32 v[194:195], v[194:195], s[44:45], v[218:219] op_sel:[0,0,0] op_sel_hi:[1,0,0] neg_lo:[0,0,1] neg_hi:[0,0,1]
    v_exp_f32 v188, v188
    v_exp_f32 v189, v189
    s_cmp_eq_u32 s39, 0
    s_cbranch_scc0 L_ws38
    s_mov_b32 m0, 154240
    v_min_u32 v65, 7864304, v64
    global_load_lds_dwordx4 v65, s[14:15]
    v_add_u32 v64, 8192, v64
L_ws38:
    v_exp_f32 v190, v190
    v_exp_f32 v191, v191
    v_exp_f32 v192, v192
    v_exp_f32 v193, v193
    v_exp_f32 v194, v194
    v_exp_f32 v195, v195
    v_pk_add_f32 v[244:245], v[188:189], v[190:191]
    v_pk_add_f32 v[246:247], v[192:193], v[194:195]
    v_cvt_pk_bf16_f32 v188, v188, v189
    v_cvt_pk_bf16_f32 v189, v190, v191
    v_cvt_pk_bf16_f32 v190, v192, v193
    v_cvt_pk_bf16_f32 v191, v194, v195
    v_pk_add_f32 v[244:245], v[244:245], v[246:247]
    v_pk_add_f32 v[234:235], v[234:235], v[244:245]
    v_pk_fma_f32 v[196:197], v[196:197], s[44:45], v[218:219] op_sel:[0,0,1] op_sel_hi:[1,0,1] neg_lo:[0,0,1] neg_hi:[0,0,1]
    v_pk_fma_f32 v[198:199], v[198:199], s[44:45], v[218:219] op_sel:[0,0,1] op_sel_hi:[1,0,1] neg_lo:[0,0,1] neg_hi:[0,0,1]
    v_pk_fma_f32 v[200:201], v[200:201], s[44:45], v[218:219] op_sel:[0,0,1] op_sel_hi:[1,0,1] neg_lo:[0,0,1] neg_hi:[0,0,1]
    v_pk_fma_f32 v[202:203], v[202:203], s[44:45], v[218:219] op_sel:[0,0,1] op_sel_hi:[1,0,1] neg_lo:[0,0,1] neg_hi:[0,0,1]
    v_exp_f32 v196, v196
    v_exp_f32 v197, v197
    v_exp_f32 v198, v198
    v_exp_f32 v199, v199
    v_exp_f32 v200, v200
    v_exp_f32 v201, v201
    v_exp_f32 v202, v202
    v_exp_f32 v203, v203
    v_pk_add_f32 v[244:245], v[196:197], v[198:199]
    v_pk_add_f32 v[246:247], v[200:201], v[202:203]
    v_cvt_pk_bf16_f32 v196, v196, v197
    v_cvt_pk_bf16_f32 v197, v198, v199
    v_cvt_pk_bf16_f32 v198, v200, v201
    v_cvt_pk_bf16_f32 v199, v202, v203
    v_pk_add_f32 v[244:245], v[244:245], v[246:247]
    v_pk_add_f32 v[236:237], v[236:237], v[244:245]
    v_pk_fma_f32 v[204:205], v[204:205], s[44:45], v[220:221] op_sel:[0,0,0] op_sel_hi:[1,0,0] neg_lo:[0,0,1] neg_hi:[0,0,1]
    v_pk_fma_f32 v[206:207], v[206:207], s[44:45], v[220:221] op_sel:[0,0,0] op_sel_hi:[1,0,0] neg_lo:[0,0,1] neg_hi:[0,0,1]
    v_pk_fma_f32 v[208:209], v[208:209], s[44:45], v[220:221] op_sel:[0,0,0] op_sel_hi:[1,0,0] neg_lo:[0,0,1] neg_hi:[0,0,1]
    v_pk_fma_f32 v[210:211], v[210:211], s[44:45], v[220:221] op_sel:[0,0,0] op_sel_hi:[1,0,0] neg_lo:[0,0,1] neg_hi:[0,0,1]
    v_exp_f32 v204, v204
    v_exp_f32 v205, v205
    v_exp_f32 v206, v206
    v_exp_f32 v207, v207
    v_exp_f32 v208, v208
    v_exp_f32 v209, v209
    v_exp_f32 v210, v210
    v_exp_f32 v211, v211
    v_pk_add_f32 v[244:245], v[204:205], v[206:207]
    v_pk_add_f32 v[246:247], v[208:209], v[210:211]
    v_cvt_pk_bf16_f32 v204, v204, v205
    v_cvt_pk_bf16_f32 v205, v206, v207
    v_cvt_pk_bf16_f32 v206, v208, v209
    v_cvt_pk_bf16_f32 v207, v210, v211
    v_pk_add_f32 v[244:245], v[244:245], v[246:247]
    v_pk_add_f32 v[238:239], v[238:239], v[244:245]
    s_barrier
    ds_read_b64_tr_b16 v[200:201], v12 offset:24576
    ds_read_b64_tr_b16 v[202:203], v12 offset:30720
    ds_read_b128 v[64:67], v240 offset:0
    ds_read_b64_tr_b16 v[192:193], v13 offset:24576
    ds_read_b64_tr_b16 v[194:195], v13 offset:30720
    ds_read_b64_tr_b16 v[60:61], v14 offset:24576
    ds_read_b64_tr_b16 v[62:63], v14 offset:30720
    ds_read_b128 v[68:71], v240 offset:1024
    ds_read_b128 v[72:75], v240 offset:2048
    ds_read_b128 v[76:79], v240 offset:3072
    s_waitcnt lgkmcnt(7)
    v_mfma_f32_16x16x32_bf16 v[120:123], v[200:203], v[64:67], 0
    ds_read_b64_tr_b16 v[104:105], v12 offset:36864
    ds_read_b64_tr_b16 v[106:107], v12 offset:43008
    s_waitcnt lgkmcnt(7)
    v_mfma_f32_16x16x32_bf16 v[128:131], v[192:195], v[64:67], 0
    ds_read_b128 v[84:87], v240 offset:9216
    s_waitcnt lgkmcnt(6)
    v_mfma_f32_16x16x32_bf16 v[136:139], v[60:63], v[64:67], 0
    ds_read_b64_tr_b16 v[108:109], v13 offset:36864
    ds_read_b64_tr_b16 v[110:111], v13 offset:43008
    s_waitcnt lgkmcnt(7)
    v_mfma_f32_16x16x32_bf16 v[144:147], v[200:203], v[68:71], 0
    ds_read_b64_tr_b16 v[112:113], v14 offset:36864
    v_mfma_f32_16x16x32_bf16 v[152:155], v[192:195], v[68:71], 0
    ds_read_b64_tr_b16 v[114:115], v14 offset:43008
    v_mfma_f32_16x16x32_bf16 v[160:163], v[60:63], v[68:71], 0
    ds_read_b128 v[88:91], v240 offset:10240
    ds_read_b128 v[92:95], v240 offset:11264
    s_waitcnt lgkmcnt(10)
    v_mfma_f32_16x16x32_bf16 v[168:171], v[200:203], v[72:75], 0
    ds_read_b128 v[96:99], v240 offset:12288
    v_mfma_f32_16x16x32_bf16 v[176:179], v[192:195], v[72:75], 0
    v_mfma_f32_16x16x32_bf16 v[184:187], v[60:63], v[72:75], 0
    s_waitcnt lgkmcnt(10)
    v_mfma_f32_16x16x32_bf16 v[100:103], v[200:203], v[76:79], 0
    v_mfma_f32_16x16x32_bf16 v[80:83], v[192:195], v[76:79], 0
    v_mfma_f32_16x16x32_bf16 v[208:211], v[60:63], v[76:79], 0
    s_waitcnt lgkmcnt(0)
    s_barrier
    v_mfma_f32_16x16x32_bf16 v[120:123], v[104:107], v[84:87], v[120:123]
    s_add_u32 m0, s37, 129024
    s_mov_b32 s40, 12288
    buffer_load_dwordx4 v6, s[28:31], s40 offen offset:0 nt lds
    ds_read_b64_tr_b16 v[200:201], v9 offset:24576
    ds_read_b64_tr_b16 v[202:203], v9 offset:30720
    ds_write_b128 v242, v[116:119] offset:0
    v_mfma_f32_16x16x32_bf16 v[128:131], v[108:111], v[84:87], v[128:131]
    s_add_u32 m0, s37, 129920
    s_mov_b32 s40, 12288
    buffer_load_dwordx4 v6, s[28:31], s40 offen offset:128 nt lds
    ds_read_b128 v[64:67], v240 offset:18432
    v_mfma_f32_16x16x32_bf16 v[136:139], v[112:115], v[84:87], v[136:139]
    ds_read_b64_tr_b16 v[192:193], v10 offset:24576
    ds_write_b128 v242, v[124:127] offset:1024
    v_mfma_f32_16x16x32_bf16 v[144:147], v[104:107], v[88:91], v[144:147]
    s_add_u32 m0, s37, 130816
    s_mov_b32 s40, 12288
    buffer_load_dwordx4 v6, s[28:31], s40 offen offset:256 nt lds
    ds_read_b64_tr_b16 v[194:195], v10 offset:30720
    v_mfma_f32_16x16x32_bf16 v[152:155], v[108:111], v[88:91], v[152:155]
    ds_read_b64_tr_b16 v[60:61], v11 offset:24576
    ds_write_b128 v242, v[132:135] offset:2048
    v_mfma_f32_16x16x32_bf16 v[160:163], v[112:115], v[88:91], v[160:163]
    ds_read_b64_tr_b16 v[62:63], v11 offset:30720
    ds_read_b128 v[68:71], v240 offset:19456
    v_mfma_f32_16x16x32_bf16 v[168:171], v[104:107], v[92:95], v[168:171]
    ds_read_b128 v[72:75], v240 offset:20480
    v_mfma_f32_16x16x32_bf16 v[176:179], v[108:111], v[92:95], v[176:179]
    ds_read_b128 v[76:79], v240 offset:21504
    ds_write_b128 v242, v[140:143] offset:3072
    v_mfma_f32_16x16x32_bf16 v[184:187], v[112:115], v[92:95], v[184:187]
    v_mfma_f32_16x16x32_bf16 v[100:103], v[104:107], v[96:99], v[100:103]
    ds_write_b128 v242, v[148:151] offset:4096
    v_mfma_f32_16x16x32_bf16 v[80:83], v[108:111], v[96:99], v[80:83]
    v_mfma_f32_16x16x32_bf16 v[208:211], v[112:115], v[96:99], v[208:211]
    s_waitcnt lgkmcnt(0)
    v_mfma_f32_16x16x32_bf16 v[120:123], v[200:203], v[64:67], v[120:123]
    ds_read_b64_tr_b16 v[104:105], v9 offset:36864
    ds_read_b64_tr_b16 v[106:107], v9 offset:43008
    ds_write_b128 v242, v[156:159] offset:5120
    v_mfma_f32_16x16x32_bf16 v[128:131], v[192:195], v[64:67], v[128:131]
    ds_read_b128 v[84:87], v240 offset:27648
    v_mfma_f32_16x16x32_bf16 v[136:139], v[60:63], v[64:67], v[136:139]
    ds_read_b64_tr_b16 v[108:109], v10 offset:36864
    ds_read_b64_tr_b16 v[110:111], v10 offset:43008
    ds_write_b128 v242, v[164:167] offset:6144
    v_mfma_f32_16x16x32_bf16 v[144:147], v[200:203], v[68:71], v[144:147]
    ds_read_b64_tr_b16 v[112:113], v11 offset:36864
    v_mfma_f32_16x16x32_bf16 v[152:155], v[192:195], v[68:71], v[152:155]
    ds_read_b64_tr_b16 v[114:115], v11 offset:43008
    v_mfma_f32_16x16x32_bf16 v[160:163], v[60:63], v[68:71], v[160:163]
    ds_read_b128 v[88:91], v240 offset:28672
    ds_read_b128 v[92:95], v240 offset:29696
    ds_write_b128 v242, v[172:175] offset:7168
    v_mfma_f32_16x16x32_bf16 v[168:171], v[200:203], v[72:75], v[168:171]
    ds_read_b128 v[96:99], v240 offset:30720
    v_mfma_f32_16x16x32_bf16 v[176:179], v[192:195], v[72:75], v[176:179]
    v_mfma_f32_16x16x32_bf16 v[184:187], v[60:63], v[72:75], v[184:187]
    ds_write_b128 v242, v[180:183] offset:8192
    v_mfma_f32_16x16x32_bf16 v[100:103], v[200:203], v[76:79], v[100:103]
    v_mfma_f32_16x16x32_bf16 v[80:83], v[192:195], v[76:79], v[80:83]
    v_mfma_f32_16x16x32_bf16 v[208:211], v[60:63], v[76:79], v[208:211]
    s_waitcnt lgkmcnt(0)
    s_barrier
    v_mfma_f32_16x16x32_bf16 v[120:123], v[104:107], v[84:87], v[120:123]
    s_add_u32 m0, s37, 79872
    s_mov_b32 s40, 61440
    buffer_load_dwordx4 v6, s[28:31], s40 offen offset:0 nt lds
    ds_read_b64_tr_b16 v[200:201], v12 offset:0
    ds_read_b64_tr_b16 v[202:203], v12 offset:6144
    s_lshl_b32 s41, s52, 5
    s_lshl_b32 s42, s53, 2
    s_add_u32 s41, s41, s42
    s_mul_i32 s41, s41, 55296
    s_add_u32 s16, s12, s41
    s_addc_u32 s17, s13, 0
    s_mov_b32 s18, 221184
    s_mov_b32 s19, 0x20000
    s_mov_b32 s89, 18432
    s_mul_i32 s43, s49, 5120
    s_cmp_eq_u32 s49, 3
    s_cselect_b32 s43, 14336, s43
    v_mfma_f32_16x16x32_bf16 v[128:131], v[108:111], v[84:87], v[128:131]
    s_add_u32 m0, s37, 80768
    s_mov_b32 s40, 61440
    buffer_load_dwordx4 v6, s[28:31], s40 offen offset:128 nt lds
    ds_read_b128 v[64:67], v240 offset:36864
    v_lshlrev_b32 v252, 4, v1
    v_add_u32 v252, s43, v252
    v_add_u32 v2, 0, v252
    v_add_u32 v3, 1024, v252
    v_add_u32 v4, 2048, v252
    v_add_u32 v5, 3072, v252
    v_add_u32 v7, 4096, v252
    s_and_b32 s100, s36, 1
    s_lshl_b32 s100, s100, 1
    s_add_u32 s100, s100, 6
    v_mfma_f32_16x16x32_bf16 v[136:139], v[112:115], v[84:87], v[136:139]
    ds_read_b64_tr_b16 v[192:193], v13 offset:0
    s_bfe_u32 s99, s36, 0x10001
    s_xor_b32 s99, s99, 1
    s_mul_i32 s99, s99, 5
    s_mov_b32 s81, 0
    s_mov_b32 s82, 18432
    s_mov_b32 s83, 36864
    s_mul_i32 s98, s49, 5120
    s_add_u32 s98, s43, 0
    s_add_u32 s41, s47, 0
    s_and_b32 s41, s41, 3
    v_mfma_f32_16x16x32_bf16 v[144:147], v[104:107], v[88:91], v[144:147]
    s_add_u32 m0, s37, 81664
    s_mov_b32 s40, 61440
    buffer_load_dwordx4 v6, s[28:31], s40 offen offset:256 nt lds
    ds_read_b64_tr_b16 v[194:195], v13 offset:6144
    s_mul_i32 s94, s41, 55296
    s_add_u32 s41, s47, 1
    s_and_b32 s41, s41, 3
    s_mul_i32 s95, s41, 55296
    s_add_u32 s41, s47, 2
    s_and_b32 s41, s41, 3
    s_mul_i32 s96, s41, 55296
    s_add_u32 s41, s47, 3
    s_and_b32 s41, s41, 3
    s_mul_i32 s97, s41, 55296
    v_mfma_f32_16x16x32_bf16 v[152:155], v[108:111], v[88:91], v[152:155]
    ds_read_b64_tr_b16 v[60:61], v14 offset:0
    v_lshrrev_b32 v252, 2, v1
    v_mul_u32_u24 v252, 320, v252
    v_and_b32 v253, 3, v1
    v_lshl_add_u32 v252, v253, 3, v252
    v_add_u32 v252, 79872, v252
    v_bfe_u32 v253, v1, 4, 1
    s_add_u32 s42, s100, 0
    v_xor_b32 v244, s42, v253
    v_lshl_add_u32 v248, v244, 5, v252
    s_add_u32 s42, s100, 1
    v_mfma_f32_16x16x32_bf16 v[160:163], v[112:115], v[88:91], v[160:163]
    ds_read_b64_tr_b16 v[62:63], v14 offset:6144
    ds_read_b128 v[68:71], v240 offset:37888
    v_xor_b32 v244, s42, v253
    v_lshl_add_u32 v249, v244, 5, v252
    s_lshl_b32 s41, s99, 10
    s_add_u32 s41, s41, 0
    v_lshl_add_u32 v251, v1, 4, s41
    s_lshl_b32 s41, s49, 2
    s_lshr_b32 s41, 42560, s41
    s_and_b32 s41, s41, 15
    s_lshl_b32 s42, s41, 1
    s_and_b32 s42, s42, 0x1c
    v_mfma_f32_16x16x32_bf16 v[168:171], v[104:107], v[92:95], v[168:171]
    ds_read_b128 v[72:75], v240 offset:38912
    s_lshr_b32 s42, 0x352140, s42
    s_and_b32 s42, s42, 15
    s_mul_i32 s43, s42, 9216
    v_add_u32 v254, s43, v240
    s_and_b32 s41, s41, 1
    s_lshl_b32 s42, s42, 1
    s_add_u32 s41, s41, s42
    s_lshr_b32 s42, s41, 2
    s_mul_i32 s42, s42, 20480
    s_bfe_u32 s43, s41, 0x10001
    v_mfma_f32_16x16x32_bf16 v[176:179], v[108:111], v[92:95], v[176:179]
    ds_read_b128 v[76:79], v240 offset:39936
    s_mul_i32 s43, s43, 9216
    s_add_u32 s42, s42, s43
    s_and_b32 s41, s41, 1
    s_lshl_b32 s41, s41, 3
    s_add_u32 s41, s41, s42
    s_add_u32 s41, s41, 0
    v_add_u32 v8, s41, v240
    s_lshl_b32 s41, s49, 2
    s_lshr_b32 s41, 38962, s41
    s_and_b32 s41, s41, 15
    v_mfma_f32_16x16x32_bf16 v[184:187], v[112:115], v[92:95], v[184:187]
    s_lshl_b32 s42, s41, 1
    s_and_b32 s42, s42, 0x1c
    s_lshr_b32 s42, 0x352140, s42
    s_and_b32 s42, s42, 15
    s_and_b32 s41, s41, 1
    s_lshl_b32 s42, s42, 1
    s_add_u32 s41, s41, s42
    s_lshr_b32 s42, s41, 2
    s_mul_i32 s42, s42, 20480
    s_bfe_u32 s43, s41, 0x10001
    v_mfma_f32_16x16x32_bf16 v[100:103], v[104:107], v[96:99], v[100:103]
    s_mul_i32 s43, s43, 9216
    s_add_u32 s42, s42, s43
    s_and_b32 s41, s41, 1
    s_lshl_b32 s41, s41, 3
    s_add_u32 s41, s41, s42
    s_add_u32 s41, s41, 0
    v_add_u32 v255, s41, v240
    s_lshl_b32 s41, s52, 3
    s_add_u32 s41, s41, s53
    s_lshl_b32 s41, s41, 7
    v_mfma_f32_16x16x32_bf16 v[80:83], v[108:111], v[96:99], v[80:83]
    s_add_u32 s41, s41, 29364224
    s_add_u32 s90, s12, s41
    s_addc_u32 s91, s13, 0
    s_lshl_b32 s41, s48, 7
    s_add_u32 s41, s41, 29376512
    s_add_u32 s92, s12, s41
    s_addc_u32 s93, s13, 0
    s_mul_i32 s41, s48, 376832
    s_add_u32 s41, s41, 16777216
    s_add_u32 s24, s12, s41
    s_addc_u32 s25, s13, 0
    s_mov_b32 s26, 376832
    s_mov_b32 s27, 0x20000
    v_mfma_f32_16x16x32_bf16 v[208:211], v[112:115], v[96:99], v[208:211]
    s_mul_i32 s42, s53, 47104
    s_add_u32 s41, s41, s42
    s_add_u32 s20, s12, s41
    s_addc_u32 s21, s13, 0
    s_mov_b32 s22, 47104
    s_mov_b32 s23, 0x20000
    s_mov_b32 s84, s54
    s_mov_b32 s85, s55
    s_mov_b32 s86, 1474560
    s_mov_b32 s87, 0x20000
    s_waitcnt lgkmcnt(0)
    v_mfma_f32_16x16x32_bf16 v[120:123], v[200:203], v[64:67], v[120:123]
    ds_read_b64_tr_b16 v[104:105], v12 offset:12288
    ds_read_b64_tr_b16 v[106:107], v12 offset:18432
    v_mfma_f32_16x16x32_bf16 v[128:131], v[192:195], v[64:67], v[128:131]
    ds_read_b128 v[84:87], v240 offset:46080
    v_mfma_f32_16x16x32_bf16 v[136:139], v[60:63], v[64:67], v[136:139]
    ds_read_b64_tr_b16 v[108:109], v13 offset:12288
    ds_read_b64_tr_b16 v[110:111], v13 offset:18432
    v_mfma_f32_16x16x32_bf16 v[144:147], v[200:203], v[68:71], v[144:147]
    ds_read_b64_tr_b16 v[112:113], v14 offset:12288
    v_mfma_f32_16x16x32_bf16 v[152:155], v[192:195], v[68:71], v[152:155]
    ds_read_b64_tr_b16 v[114:115], v14 offset:18432
    v_mfma_f32_16x16x32_bf16 v[160:163], v[60:63], v[68:71], v[160:163]
    ds_read_b128 v[88:91], v240 offset:47104
    ds_read_b128 v[92:95], v240 offset:48128
    v_mfma_f32_16x16x32_bf16 v[168:171], v[200:203], v[72:75], v[168:171]
    ds_read_b128 v[96:99], v240 offset:49152
    v_mfma_f32_16x16x32_bf16 v[176:179], v[192:195], v[72:75], v[176:179]
    v_mfma_f32_16x16x32_bf16 v[184:187], v[60:63], v[72:75], v[184:187]
    v_mfma_f32_16x16x32_bf16 v[100:103], v[200:203], v[76:79], v[100:103]
    v_mfma_f32_16x16x32_bf16 v[80:83], v[192:195], v[76:79], v[80:83]
    v_mfma_f32_16x16x32_bf16 v[208:211], v[60:63], v[76:79], v[208:211]
    s_waitcnt lgkmcnt(0)
    s_barrier
    v_mfma_f32_16x16x32_bf16 v[120:123], v[104:107], v[84:87], v[120:123]
    s_add_u32 m0, s37, 104448
    s_mov_b32 s40, 110592
    buffer_load_dwordx4 v6, s[28:31], s40 offen offset:0 nt lds
    ds_read_b64_tr_b16 v[200:201], v9 offset:0
    ds_read_b64_tr_b16 v[202:203], v9 offset:6144
    v_mfma_f32_16x16x32_bf16 v[128:131], v[108:111], v[84:87], v[128:131]
    s_add_u32 m0, s37, 105344
    s_mov_b32 s40, 110592
    buffer_load_dwordx4 v6, s[28:31], s40 offen offset:128 nt lds
    ds_read_b128 v[64:67], v240 offset:0
    v_mfma_f32_16x16x32_bf16 v[136:139], v[112:115], v[84:87], v[136:139]
    ds_read_b64_tr_b16 v[192:193], v10 offset:0
    v_mfma_f32_16x16x32_bf16 v[144:147], v[104:107], v[88:91], v[144:147]
    s_add_u32 m0, s37, 106240
    s_mov_b32 s40, 110592
    buffer_load_dwordx4 v6, s[28:31], s40 offen offset:256 nt lds
    ds_read_b64_tr_b16 v[194:195], v10 offset:6144
    v_mfma_f32_16x16x32_bf16 v[152:155], v[108:111], v[88:91], v[152:155]
    ds_read_b64_tr_b16 v[60:61], v11 offset:0
    v_mfma_f32_16x16x32_bf16 v[160:163], v[112:115], v[88:91], v[160:163]
    ds_read_b64_tr_b16 v[62:63], v11 offset:6144
    ds_read_b128 v[68:71], v240 offset:1024
    v_mfma_f32_16x16x32_bf16 v[168:171], v[104:107], v[92:95], v[168:171]
    ds_read_b128 v[72:75], v240 offset:2048
    v_mfma_f32_16x16x32_bf16 v[176:179], v[108:111], v[92:95], v[176:179]
    ds_read_b128 v[76:79], v240 offset:3072
    v_mfma_f32_16x16x32_bf16 v[184:187], v[112:115], v[92:95], v[184:187]
    v_mfma_f32_16x16x32_bf16 v[100:103], v[104:107], v[96:99], v[100:103]
    v_mfma_f32_16x16x32_bf16 v[80:83], v[108:111], v[96:99], v[80:83]
    v_mfma_f32_16x16x32_bf16 v[208:211], v[112:115], v[96:99], v[208:211]
    s_waitcnt lgkmcnt(0)
    v_mfma_f32_16x16x32_bf16 v[120:123], v[200:203], v[64:67], v[120:123]
    ds_read_b64_tr_b16 v[104:105], v9 offset:12288
    ds_read_b64_tr_b16 v[106:107], v9 offset:18432
    v_mfma_f32_16x16x32_bf16 v[128:131], v[192:195], v[64:67], v[128:131]
    ds_read_b128 v[84:87], v240 offset:9216
    v_mfma_f32_16x16x32_bf16 v[136:139], v[60:63], v[64:67], v[136:139]
    ds_read_b64_tr_b16 v[108:109], v10 offset:12288
    ds_read_b64_tr_b16 v[110:111], v10 offset:18432
    v_mfma_f32_16x16x32_bf16 v[144:147], v[200:203], v[68:71], v[144:147]
    ds_read_b64_tr_b16 v[112:113], v11 offset:12288
    v_mfma_f32_16x16x32_bf16 v[152:155], v[192:195], v[68:71], v[152:155]
    ds_read_b64_tr_b16 v[114:115], v11 offset:18432
    v_mfma_f32_16x16x32_bf16 v[160:163], v[60:63], v[68:71], v[160:163]
    ds_read_b128 v[88:91], v240 offset:10240
    ds_read_b128 v[92:95], v240 offset:11264
    v_mfma_f32_16x16x32_bf16 v[168:171], v[200:203], v[72:75], v[168:171]
    ds_read_b128 v[96:99], v240 offset:12288
    v_mfma_f32_16x16x32_bf16 v[176:179], v[192:195], v[72:75], v[176:179]
    v_mfma_f32_16x16x32_bf16 v[184:187], v[60:63], v[72:75], v[184:187]
    v_mfma_f32_16x16x32_bf16 v[100:103], v[200:203], v[76:79], v[100:103]
    v_mfma_f32_16x16x32_bf16 v[80:83], v[192:195], v[76:79], v[80:83]
    v_mfma_f32_16x16x32_bf16 v[208:211], v[60:63], v[76:79], v[208:211]
    s_waitcnt vmcnt(6) lgkmcnt(0)
    s_barrier
    v_mfma_f32_16x16x32_bf16 v[120:123], v[104:107], v[84:87], v[120:123]
    s_add_u32 m0, s37, 55296
    s_mov_b32 s40, 159744
    buffer_load_dwordx4 v6, s[28:31], s40 offen offset:0 nt lds
    ds_read_b64_tr_b16 v[200:201], v12 offset:24576
    ds_read_b64_tr_b16 v[202:203], v12 offset:30720
    v_mfma_f32_16x16x32_bf16 v[128:131], v[108:111], v[84:87], v[128:131]
    s_add_u32 m0, s37, 56192
    s_mov_b32 s40, 159744
    buffer_load_dwordx4 v6, s[28:31], s40 offen offset:128 nt lds
    ds_read_b128 v[64:67], v240 offset:18432
    v_mfma_f32_16x16x32_bf16 v[136:139], v[112:115], v[84:87], v[136:139]
    ds_read_b64_tr_b16 v[192:193], v13 offset:24576
    v_mfma_f32_16x16x32_bf16 v[144:147], v[104:107], v[88:91], v[144:147]
    s_add_u32 m0, s37, 57088
    s_mov_b32 s40, 159744
    buffer_load_dwordx4 v6, s[28:31], s40 offen offset:256 nt lds
    ds_read_b64_tr_b16 v[194:195], v13 offset:30720
    v_mfma_f32_16x16x32_bf16 v[152:155], v[108:111], v[88:91], v[152:155]
    ds_read_b64_tr_b16 v[60:61], v14 offset:24576
    v_mfma_f32_16x16x32_bf16 v[160:163], v[112:115], v[88:91], v[160:163]
    ds_read_b64_tr_b16 v[62:63], v14 offset:30720
    ds_read_b128 v[68:71], v240 offset:19456
    v_mfma_f32_16x16x32_bf16 v[168:171], v[104:107], v[92:95], v[168:171]
    ds_read_b128 v[72:75], v240 offset:20480
    v_mfma_f32_16x16x32_bf16 v[176:179], v[108:111], v[92:95], v[176:179]
    ds_read_b128 v[76:79], v240 offset:21504
    v_mfma_f32_16x16x32_bf16 v[184:187], v[112:115], v[92:95], v[184:187]
    v_mfma_f32_16x16x32_bf16 v[100:103], v[104:107], v[96:99], v[100:103]
    v_mfma_f32_16x16x32_bf16 v[80:83], v[108:111], v[96:99], v[80:83]
    v_mfma_f32_16x16x32_bf16 v[208:211], v[112:115], v[96:99], v[208:211]
    s_waitcnt lgkmcnt(0)
    v_mfma_f32_16x16x32_bf16 v[120:123], v[200:203], v[64:67], v[120:123]
    ds_read_b64_tr_b16 v[104:105], v12 offset:36864
    ds_read_b64_tr_b16 v[106:107], v12 offset:43008
    v_mfma_f32_16x16x32_bf16 v[128:131], v[192:195], v[64:67], v[128:131]
    ds_read_b128 v[84:87], v240 offset:27648
    v_mfma_f32_16x16x32_bf16 v[136:139], v[60:63], v[64:67], v[136:139]
    ds_read_b64_tr_b16 v[108:109], v13 offset:36864
    ds_read_b64_tr_b16 v[110:111], v13 offset:43008
    v_mfma_f32_16x16x32_bf16 v[144:147], v[200:203], v[68:71], v[144:147]
    ds_read_b64_tr_b16 v[112:113], v14 offset:36864
    v_mfma_f32_16x16x32_bf16 v[152:155], v[192:195], v[68:71], v[152:155]
    ds_read_b64_tr_b16 v[114:115], v14 offset:43008
    v_mfma_f32_16x16x32_bf16 v[160:163], v[60:63], v[68:71], v[160:163]
    ds_read_b128 v[88:91], v240 offset:28672
    ds_read_b128 v[92:95], v240 offset:29696
    v_mfma_f32_16x16x32_bf16 v[168:171], v[200:203], v[72:75], v[168:171]
    ds_read_b128 v[96:99], v240 offset:30720
    v_mfma_f32_16x16x32_bf16 v[176:179], v[192:195], v[72:75], v[176:179]
    v_mfma_f32_16x16x32_bf16 v[184:187], v[60:63], v[72:75], v[184:187]
    v_mfma_f32_16x16x32_bf16 v[100:103], v[200:203], v[76:79], v[100:103]
    v_mfma_f32_16x16x32_bf16 v[80:83], v[192:195], v[76:79], v[80:83]
    v_mfma_f32_16x16x32_bf16 v[208:211], v[60:63], v[76:79], v[208:211]
    s_waitcnt vmcnt(6) lgkmcnt(0)
    s_barrier
    v_mfma_f32_16x16x32_bf16 v[120:123], v[104:107], v[84:87], v[120:123]
    ds_read_b64_tr_b16 v[200:201], v9 offset:24576
    ds_read_b64_tr_b16 v[202:203], v9 offset:30720
    ds_write_b128 v241, v[48:51] offset:4096
    v_mfma_f32_16x16x32_bf16 v[128:131], v[108:111], v[84:87], v[128:131]
    ds_read_b128 v[64:67], v240 offset:36864
    v_mfma_f32_16x16x32_bf16 v[136:139], v[112:115], v[84:87], v[136:139]
    ds_read_b64_tr_b16 v[192:193], v10 offset:24576
    ds_write_b128 v241, v[56:59] offset:5120
    v_mfma_f32_16x16x32_bf16 v[144:147], v[104:107], v[88:91], v[144:147]
    ds_read_b64_tr_b16 v[194:195], v10 offset:30720
    v_mfma_f32_16x16x32_bf16 v[152:155], v[108:111], v[88:91], v[152:155]
    ds_read_b64_tr_b16 v[60:61], v11 offset:24576
    ds_write_b128 v241, v[188:191] offset:6144
    v_mfma_f32_16x16x32_bf16 v[160:163], v[112:115], v[88:91], v[160:163]
    ds_read_b64_tr_b16 v[62:63], v11 offset:30720
    ds_read_b128 v[68:71], v240 offset:37888
    v_mfma_f32_16x16x32_bf16 v[168:171], v[104:107], v[92:95], v[168:171]
    ds_read_b128 v[72:75], v240 offset:38912
    v_mfma_f32_16x16x32_bf16 v[176:179], v[108:111], v[92:95], v[176:179]
    ds_read_b128 v[76:79], v240 offset:39936
    ds_write_b128 v241, v[196:199] offset:7168
    v_mfma_f32_16x16x32_bf16 v[184:187], v[112:115], v[92:95], v[184:187]
    v_mfma_f32_16x16x32_bf16 v[100:103], v[104:107], v[96:99], v[100:103]
    ds_write_b128 v241, v[204:207] offset:8192
    v_mfma_f32_16x16x32_bf16 v[80:83], v[108:111], v[96:99], v[80:83]
    v_mfma_f32_16x16x32_bf16 v[208:211], v[112:115], v[96:99], v[208:211]
    s_waitcnt lgkmcnt(0)
    v_mfma_f32_16x16x32_bf16 v[120:123], v[200:203], v[64:67], v[120:123]
    ds_read_b64_tr_b16 v[104:105], v9 offset:36864
    ds_read_b64_tr_b16 v[106:107], v9 offset:43008
    ds_write_b128 v241, v[16:19] offset:0
    v_mfma_f32_16x16x32_bf16 v[128:131], v[192:195], v[64:67], v[128:131]
    ds_read_b128 v[84:87], v240 offset:46080
    v_mfma_f32_16x16x32_bf16 v[136:139], v[60:63], v[64:67], v[136:139]
    ds_read_b64_tr_b16 v[108:109], v10 offset:36864
    ds_read_b64_tr_b16 v[110:111], v10 offset:43008
    ds_write_b128 v241, v[24:27] offset:1024
    v_mfma_f32_16x16x32_bf16 v[144:147], v[200:203], v[68:71], v[144:147]
    ds_read_b64_tr_b16 v[112:113], v11 offset:36864
    v_mfma_f32_16x16x32_bf16 v[152:155], v[192:195], v[68:71], v[152:155]
    ds_read_b64_tr_b16 v[114:115], v11 offset:43008
    v_mfma_f32_16x16x32_bf16 v[160:163], v[60:63], v[68:71], v[160:163]
    ds_read_b128 v[88:91], v240 offset:47104
    ds_read_b128 v[92:95], v240 offset:48128
    ds_write_b128 v241, v[32:35] offset:2048
    v_mfma_f32_16x16x32_bf16 v[168:171], v[200:203], v[72:75], v[168:171]
    ds_read_b128 v[96:99], v240 offset:49152
    v_mfma_f32_16x16x32_bf16 v[176:179], v[192:195], v[72:75], v[176:179]
    v_mfma_f32_16x16x32_bf16 v[184:187], v[60:63], v[72:75], v[184:187]
    ds_write_b128 v241, v[40:43] offset:3072
    v_mfma_f32_16x16x32_bf16 v[100:103], v[200:203], v[76:79], v[100:103]
    v_mfma_f32_16x16x32_bf16 v[80:83], v[192:195], v[76:79], v[80:83]
    v_mfma_f32_16x16x32_bf16 v[208:211], v[60:63], v[76:79], v[208:211]
    s_waitcnt vmcnt(3) lgkmcnt(0)
    s_barrier
    v_mfma_f32_16x16x32_bf16 v[120:123], v[104:107], v[84:87], v[120:123]
    ds_read_b64_tr_b16 v[200:201], v12 offset:0
    ds_read_b64_tr_b16 v[202:203], v12 offset:6144
    v_add_f32 v221, v222, v223
    v_add_f32 v222, v224, v225
    v_add_f32 v223, v226, v227
    v_add_f32 v224, v228, v229
    v_mfma_f32_16x16x32_bf16 v[128:131], v[108:111], v[84:87], v[128:131]
    ds_read_b128 v[64:67], v240 offset:0
    v_add_f32 v225, v230, v231
    v_add_f32 v226, v232, v233
    v_add_f32 v227, v234, v235
    v_mfma_f32_16x16x32_bf16 v[136:139], v[112:115], v[84:87], v[136:139]
    ds_read_b64_tr_b16 v[192:193], v13 offset:0
    v_add_f32 v228, v236, v237
    v_add_f32 v229, v238, v239
    v_mov_b32 v212, 0
    v_mov_b32 v213, 0
    v_mfma_f32_16x16x32_bf16 v[144:147], v[104:107], v[88:91], v[144:147]
    ds_read_b64_tr_b16 v[194:195], v13 offset:6144
    v_bfe_u32 v246, v1, 4, 1
    v_lshlrev_b32 v246, 10, v246
    v_bfe_u32 v247, v1, 5, 1
    v_mfma_f32_16x16x32_bf16 v[152:155], v[108:111], v[88:91], v[152:155]
    ds_read_b64_tr_b16 v[60:61], v14 offset:0
    v_lshlrev_b32 v247, 9, v247
    v_add_u32 v246, v246, v247
    v_and_b32 v247, 15, v1
    v_lshlrev_b32 v247, 5, v247
    v_mfma_f32_16x16x32_bf16 v[160:163], v[112:115], v[88:91], v[160:163]
    ds_read_b64_tr_b16 v[62:63], v14 offset:6144
    ds_read_b128 v[68:71], v240 offset:1024
    v_add_u32 v246, v246, v247
    s_lshl_b32 s41, s36, 2
    s_add_u32 s41, s41, 155648
    v_mfma_f32_16x16x32_bf16 v[168:171], v[104:107], v[92:95], v[168:171]
    ds_read_b128 v[72:75], v240 offset:2048
    v_add_u32 v246, s41, v246
    v_permlane32_swap_b32 v221, v222
    v_permlane32_swap_b32 v223, v224
    v_mfma_f32_16x16x32_bf16 v[176:179], v[108:111], v[92:95], v[176:179]
    ds_read_b128 v[76:79], v240 offset:3072
    v_permlane32_swap_b32 v225, v226
    v_permlane32_swap_b32 v227, v228
    v_permlane32_swap_b32 v229, v212
    v_add_f32 v221, v221, v222
    v_mfma_f32_16x16x32_bf16 v[184:187], v[112:115], v[92:95], v[184:187]
    v_add_f32 v223, v223, v224
    v_add_f32 v225, v225, v226
    v_add_f32 v227, v227, v228
    v_mfma_f32_16x16x32_bf16 v[100:103], v[104:107], v[96:99], v[100:103]
    v_add_f32 v229, v229, v212
    v_permlane16_swap_b32 v221, v223
    v_permlane16_swap_b32 v225, v227
    v_permlane16_swap_b32 v229, v213
    v_mfma_f32_16x16x32_bf16 v[80:83], v[108:111], v[96:99], v[80:83]
    v_add_f32 v221, v221, v223
    v_add_f32 v225, v225, v227
    v_add_f32 v229, v229, v213
    v_mfma_f32_16x16x32_bf16 v[208:211], v[112:115], v[96:99], v[208:211]
    ds_write_b32 v246, v221 offset:0
    ds_write_b32 v246, v225 offset:2048
    ds_write_b32 v246, v229 offset:4096
    s_waitcnt lgkmcnt(0)
    v_mfma_f32_16x16x32_bf16 v[120:123], v[200:203], v[64:67], v[120:123]
    ds_read_b64_tr_b16 v[104:105], v12 offset:12288
    ds_read_b64_tr_b16 v[106:107], v12 offset:18432
    v_mfma_f32_16x16x32_bf16 v[128:131], v[192:195], v[64:67], v[128:131]
    ds_read_b128 v[84:87], v240 offset:9216
    v_mfma_f32_16x16x32_bf16 v[136:139], v[60:63], v[64:67], v[136:139]
    ds_read_b64_tr_b16 v[108:109], v13 offset:12288
    ds_read_b64_tr_b16 v[110:111], v13 offset:18432
    v_mfma_f32_16x16x32_bf16 v[144:147], v[200:203], v[68:71], v[144:147]
    ds_read_b64_tr_b16 v[112:113], v14 offset:12288
    v_mfma_f32_16x16x32_bf16 v[152:155], v[192:195], v[68:71], v[152:155]
    ds_read_b64_tr_b16 v[114:115], v14 offset:18432
    v_mfma_f32_16x16x32_bf16 v[160:163], v[60:63], v[68:71], v[160:163]
    ds_read_b128 v[88:91], v240 offset:10240
    ds_read_b128 v[92:95], v240 offset:11264
    v_mfma_f32_16x16x32_bf16 v[168:171], v[200:203], v[72:75], v[168:171]
    ds_read_b128 v[96:99], v240 offset:12288
    v_mfma_f32_16x16x32_bf16 v[176:179], v[192:195], v[72:75], v[176:179]
    v_mfma_f32_16x16x32_bf16 v[184:187], v[60:63], v[72:75], v[184:187]
    v_mfma_f32_16x16x32_bf16 v[100:103], v[200:203], v[76:79], v[100:103]
    v_mfma_f32_16x16x32_bf16 v[80:83], v[192:195], v[76:79], v[80:83]
    v_mfma_f32_16x16x32_bf16 v[208:211], v[60:63], v[76:79], v[208:211]
    s_waitcnt vmcnt(0) lgkmcnt(0)
    s_barrier
    v_mfma_f32_16x16x32_bf16 v[120:123], v[104:107], v[84:87], v[120:123]
    ds_read_b64_tr_b16 v[200:201], v9 offset:0
    ds_read_b64_tr_b16 v[202:203], v9 offset:6144
    v_and_b32 v246, 15, v1
    v_lshlrev_b32 v246, 5, v246
    v_mfma_f32_16x16x32_bf16 v[128:131], v[108:111], v[84:87], v[128:131]
    ds_read_b128 v[64:67], v240 offset:18432
    v_add_u32 v246, 158208, v246
    ds_read_b128 v[16:19], v246 offset:0
    v_mfma_f32_16x16x32_bf16 v[136:139], v[112:115], v[84:87], v[136:139]
    ds_read_b64_tr_b16 v[192:193], v10 offset:0
    ds_read_b128 v[20:23], v246 offset:16
    ds_read_b128 v[24:27], v246 offset:512
    v_mfma_f32_16x16x32_bf16 v[144:147], v[104:107], v[88:91], v[144:147]
    ds_read_b64_tr_b16 v[194:195], v10 offset:6144
    ds_read_b128 v[28:31], v246 offset:528
    v_mfma_f32_16x16x32_bf16 v[152:155], v[108:111], v[88:91], v[152:155]
    ds_read_b64_tr_b16 v[60:61], v11 offset:0
    ds_read_b128 v[32:35], v246 offset:1024
    ds_read_b128 v[36:39], v246 offset:1040
    v_mfma_f32_16x16x32_bf16 v[160:163], v[112:115], v[88:91], v[160:163]
    ds_read_b64_tr_b16 v[62:63], v11 offset:6144
    ds_read_b128 v[68:71], v240 offset:19456
    ds_read_b128 v[40:43], v246 offset:1536
    ds_read_b128 v[44:47], v246 offset:1552
    v_mfma_f32_16x16x32_bf16 v[168:171], v[104:107], v[92:95], v[168:171]
    ds_read_b128 v[72:75], v240 offset:20480
    s_waitcnt lgkmcnt(13)
    v_add_f32 v16, v16, v17
    v_add_f32 v18, v18, v19
    v_mfma_f32_16x16x32_bf16 v[176:179], v[108:111], v[92:95], v[176:179]
    ds_read_b128 v[76:79], v240 offset:21504
    s_waitcnt lgkmcnt(12)
    v_add_f32 v20, v20, v21
    v_mfma_f32_16x16x32_bf16 v[184:187], v[112:115], v[92:95], v[184:187]
    v_add_f32 v22, v22, v23
    v_add_f32 v16, v16, v18
    v_mfma_f32_16x16x32_bf16 v[100:103], v[104:107], v[96:99], v[100:103]
    v_add_f32 v20, v20, v22
    v_add_f32 v16, v16, v20
    v_mfma_f32_16x16x32_bf16 v[80:83], v[108:111], v[96:99], v[80:83]
    v_rcp_f32 v212, v16
    s_waitcnt lgkmcnt(11)
    v_add_f32 v24, v24, v25
    v_mfma_f32_16x16x32_bf16 v[208:211], v[112:115], v[96:99], v[208:211]
    v_add_f32 v26, v26, v27
    s_waitcnt lgkmcnt(0)
    v_mfma_f32_16x16x32_bf16 v[120:123], v[200:203], v[64:67], v[120:123]
    ds_read_b64_tr_b16 v[104:105], v9 offset:12288
    ds_read_b64_tr_b16 v[106:107], v9 offset:18432
    v_add_f32 v28, v28, v29
    v_add_f32 v30, v30, v31
    v_mfma_f32_16x16x32_bf16 v[128:131], v[192:195], v[64:67], v[128:131]
    ds_read_b128 v[84:87], v240 offset:27648
    v_add_f32 v24, v24, v26
    v_add_f32 v28, v28, v30
    v_mfma_f32_16x16x32_bf16 v[136:139], v[60:63], v[64:67], v[136:139]
    ds_read_b64_tr_b16 v[108:109], v10 offset:12288
    ds_read_b64_tr_b16 v[110:111], v10 offset:18432
    v_add_f32 v24, v24, v28
    v_rcp_f32 v214, v24
    v_mfma_f32_16x16x32_bf16 v[144:147], v[200:203], v[68:71], v[144:147]
    ds_read_b64_tr_b16 v[112:113], v11 offset:12288
    v_add_f32 v32, v32, v33
    v_add_f32 v34, v34, v35
    v_mfma_f32_16x16x32_bf16 v[152:155], v[192:195], v[68:71], v[152:155]
    ds_read_b64_tr_b16 v[114:115], v11 offset:18432
    v_add_f32 v36, v36, v37
    v_add_f32 v38, v38, v39
    v_mfma_f32_16x16x32_bf16 v[160:163], v[60:63], v[68:71], v[160:163]
    ds_read_b128 v[88:91], v240 offset:28672
    ds_read_b128 v[92:95], v240 offset:29696
    v_add_f32 v32, v32, v34
    v_add_f32 v36, v36, v38
    v_mfma_f32_16x16x32_bf16 v[168:171], v[200:203], v[72:75], v[168:171]
    ds_read_b128 v[96:99], v240 offset:30720
    v_add_f32 v32, v32, v36
    v_rcp_f32 v216, v32
    v_mfma_f32_16x16x32_bf16 v[176:179], v[192:195], v[72:75], v[176:179]
    v_add_f32 v40, v40, v41
    v_add_f32 v42, v42, v43
    v_mfma_f32_16x16x32_bf16 v[184:187], v[60:63], v[72:75], v[184:187]
    v_add_f32 v44, v44, v45
    v_add_f32 v46, v46, v47
    v_mfma_f32_16x16x32_bf16 v[100:103], v[200:203], v[76:79], v[100:103]
    v_add_f32 v40, v40, v42
    v_add_f32 v44, v44, v46
    v_mfma_f32_16x16x32_bf16 v[80:83], v[192:195], v[76:79], v[80:83]
    v_add_f32 v40, v40, v44
    v_rcp_f32 v218, v40
    v_mfma_f32_16x16x32_bf16 v[208:211], v[60:63], v[76:79], v[208:211]
    s_waitcnt lgkmcnt(0)
    s_barrier
    v_mfma_f32_16x16x32_bf16 v[120:123], v[104:107], v[84:87], v[120:123]
    v_mfma_f32_16x16x32_bf16 v[128:131], v[108:111], v[84:87], v[128:131]
    v_mfma_f32_16x16x32_bf16 v[136:139], v[112:115], v[84:87], v[136:139]
    v_mfma_f32_16x16x32_bf16 v[144:147], v[104:107], v[88:91], v[144:147]
    v_mfma_f32_16x16x32_bf16 v[152:155], v[108:111], v[88:91], v[152:155]
    v_mfma_f32_16x16x32_bf16 v[160:163], v[112:115], v[88:91], v[160:163]
    s_nop 2
    v_mul_f32 v120, v120, v212
    v_mul_f32 v121, v121, v212
    v_mul_f32 v122, v122, v212
    v_mul_f32 v123, v123, v212
    v_mul_f32 v128, v128, v212
    v_mul_f32 v129, v129, v212
    v_mul_f32 v130, v130, v212
    v_mul_f32 v131, v131, v212
    v_cvt_pk_bf16_f32 v120, v120, v121
    v_cvt_pk_bf16_f32 v121, v122, v123
    v_cvt_pk_bf16_f32 v122, v128, v129
    v_cvt_pk_bf16_f32 v123, v130, v131
    ds_write_b128 v8, v[120:123] offset:0
    s_mov_b32 s41, 0
    buffer_store_dwordx4 v[120:123], v254, s[32:35], s41 offen sc1
    v_mfma_f32_16x16x32_bf16 v[168:171], v[104:107], v[92:95], v[168:171]
    v_mul_f32 v136, v136, v212
    v_mul_f32 v137, v137, v212
    v_mul_f32 v138, v138, v212
    v_mul_f32 v139, v139, v212
    v_cvt_pk_bf16_f32 v136, v136, v137
    v_cvt_pk_bf16_f32 v137, v138, v139
    ds_write_b64 v255, v[136:137] offset:0
    v_mfma_f32_16x16x32_bf16 v[176:179], v[108:111], v[92:95], v[176:179]
    v_mfma_f32_16x16x32_bf16 v[184:187], v[112:115], v[92:95], v[184:187]
    v_mul_f32 v144, v144, v214
    v_mul_f32 v145, v145, v214
    v_mul_f32 v146, v146, v214
    v_mul_f32 v147, v147, v214
    v_mul_f32 v152, v152, v214
    v_mul_f32 v153, v153, v214
    v_mul_f32 v154, v154, v214
    v_mul_f32 v155, v155, v214
    v_cvt_pk_bf16_f32 v144, v144, v145
    v_cvt_pk_bf16_f32 v145, v146, v147
    v_cvt_pk_bf16_f32 v146, v152, v153
    v_cvt_pk_bf16_f32 v147, v154, v155
    ds_write_b128 v8, v[144:147] offset:1024
    s_mov_b32 s41, 1024
    buffer_store_dwordx4 v[144:147], v254, s[32:35], s41 offen sc1
    v_mfma_f32_16x16x32_bf16 v[100:103], v[104:107], v[96:99], v[100:103]
    v_mul_f32 v160, v160, v214
    v_mul_f32 v161, v161, v214
    v_mul_f32 v162, v162, v214
    v_mul_f32 v163, v163, v214
    v_cvt_pk_bf16_f32 v160, v160, v161
    v_cvt_pk_bf16_f32 v161, v162, v163
    ds_write_b64 v255, v[160:161] offset:1024
    v_mfma_f32_16x16x32_bf16 v[80:83], v[108:111], v[96:99], v[80:83]
    v_mfma_f32_16x16x32_bf16 v[208:211], v[112:115], v[96:99], v[208:211]
    v_mul_f32 v168, v168, v216
    v_mul_f32 v169, v169, v216
    v_mul_f32 v170, v170, v216
    v_mul_f32 v171, v171, v216
    v_mul_f32 v176, v176, v216
    v_mul_f32 v177, v177, v216
    v_mul_f32 v178, v178, v216
    v_mul_f32 v179, v179, v216
    v_cvt_pk_bf16_f32 v168, v168, v169
    v_cvt_pk_bf16_f32 v169, v170, v171
    v_cvt_pk_bf16_f32 v170, v176, v177
    v_cvt_pk_bf16_f32 v171, v178, v179
    ds_write_b128 v8, v[168:171] offset:2048
    s_mov_b32 s41, 2048
    buffer_store_dwordx4 v[168:171], v254, s[32:35], s41 offen sc1
    v_pk_mul_f32 v[184:185], v[184:185], v[216:217] op_sel_hi:[1,0]
    v_pk_mul_f32 v[186:187], v[186:187], v[216:217] op_sel_hi:[1,0]
    v_cvt_pk_bf16_f32 v184, v184, v185
    v_cvt_pk_bf16_f32 v185, v186, v187
    ds_write_b64 v255, v[184:185] offset:2048
    v_pk_mul_f32 v[100:101], v[100:101], v[218:219] op_sel_hi:[1,0]
    v_pk_mul_f32 v[102:103], v[102:103], v[218:219] op_sel_hi:[1,0]
    v_pk_mul_f32 v[80:81], v[80:81], v[218:219] op_sel_hi:[1,0]
    v_pk_mul_f32 v[82:83], v[82:83], v[218:219] op_sel_hi:[1,0]
    v_cvt_pk_bf16_f32 v100, v100, v101
    v_cvt_pk_bf16_f32 v101, v102, v103
    v_cvt_pk_bf16_f32 v102, v80, v81
    v_cvt_pk_bf16_f32 v103, v82, v83
    ds_write_b128 v8, v[100:103] offset:3072
    s_mov_b32 s41, 3072
    buffer_store_dwordx4 v[100:103], v254, s[32:35], s41 offen sc1
    v_pk_mul_f32 v[208:209], v[208:209], v[218:219] op_sel_hi:[1,0]
    v_pk_mul_f32 v[210:211], v[210:211], v[218:219] op_sel_hi:[1,0]
    v_cvt_pk_bf16_f32 v208, v208, v209
    v_cvt_pk_bf16_f32 v209, v210, v211
    ds_write_b64 v255, v[208:209] offset:3072
    s_waitcnt lgkmcnt(0)
    s_barrier
    s_bitcmp1_b32 s36, 1
    s_cbranch_scc1 L_tail3
    v_lshlrev_b32 v56, 4, v0
    v_add_u32 v57, 0, v56
    ds_read_b128 v[176:179], v57 offset:40960
    ds_read_b128 v[180:183], v57 offset:49152
    s_mov_b32 s41, 36864
    s_waitcnt lgkmcnt(1)
    buffer_store_dwordx4 v[176:179], v56, s[32:35], s41 offen sc1
    s_mov_b32 s41, 45056
    s_waitcnt lgkmcnt(0)
    buffer_store_dwordx4 v[180:183], v56, s[32:35], s41 offen sc1
    ds_read_b64_tr_b16 v[76:77], v248 offset:49152
    ds_read_b64_tr_b16 v[78:79], v248 offset:54272
    ds_read_b128 v[16:19], v251 offset:0
    ds_read_b64_tr_b16 v[80:81], v249 offset:49152
    ds_read_b64_tr_b16 v[82:83], v249 offset:54272
    ds_read_b128 v[20:23], v251 offset:1024
    ds_read_b128 v[24:27], v251 offset:2048
    ds_read_b128 v[28:31], v251 offset:3072
    v_lshlrev_b32 v57, 4, v1
    s_and_b32 s42, s36, 1
    s_add_u32 s43, s42, 2
    s_mul_i32 s43, s43, 9
    s_add_u32 s43, s43, s99
    s_lshl_b32 s43, s43, 10
    v_add_u32 v58, s43, v57
    s_mul_i32 s42, s42, 5120
    s_add_u32 s42, s42, 36864
    v_add_u32 v59, s42, v57
    s_waitcnt lgkmcnt(5)
    v_mfma_f32_16x16x32_bf16 v[116:119], v[76:79], v[16:19], 0
    ds_read_b64_tr_b16 v[88:89], v248 offset:59392
    ds_read_b64_tr_b16 v[90:91], v248 offset:64512
    s_waitcnt lgkmcnt(5)
    v_mfma_f32_16x16x32_bf16 v[120:123], v[80:83], v[16:19], 0
    ds_read_b128 v[36:39], v251 offset:9216
    ds_read_b64_tr_b16 v[92:93], v249 offset:59392
    s_waitcnt lgkmcnt(6)
    v_mfma_f32_16x16x32_bf16 v[124:127], v[76:79], v[20:23], 0
    ds_read_b64_tr_b16 v[94:95], v249 offset:64512
    v_mfma_f32_16x16x32_bf16 v[128:131], v[80:83], v[20:23], 0
    ds_read_b128 v[40:43], v251 offset:10240
    ds_read_b128 v[44:47], v251 offset:11264
    s_waitcnt lgkmcnt(8)
    v_mfma_f32_16x16x32_bf16 v[132:135], v[76:79], v[24:27], 0
    ds_read_b128 v[48:51], v251 offset:12288
    v_mfma_f32_16x16x32_bf16 v[136:139], v[80:83], v[24:27], 0
    s_waitcnt lgkmcnt(8)
    v_mfma_f32_16x16x32_bf16 v[140:143], v[76:79], v[28:31], 0
    v_mfma_f32_16x16x32_bf16 v[144:147], v[80:83], v[28:31], 0
    s_waitcnt vmcnt(2) lgkmcnt(0)
    s_barrier
    s_cmp_eq_u32 s36, 4
    s_cbranch_scc0 L_f1
    s_lshl_b32 s41, s47, 2
    v_mov_b32 v60, s41
    v_mov_b32 v61, s88
    s_mov_b64 exec, 1
    global_store_dword v60, v61, s[90:91] offset:0 sc1
    s_mov_b64 exec, -1
L_f1:
    s_mov_b32 s56, 0
    v_and_b32 v62, 3, v1
    v_lshlrev_b32 v62, 2, v62
    v_mfma_f32_16x16x32_bf16 v[116:119], v[88:91], v[36:39], v[116:119]
    ds_read_b64_tr_b16 v[76:77], v248 offset:0
    ds_read_b64_tr_b16 v[78:79], v248 offset:5120
    v_mfma_f32_16x16x32_bf16 v[120:123], v[92:95], v[36:39], v[120:123]
    ds_read_b128 v[16:19], v251 offset:20480
    ds_read_b64_tr_b16 v[80:81], v249 offset:0
    v_mfma_f32_16x16x32_bf16 v[124:127], v[88:91], v[40:43], v[124:127]
    ds_read_b64_tr_b16 v[82:83], v249 offset:5120
    v_mfma_f32_16x16x32_bf16 v[128:131], v[92:95], v[40:43], v[128:131]
    ds_read_b128 v[20:23], v251 offset:21504
    ds_read_b128 v[24:27], v251 offset:22528
    v_mfma_f32_16x16x32_bf16 v[132:135], v[88:91], v[44:47], v[132:135]
    ds_read_b128 v[28:31], v251 offset:23552
    v_mfma_f32_16x16x32_bf16 v[136:139], v[92:95], v[44:47], v[136:139]
    v_mfma_f32_16x16x32_bf16 v[140:143], v[88:91], v[48:51], v[140:143]
    v_mfma_f32_16x16x32_bf16 v[144:147], v[92:95], v[48:51], v[144:147]
    global_load_dword v63, v62, s[90:91] sc1
    s_waitcnt lgkmcnt(0)
    v_mfma_f32_16x16x32_bf16 v[116:119], v[76:79], v[16:19], v[116:119]
    ds_read_b64_tr_b16 v[88:89], v248 offset:10240
    ds_read_b64_tr_b16 v[90:91], v248 offset:15360
    v_mfma_f32_16x16x32_bf16 v[120:123], v[80:83], v[16:19], v[120:123]
    ds_read_b128 v[36:39], v251 offset:29696
    ds_read_b64_tr_b16 v[92:93], v249 offset:10240
    v_mfma_f32_16x16x32_bf16 v[124:127], v[76:79], v[20:23], v[124:127]
    ds_read_b64_tr_b16 v[94:95], v249 offset:15360
    v_mfma_f32_16x16x32_bf16 v[128:131], v[80:83], v[20:23], v[128:131]
    ds_read_b128 v[40:43], v251 offset:30720
    ds_read_b128 v[44:47], v251 offset:31744
    v_mfma_f32_16x16x32_bf16 v[132:135], v[76:79], v[24:27], v[132:135]
    ds_read_b128 v[48:51], v251 offset:32768
    v_mfma_f32_16x16x32_bf16 v[136:139], v[80:83], v[24:27], v[136:139]
    v_mfma_f32_16x16x32_bf16 v[140:143], v[76:79], v[28:31], v[140:143]
    v_mfma_f32_16x16x32_bf16 v[144:147], v[80:83], v[28:31], v[144:147]
    s_waitcnt vmcnt(0)
    v_cmp_ne_u32 vcc, s88, v63
    s_nop 4
    s_cbranch_vccnz L_np2
    s_add_u32 m0, s98, 0
    s_add_u32 s40, s81, s95
    buffer_load_dwordx4 v2, s[16:19], s40 offen sc1 lds
    s_add_u32 m0, s98, 1024
    s_nop 0
    buffer_load_dwordx4 v3, s[16:19], s40 offen sc1 lds
    s_add_u32 m0, s98, 2048
    s_nop 0
    buffer_load_dwordx4 v4, s[16:19], s40 offen sc1 lds
    s_add_u32 m0, s98, 3072
    s_nop 0
    buffer_load_dwordx4 v5, s[16:19], s40 offen sc1 lds
    s_add_u32 m0, s98, 4096
    s_nop 0
    buffer_load_dwordx4 v7, s[16:19], s40 offen sc1 lds
    s_mov_b32 s56, 1
L_np2:
    s_waitcnt lgkmcnt(0)
    s_barrier
    s_cmp_eq_u32 s56, 1
    s_cbranch_scc1 L_ep2
    v_and_b32 v62, 3, v1
    v_lshlrev_b32 v62, 2, v62
    s_mov_b32 s101, 0x20000
    s_waitcnt vmcnt(0)
L_p1_2:
    global_load_dword v63, v62, s[90:91] offset:0 sc1
    s_sub_u32 s101, s101, 1
    s_cbranch_scc1 L_p1_2_done
    s_waitcnt vmcnt(0)
    v_cmp_ne_u32 vcc, s88, v63
    s_nop 4
    s_cbranch_vccz L_p1_2_done
    s_sleep 1
    s_branch L_p1_2
L_p1_2_done:
    s_waitcnt vmcnt(0)
    s_add_u32 m0, s98, 0
    s_add_u32 s40, s81, s95
    buffer_load_dwordx4 v2, s[16:19], s40 offen sc1 lds
    s_add_u32 m0, s98, 1024
    s_nop 0
    buffer_load_dwordx4 v3, s[16:19], s40 offen sc1 lds
    s_add_u32 m0, s98, 2048
    s_nop 0
    buffer_load_dwordx4 v4, s[16:19], s40 offen sc1 lds
    s_add_u32 m0, s98, 3072
    s_nop 0
    buffer_load_dwordx4 v5, s[16:19], s40 offen sc1 lds
    s_add_u32 m0, s98, 4096
    s_nop 0
    buffer_load_dwordx4 v7, s[16:19], s40 offen sc1 lds
L_ep2:
    v_mfma_f32_16x16x32_bf16 v[116:119], v[88:91], v[36:39], v[116:119]
    s_add_u32 m0, s98, 20480
    s_add_u32 s40, s81, s96
    buffer_load_dwordx4 v2, s[16:19], s40 offen sc1 lds
    ds_read_b64_tr_b16 v[76:77], v248 offset:24576
    ds_read_b64_tr_b16 v[78:79], v248 offset:29696
    v_mfma_f32_16x16x32_bf16 v[120:123], v[92:95], v[36:39], v[120:123]
    s_add_u32 m0, s98, 21504
    s_nop 0
    buffer_load_dwordx4 v3, s[16:19], s40 offen sc1 lds
    ds_read_b128 v[16:19], v251 offset:40960
    ds_read_b64_tr_b16 v[80:81], v249 offset:24576
    v_mfma_f32_16x16x32_bf16 v[124:127], v[88:91], v[40:43], v[124:127]
    ds_read_b64_tr_b16 v[82:83], v249 offset:29696
    v_mfma_f32_16x16x32_bf16 v[128:131], v[92:95], v[40:43], v[128:131]
    s_add_u32 m0, s98, 22528
    s_nop 0
    buffer_load_dwordx4 v4, s[16:19], s40 offen sc1 lds
    ds_read_b128 v[20:23], v251 offset:41984
    ds_read_b128 v[24:27], v251 offset:43008
    v_mfma_f32_16x16x32_bf16 v[132:135], v[88:91], v[44:47], v[132:135]
    s_add_u32 m0, s98, 23552
    s_nop 0
    buffer_load_dwordx4 v5, s[16:19], s40 offen sc1 lds
    ds_read_b128 v[28:31], v251 offset:44032
    v_mfma_f32_16x16x32_bf16 v[136:139], v[92:95], v[44:47], v[136:139]
    v_mfma_f32_16x16x32_bf16 v[140:143], v[88:91], v[48:51], v[140:143]
    s_add_u32 m0, s98, 24576
    s_nop 0
    buffer_load_dwordx4 v7, s[16:19], s40 offen sc1 lds
    v_mfma_f32_16x16x32_bf16 v[144:147], v[92:95], v[48:51], v[144:147]
    s_waitcnt lgkmcnt(0)
    v_mfma_f32_16x16x32_bf16 v[116:119], v[76:79], v[16:19], v[116:119]
    ds_read_b64_tr_b16 v[88:89], v248 offset:34816
    ds_read_b64_tr_b16 v[90:91], v248 offset:39936
    v_mfma_f32_16x16x32_bf16 v[120:123], v[80:83], v[16:19], v[120:123]
    ds_read_b128 v[36:39], v251 offset:50176
    ds_read_b64_tr_b16 v[92:93], v249 offset:34816
    v_mfma_f32_16x16x32_bf16 v[124:127], v[76:79], v[20:23], v[124:127]
    ds_read_b64_tr_b16 v[94:95], v249 offset:39936
    v_mfma_f32_16x16x32_bf16 v[128:131], v[80:83], v[20:23], v[128:131]
    ds_read_b128 v[40:43], v251 offset:51200
    ds_read_b128 v[44:47], v251 offset:52224
    v_mfma_f32_16x16x32_bf16 v[132:135], v[76:79], v[24:27], v[132:135]
    ds_read_b128 v[48:51], v251 offset:53248
    v_mfma_f32_16x16x32_bf16 v[136:139], v[80:83], v[24:27], v[136:139]
    v_mfma_f32_16x16x32_bf16 v[140:143], v[76:79], v[28:31], v[140:143]
    v_mfma_f32_16x16x32_bf16 v[144:147], v[80:83], v[28:31], v[144:147]
    s_waitcnt vmcnt(5) lgkmcnt(0)
    s_barrier
    v_mfma_f32_16x16x32_bf16 v[116:119], v[88:91], v[36:39], v[116:119]
    s_add_u32 m0, s98, 40960
    s_add_u32 s40, s81, s97
    buffer_load_dwordx4 v2, s[16:19], s40 offen sc1 lds
    ds_read_b64_tr_b16 v[76:77], v248 offset:49152
    ds_read_b64_tr_b16 v[78:79], v248 offset:54272
    v_mfma_f32_16x16x32_bf16 v[120:123], v[92:95], v[36:39], v[120:123]
    ds_read_b128 v[16:19], v251 offset:0
    ds_read_b64_tr_b16 v[80:81], v249 offset:49152
    v_mfma_f32_16x16x32_bf16 v[124:127], v[88:91], v[40:43], v[124:127]
    s_add_u32 m0, s98, 41984
    s_nop 0
    buffer_load_dwordx4 v3, s[16:19], s40 offen sc1 lds
    ds_read_b64_tr_b16 v[82:83], v249 offset:54272
    v_mfma_f32_16x16x32_bf16 v[128:131], v[92:95], v[40:43], v[128:131]
    ds_read_b128 v[20:23], v251 offset:1024
    ds_read_b128 v[24:27], v251 offset:2048
    v_mfma_f32_16x16x32_bf16 v[132:135], v[88:91], v[44:47], v[132:135]
    ds_read_b128 v[28:31], v251 offset:3072
    v_mfma_f32_16x16x32_bf16 v[136:139], v[92:95], v[44:47], v[136:139]
    s_add_u32 m0, s98, 43008
    s_nop 0
    buffer_load_dwordx4 v4, s[16:19], s40 offen sc1 lds
    v_mfma_f32_16x16x32_bf16 v[140:143], v[88:91], v[48:51], v[140:143]
    v_mfma_f32_16x16x32_bf16 v[144:147], v[92:95], v[48:51], v[144:147]
    s_waitcnt lgkmcnt(0)
    v_mfma_f32_16x16x32_bf16 v[116:119], v[76:79], v[16:19], v[116:119]
    ds_read_b64_tr_b16 v[88:89], v248 offset:59392
    ds_read_b64_tr_b16 v[90:91], v248 offset:64512
    s_add_u32 m0, s98, 44032
    s_nop 0
    buffer_load_dwordx4 v5, s[16:19], s40 offen sc1 lds
    v_mfma_f32_16x16x32_bf16 v[120:123], v[80:83], v[16:19], v[120:123]
    ds_read_b128 v[36:39], v251 offset:9216
    ds_read_b64_tr_b16 v[92:93], v249 offset:59392
    v_mfma_f32_16x16x32_bf16 v[124:127], v[76:79], v[20:23], v[124:127]
    ds_read_b64_tr_b16 v[94:95], v249 offset:64512
    v_mfma_f32_16x16x32_bf16 v[128:131], v[80:83], v[20:23], v[128:131]
    ds_read_b128 v[40:43], v251 offset:10240
    ds_read_b128 v[44:47], v251 offset:11264
    s_add_u32 m0, s98, 45056
    s_nop 0
    buffer_load_dwordx4 v7, s[16:19], s40 offen sc1 lds
    v_mfma_f32_16x16x32_bf16 v[132:135], v[76:79], v[24:27], v[132:135]
    ds_read_b128 v[48:51], v251 offset:12288
    v_mfma_f32_16x16x32_bf16 v[136:139], v[80:83], v[24:27], v[136:139]
    v_mfma_f32_16x16x32_bf16 v[140:143], v[76:79], v[28:31], v[140:143]
    v_mfma_f32_16x16x32_bf16 v[144:147], v[80:83], v[28:31], v[144:147]
    s_waitcnt vmcnt(5) lgkmcnt(0)
    s_barrier
    v_mfma_f32_16x16x32_bf16 v[116:119], v[88:91], v[36:39], v[116:119]
    s_add_u32 m0, s98, 0
    s_add_u32 s40, s82, s95
    buffer_load_dwordx4 v2, s[16:19], s40 offen sc1 lds
    ds_read_b64_tr_b16 v[76:77], v248 offset:0
    ds_read_b64_tr_b16 v[78:79], v248 offset:5120
    v_mfma_f32_16x16x32_bf16 v[120:123], v[92:95], v[36:39], v[120:123]
    ds_read_b128 v[16:19], v251 offset:20480
    ds_read_b64_tr_b16 v[80:81], v249 offset:0
    v_mfma_f32_16x16x32_bf16 v[124:127], v[88:91], v[40:43], v[124:127]
    s_add_u32 m0, s98, 1024
    s_nop 0
    buffer_load_dwordx4 v3, s[16:19], s40 offen sc1 lds
    ds_read_b64_tr_b16 v[82:83], v249 offset:5120
    v_mfma_f32_16x16x32_bf16 v[128:131], v[92:95], v[40:43], v[128:131]
    ds_read_b128 v[20:23], v251 offset:21504
    ds_read_b128 v[24:27], v251 offset:22528
    v_mfma_f32_16x16x32_bf16 v[132:135], v[88:91], v[44:47], v[132:135]
    ds_read_b128 v[28:31], v251 offset:23552
    v_mfma_f32_16x16x32_bf16 v[136:139], v[92:95], v[44:47], v[136:139]
    s_add_u32 m0, s98, 2048
    s_nop 0
    buffer_load_dwordx4 v4, s[16:19], s40 offen sc1 lds
    v_mfma_f32_16x16x32_bf16 v[140:143], v[88:91], v[48:51], v[140:143]
    v_mfma_f32_16x16x32_bf16 v[144:147], v[92:95], v[48:51], v[144:147]
    s_waitcnt lgkmcnt(0)
    v_mfma_f32_16x16x32_bf16 v[116:119], v[76:79], v[16:19], v[116:119]
    ds_read_b64_tr_b16 v[88:89], v248 offset:10240
    ds_read_b64_tr_b16 v[90:91], v248 offset:15360
    s_add_u32 m0, s98, 3072
    s_nop 0
    buffer_load_dwordx4 v5, s[16:19], s40 offen sc1 lds
    v_mfma_f32_16x16x32_bf16 v[120:123], v[80:83], v[16:19], v[120:123]
    ds_read_b128 v[36:39], v251 offset:29696
    ds_read_b64_tr_b16 v[92:93], v249 offset:10240
    v_mfma_f32_16x16x32_bf16 v[124:127], v[76:79], v[20:23], v[124:127]
    ds_read_b64_tr_b16 v[94:95], v249 offset:15360
    v_mfma_f32_16x16x32_bf16 v[128:131], v[80:83], v[20:23], v[128:131]
    ds_read_b128 v[40:43], v251 offset:30720
    ds_read_b128 v[44:47], v251 offset:31744
    s_add_u32 m0, s98, 4096
    s_nop 0
    buffer_load_dwordx4 v7, s[16:19], s40 offen sc1 lds
    v_mfma_f32_16x16x32_bf16 v[132:135], v[76:79], v[24:27], v[132:135]
    ds_read_b128 v[48:51], v251 offset:32768
    v_mfma_f32_16x16x32_bf16 v[136:139], v[80:83], v[24:27], v[136:139]
    v_mfma_f32_16x16x32_bf16 v[140:143], v[76:79], v[28:31], v[140:143]
    v_mfma_f32_16x16x32_bf16 v[144:147], v[80:83], v[28:31], v[144:147]
    s_waitcnt vmcnt(5) lgkmcnt(0)
    s_barrier
    v_mfma_f32_16x16x32_bf16 v[116:119], v[88:91], v[36:39], v[116:119]
    s_add_u32 m0, s98, 20480
    s_add_u32 s40, s82, s96
    buffer_load_dwordx4 v2, s[16:19], s40 offen sc1 lds
    ds_read_b64_tr_b16 v[76:77], v248 offset:24576
    ds_read_b64_tr_b16 v[78:79], v248 offset:29696
    v_mfma_f32_16x16x32_bf16 v[120:123], v[92:95], v[36:39], v[120:123]
    ds_read_b128 v[16:19], v251 offset:40960
    ds_read_b64_tr_b16 v[80:81], v249 offset:24576
    v_mfma_f32_16x16x32_bf16 v[124:127], v[88:91], v[40:43], v[124:127]
    s_add_u32 m0, s98, 21504
    s_nop 0
    buffer_load_dwordx4 v3, s[16:19], s40 offen sc1 lds
    ds_read_b64_tr_b16 v[82:83], v249 offset:29696
    v_mfma_f32_16x16x32_bf16 v[128:131], v[92:95], v[40:43], v[128:131]
    ds_read_b128 v[20:23], v251 offset:41984
    ds_read_b128 v[24:27], v251 offset:43008
    v_mfma_f32_16x16x32_bf16 v[132:135], v[88:91], v[44:47], v[132:135]
    ds_read_b128 v[28:31], v251 offset:44032
    v_mfma_f32_16x16x32_bf16 v[136:139], v[92:95], v[44:47], v[136:139]
    s_add_u32 m0, s98, 22528
    s_nop 0
    buffer_load_dwordx4 v4, s[16:19], s40 offen sc1 lds
    v_mfma_f32_16x16x32_bf16 v[140:143], v[88:91], v[48:51], v[140:143]
    v_mfma_f32_16x16x32_bf16 v[144:147], v[92:95], v[48:51], v[144:147]
    s_waitcnt lgkmcnt(0)
    v_mfma_f32_16x16x32_bf16 v[116:119], v[76:79], v[16:19], v[116:119]
    ds_read_b64_tr_b16 v[88:89], v248 offset:34816
    ds_read_b64_tr_b16 v[90:91], v248 offset:39936
    s_add_u32 m0, s98, 23552
    s_nop 0
    buffer_load_dwordx4 v5, s[16:19], s40 offen sc1 lds
    v_mfma_f32_16x16x32_bf16 v[120:123], v[80:83], v[16:19], v[120:123]
    ds_read_b128 v[36:39], v251 offset:50176
    ds_read_b64_tr_b16 v[92:93], v249 offset:34816
    v_mfma_f32_16x16x32_bf16 v[124:127], v[76:79], v[20:23], v[124:127]
    ds_read_b64_tr_b16 v[94:95], v249 offset:39936
    v_mfma_f32_16x16x32_bf16 v[128:131], v[80:83], v[20:23], v[128:131]
    ds_read_b128 v[40:43], v251 offset:51200
    ds_read_b128 v[44:47], v251 offset:52224
    s_add_u32 m0, s98, 24576
    s_nop 0
    buffer_load_dwordx4 v7, s[16:19], s40 offen sc1 lds
    v_mfma_f32_16x16x32_bf16 v[132:135], v[76:79], v[24:27], v[132:135]
    ds_read_b128 v[48:51], v251 offset:53248
    v_mfma_f32_16x16x32_bf16 v[136:139], v[80:83], v[24:27], v[136:139]
    v_mfma_f32_16x16x32_bf16 v[140:143], v[76:79], v[28:31], v[140:143]
    v_mfma_f32_16x16x32_bf16 v[144:147], v[80:83], v[28:31], v[144:147]
    s_waitcnt vmcnt(5) lgkmcnt(0)
    s_barrier
    global_load_dword v63, v62, s[90:91] offset:16 sc1
    v_mfma_f32_16x16x32_bf16 v[116:119], v[88:91], v[36:39], v[116:119]
    s_add_u32 m0, s98, 40960
    s_add_u32 s40, s82, s97
    buffer_load_dwordx4 v2, s[16:19], s40 offen sc1 lds
    ds_read_b64_tr_b16 v[76:77], v248 offset:49152
    ds_read_b64_tr_b16 v[78:79], v248 offset:54272
    v_mfma_f32_16x16x32_bf16 v[120:123], v[92:95], v[36:39], v[120:123]
    ds_read_b128 v[16:19], v251 offset:0
    ds_read_b64_tr_b16 v[80:81], v249 offset:49152
    v_mfma_f32_16x16x32_bf16 v[124:127], v[88:91], v[40:43], v[124:127]
    s_add_u32 m0, s98, 41984
    s_nop 0
    buffer_load_dwordx4 v3, s[16:19], s40 offen sc1 lds
    ds_read_b64_tr_b16 v[82:83], v249 offset:54272
    v_mfma_f32_16x16x32_bf16 v[128:131], v[92:95], v[40:43], v[128:131]
    ds_read_b128 v[20:23], v251 offset:1024
    ds_read_b128 v[24:27], v251 offset:2048
    v_mfma_f32_16x16x32_bf16 v[132:135], v[88:91], v[44:47], v[132:135]
    ds_read_b128 v[28:31], v251 offset:3072
    v_mfma_f32_16x16x32_bf16 v[136:139], v[92:95], v[44:47], v[136:139]
    s_add_u32 m0, s98, 43008
    s_nop 0
    buffer_load_dwordx4 v4, s[16:19], s40 offen sc1 lds
    v_mfma_f32_16x16x32_bf16 v[140:143], v[88:91], v[48:51], v[140:143]
    v_mfma_f32_16x16x32_bf16 v[144:147], v[92:95], v[48:51], v[144:147]
    s_waitcnt lgkmcnt(0)
    v_mfma_f32_16x16x32_bf16 v[116:119], v[76:79], v[16:19], v[116:119]
    ds_read_b64_tr_b16 v[88:89], v248 offset:59392
    ds_read_b64_tr_b16 v[90:91], v248 offset:64512
    s_add_u32 m0, s98, 44032
    s_nop 0
    buffer_load_dwordx4 v5, s[16:19], s40 offen sc1 lds
    v_mfma_f32_16x16x32_bf16 v[120:123], v[80:83], v[16:19], v[120:123]
    ds_read_b128 v[36:39], v251 offset:9216
    ds_read_b64_tr_b16 v[92:93], v249 offset:59392
    v_mfma_f32_16x16x32_bf16 v[124:127], v[76:79], v[20:23], v[124:127]
    ds_read_b64_tr_b16 v[94:95], v249 offset:64512
    v_mfma_f32_16x16x32_bf16 v[128:131], v[80:83], v[20:23], v[128:131]
    ds_read_b128 v[40:43], v251 offset:10240
    ds_read_b128 v[44:47], v251 offset:11264
    s_add_u32 m0, s98, 45056
    s_nop 0
    buffer_load_dwordx4 v7, s[16:19], s40 offen sc1 lds
    v_mfma_f32_16x16x32_bf16 v[132:135], v[76:79], v[24:27], v[132:135]
    ds_read_b128 v[48:51], v251 offset:12288
    v_mfma_f32_16x16x32_bf16 v[136:139], v[80:83], v[24:27], v[136:139]
    v_mfma_f32_16x16x32_bf16 v[140:143], v[76:79], v[28:31], v[140:143]
    v_mfma_f32_16x16x32_bf16 v[144:147], v[80:83], v[28:31], v[144:147]
    s_waitcnt vmcnt(6) lgkmcnt(0)
    s_barrier
    s_waitcnt vmcnt(5)
    v_cmp_ne_u32 vcc, s88, v63
    s_nop 4
    s_cbranch_vccz L_p1c_2
    v_and_b32 v62, 3, v1
    v_lshlrev_b32 v62, 2, v62
    s_mov_b32 s101, 0x20000
L_p1b_2:
    global_load_dword v63, v62, s[90:91] offset:16 sc1
    s_sub_u32 s101, s101, 1
    s_cbranch_scc1 L_p1b_2_done
    s_waitcnt vmcnt(0)
    v_cmp_ne_u32 vcc, s88, v63
    s_nop 4
    s_cbranch_vccz L_p1b_2_done
    s_sleep 1
    s_branch L_p1b_2
L_p1b_2_done:
    s_waitcnt vmcnt(0)
L_p1c_2:
    v_mfma_f32_16x16x32_bf16 v[116:119], v[88:91], v[36:39], v[116:119]
    s_add_u32 m0, s98, 0
    s_add_u32 s40, s83, s95
    buffer_load_dwordx4 v2, s[16:19], s40 offen sc1 lds
    ds_read_b64_tr_b16 v[76:77], v248 offset:0
    ds_read_b64_tr_b16 v[78:79], v248 offset:5120
    v_mfma_f32_16x16x32_bf16 v[120:123], v[92:95], v[36:39], v[120:123]
    ds_read_b128 v[16:19], v251 offset:20480
    ds_read_b64_tr_b16 v[80:81], v249 offset:0
    v_mfma_f32_16x16x32_bf16 v[124:127], v[88:91], v[40:43], v[124:127]
    s_add_u32 m0, s98, 1024
    s_nop 0
    buffer_load_dwordx4 v3, s[16:19], s40 offen sc1 lds
    ds_read_b64_tr_b16 v[82:83], v249 offset:5120
    v_mfma_f32_16x16x32_bf16 v[128:131], v[92:95], v[40:43], v[128:131]
    ds_read_b128 v[20:23], v251 offset:21504
    ds_read_b128 v[24:27], v251 offset:22528
    v_mfma_f32_16x16x32_bf16 v[132:135], v[88:91], v[44:47], v[132:135]
    ds_read_b128 v[28:31], v251 offset:23552
    v_mfma_f32_16x16x32_bf16 v[136:139], v[92:95], v[44:47], v[136:139]
    s_add_u32 m0, s98, 2048
    s_nop 0
    buffer_load_dwordx4 v4, s[16:19], s40 offen sc1 lds
    v_mfma_f32_16x16x32_bf16 v[140:143], v[88:91], v[48:51], v[140:143]
    v_mfma_f32_16x16x32_bf16 v[144:147], v[92:95], v[48:51], v[144:147]
    s_waitcnt lgkmcnt(0)
    v_mfma_f32_16x16x32_bf16 v[116:119], v[76:79], v[16:19], v[116:119]
    ds_read_b64_tr_b16 v[88:89], v248 offset:10240
    ds_read_b64_tr_b16 v[90:91], v248 offset:15360
    s_add_u32 m0, s98, 3072
    s_nop 0
    buffer_load_dwordx4 v5, s[16:19], s40 offen sc1 lds
    v_mfma_f32_16x16x32_bf16 v[120:123], v[80:83], v[16:19], v[120:123]
    ds_read_b128 v[36:39], v251 offset:29696
    ds_read_b64_tr_b16 v[92:93], v249 offset:10240
    v_mfma_f32_16x16x32_bf16 v[124:127], v[76:79], v[20:23], v[124:127]
    ds_read_b64_tr_b16 v[94:95], v249 offset:15360
    v_mfma_f32_16x16x32_bf16 v[128:131], v[80:83], v[20:23], v[128:131]
    ds_read_b128 v[40:43], v251 offset:30720
    ds_read_b128 v[44:47], v251 offset:31744
    s_add_u32 m0, s98, 4096
    s_nop 0
    buffer_load_dwordx4 v7, s[16:19], s40 offen sc1 lds
    v_mfma_f32_16x16x32_bf16 v[132:135], v[76:79], v[24:27], v[132:135]
    ds_read_b128 v[48:51], v251 offset:32768
    v_mfma_f32_16x16x32_bf16 v[136:139], v[80:83], v[24:27], v[136:139]
    v_mfma_f32_16x16x32_bf16 v[140:143], v[76:79], v[28:31], v[140:143]
    v_mfma_f32_16x16x32_bf16 v[144:147], v[80:83], v[28:31], v[144:147]
    s_waitcnt vmcnt(5) lgkmcnt(0)
    s_barrier
    v_mfma_f32_16x16x32_bf16 v[116:119], v[88:91], v[36:39], v[116:119]
    s_add_u32 m0, s98, 20480
    s_add_u32 s40, s83, s96
    buffer_load_dwordx4 v2, s[16:19], s40 offen sc1 lds
    ds_read_b64_tr_b16 v[76:77], v248 offset:24576
    ds_read_b64_tr_b16 v[78:79], v248 offset:29696
    v_mfma_f32_16x16x32_bf16 v[120:123], v[92:95], v[36:39], v[120:123]
    ds_read_b128 v[16:19], v251 offset:40960
    ds_read_b64_tr_b16 v[80:81], v249 offset:24576
    v_mfma_f32_16x16x32_bf16 v[124:127], v[88:91], v[40:43], v[124:127]
    s_add_u32 m0, s98, 21504
    s_nop 0
    buffer_load_dwordx4 v3, s[16:19], s40 offen sc1 lds
    ds_read_b64_tr_b16 v[82:83], v249 offset:29696
    v_mfma_f32_16x16x32_bf16 v[128:131], v[92:95], v[40:43], v[128:131]
    ds_read_b128 v[20:23], v251 offset:41984
    ds_read_b128 v[24:27], v251 offset:43008
    v_mfma_f32_16x16x32_bf16 v[132:135], v[88:91], v[44:47], v[132:135]
    ds_read_b128 v[28:31], v251 offset:44032
    v_mfma_f32_16x16x32_bf16 v[136:139], v[92:95], v[44:47], v[136:139]
    s_add_u32 m0, s98, 22528
    s_nop 0
    buffer_load_dwordx4 v4, s[16:19], s40 offen sc1 lds
    v_mfma_f32_16x16x32_bf16 v[140:143], v[88:91], v[48:51], v[140:143]
    v_mfma_f32_16x16x32_bf16 v[144:147], v[92:95], v[48:51], v[144:147]
    s_waitcnt lgkmcnt(0)
    v_mfma_f32_16x16x32_bf16 v[116:119], v[76:79], v[16:19], v[116:119]
    ds_read_b64_tr_b16 v[88:89], v248 offset:34816
    ds_read_b64_tr_b16 v[90:91], v248 offset:39936
    s_add_u32 m0, s98, 23552
    s_nop 0
    buffer_load_dwordx4 v5, s[16:19], s40 offen sc1 lds
    v_mfma_f32_16x16x32_bf16 v[120:123], v[80:83], v[16:19], v[120:123]
    ds_read_b128 v[36:39], v251 offset:50176
    ds_read_b64_tr_b16 v[92:93], v249 offset:34816
    v_mfma_f32_16x16x32_bf16 v[124:127], v[76:79], v[20:23], v[124:127]
    ds_read_b64_tr_b16 v[94:95], v249 offset:39936
    v_mfma_f32_16x16x32_bf16 v[128:131], v[80:83], v[20:23], v[128:131]
    ds_read_b128 v[40:43], v251 offset:51200
    ds_read_b128 v[44:47], v251 offset:52224
    s_add_u32 m0, s98, 24576
    s_nop 0
    buffer_load_dwordx4 v7, s[16:19], s40 offen sc1 lds
    v_mfma_f32_16x16x32_bf16 v[132:135], v[76:79], v[24:27], v[132:135]
    ds_read_b128 v[48:51], v251 offset:53248
    v_mfma_f32_16x16x32_bf16 v[136:139], v[80:83], v[24:27], v[136:139]
    v_mfma_f32_16x16x32_bf16 v[140:143], v[76:79], v[28:31], v[140:143]
    v_mfma_f32_16x16x32_bf16 v[144:147], v[80:83], v[28:31], v[144:147]
    s_waitcnt vmcnt(5) lgkmcnt(0)
    s_barrier
    v_mfma_f32_16x16x32_bf16 v[116:119], v[88:91], v[36:39], v[116:119]
    s_add_u32 m0, s98, 40960
    s_add_u32 s40, s83, s97
    buffer_load_dwordx4 v2, s[16:19], s40 offen sc1 lds
    ds_read_b64_tr_b16 v[76:77], v248 offset:49152
    ds_read_b64_tr_b16 v[78:79], v248 offset:54272
    v_mfma_f32_16x16x32_bf16 v[120:123], v[92:95], v[36:39], v[120:123]
    ds_read_b128 v[16:19], v251 offset:0
    ds_read_b64_tr_b16 v[80:81], v249 offset:49152
    v_mfma_f32_16x16x32_bf16 v[124:127], v[88:91], v[40:43], v[124:127]
    s_add_u32 m0, s98, 41984
    s_nop 0
    buffer_load_dwordx4 v3, s[16:19], s40 offen sc1 lds
    ds_read_b64_tr_b16 v[82:83], v249 offset:54272
    v_mfma_f32_16x16x32_bf16 v[128:131], v[92:95], v[40:43], v[128:131]
    ds_read_b128 v[20:23], v251 offset:1024
    ds_read_b128 v[24:27], v251 offset:2048
    v_mfma_f32_16x16x32_bf16 v[132:135], v[88:91], v[44:47], v[132:135]
    ds_read_b128 v[28:31], v251 offset:3072
    v_mfma_f32_16x16x32_bf16 v[136:139], v[92:95], v[44:47], v[136:139]
    s_add_u32 m0, s98, 43008
    s_nop 0
    buffer_load_dwordx4 v4, s[16:19], s40 offen sc1 lds
    v_mfma_f32_16x16x32_bf16 v[140:143], v[88:91], v[48:51], v[140:143]
    v_mfma_f32_16x16x32_bf16 v[144:147], v[92:95], v[48:51], v[144:147]
    s_waitcnt lgkmcnt(0)
    v_mfma_f32_16x16x32_bf16 v[116:119], v[76:79], v[16:19], v[116:119]
    ds_read_b64_tr_b16 v[88:89], v248 offset:59392
    ds_read_b64_tr_b16 v[90:91], v248 offset:64512
    s_add_u32 m0, s98, 44032
    s_nop 0
    buffer_load_dwordx4 v5, s[16:19], s40 offen sc1 lds
    v_mfma_f32_16x16x32_bf16 v[120:123], v[80:83], v[16:19], v[120:123]
    ds_read_b128 v[36:39], v251 offset:9216
    ds_read_b64_tr_b16 v[92:93], v249 offset:59392
    v_mfma_f32_16x16x32_bf16 v[124:127], v[76:79], v[20:23], v[124:127]
    ds_read_b64_tr_b16 v[94:95], v249 offset:64512
    v_mfma_f32_16x16x32_bf16 v[128:131], v[80:83], v[20:23], v[128:131]
    ds_read_b128 v[40:43], v251 offset:10240
    ds_read_b128 v[44:47], v251 offset:11264
    s_add_u32 m0, s98, 45056
    s_nop 0
    buffer_load_dwordx4 v7, s[16:19], s40 offen sc1 lds
    v_mfma_f32_16x16x32_bf16 v[132:135], v[76:79], v[24:27], v[132:135]
    ds_read_b128 v[48:51], v251 offset:12288
    v_mfma_f32_16x16x32_bf16 v[136:139], v[80:83], v[24:27], v[136:139]
    v_mfma_f32_16x16x32_bf16 v[140:143], v[76:79], v[28:31], v[140:143]
    v_mfma_f32_16x16x32_bf16 v[144:147], v[80:83], v[28:31], v[144:147]
    s_waitcnt vmcnt(5) lgkmcnt(0)
    s_barrier
    v_mfma_f32_16x16x32_bf16 v[116:119], v[88:91], v[36:39], v[116:119]
    ds_read_b64_tr_b16 v[76:77], v248 offset:0
    ds_read_b64_tr_b16 v[78:79], v248 offset:5120
    v_mfma_f32_16x16x32_bf16 v[120:123], v[92:95], v[36:39], v[120:123]
    ds_read_b128 v[16:19], v251 offset:20480
    ds_read_b64_tr_b16 v[80:81], v249 offset:0
    v_mfma_f32_16x16x32_bf16 v[124:127], v[88:91], v[40:43], v[124:127]
    ds_read_b64_tr_b16 v[82:83], v249 offset:5120
    v_mfma_f32_16x16x32_bf16 v[128:131], v[92:95], v[40:43], v[128:131]
    ds_read_b128 v[20:23], v251 offset:21504
    ds_read_b128 v[24:27], v251 offset:22528
    v_mfma_f32_16x16x32_bf16 v[132:135], v[88:91], v[44:47], v[132:135]
    ds_read_b128 v[28:31], v251 offset:23552
    v_mfma_f32_16x16x32_bf16 v[136:139], v[92:95], v[44:47], v[136:139]
    v_mfma_f32_16x16x32_bf16 v[140:143], v[88:91], v[48:51], v[140:143]
    v_mfma_f32_16x16x32_bf16 v[144:147], v[92:95], v[48:51], v[144:147]
    s_waitcnt lgkmcnt(0)
    v_mfma_f32_16x16x32_bf16 v[116:119], v[76:79], v[16:19], v[116:119]
    ds_read_b64_tr_b16 v[88:89], v248 offset:10240
    ds_read_b64_tr_b16 v[90:91], v248 offset:15360
    v_mfma_f32_16x16x32_bf16 v[120:123], v[80:83], v[16:19], v[120:123]
    ds_read_b128 v[36:39], v251 offset:29696
    ds_read_b64_tr_b16 v[92:93], v249 offset:10240
    v_mfma_f32_16x16x32_bf16 v[124:127], v[76:79], v[20:23], v[124:127]
    ds_read_b64_tr_b16 v[94:95], v249 offset:15360
    v_mfma_f32_16x16x32_bf16 v[128:131], v[80:83], v[20:23], v[128:131]
    ds_read_b128 v[40:43], v251 offset:30720
    ds_read_b128 v[44:47], v251 offset:31744
    v_mfma_f32_16x16x32_bf16 v[132:135], v[76:79], v[24:27], v[132:135]
    ds_read_b128 v[48:51], v251 offset:32768
    v_mfma_f32_16x16x32_bf16 v[136:139], v[80:83], v[24:27], v[136:139]
    v_mfma_f32_16x16x32_bf16 v[140:143], v[76:79], v[28:31], v[140:143]
    v_mfma_f32_16x16x32_bf16 v[144:147], v[80:83], v[28:31], v[144:147]
    s_waitcnt vmcnt(0) lgkmcnt(0)
    s_barrier
    v_mfma_f32_16x16x32_bf16 v[116:119], v[88:91], v[36:39], v[116:119]
    ds_read_b64_tr_b16 v[76:77], v248 offset:24576
    ds_read_b64_tr_b16 v[78:79], v248 offset:29696
    v_mfma_f32_16x16x32_bf16 v[120:123], v[92:95], v[36:39], v[120:123]
    ds_read_b128 v[16:19], v251 offset:40960
    ds_read_b64_tr_b16 v[80:81], v249 offset:24576
    v_mfma_f32_16x16x32_bf16 v[124:127], v[88:91], v[40:43], v[124:127]
    ds_read_b64_tr_b16 v[82:83], v249 offset:29696
    v_mfma_f32_16x16x32_bf16 v[128:131], v[92:95], v[40:43], v[128:131]
    ds_read_b128 v[20:23], v251 offset:41984
    ds_read_b128 v[24:27], v251 offset:43008
    v_mfma_f32_16x16x32_bf16 v[132:135], v[88:91], v[44:47], v[132:135]
    ds_read_b128 v[28:31], v251 offset:44032
    v_mfma_f32_16x16x32_bf16 v[136:139], v[92:95], v[44:47], v[136:139]
    v_mfma_f32_16x16x32_bf16 v[140:143], v[88:91], v[48:51], v[140:143]
    v_mfma_f32_16x16x32_bf16 v[144:147], v[92:95], v[48:51], v[144:147]
    s_waitcnt lgkmcnt(0)
    v_mfma_f32_16x16x32_bf16 v[116:119], v[76:79], v[16:19], v[116:119]
    ds_read_b64_tr_b16 v[88:89], v248 offset:34816
    ds_read_b64_tr_b16 v[90:91], v248 offset:39936
    v_mfma_f32_16x16x32_bf16 v[120:123], v[80:83], v[16:19], v[120:123]
    ds_read_b128 v[36:39], v251 offset:50176
    ds_read_b64_tr_b16 v[92:93], v249 offset:34816
    v_mfma_f32_16x16x32_bf16 v[124:127], v[76:79], v[20:23], v[124:127]
    ds_read_b64_tr_b16 v[94:95], v249 offset:39936
    v_mfma_f32_16x16x32_bf16 v[128:131], v[80:83], v[20:23], v[128:131]
    ds_read_b128 v[40:43], v251 offset:51200
    ds_read_b128 v[44:47], v251 offset:52224
    v_mfma_f32_16x16x32_bf16 v[132:135], v[76:79], v[24:27], v[132:135]
    ds_read_b128 v[48:51], v251 offset:53248
    v_mfma_f32_16x16x32_bf16 v[136:139], v[80:83], v[24:27], v[136:139]
    v_mfma_f32_16x16x32_bf16 v[140:143], v[76:79], v[28:31], v[140:143]
    v_mfma_f32_16x16x32_bf16 v[144:147], v[80:83], v[28:31], v[144:147]
    s_waitcnt lgkmcnt(5)
    v_mfma_f32_16x16x32_bf16 v[116:119], v[88:91], v[36:39], v[116:119]
    s_waitcnt lgkmcnt(3)
    v_mfma_f32_16x16x32_bf16 v[120:123], v[92:95], v[36:39], v[120:123]
    s_waitcnt lgkmcnt(2)
    v_mfma_f32_16x16x32_bf16 v[124:127], v[88:91], v[40:43], v[124:127]
    v_mfma_f32_16x16x32_bf16 v[128:131], v[92:95], v[40:43], v[128:131]
    s_waitcnt lgkmcnt(1)
    v_mfma_f32_16x16x32_bf16 v[132:135], v[88:91], v[44:47], v[132:135]
    v_mfma_f32_16x16x32_bf16 v[136:139], v[92:95], v[44:47], v[136:139]
    v_cvt_pk_bf16_f32 v116, v116, v117
    v_cvt_pk_bf16_f32 v117, v118, v119
    v_cvt_pk_bf16_f32 v118, v120, v121
    v_cvt_pk_bf16_f32 v119, v122, v123
    s_mov_b32 s41, 0
    buffer_store_dwordx4 v[116:119], v58, s[20:23], s41 offen sc1
    s_waitcnt lgkmcnt(0)
    v_mfma_f32_16x16x32_bf16 v[140:143], v[88:91], v[48:51], v[140:143]
    v_mfma_f32_16x16x32_bf16 v[144:147], v[92:95], v[48:51], v[144:147]
    v_cvt_pk_bf16_f32 v124, v124, v125
    v_cvt_pk_bf16_f32 v125, v126, v127
    v_cvt_pk_bf16_f32 v126, v128, v129
    v_cvt_pk_bf16_f32 v127, v130, v131
    s_mov_b32 s41, 1024
    buffer_store_dwordx4 v[124:127], v58, s[20:23], s41 offen sc1
    v_cvt_pk_bf16_f32 v132, v132, v133
    v_cvt_pk_bf16_f32 v133, v134, v135
    v_cvt_pk_bf16_f32 v134, v136, v137
    v_cvt_pk_bf16_f32 v135, v138, v139
    s_mov_b32 s41, 2048
    buffer_store_dwordx4 v[132:135], v58, s[20:23], s41 offen sc1
    v_cvt_pk_bf16_f32 v140, v140, v141
    v_cvt_pk_bf16_f32 v141, v142, v143
    v_cvt_pk_bf16_f32 v142, v144, v145
    v_cvt_pk_bf16_f32 v143, v146, v147
    s_mov_b32 s41, 3072
    buffer_store_dwordx4 v[140:143], v58, s[20:23], s41 offen sc1
    s_lshl_b32 s56, s36, 3
    s_add_u32 s56, s56, s53
    s_lshl_b32 s41, s56, 10
    v_add_u32 v58, s41, v57
    s_mul_i32 s41, s56, 57
    s_lshr_b32 s41, s41, 9
    s_mul_i32 s42, s41, 9
    s_sub_u32 s42, s56, s42
    s_lshl_b32 s41, s41, 2
    s_lshr_b32 s41, 0x8630, s41
    s_and_b32 s41, s41, 15
    s_mov_b32 s59, 32
    s_cmp_lt_u32 s56, 36
    s_cbranch_scc1 L_dec2
    s_cmp_ge_u32 s56, 41
    s_cselect_b32 s41, 5, 2
    s_cselect_b32 s42, 41, 36
    s_sub_u32 s42, s56, s42
    s_cmp_eq_u32 s42, 2
    s_mov_b32 s59, 20480
    s_cselect_b32 s59, 0x40000000, s59
    s_lshl_b32 s42, s42, 2
    s_lshr_b32 s42, 0x75420, s42
    s_and_b32 s42, s42, 15
L_dec2:
    s_lshl_b32 s42, s42, 4
    s_mul_i32 s43, s52, 144
    s_add_u32 s42, s42, s43
    s_mul_i32 s42, s42, 1280
    s_lshl_b32 s41, s41, 5
    s_add_u32 s42, s42, s41
    s_mul_i32 s41, s47, 320
    s_add_u32 s42, s42, s41
    v_and_b32 v59, 15, v1
    v_mul_u32_u24 v59, 1280, v59
    v_lshrrev_b32 v56, 4, v1
    v_lshl_add_u32 v59, v56, 3, v59
    v_add_u32 v59, s42, v59
    s_waitcnt vmcnt(0)
    s_barrier
    s_cmp_ge_u32 s56, 46
    s_cbranch_scc1 L_fin2
    v_and_b32 v62, 7, v1
    v_lshlrev_b32 v62, 2, v62
    s_mov_b32 s101, 0x20000
    s_waitcnt vmcnt(0)
L_p2_2:
    global_load_dword v63, v62, s[92:93] offset:0 sc1
    s_sub_u32 s101, s101, 1
    s_cbranch_scc1 L_p2_2_done
    s_waitcnt vmcnt(0)
    v_cmp_ne_u32 vcc, s88, v63
    s_nop 4
    s_cbranch_vccz L_p2_2_done
    s_sleep 1
    s_branch L_p2_2
L_p2_2_done:
    s_waitcnt vmcnt(0)
    s_mov_b32 s41, 0
    buffer_load_dwordx4 v[76:79], v58, s[24:27], s41 offen sc1
    s_mov_b32 s41, 47104
    buffer_load_dwordx4 v[80:83], v58, s[24:27], s41 offen sc1
    s_mov_b32 s41, 94208
    buffer_load_dwordx4 v[84:87], v58, s[24:27], s41 offen sc1
    s_mov_b32 s41, 141312
    buffer_load_dwordx4 v[88:91], v58, s[24:27], s41 offen sc1
    s_mov_b32 s41, 188416
    buffer_load_dwordx4 v[92:95], v58, s[24:27], s41 offen sc1
    s_mov_b32 s41, 235520
    buffer_load_dwordx4 v[96:99], v58, s[24:27], s41 offen sc1
    s_mov_b32 s41, 282624
    buffer_load_dwordx4 v[100:103], v58, s[24:27], s41 offen sc1
    s_mov_b32 s41, 329728
    buffer_load_dwordx4 v[104:107], v58, s[24:27], s41 offen sc1
    s_waitcnt vmcnt(7)
    v_lshlrev_b32 v108, 16, v76
    v_and_b32 v109, 0xffff0000, v76
    v_lshlrev_b32 v110, 16, v77
    v_and_b32 v111, 0xffff0000, v77
    v_lshlrev_b32 v112, 16, v78
    v_and_b32 v113, 0xffff0000, v78
    v_lshlrev_b32 v114, 16, v79
    v_and_b32 v115, 0xffff0000, v79
    s_waitcnt vmcnt(6)
    v_lshlrev_b32 v116, 16, v80
    v_and_b32 v117, 0xffff0000, v80
    v_pk_add_f32 v[108:109], v[108:109], v[116:117]
    v_lshlrev_b32 v118, 16, v81
    v_and_b32 v119, 0xffff0000, v81
    v_pk_add_f32 v[110:111], v[110:111], v[118:119]
    v_lshlrev_b32 v116, 16, v82
    v_and_b32 v117, 0xffff0000, v82
    v_pk_add_f32 v[112:113], v[112:113], v[116:117]
    v_lshlrev_b32 v118, 16, v83
    v_and_b32 v119, 0xffff0000, v83
    v_pk_add_f32 v[114:115], v[114:115], v[118:119]
    s_waitcnt vmcnt(5)
    v_lshlrev_b32 v116, 16, v84
    v_and_b32 v117, 0xffff0000, v84
    v_pk_add_f32 v[108:109], v[108:109], v[116:117]
    v_lshlrev_b32 v118, 16, v85
    v_and_b32 v119, 0xffff0000, v85
    v_pk_add_f32 v[110:111], v[110:111], v[118:119]
    v_lshlrev_b32 v116, 16, v86
    v_and_b32 v117, 0xffff0000, v86
    v_pk_add_f32 v[112:113], v[112:113], v[116:117]
    v_lshlrev_b32 v118, 16, v87
    v_and_b32 v119, 0xffff0000, v87
    v_pk_add_f32 v[114:115], v[114:115], v[118:119]
    s_waitcnt vmcnt(4)
    v_lshlrev_b32 v116, 16, v88
    v_and_b32 v117, 0xffff0000, v88
    v_pk_add_f32 v[108:109], v[108:109], v[116:117]
    v_lshlrev_b32 v118, 16, v89
    v_and_b32 v119, 0xffff0000, v89
    v_pk_add_f32 v[110:111], v[110:111], v[118:119]
    v_lshlrev_b32 v116, 16, v90
    v_and_b32 v117, 0xffff0000, v90
    v_pk_add_f32 v[112:113], v[112:113], v[116:117]
    v_lshlrev_b32 v118, 16, v91
    v_and_b32 v119, 0xffff0000, v91
    v_pk_add_f32 v[114:115], v[114:115], v[118:119]
    s_waitcnt vmcnt(3)
    v_lshlrev_b32 v116, 16, v92
    v_and_b32 v117, 0xffff0000, v92
    v_pk_add_f32 v[108:109], v[108:109], v[116:117]
    v_lshlrev_b32 v118, 16, v93
    v_and_b32 v119, 0xffff0000, v93
    v_pk_add_f32 v[110:111], v[110:111], v[118:119]
    v_lshlrev_b32 v116, 16, v94
    v_and_b32 v117, 0xffff0000, v94
    v_pk_add_f32 v[112:113], v[112:113], v[116:117]
    v_lshlrev_b32 v118, 16, v95
    v_and_b32 v119, 0xffff0000, v95
    v_pk_add_f32 v[114:115], v[114:115], v[118:119]
    s_waitcnt vmcnt(2)
    v_lshlrev_b32 v116, 16, v96
    v_and_b32 v117, 0xffff0000, v96
    v_pk_add_f32 v[108:109], v[108:109], v[116:117]
    v_lshlrev_b32 v118, 16, v97
    v_and_b32 v119, 0xffff0000, v97
    v_pk_add_f32 v[110:111], v[110:111], v[118:119]
    v_lshlrev_b32 v116, 16, v98
    v_and_b32 v117, 0xffff0000, v98
    v_pk_add_f32 v[112:113], v[112:113], v[116:117]
    v_lshlrev_b32 v118, 16, v99
    v_and_b32 v119, 0xffff0000, v99
    v_pk_add_f32 v[114:115], v[114:115], v[118:119]
    s_waitcnt vmcnt(1)
    v_lshlrev_b32 v116, 16, v100
    v_and_b32 v117, 0xffff0000, v100
    v_pk_add_f32 v[108:109], v[108:109], v[116:117]
    v_lshlrev_b32 v118, 16, v101
    v_and_b32 v119, 0xffff0000, v101
    v_pk_add_f32 v[110:111], v[110:111], v[118:119]
    v_lshlrev_b32 v116, 16, v102
    v_and_b32 v117, 0xffff0000, v102
    v_pk_add_f32 v[112:113], v[112:113], v[116:117]
    v_lshlrev_b32 v118, 16, v103
    v_and_b32 v119, 0xffff0000, v103
    v_pk_add_f32 v[114:115], v[114:115], v[118:119]
    s_waitcnt vmcnt(0)
    v_lshlrev_b32 v116, 16, v104
    v_and_b32 v117, 0xffff0000, v104
    v_pk_add_f32 v[108:109], v[108:109], v[116:117]
    v_lshlrev_b32 v118, 16, v105
    v_and_b32 v119, 0xffff0000, v105
    v_pk_add_f32 v[110:111], v[110:111], v[118:119]
    v_lshlrev_b32 v116, 16, v106
    v_and_b32 v117, 0xffff0000, v106
    v_pk_add_f32 v[112:113], v[112:113], v[116:117]
    v_lshlrev_b32 v118, 16, v107
    v_and_b32 v119, 0xffff0000, v107
    v_pk_add_f32 v[114:115], v[114:115], v[118:119]
    v_cvt_pk_bf16_f32 v108, v108, v109
    v_cvt_pk_bf16_f32 v109, v110, v111
    v_cvt_pk_bf16_f32 v110, v112, v113
    v_cvt_pk_bf16_f32 v111, v114, v115
    buffer_store_dwordx2 v[108:109], v59, s[84:87], 0 offen
    buffer_store_dwordx2 v[110:111], v59, s[84:87], s59 offen
L_fin2:
    s_endpgm
L_tail3:
    v_lshlrev_b32 v56, 4, v0
    v_add_u32 v57, 0, v56
    ds_read_b128 v[176:179], v57 offset:40960
    ds_read_b128 v[180:183], v57 offset:49152
    s_mov_b32 s41, 36864
    s_waitcnt lgkmcnt(1)
    buffer_store_dwordx4 v[176:179], v56, s[32:35], s41 offen sc1
    s_mov_b32 s41, 45056
    s_waitcnt lgkmcnt(0)
    buffer_store_dwordx4 v[180:183], v56, s[32:35], s41 offen sc1
    ds_read_b64_tr_b16 v[76:77], v248 offset:49152
    ds_read_b64_tr_b16 v[78:79], v248 offset:54272
    ds_read_b128 v[16:19], v251 offset:0
    ds_read_b64_tr_b16 v[80:81], v249 offset:49152
    ds_read_b64_tr_b16 v[82:83], v249 offset:54272
    ds_read_b128 v[20:23], v251 offset:1024
    ds_read_b128 v[24:27], v251 offset:2048
    ds_read_b128 v[28:31], v251 offset:3072
    ds_read_b128 v[32:35], v251 offset:4096
    v_lshlrev_b32 v57, 4, v1
    s_and_b32 s42, s36, 1
    s_add_u32 s43, s42, 2
    s_mul_i32 s43, s43, 9
    s_add_u32 s43, s43, s99
    s_lshl_b32 s43, s43, 10
    v_add_u32 v58, s43, v57
    s_mul_i32 s42, s42, 5120
    s_add_u32 s42, s42, 36864
    v_add_u32 v59, s42, v57
    s_waitcnt lgkmcnt(6)
    v_mfma_f32_16x16x32_bf16 v[116:119], v[76:79], v[16:19], 0
    ds_read_b64_tr_b16 v[88:89], v248 offset:59392
    ds_read_b64_tr_b16 v[90:91], v248 offset:64512
    s_waitcnt lgkmcnt(6)
    v_mfma_f32_16x16x32_bf16 v[120:123], v[80:83], v[16:19], 0
    ds_read_b128 v[36:39], v251 offset:9216
    s_waitcnt lgkmcnt(6)
    v_mfma_f32_16x16x32_bf16 v[124:127], v[76:79], v[20:23], 0
    ds_read_b64_tr_b16 v[92:93], v249 offset:59392
    ds_read_b64_tr_b16 v[94:95], v249 offset:64512
    v_mfma_f32_16x16x32_bf16 v[128:131], v[80:83], v[20:23], 0
    ds_read_b128 v[40:43], v251 offset:10240
    s_waitcnt lgkmcnt(8)
    v_mfma_f32_16x16x32_bf16 v[132:135], v[76:79], v[24:27], 0
    ds_read_b128 v[44:47], v251 offset:11264
    ds_read_b128 v[48:51], v251 offset:12288
    v_mfma_f32_16x16x32_bf16 v[136:139], v[80:83], v[24:27], 0
    ds_read_b128 v[52:55], v251 offset:13312
    s_waitcnt lgkmcnt(10)
    v_mfma_f32_16x16x32_bf16 v[140:143], v[76:79], v[28:31], 0
    v_mfma_f32_16x16x32_bf16 v[144:147], v[80:83], v[28:31], 0
    s_waitcnt lgkmcnt(9)
    v_mfma_f32_16x16x32_bf16 v[148:151], v[76:79], v[32:35], 0
    v_mfma_f32_16x16x32_bf16 v[152:155], v[80:83], v[32:35], 0
    s_waitcnt vmcnt(2) lgkmcnt(0)
    s_barrier
    s_mov_b32 s56, 0
    v_and_b32 v62, 3, v1
    v_lshlrev_b32 v62, 2, v62
    v_mfma_f32_16x16x32_bf16 v[116:119], v[88:91], v[36:39], v[116:119]
    ds_read_b64_tr_b16 v[76:77], v248 offset:0
    ds_read_b64_tr_b16 v[78:79], v248 offset:5120
    v_mfma_f32_16x16x32_bf16 v[120:123], v[92:95], v[36:39], v[120:123]
    ds_read_b128 v[16:19], v251 offset:20480
    v_mfma_f32_16x16x32_bf16 v[124:127], v[88:91], v[40:43], v[124:127]
    ds_read_b64_tr_b16 v[80:81], v249 offset:0
    ds_read_b64_tr_b16 v[82:83], v249 offset:5120
    v_mfma_f32_16x16x32_bf16 v[128:131], v[92:95], v[40:43], v[128:131]
    ds_read_b128 v[20:23], v251 offset:21504
    v_mfma_f32_16x16x32_bf16 v[132:135], v[88:91], v[44:47], v[132:135]
    ds_read_b128 v[24:27], v251 offset:22528
    ds_read_b128 v[28:31], v251 offset:23552
    v_mfma_f32_16x16x32_bf16 v[136:139], v[92:95], v[44:47], v[136:139]
    ds_read_b128 v[32:35], v251 offset:24576
    v_mfma_f32_16x16x32_bf16 v[140:143], v[88:91], v[48:51], v[140:143]
    v_mfma_f32_16x16x32_bf16 v[144:147], v[92:95], v[48:51], v[144:147]
    v_mfma_f32_16x16x32_bf16 v[148:151], v[88:91], v[52:55], v[148:151]
    v_mfma_f32_16x16x32_bf16 v[152:155], v[92:95], v[52:55], v[152:155]
    global_load_dword v63, v62, s[90:91] sc1
    s_waitcnt lgkmcnt(0)
    v_mfma_f32_16x16x32_bf16 v[116:119], v[76:79], v[16:19], v[116:119]
    ds_read_b64_tr_b16 v[88:89], v248 offset:10240
    ds_read_b64_tr_b16 v[90:91], v248 offset:15360
    v_mfma_f32_16x16x32_bf16 v[120:123], v[80:83], v[16:19], v[120:123]
    ds_read_b128 v[36:39], v251 offset:29696
    v_mfma_f32_16x16x32_bf16 v[124:127], v[76:79], v[20:23], v[124:127]
    ds_read_b64_tr_b16 v[92:93], v249 offset:10240
    ds_read_b64_tr_b16 v[94:95], v249 offset:15360
    v_mfma_f32_16x16x32_bf16 v[128:131], v[80:83], v[20:23], v[128:131]
    ds_read_b128 v[40:43], v251 offset:30720
    v_mfma_f32_16x16x32_bf16 v[132:135], v[76:79], v[24:27], v[132:135]
    ds_read_b128 v[44:47], v251 offset:31744
    ds_read_b128 v[48:51], v251 offset:32768
    v_mfma_f32_16x16x32_bf16 v[136:139], v[80:83], v[24:27], v[136:139]
    ds_read_b128 v[52:55], v251 offset:33792
    v_mfma_f32_16x16x32_bf16 v[140:143], v[76:79], v[28:31], v[140:143]
    v_mfma_f32_16x16x32_bf16 v[144:147], v[80:83], v[28:31], v[144:147]
    v_mfma_f32_16x16x32_bf16 v[148:151], v[76:79], v[32:35], v[148:151]
    v_mfma_f32_16x16x32_bf16 v[152:155], v[80:83], v[32:35], v[152:155]
    s_waitcnt vmcnt(0)
    v_cmp_ne_u32 vcc, s88, v63
    s_nop 4
    s_cbranch_vccnz L_np3
    s_add_u32 m0, s98, 0
    s_add_u32 s40, s81, s95
    buffer_load_dwordx4 v2, s[16:19], s40 offen sc1 lds
    s_add_u32 m0, s98, 1024
    s_nop 0
    buffer_load_dwordx4 v3, s[16:19], s40 offen sc1 lds
    s_add_u32 m0, s98, 2048
    s_nop 0
    buffer_load_dwordx4 v4, s[16:19], s40 offen sc1 lds
    s_add_u32 m0, s98, 3072
    s_nop 0
    buffer_load_dwordx4 v5, s[16:19], s40 offen sc1 lds
    s_mov_b32 s56, 1
L_np3:
    s_waitcnt lgkmcnt(0)
    s_barrier
    s_cmp_eq_u32 s36, 6
    s_cbranch_scc0 L_f1b
    s_lshl_b32 s41, s47, 2
    v_mov_b32 v60, s41
    v_mov_b32 v61, s88
    s_mov_b64 exec, 1
    global_store_dword v60, v61, s[90:91] offset:16 sc1
    s_mov_b64 exec, -1
L_f1b:
    s_cmp_eq_u32 s56, 1
    s_cbranch_scc1 L_ep3
    v_and_b32 v62, 3, v1
    v_lshlrev_b32 v62, 2, v62
    s_mov_b32 s101, 0x20000
    s_waitcnt vmcnt(0)
L_p1_3:
    global_load_dword v63, v62, s[90:91] offset:0 sc1
    s_sub_u32 s101, s101, 1
    s_cbranch_scc1 L_p1_3_done
    s_waitcnt vmcnt(0)
    v_cmp_ne_u32 vcc, s88, v63
    s_nop 4
    s_cbranch_vccz L_p1_3_done
    s_sleep 1
    s_branch L_p1_3
L_p1_3_done:
    s_waitcnt vmcnt(0)
    s_add_u32 m0, s98, 0
    s_add_u32 s40, s81, s95
    buffer_load_dwordx4 v2, s[16:19], s40 offen sc1 lds
    s_add_u32 m0, s98, 1024
    s_nop 0
    buffer_load_dwordx4 v3, s[16:19], s40 offen sc1 lds
    s_add_u32 m0, s98, 2048
    s_nop 0
    buffer_load_dwordx4 v4, s[16:19], s40 offen sc1 lds
    s_add_u32 m0, s98, 3072
    s_nop 0
    buffer_load_dwordx4 v5, s[16:19], s40 offen sc1 lds
L_ep3:
    v_mfma_f32_16x16x32_bf16 v[116:119], v[88:91], v[36:39], v[116:119]
    s_add_u32 m0, s98, 20480
    s_add_u32 s40, s81, s96
    buffer_load_dwordx4 v2, s[16:19], s40 offen sc1 lds
    ds_read_b64_tr_b16 v[76:77], v248 offset:24576
    ds_read_b64_tr_b16 v[78:79], v248 offset:29696
    v_mfma_f32_16x16x32_bf16 v[120:123], v[92:95], v[36:39], v[120:123]
    ds_read_b128 v[16:19], v251 offset:40960
    v_mfma_f32_16x16x32_bf16 v[124:127], v[88:91], v[40:43], v[124:127]
    s_add_u32 m0, s98, 21504
    s_nop 0
    buffer_load_dwordx4 v3, s[16:19], s40 offen sc1 lds
    ds_read_b64_tr_b16 v[80:81], v249 offset:24576
    ds_read_b64_tr_b16 v[82:83], v249 offset:29696
    v_mfma_f32_16x16x32_bf16 v[128:131], v[92:95], v[40:43], v[128:131]
    ds_read_b128 v[20:23], v251 offset:41984
    v_mfma_f32_16x16x32_bf16 v[132:135], v[88:91], v[44:47], v[132:135]
    ds_read_b128 v[24:27], v251 offset:43008
    ds_read_b128 v[28:31], v251 offset:44032
    v_mfma_f32_16x16x32_bf16 v[136:139], v[92:95], v[44:47], v[136:139]
    s_add_u32 m0, s98, 22528
    s_nop 0
    buffer_load_dwordx4 v4, s[16:19], s40 offen sc1 lds
    ds_read_b128 v[32:35], v251 offset:45056
    v_mfma_f32_16x16x32_bf16 v[140:143], v[88:91], v[48:51], v[140:143]
    v_mfma_f32_16x16x32_bf16 v[144:147], v[92:95], v[48:51], v[144:147]
    s_add_u32 m0, s98, 23552
    s_nop 0
    buffer_load_dwordx4 v5, s[16:19], s40 offen sc1 lds
    v_mfma_f32_16x16x32_bf16 v[148:151], v[88:91], v[52:55], v[148:151]
    v_mfma_f32_16x16x32_bf16 v[152:155], v[92:95], v[52:55], v[152:155]
    s_waitcnt lgkmcnt(0)
    v_mfma_f32_16x16x32_bf16 v[116:119], v[76:79], v[16:19], v[116:119]
    ds_read_b64_tr_b16 v[88:89], v248 offset:34816
    ds_read_b64_tr_b16 v[90:91], v248 offset:39936
    v_mfma_f32_16x16x32_bf16 v[120:123], v[80:83], v[16:19], v[120:123]
    ds_read_b128 v[36:39], v251 offset:50176
    v_mfma_f32_16x16x32_bf16 v[124:127], v[76:79], v[20:23], v[124:127]
    ds_read_b64_tr_b16 v[92:93], v249 offset:34816
    ds_read_b64_tr_b16 v[94:95], v249 offset:39936
    v_mfma_f32_16x16x32_bf16 v[128:131], v[80:83], v[20:23], v[128:131]
    ds_read_b128 v[40:43], v251 offset:51200
    v_mfma_f32_16x16x32_bf16 v[132:135], v[76:79], v[24:27], v[132:135]
    ds_read_b128 v[44:47], v251 offset:52224
    ds_read_b128 v[48:51], v251 offset:53248
    v_mfma_f32_16x16x32_bf16 v[136:139], v[80:83], v[24:27], v[136:139]
    ds_read_b128 v[52:55], v251 offset:54272
    v_mfma_f32_16x16x32_bf16 v[140:143], v[76:79], v[28:31], v[140:143]
    v_mfma_f32_16x16x32_bf16 v[144:147], v[80:83], v[28:31], v[144:147]
    v_mfma_f32_16x16x32_bf16 v[148:151], v[76:79], v[32:35], v[148:151]
    v_mfma_f32_16x16x32_bf16 v[152:155], v[80:83], v[32:35], v[152:155]
    s_waitcnt vmcnt(4) lgkmcnt(0)
    s_barrier
    v_mfma_f32_16x16x32_bf16 v[116:119], v[88:91], v[36:39], v[116:119]
    s_add_u32 m0, s98, 40960
    s_add_u32 s40, s81, s97
    buffer_load_dwordx4 v2, s[16:19], s40 offen sc1 lds
    ds_read_b64_tr_b16 v[76:77], v248 offset:49152
    ds_read_b64_tr_b16 v[78:79], v248 offset:54272
    v_mfma_f32_16x16x32_bf16 v[120:123], v[92:95], v[36:39], v[120:123]
    ds_read_b128 v[16:19], v251 offset:0
    v_mfma_f32_16x16x32_bf16 v[124:127], v[88:91], v[40:43], v[124:127]
    ds_read_b64_tr_b16 v[80:81], v249 offset:49152
    ds_read_b64_tr_b16 v[82:83], v249 offset:54272
    v_mfma_f32_16x16x32_bf16 v[128:131], v[92:95], v[40:43], v[128:131]
    s_add_u32 m0, s98, 41984
    s_nop 0
    buffer_load_dwordx4 v3, s[16:19], s40 offen sc1 lds
    ds_read_b128 v[20:23], v251 offset:1024
    v_mfma_f32_16x16x32_bf16 v[132:135], v[88:91], v[44:47], v[132:135]
    ds_read_b128 v[24:27], v251 offset:2048
    ds_read_b128 v[28:31], v251 offset:3072
    v_mfma_f32_16x16x32_bf16 v[136:139], v[92:95], v[44:47], v[136:139]
    ds_read_b128 v[32:35], v251 offset:4096
    v_mfma_f32_16x16x32_bf16 v[140:143], v[88:91], v[48:51], v[140:143]
    s_add_u32 m0, s98, 43008
    s_nop 0
    buffer_load_dwordx4 v4, s[16:19], s40 offen sc1 lds
    v_mfma_f32_16x16x32_bf16 v[144:147], v[92:95], v[48:51], v[144:147]
    v_mfma_f32_16x16x32_bf16 v[148:151], v[88:91], v[52:55], v[148:151]
    v_mfma_f32_16x16x32_bf16 v[152:155], v[92:95], v[52:55], v[152:155]
    s_waitcnt lgkmcnt(0)
    v_mfma_f32_16x16x32_bf16 v[116:119], v[76:79], v[16:19], v[116:119]
    ds_read_b64_tr_b16 v[88:89], v248 offset:59392
    ds_read_b64_tr_b16 v[90:91], v248 offset:64512
    s_add_u32 m0, s98, 44032
    s_nop 0
    buffer_load_dwordx4 v5, s[16:19], s40 offen sc1 lds
    v_mfma_f32_16x16x32_bf16 v[120:123], v[80:83], v[16:19], v[120:123]
    ds_read_b128 v[36:39], v251 offset:9216
    v_mfma_f32_16x16x32_bf16 v[124:127], v[76:79], v[20:23], v[124:127]
    ds_read_b64_tr_b16 v[92:93], v249 offset:59392
    ds_read_b64_tr_b16 v[94:95], v249 offset:64512
    v_mfma_f32_16x16x32_bf16 v[128:131], v[80:83], v[20:23], v[128:131]
    ds_read_b128 v[40:43], v251 offset:10240
    v_mfma_f32_16x16x32_bf16 v[132:135], v[76:79], v[24:27], v[132:135]
    ds_read_b128 v[44:47], v251 offset:11264
    ds_read_b128 v[48:51], v251 offset:12288
    v_mfma_f32_16x16x32_bf16 v[136:139], v[80:83], v[24:27], v[136:139]
    ds_read_b128 v[52:55], v251 offset:13312
    v_mfma_f32_16x16x32_bf16 v[140:143], v[76:79], v[28:31], v[140:143]
    v_mfma_f32_16x16x32_bf16 v[144:147], v[80:83], v[28:31], v[144:147]
    v_mfma_f32_16x16x32_bf16 v[148:151], v[76:79], v[32:35], v[148:151]
    v_mfma_f32_16x16x32_bf16 v[152:155], v[80:83], v[32:35], v[152:155]
    s_waitcnt vmcnt(4) lgkmcnt(0)
    s_barrier
    v_mfma_f32_16x16x32_bf16 v[116:119], v[88:91], v[36:39], v[116:119]
    s_add_u32 m0, s98, 0
    s_add_u32 s40, s82, s95
    buffer_load_dwordx4 v2, s[16:19], s40 offen sc1 lds
    ds_read_b64_tr_b16 v[76:77], v248 offset:0
    ds_read_b64_tr_b16 v[78:79], v248 offset:5120
    v_mfma_f32_16x16x32_bf16 v[120:123], v[92:95], v[36:39], v[120:123]
    ds_read_b128 v[16:19], v251 offset:20480
    v_mfma_f32_16x16x32_bf16 v[124:127], v[88:91], v[40:43], v[124:127]
    ds_read_b64_tr_b16 v[80:81], v249 offset:0
    ds_read_b64_tr_b16 v[82:83], v249 offset:5120
    v_mfma_f32_16x16x32_bf16 v[128:131], v[92:95], v[40:43], v[128:131]
    s_add_u32 m0, s98, 1024
    s_nop 0
    buffer_load_dwordx4 v3, s[16:19], s40 offen sc1 lds
    ds_read_b128 v[20:23], v251 offset:21504
    v_mfma_f32_16x16x32_bf16 v[132:135], v[88:91], v[44:47], v[132:135]
    ds_read_b128 v[24:27], v251 offset:22528
    ds_read_b128 v[28:31], v251 offset:23552
    v_mfma_f32_16x16x32_bf16 v[136:139], v[92:95], v[44:47], v[136:139]
    ds_read_b128 v[32:35], v251 offset:24576
    v_mfma_f32_16x16x32_bf16 v[140:143], v[88:91], v[48:51], v[140:143]
    s_add_u32 m0, s98, 2048
    s_nop 0
    buffer_load_dwordx4 v4, s[16:19], s40 offen sc1 lds
    v_mfma_f32_16x16x32_bf16 v[144:147], v[92:95], v[48:51], v[144:147]
    v_mfma_f32_16x16x32_bf16 v[148:151], v[88:91], v[52:55], v[148:151]
    v_mfma_f32_16x16x32_bf16 v[152:155], v[92:95], v[52:55], v[152:155]
    s_waitcnt lgkmcnt(0)
    v_mfma_f32_16x16x32_bf16 v[116:119], v[76:79], v[16:19], v[116:119]
    ds_read_b64_tr_b16 v[88:89], v248 offset:10240
    ds_read_b64_tr_b16 v[90:91], v248 offset:15360
    s_add_u32 m0, s98, 3072
    s_nop 0
    buffer_load_dwordx4 v5, s[16:19], s40 offen sc1 lds
    v_mfma_f32_16x16x32_bf16 v[120:123], v[80:83], v[16:19], v[120:123]
    ds_read_b128 v[36:39], v251 offset:29696
    v_mfma_f32_16x16x32_bf16 v[124:127], v[76:79], v[20:23], v[124:127]
    ds_read_b64_tr_b16 v[92:93], v249 offset:10240
    ds_read_b64_tr_b16 v[94:95], v249 offset:15360
    v_mfma_f32_16x16x32_bf16 v[128:131], v[80:83], v[20:23], v[128:131]
    ds_read_b128 v[40:43], v251 offset:30720
    v_mfma_f32_16x16x32_bf16 v[132:135], v[76:79], v[24:27], v[132:135]
    ds_read_b128 v[44:47], v251 offset:31744
    ds_read_b128 v[48:51], v251 offset:32768
    v_mfma_f32_16x16x32_bf16 v[136:139], v[80:83], v[24:27], v[136:139]
    ds_read_b128 v[52:55], v251 offset:33792
    v_mfma_f32_16x16x32_bf16 v[140:143], v[76:79], v[28:31], v[140:143]
    v_mfma_f32_16x16x32_bf16 v[144:147], v[80:83], v[28:31], v[144:147]
    v_mfma_f32_16x16x32_bf16 v[148:151], v[76:79], v[32:35], v[148:151]
    v_mfma_f32_16x16x32_bf16 v[152:155], v[80:83], v[32:35], v[152:155]
    s_waitcnt vmcnt(4) lgkmcnt(0)
    s_barrier
    v_mfma_f32_16x16x32_bf16 v[116:119], v[88:91], v[36:39], v[116:119]
    s_add_u32 m0, s98, 20480
    s_add_u32 s40, s82, s96
    buffer_load_dwordx4 v2, s[16:19], s40 offen sc1 lds
    ds_read_b64_tr_b16 v[76:77], v248 offset:24576
    ds_read_b64_tr_b16 v[78:79], v248 offset:29696
    v_mfma_f32_16x16x32_bf16 v[120:123], v[92:95], v[36:39], v[120:123]
    ds_read_b128 v[16:19], v251 offset:40960
    v_mfma_f32_16x16x32_bf16 v[124:127], v[88:91], v[40:43], v[124:127]
    ds_read_b64_tr_b16 v[80:81], v249 offset:24576
    ds_read_b64_tr_b16 v[82:83], v249 offset:29696
    v_mfma_f32_16x16x32_bf16 v[128:131], v[92:95], v[40:43], v[128:131]
    s_add_u32 m0, s98, 21504
    s_nop 0
    buffer_load_dwordx4 v3, s[16:19], s40 offen sc1 lds
    ds_read_b128 v[20:23], v251 offset:41984
    v_mfma_f32_16x16x32_bf16 v[132:135], v[88:91], v[44:47], v[132:135]
    ds_read_b128 v[24:27], v251 offset:43008
    ds_read_b128 v[28:31], v251 offset:44032
    v_mfma_f32_16x16x32_bf16 v[136:139], v[92:95], v[44:47], v[136:139]
    ds_read_b128 v[32:35], v251 offset:45056
    v_mfma_f32_16x16x32_bf16 v[140:143], v[88:91], v[48:51], v[140:143]
    s_add_u32 m0, s98, 22528
    s_nop 0
    buffer_load_dwordx4 v4, s[16:19], s40 offen sc1 lds
    v_mfma_f32_16x16x32_bf16 v[144:147], v[92:95], v[48:51], v[144:147]
    v_mfma_f32_16x16x32_bf16 v[148:151], v[88:91], v[52:55], v[148:151]
    v_mfma_f32_16x16x32_bf16 v[152:155], v[92:95], v[52:55], v[152:155]
    s_waitcnt lgkmcnt(0)
    v_mfma_f32_16x16x32_bf16 v[116:119], v[76:79], v[16:19], v[116:119]
    ds_read_b64_tr_b16 v[88:89], v248 offset:34816
    ds_read_b64_tr_b16 v[90:91], v248 offset:39936
    s_add_u32 m0, s98, 23552
    s_nop 0
    buffer_load_dwordx4 v5, s[16:19], s40 offen sc1 lds
    v_mfma_f32_16x16x32_bf16 v[120:123], v[80:83], v[16:19], v[120:123]
    ds_read_b128 v[36:39], v251 offset:50176
    v_mfma_f32_16x16x32_bf16 v[124:127], v[76:79], v[20:23], v[124:127]
    ds_read_b64_tr_b16 v[92:93], v249 offset:34816
    ds_read_b64_tr_b16 v[94:95], v249 offset:39936
    v_mfma_f32_16x16x32_bf16 v[128:131], v[80:83], v[20:23], v[128:131]
    ds_read_b128 v[40:43], v251 offset:51200
    v_mfma_f32_16x16x32_bf16 v[132:135], v[76:79], v[24:27], v[132:135]
    ds_read_b128 v[44:47], v251 offset:52224
    ds_read_b128 v[48:51], v251 offset:53248
    v_mfma_f32_16x16x32_bf16 v[136:139], v[80:83], v[24:27], v[136:139]
    ds_read_b128 v[52:55], v251 offset:54272
    v_mfma_f32_16x16x32_bf16 v[140:143], v[76:79], v[28:31], v[140:143]
    v_mfma_f32_16x16x32_bf16 v[144:147], v[80:83], v[28:31], v[144:147]
    v_mfma_f32_16x16x32_bf16 v[148:151], v[76:79], v[32:35], v[148:151]
    v_mfma_f32_16x16x32_bf16 v[152:155], v[80:83], v[32:35], v[152:155]
    s_waitcnt vmcnt(4) lgkmcnt(0)
    s_barrier
    global_load_dword v63, v62, s[90:91] offset:16 sc1
    v_mfma_f32_16x16x32_bf16 v[116:119], v[88:91], v[36:39], v[116:119]
    s_add_u32 m0, s98, 40960
    s_add_u32 s40, s82, s97
    buffer_load_dwordx4 v2, s[16:19], s40 offen sc1 lds
    ds_read_b64_tr_b16 v[76:77], v248 offset:49152
    ds_read_b64_tr_b16 v[78:79], v248 offset:54272
    v_mfma_f32_16x16x32_bf16 v[120:123], v[92:95], v[36:39], v[120:123]
    ds_read_b128 v[16:19], v251 offset:0
    v_mfma_f32_16x16x32_bf16 v[124:127], v[88:91], v[40:43], v[124:127]
    ds_read_b64_tr_b16 v[80:81], v249 offset:49152
    ds_read_b64_tr_b16 v[82:83], v249 offset:54272
    v_mfma_f32_16x16x32_bf16 v[128:131], v[92:95], v[40:43], v[128:131]
    s_add_u32 m0, s98, 41984
    s_nop 0
    buffer_load_dwordx4 v3, s[16:19], s40 offen sc1 lds
    ds_read_b128 v[20:23], v251 offset:1024
    v_mfma_f32_16x16x32_bf16 v[132:135], v[88:91], v[44:47], v[132:135]
    ds_read_b128 v[24:27], v251 offset:2048
    ds_read_b128 v[28:31], v251 offset:3072
    v_mfma_f32_16x16x32_bf16 v[136:139], v[92:95], v[44:47], v[136:139]
    ds_read_b128 v[32:35], v251 offset:4096
    v_mfma_f32_16x16x32_bf16 v[140:143], v[88:91], v[48:51], v[140:143]
    s_add_u32 m0, s98, 43008
    s_nop 0
    buffer_load_dwordx4 v4, s[16:19], s40 offen sc1 lds
    v_mfma_f32_16x16x32_bf16 v[144:147], v[92:95], v[48:51], v[144:147]
    v_mfma_f32_16x16x32_bf16 v[148:151], v[88:91], v[52:55], v[148:151]
    v_mfma_f32_16x16x32_bf16 v[152:155], v[92:95], v[52:55], v[152:155]
    s_waitcnt lgkmcnt(0)
    v_mfma_f32_16x16x32_bf16 v[116:119], v[76:79], v[16:19], v[116:119]
    ds_read_b64_tr_b16 v[88:89], v248 offset:59392
    ds_read_b64_tr_b16 v[90:91], v248 offset:64512
    s_add_u32 m0, s98, 44032
    s_nop 0
    buffer_load_dwordx4 v5, s[16:19], s40 offen sc1 lds
    v_mfma_f32_16x16x32_bf16 v[120:123], v[80:83], v[16:19], v[120:123]
    ds_read_b128 v[36:39], v251 offset:9216
    v_mfma_f32_16x16x32_bf16 v[124:127], v[76:79], v[20:23], v[124:127]
    ds_read_b64_tr_b16 v[92:93], v249 offset:59392
    ds_read_b64_tr_b16 v[94:95], v249 offset:64512
    v_mfma_f32_16x16x32_bf16 v[128:131], v[80:83], v[20:23], v[128:131]
    ds_read_b128 v[40:43], v251 offset:10240
    v_mfma_f32_16x16x32_bf16 v[132:135], v[76:79], v[24:27], v[132:135]
    ds_read_b128 v[44:47], v251 offset:11264
    ds_read_b128 v[48:51], v251 offset:12288
    v_mfma_f32_16x16x32_bf16 v[136:139], v[80:83], v[24:27], v[136:139]
    ds_read_b128 v[52:55], v251 offset:13312
    v_mfma_f32_16x16x32_bf16 v[140:143], v[76:79], v[28:31], v[140:143]
    v_mfma_f32_16x16x32_bf16 v[144:147], v[80:83], v[28:31], v[144:147]
    v_mfma_f32_16x16x32_bf16 v[148:151], v[76:79], v[32:35], v[148:151]
    v_mfma_f32_16x16x32_bf16 v[152:155], v[80:83], v[32:35], v[152:155]
    s_waitcnt vmcnt(5) lgkmcnt(0)
    s_barrier
    s_waitcnt vmcnt(4)
    v_cmp_ne_u32 vcc, s88, v63
    s_nop 4
    s_cbranch_vccz L_p1c_3
    v_and_b32 v62, 3, v1
    v_lshlrev_b32 v62, 2, v62
    s_mov_b32 s101, 0x20000
L_p1b_3:
    global_load_dword v63, v62, s[90:91] offset:16 sc1
    s_sub_u32 s101, s101, 1
    s_cbranch_scc1 L_p1b_3_done
    s_waitcnt vmcnt(0)
    v_cmp_ne_u32 vcc, s88, v63
    s_nop 4
    s_cbranch_vccz L_p1b_3_done
    s_sleep 1
    s_branch L_p1b_3
L_p1b_3_done:
    s_waitcnt vmcnt(0)
L_p1c_3:
    v_mfma_f32_16x16x32_bf16 v[116:119], v[88:91], v[36:39], v[116:119]
    s_add_u32 m0, s98, 0
    s_add_u32 s40, s83, s95
    buffer_load_dwordx4 v2, s[16:19], s40 offen sc1 lds
    ds_read_b64_tr_b16 v[76:77], v248 offset:0
    ds_read_b64_tr_b16 v[78:79], v248 offset:5120
    v_mfma_f32_16x16x32_bf16 v[120:123], v[92:95], v[36:39], v[120:123]
    ds_read_b128 v[16:19], v251 offset:20480
    v_mfma_f32_16x16x32_bf16 v[124:127], v[88:91], v[40:43], v[124:127]
    ds_read_b64_tr_b16 v[80:81], v249 offset:0
    ds_read_b64_tr_b16 v[82:83], v249 offset:5120
    v_mfma_f32_16x16x32_bf16 v[128:131], v[92:95], v[40:43], v[128:131]
    s_add_u32 m0, s98, 1024
    s_nop 0
    buffer_load_dwordx4 v3, s[16:19], s40 offen sc1 lds
    ds_read_b128 v[20:23], v251 offset:21504
    v_mfma_f32_16x16x32_bf16 v[132:135], v[88:91], v[44:47], v[132:135]
    ds_read_b128 v[24:27], v251 offset:22528
    ds_read_b128 v[28:31], v251 offset:23552
    v_mfma_f32_16x16x32_bf16 v[136:139], v[92:95], v[44:47], v[136:139]
    ds_read_b128 v[32:35], v251 offset:24576
    v_mfma_f32_16x16x32_bf16 v[140:143], v[88:91], v[48:51], v[140:143]
    s_add_u32 m0, s98, 2048
    s_nop 0
    buffer_load_dwordx4 v4, s[16:19], s40 offen sc1 lds
    v_mfma_f32_16x16x32_bf16 v[144:147], v[92:95], v[48:51], v[144:147]
    v_mfma_f32_16x16x32_bf16 v[148:151], v[88:91], v[52:55], v[148:151]
    v_mfma_f32_16x16x32_bf16 v[152:155], v[92:95], v[52:55], v[152:155]
    s_waitcnt lgkmcnt(0)
    v_mfma_f32_16x16x32_bf16 v[116:119], v[76:79], v[16:19], v[116:119]
    ds_read_b64_tr_b16 v[88:89], v248 offset:10240
    ds_read_b64_tr_b16 v[90:91], v248 offset:15360
    s_add_u32 m0, s98, 3072
    s_nop 0
    buffer_load_dwordx4 v5, s[16:19], s40 offen sc1 lds
    v_mfma_f32_16x16x32_bf16 v[120:123], v[80:83], v[16:19], v[120:123]
    ds_read_b128 v[36:39], v251 offset:29696
    v_mfma_f32_16x16x32_bf16 v[124:127], v[76:79], v[20:23], v[124:127]
    ds_read_b64_tr_b16 v[92:93], v249 offset:10240
    ds_read_b64_tr_b16 v[94:95], v249 offset:15360
    v_mfma_f32_16x16x32_bf16 v[128:131], v[80:83], v[20:23], v[128:131]
    ds_read_b128 v[40:43], v251 offset:30720
    v_mfma_f32_16x16x32_bf16 v[132:135], v[76:79], v[24:27], v[132:135]
    ds_read_b128 v[44:47], v251 offset:31744
    ds_read_b128 v[48:51], v251 offset:32768
    v_mfma_f32_16x16x32_bf16 v[136:139], v[80:83], v[24:27], v[136:139]
    ds_read_b128 v[52:55], v251 offset:33792
    v_mfma_f32_16x16x32_bf16 v[140:143], v[76:79], v[28:31], v[140:143]
    v_mfma_f32_16x16x32_bf16 v[144:147], v[80:83], v[28:31], v[144:147]
    v_mfma_f32_16x16x32_bf16 v[148:151], v[76:79], v[32:35], v[148:151]
    v_mfma_f32_16x16x32_bf16 v[152:155], v[80:83], v[32:35], v[152:155]
    s_waitcnt vmcnt(4) lgkmcnt(0)
    s_barrier
    v_mfma_f32_16x16x32_bf16 v[116:119], v[88:91], v[36:39], v[116:119]
    s_add_u32 m0, s98, 20480
    s_add_u32 s40, s83, s96
    buffer_load_dwordx4 v2, s[16:19], s40 offen sc1 lds
    ds_read_b64_tr_b16 v[76:77], v248 offset:24576
    ds_read_b64_tr_b16 v[78:79], v248 offset:29696
    v_mfma_f32_16x16x32_bf16 v[120:123], v[92:95], v[36:39], v[120:123]
    ds_read_b128 v[16:19], v251 offset:40960
    v_mfma_f32_16x16x32_bf16 v[124:127], v[88:91], v[40:43], v[124:127]
    ds_read_b64_tr_b16 v[80:81], v249 offset:24576
    ds_read_b64_tr_b16 v[82:83], v249 offset:29696
    v_mfma_f32_16x16x32_bf16 v[128:131], v[92:95], v[40:43], v[128:131]
    s_add_u32 m0, s98, 21504
    s_nop 0
    buffer_load_dwordx4 v3, s[16:19], s40 offen sc1 lds
    ds_read_b128 v[20:23], v251 offset:41984
    v_mfma_f32_16x16x32_bf16 v[132:135], v[88:91], v[44:47], v[132:135]
    ds_read_b128 v[24:27], v251 offset:43008
    ds_read_b128 v[28:31], v251 offset:44032
    v_mfma_f32_16x16x32_bf16 v[136:139], v[92:95], v[44:47], v[136:139]
    ds_read_b128 v[32:35], v251 offset:45056
    v_mfma_f32_16x16x32_bf16 v[140:143], v[88:91], v[48:51], v[140:143]
    s_add_u32 m0, s98, 22528
    s_nop 0
    buffer_load_dwordx4 v4, s[16:19], s40 offen sc1 lds
    v_mfma_f32_16x16x32_bf16 v[144:147], v[92:95], v[48:51], v[144:147]
    v_mfma_f32_16x16x32_bf16 v[148:151], v[88:91], v[52:55], v[148:151]
    v_mfma_f32_16x16x32_bf16 v[152:155], v[92:95], v[52:55], v[152:155]
    s_waitcnt lgkmcnt(0)
    v_mfma_f32_16x16x32_bf16 v[116:119], v[76:79], v[16:19], v[116:119]
    ds_read_b64_tr_b16 v[88:89], v248 offset:34816
    ds_read_b64_tr_b16 v[90:91], v248 offset:39936
    s_add_u32 m0, s98, 23552
    s_nop 0
    buffer_load_dwordx4 v5, s[16:19], s40 offen sc1 lds
    v_mfma_f32_16x16x32_bf16 v[120:123], v[80:83], v[16:19], v[120:123]
    ds_read_b128 v[36:39], v251 offset:50176
    v_mfma_f32_16x16x32_bf16 v[124:127], v[76:79], v[20:23], v[124:127]
    ds_read_b64_tr_b16 v[92:93], v249 offset:34816
    ds_read_b64_tr_b16 v[94:95], v249 offset:39936
    v_mfma_f32_16x16x32_bf16 v[128:131], v[80:83], v[20:23], v[128:131]
    ds_read_b128 v[40:43], v251 offset:51200
    v_mfma_f32_16x16x32_bf16 v[132:135], v[76:79], v[24:27], v[132:135]
    ds_read_b128 v[44:47], v251 offset:52224
    ds_read_b128 v[48:51], v251 offset:53248
    v_mfma_f32_16x16x32_bf16 v[136:139], v[80:83], v[24:27], v[136:139]
    ds_read_b128 v[52:55], v251 offset:54272
    v_mfma_f32_16x16x32_bf16 v[140:143], v[76:79], v[28:31], v[140:143]
    v_mfma_f32_16x16x32_bf16 v[144:147], v[80:83], v[28:31], v[144:147]
    v_mfma_f32_16x16x32_bf16 v[148:151], v[76:79], v[32:35], v[148:151]
    v_mfma_f32_16x16x32_bf16 v[152:155], v[80:83], v[32:35], v[152:155]
    s_waitcnt vmcnt(4) lgkmcnt(0)
    s_barrier
    v_mfma_f32_16x16x32_bf16 v[116:119], v[88:91], v[36:39], v[116:119]
    s_add_u32 m0, s98, 40960
    s_add_u32 s40, s83, s97
    buffer_load_dwordx4 v2, s[16:19], s40 offen sc1 lds
    ds_read_b64_tr_b16 v[76:77], v248 offset:49152
    ds_read_b64_tr_b16 v[78:79], v248 offset:54272
    v_mfma_f32_16x16x32_bf16 v[120:123], v[92:95], v[36:39], v[120:123]
    ds_read_b128 v[16:19], v251 offset:0
    v_mfma_f32_16x16x32_bf16 v[124:127], v[88:91], v[40:43], v[124:127]
    ds_read_b64_tr_b16 v[80:81], v249 offset:49152
    ds_read_b64_tr_b16 v[82:83], v249 offset:54272
    v_mfma_f32_16x16x32_bf16 v[128:131], v[92:95], v[40:43], v[128:131]
    s_add_u32 m0, s98, 41984
    s_nop 0
    buffer_load_dwordx4 v3, s[16:19], s40 offen sc1 lds
    ds_read_b128 v[20:23], v251 offset:1024
    v_mfma_f32_16x16x32_bf16 v[132:135], v[88:91], v[44:47], v[132:135]
    ds_read_b128 v[24:27], v251 offset:2048
    ds_read_b128 v[28:31], v251 offset:3072
    v_mfma_f32_16x16x32_bf16 v[136:139], v[92:95], v[44:47], v[136:139]
    ds_read_b128 v[32:35], v251 offset:4096
    v_mfma_f32_16x16x32_bf16 v[140:143], v[88:91], v[48:51], v[140:143]
    s_add_u32 m0, s98, 43008
    s_nop 0
    buffer_load_dwordx4 v4, s[16:19], s40 offen sc1 lds
    v_mfma_f32_16x16x32_bf16 v[144:147], v[92:95], v[48:51], v[144:147]
    v_mfma_f32_16x16x32_bf16 v[148:151], v[88:91], v[52:55], v[148:151]
    v_mfma_f32_16x16x32_bf16 v[152:155], v[92:95], v[52:55], v[152:155]
    s_waitcnt lgkmcnt(0)
    v_mfma_f32_16x16x32_bf16 v[116:119], v[76:79], v[16:19], v[116:119]
    ds_read_b64_tr_b16 v[88:89], v248 offset:59392
    ds_read_b64_tr_b16 v[90:91], v248 offset:64512
    s_add_u32 m0, s98, 44032
    s_nop 0
    buffer_load_dwordx4 v5, s[16:19], s40 offen sc1 lds
    v_mfma_f32_16x16x32_bf16 v[120:123], v[80:83], v[16:19], v[120:123]
    ds_read_b128 v[36:39], v251 offset:9216
    v_mfma_f32_16x16x32_bf16 v[124:127], v[76:79], v[20:23], v[124:127]
    ds_read_b64_tr_b16 v[92:93], v249 offset:59392
    ds_read_b64_tr_b16 v[94:95], v249 offset:64512
    v_mfma_f32_16x16x32_bf16 v[128:131], v[80:83], v[20:23], v[128:131]
    ds_read_b128 v[40:43], v251 offset:10240
    v_mfma_f32_16x16x32_bf16 v[132:135], v[76:79], v[24:27], v[132:135]
    ds_read_b128 v[44:47], v251 offset:11264
    ds_read_b128 v[48:51], v251 offset:12288
    v_mfma_f32_16x16x32_bf16 v[136:139], v[80:83], v[24:27], v[136:139]
    ds_read_b128 v[52:55], v251 offset:13312
    v_mfma_f32_16x16x32_bf16 v[140:143], v[76:79], v[28:31], v[140:143]
    v_mfma_f32_16x16x32_bf16 v[144:147], v[80:83], v[28:31], v[144:147]
    v_mfma_f32_16x16x32_bf16 v[148:151], v[76:79], v[32:35], v[148:151]
    v_mfma_f32_16x16x32_bf16 v[152:155], v[80:83], v[32:35], v[152:155]
    s_waitcnt vmcnt(4) lgkmcnt(0)
    s_barrier
    v_mfma_f32_16x16x32_bf16 v[116:119], v[88:91], v[36:39], v[116:119]
    ds_read_b64_tr_b16 v[76:77], v248 offset:0
    ds_read_b64_tr_b16 v[78:79], v248 offset:5120
    v_mfma_f32_16x16x32_bf16 v[120:123], v[92:95], v[36:39], v[120:123]
    ds_read_b128 v[16:19], v251 offset:20480
    v_mfma_f32_16x16x32_bf16 v[124:127], v[88:91], v[40:43], v[124:127]
    ds_read_b64_tr_b16 v[80:81], v249 offset:0
    ds_read_b64_tr_b16 v[82:83], v249 offset:5120
    v_mfma_f32_16x16x32_bf16 v[128:131], v[92:95], v[40:43], v[128:131]
    ds_read_b128 v[20:23], v251 offset:21504
    v_mfma_f32_16x16x32_bf16 v[132:135], v[88:91], v[44:47], v[132:135]
    ds_read_b128 v[24:27], v251 offset:22528
    ds_read_b128 v[28:31], v251 offset:23552
    v_mfma_f32_16x16x32_bf16 v[136:139], v[92:95], v[44:47], v[136:139]
    ds_read_b128 v[32:35], v251 offset:24576
    v_mfma_f32_16x16x32_bf16 v[140:143], v[88:91], v[48:51], v[140:143]
    v_mfma_f32_16x16x32_bf16 v[144:147], v[92:95], v[48:51], v[144:147]
    v_mfma_f32_16x16x32_bf16 v[148:151], v[88:91], v[52:55], v[148:151]
    v_mfma_f32_16x16x32_bf16 v[152:155], v[92:95], v[52:55], v[152:155]
    s_waitcnt lgkmcnt(0)
    v_mfma_f32_16x16x32_bf16 v[116:119], v[76:79], v[16:19], v[116:119]
    ds_read_b64_tr_b16 v[88:89], v248 offset:10240
    ds_read_b64_tr_b16 v[90:91], v248 offset:15360
    v_mfma_f32_16x16x32_bf16 v[120:123], v[80:83], v[16:19], v[120:123]
    ds_read_b128 v[36:39], v251 offset:29696
    v_mfma_f32_16x16x32_bf16 v[124:127], v[76:79], v[20:23], v[124:127]
    ds_read_b64_tr_b16 v[92:93], v249 offset:10240
    ds_read_b64_tr_b16 v[94:95], v249 offset:15360
    v_mfma_f32_16x16x32_bf16 v[128:131], v[80:83], v[20:23], v[128:131]
    ds_read_b128 v[40:43], v251 offset:30720
    v_mfma_f32_16x16x32_bf16 v[132:135], v[76:79], v[24:27], v[132:135]
    ds_read_b128 v[44:47], v251 offset:31744
    ds_read_b128 v[48:51], v251 offset:32768
    v_mfma_f32_16x16x32_bf16 v[136:139], v[80:83], v[24:27], v[136:139]
    ds_read_b128 v[52:55], v251 offset:33792
    v_mfma_f32_16x16x32_bf16 v[140:143], v[76:79], v[28:31], v[140:143]
    v_mfma_f32_16x16x32_bf16 v[144:147], v[80:83], v[28:31], v[144:147]
    v_mfma_f32_16x16x32_bf16 v[148:151], v[76:79], v[32:35], v[148:151]
    v_mfma_f32_16x16x32_bf16 v[152:155], v[80:83], v[32:35], v[152:155]
    s_waitcnt vmcnt(0) lgkmcnt(0)
    s_barrier
    v_mfma_f32_16x16x32_bf16 v[116:119], v[88:91], v[36:39], v[116:119]
    ds_read_b64_tr_b16 v[76:77], v248 offset:24576
    ds_read_b64_tr_b16 v[78:79], v248 offset:29696
    v_mfma_f32_16x16x32_bf16 v[120:123], v[92:95], v[36:39], v[120:123]
    ds_read_b128 v[16:19], v251 offset:40960
    v_mfma_f32_16x16x32_bf16 v[124:127], v[88:91], v[40:43], v[124:127]
    ds_read_b64_tr_b16 v[80:81], v249 offset:24576
    ds_read_b64_tr_b16 v[82:83], v249 offset:29696
    v_mfma_f32_16x16x32_bf16 v[128:131], v[92:95], v[40:43], v[128:131]
    ds_read_b128 v[20:23], v251 offset:41984
    v_mfma_f32_16x16x32_bf16 v[132:135], v[88:91], v[44:47], v[132:135]
    ds_read_b128 v[24:27], v251 offset:43008
    ds_read_b128 v[28:31], v251 offset:44032
    v_mfma_f32_16x16x32_bf16 v[136:139], v[92:95], v[44:47], v[136:139]
    ds_read_b128 v[32:35], v251 offset:45056
    v_mfma_f32_16x16x32_bf16 v[140:143], v[88:91], v[48:51], v[140:143]
    v_mfma_f32_16x16x32_bf16 v[144:147], v[92:95], v[48:51], v[144:147]
    v_mfma_f32_16x16x32_bf16 v[148:151], v[88:91], v[52:55], v[148:151]
    v_mfma_f32_16x16x32_bf16 v[152:155], v[92:95], v[52:55], v[152:155]
    s_waitcnt lgkmcnt(0)
    v_mfma_f32_16x16x32_bf16 v[116:119], v[76:79], v[16:19], v[116:119]
    ds_read_b64_tr_b16 v[88:89], v248 offset:34816
    ds_read_b64_tr_b16 v[90:91], v248 offset:39936
    v_mfma_f32_16x16x32_bf16 v[120:123], v[80:83], v[16:19], v[120:123]
    ds_read_b128 v[36:39], v251 offset:50176
    v_mfma_f32_16x16x32_bf16 v[124:127], v[76:79], v[20:23], v[124:127]
    ds_read_b64_tr_b16 v[92:93], v249 offset:34816
    ds_read_b64_tr_b16 v[94:95], v249 offset:39936
    v_mfma_f32_16x16x32_bf16 v[128:131], v[80:83], v[20:23], v[128:131]
    ds_read_b128 v[40:43], v251 offset:51200
    v_mfma_f32_16x16x32_bf16 v[132:135], v[76:79], v[24:27], v[132:135]
    ds_read_b128 v[44:47], v251 offset:52224
    ds_read_b128 v[48:51], v251 offset:53248
    v_mfma_f32_16x16x32_bf16 v[136:139], v[80:83], v[24:27], v[136:139]
    ds_read_b128 v[52:55], v251 offset:54272
    v_mfma_f32_16x16x32_bf16 v[140:143], v[76:79], v[28:31], v[140:143]
    v_mfma_f32_16x16x32_bf16 v[144:147], v[80:83], v[28:31], v[144:147]
    v_mfma_f32_16x16x32_bf16 v[148:151], v[76:79], v[32:35], v[148:151]
    v_mfma_f32_16x16x32_bf16 v[152:155], v[80:83], v[32:35], v[152:155]
    s_waitcnt lgkmcnt(6)
    v_mfma_f32_16x16x32_bf16 v[116:119], v[88:91], v[36:39], v[116:119]
    s_waitcnt lgkmcnt(4)
    v_mfma_f32_16x16x32_bf16 v[120:123], v[92:95], v[36:39], v[120:123]
    s_waitcnt lgkmcnt(3)
    v_mfma_f32_16x16x32_bf16 v[124:127], v[88:91], v[40:43], v[124:127]
    v_mfma_f32_16x16x32_bf16 v[128:131], v[92:95], v[40:43], v[128:131]
    s_waitcnt lgkmcnt(2)
    v_mfma_f32_16x16x32_bf16 v[132:135], v[88:91], v[44:47], v[132:135]
    v_mfma_f32_16x16x32_bf16 v[136:139], v[92:95], v[44:47], v[136:139]
    v_cvt_pk_bf16_f32 v116, v116, v117
    v_cvt_pk_bf16_f32 v117, v118, v119
    v_cvt_pk_bf16_f32 v118, v120, v121
    v_cvt_pk_bf16_f32 v119, v122, v123
    s_mov_b32 s41, 0
    buffer_store_dwordx4 v[116:119], v58, s[20:23], s41 offen sc1
    s_waitcnt lgkmcnt(1)
    v_mfma_f32_16x16x32_bf16 v[140:143], v[88:91], v[48:51], v[140:143]
    v_mfma_f32_16x16x32_bf16 v[144:147], v[92:95], v[48:51], v[144:147]
    v_cvt_pk_bf16_f32 v124, v124, v125
    v_cvt_pk_bf16_f32 v125, v126, v127
    v_cvt_pk_bf16_f32 v126, v128, v129
    v_cvt_pk_bf16_f32 v127, v130, v131
    s_mov_b32 s41, 1024
    buffer_store_dwordx4 v[124:127], v58, s[20:23], s41 offen sc1
    s_waitcnt lgkmcnt(0)
    v_mfma_f32_16x16x32_bf16 v[148:151], v[88:91], v[52:55], v[148:151]
    v_mfma_f32_16x16x32_bf16 v[152:155], v[92:95], v[52:55], v[152:155]
    v_cvt_pk_bf16_f32 v132, v132, v133
    v_cvt_pk_bf16_f32 v133, v134, v135
    v_cvt_pk_bf16_f32 v134, v136, v137
    v_cvt_pk_bf16_f32 v135, v138, v139
    s_mov_b32 s41, 2048
    buffer_store_dwordx4 v[132:135], v58, s[20:23], s41 offen sc1
    v_cvt_pk_bf16_f32 v140, v140, v141
    v_cvt_pk_bf16_f32 v141, v142, v143
    v_cvt_pk_bf16_f32 v142, v144, v145
    v_cvt_pk_bf16_f32 v143, v146, v147
    s_mov_b32 s41, 3072
    buffer_store_dwordx4 v[140:143], v58, s[20:23], s41 offen sc1
    v_cvt_pk_bf16_f32 v148, v148, v149
    v_cvt_pk_bf16_f32 v149, v150, v151
    v_cvt_pk_bf16_f32 v150, v152, v153
    v_cvt_pk_bf16_f32 v151, v154, v155
    s_mov_b32 s41, 4096
    buffer_store_dwordx4 v[148:151], v58, s[20:23], s41 offen sc1
    s_waitcnt vmcnt(0)
    s_barrier
    s_cmp_eq_u32 s36, 7
    s_cbranch_scc0 L_f2
    s_lshl_b32 s41, s53, 2
    v_mov_b32 v60, s41
    v_mov_b32 v61, s88
    s_mov_b64 exec, 1
    global_store_dword v60, v61, s[92:93] offset:0 sc1
    s_mov_b64 exec, -1
L_f2:
    s_endpgm
k1_body_end:
L_k1_exit:
    s_endpgm
.section .rodata,"a"
.p2align 6
.amdhsa_kernel standalone__gqa_block_cached__near_ridge_kernel
  .amdhsa_next_free_vgpr 256
  .amdhsa_next_free_sgpr 102
  .amdhsa_accum_offset 256
  .amdhsa_group_segment_fixed_size 0
  .amdhsa_kernarg_size 64
  .amdhsa_user_sgpr_count 2
  .amdhsa_user_sgpr_kernarg_segment_ptr 1
  .amdhsa_system_sgpr_workgroup_id_x 1
.end_amdhsa_kernel
```
